```python
import torch

def _softmax(x, axis=-1):
    return torch.softmax(x, dim=axis)

def _gelu(x):
    return torch.nn.functional.gelu(x, approximate='tanh')

def _silu(x):
    return torch.nn.functional.silu(x)

def _sigmoid(x):
    return torch.sigmoid(x)

def _layernorm(x, axis=-1, eps=1e-05):
    m = x.mean(dim=axis, keepdim=True)
    v = x.var(dim=axis, keepdim=True, unbiased=False)
    return (x - m) / torch.sqrt(v + eps)

def _scatter_add(tgt, idx, src, axis=0):
    return tgt.clone().index_add_(axis, idx, src)

def _segment_sum(src, seg, n):
    out = torch.zeros((n,) + src.shape[1:], dtype=src.dtype)
    return out.index_add_(0, seg, src)

def _pad(x, pw):
    flat = tuple((v for pair in reversed(pw) for v in pair))
    return torch.nn.functional.pad(x, flat)
kernel_name = 'sequential_preLN__memory_aug_recurrent_mem_tr__mixer_gmlp__prompt'

def setup_inputs():

    _w = lambda a: (lambda t: t.to(torch.bfloat16) if t.is_floating_point() else t)(torch.as_tensor(a))

    def _A_setup():
        B, S, Dm = (1, 2048, 448)
        H, Dh = (16, 256)
        M, seg = (8, 32)
        seg = min(seg, S)
        S = S // seg * seg
        return {'x': _w((lambda *s: torch.randn(*s, dtype=torch.bfloat16) * 0.05)(B, S, Dm)), 'mem0': _w((lambda *s: torch.randn(*s, dtype=torch.bfloat16) * 0.2)(B, M, Dm)), 'Wq': _w((lambda *s: torch.randn(*s, dtype=torch.bfloat16) * 1.6)(Dm, H, Dh) * Dm ** (-0.5)), 'Wk': _w((lambda *s: torch.randn(*s, dtype=torch.bfloat16) * 1.6)(Dm, H, Dh) * Dm ** (-0.5)), 'Wv': _w((lambda *s: torch.randn(*s, dtype=torch.bfloat16) * 0.2)(Dm, H, Dh) * Dm ** (-0.5)), 'Wo': _w((lambda *s: torch.randn(*s, dtype=torch.bfloat16) * 0.2)(H, Dh, Dm) * (H * Dh) ** (-0.5)), 'seg_len': seg}
    _A_in = _A_setup()

    def _B_setup():
        B, S, D, F = (1, 2048, 448, 1792)
        Fh = F // 2
        return {'x': _w((lambda *s: torch.randn(*s, dtype=torch.bfloat16) * 0.05)(B, S, D)), 'w_in': _w((lambda *s: torch.randn(*s, dtype=torch.bfloat16) * 0.4)(D, 2 * Fh)), 'w_sp': _w(0.01 * (lambda *s: torch.randn(*s, dtype=torch.bfloat16) * 0.4)(S, S)), 'b_sp': _w(1.0 + 0.01 * (lambda *s: torch.randn(*s, dtype=torch.bfloat16) * 0.05)(S)), 'w_out': _w((lambda *s: torch.randn(*s, dtype=torch.bfloat16) * 0.05)(Fh, D))}
    _B_in = _B_setup()
    return {'A_x': _A_in['x'], 'A_mem0': _A_in['mem0'], 'A_Wq': _A_in['Wq'], 'A_Wk': _A_in['Wk'], 'A_Wv': _A_in['Wv'], 'A_Wo': _A_in['Wo'], 'A_seg_len': _A_in['seg_len'], 'B_x': _B_in['x'], 'B_w_in': _B_in['w_in'], 'B_w_sp': _B_in['w_sp'], 'B_b_sp': _B_in['b_sp'], 'B_w_out': _B_in['w_out']}

def reference(A_x, A_mem0, A_Wq, A_Wk, A_Wv, A_Wo, A_seg_len, B_x, B_w_in, B_w_sp, B_b_sp, B_w_out):

    def _A_ref(x, mem0, Wq, Wk, Wv, Wo, seg_len):
        B, S, Dm = x.shape
        H, Dh = (Wq.shape[1], Wq.shape[2])
        M = mem0.shape[1]
        scale = Dh ** (-0.5)
        n_seg = S // seg_len
        L = M + seg_len
        idx = torch.arange(L)
        mask = (idx[:, None] < M) | (idx[:, None] >= idx[None, :])
        mem = mem0
        outs = []
        for s in range(n_seg):
            xs = x[:, s * seg_len:(s + 1) * seg_len, :].clone()
            h = torch.concatenate([mem, xs], axis=1)
            q = torch.einsum('btd,dhe->bhte', h, Wq)
            k = torch.einsum('btd,dhe->bhte', h, Wk)
            v = torch.einsum('btd,dhe->bhte', h, Wv)
            scores = torch.einsum('bhqe,bhke->bhqk', q, k) * scale
            scores = torch.where(mask[None, None], scores, -1000000000.0)
            p = _softmax(scores, axis=-1)
            o = torch.einsum('bhqk,bhke->bhqe', p, v)
            o = torch.einsum('bhte,hed->btd', o, Wo)
            mem = o[:, :M, :].clone()
            outs.append(o[:, M:, :])
        return torch.concatenate(outs, axis=1)

    def _B_ref(x, w_in, w_sp, b_sp, w_out):
        B, S, D = x.shape
        F = w_in.shape[-1]
        Fh = F // 2
        z = _gelu(torch.einsum('bsd,df->bsf', x, w_in))
        z1 = z[..., :Fh].clone()
        z2 = _layernorm(z[..., Fh:], axis=-1)
        g = torch.einsum('ts,bsf->btf', w_sp, z2) + b_sp[None, :, None]
        return torch.einsum('bsf,fd->bsd', z1 * g, w_out)
    x = A_x
    h = x + _A_ref(_layernorm(x, axis=-1), A_mem0, A_Wq, A_Wk, A_Wv, A_Wo, A_seg_len)
    h2 = h + _B_ref(_layernorm(h, axis=-1), B_w_in, B_w_sp, B_b_sp, B_w_out)
    return h2
```

```asm
; @launch kernel=main_kernel grid=(256,1,1) block=(256,1,1) lds=163840
.amdgcn_target "amdgcn-amd-amdhsa--gfx950"
.text
.globl main_kernel
.p2align 8
.type main_kernel,@function
main_kernel:
    s_cmp_ge_u32 s2, 256
    s_cbranch_scc1 ch_exit
    s_load_dwordx2 s[4:5], s[0:1], 112
    s_load_dwordx2 s[6:7], s[0:1], 104
    s_getreg_b32 s12, hwreg(HW_REG_XCC_ID, 0, 4)
    v_lshrrev_b32 v1, 6, v0
    s_nop 0
    v_readfirstlane_b32 s14, v1
    v_and_b32 v0, 63, v0
    s_waitcnt lgkmcnt(0)
    s_mov_b32 s8, s4
    s_and_b32 s9, s5, 0xffff
    s_mov_b32 s10, 268435456
    s_mov_b32 s11, 0x20000
    s_mov_b32 s17, 400000
    s_nop 3
    s_cmp_lg_u32 s14, 0
    s_cbranch_scc1 e4_bw
    s_mov_b64 exec, 1
    v_mov_b32 v3, 1
    s_mov_b32 s13, 255
    s_mov_b32 s18, 255
    s_cmp_lg_u32 s12, 0
    s_cbranch_scc1 e4_w
    v_mov_b32 v2, 0
    global_atomic_add v4, v2, v3, s[6:7] sc0
    s_waitcnt vmcnt(0)
    v_readfirstlane_b32 s20, v4
    s_nop 2
    s_cmp_lt_u32 s20, 32
    s_cselect_b32 s13, s20, s13
    s_cbranch_scc1 e4_pub
e4_w:
    s_add_u32 s37, s12, 6
    s_cmp_ge_u32 s37, 7
    s_cselect_b32 s20, 7, 0
    s_sub_u32 s37, s37, s20
    s_cmp_ge_u32 s37, 7
    s_cselect_b32 s20, 7, 0
    s_sub_u32 s37, s37, s20
    s_cmp_ge_u32 s37, 7
    s_cselect_b32 s20, 7, 0
    s_sub_u32 s37, s37, s20
    s_mov_b32 s36, 0
e4_cl:
    s_add_u32 s20, s37, 4
    s_add_u32 s21, s37, 29
    s_cmp_lt_u32 s37, 3
    s_cselect_b32 s20, s20, s21
    s_lshl_b32 s20, s20, 2
    v_mov_b32 v2, s20
    global_atomic_add v4, v2, v3, s[6:7] sc0
    s_waitcnt vmcnt(0)
    v_readfirstlane_b32 s20, v4
    s_nop 2
    s_cmp_lt_u32 s20, 32
    s_cbranch_scc1 e4_got
    s_add_u32 s37, s37, 1
    s_cmp_ge_u32 s37, 7
    s_cselect_b32 s21, 7, 0
    s_sub_u32 s37, s37, s21
    s_add_u32 s36, s36, 1
    s_cmp_lt_u32 s36, 7
    s_cbranch_scc1 e4_cl
    v_mov_b32 v2, 4
    global_atomic_add v4, v2, v3, s[6:7] sc0
    s_waitcnt vmcnt(0)
    v_readfirstlane_b32 s20, v4
    s_nop 2
    s_sub_u32 s13, 31, s20
    s_branch e4_pub
e4_got:
    s_lshl_b32 s18, s37, 5
    s_add_u32 s18, s18, s20
e4_pub:
    v_mov_b32 v4, s13
    v_mov_b32 v5, s18
    v_mov_b32 v6, 163824
    ds_write_b64 v6, v[4:5]
    s_waitcnt lgkmcnt(0)
    s_mov_b64 exec, -1
e4_bw:
    s_barrier
    v_mov_b32 v6, 163824
    ds_read_b64 v[4:5], v6
    s_waitcnt lgkmcnt(0)
    v_readfirstlane_b32 s13, v4
    v_readfirstlane_b32 s18, v5
    s_barrier
    s_nop 3
    s_cmp_lt_u32 s13, 32
    s_cbranch_scc1 e4_chain
    s_mul_hi_u32 s30, s18, 613566757
    s_mul_i32 s20, s30, 7
    s_sub_u32 s41, s18, s20
    s_lshr_b32 s40, s30, 1
    s_and_b32 s30, s30, 1
    s_cmp_eq_u32 s30, 1
    s_cbranch_scc1 v4_w
    s_load_dwordx2 s[24:25], s[0:1], 16
    s_waitcnt lgkmcnt(0)
    s_mov_b32 s56, s24
    s_and_b32 s57, s25, 0xffff
    s_mov_b32 s58, 3670016
    s_mov_b32 s59, 0x20000
    s_load_dwordx2 s[24:25], s[0:1], 24
    s_waitcnt lgkmcnt(0)
    s_mov_b32 s60, s24
    s_and_b32 s61, s25, 0xffff
    s_mov_b32 s62, 3670016
    s_mov_b32 s63, 0x20000
    v_and_b32 v2, 31, v0
    v_lshrrev_b32 v3, 5, v0
    v_add_u32 v4, 0, v3
    v_xor_b32 v4, v4, v2
    v_and_b32 v4, 15, v4
    v_and_b32 v5, 16, v2
    v_or_b32 v4, v4, v5
    v_lshlrev_b32 v4, 4, v4
    v_lshl_add_u32 v16, v3, 13, v4
    v_add_u32 v4, 2, v3
    v_xor_b32 v4, v4, v2
    v_and_b32 v4, 15, v4
    v_and_b32 v5, 16, v2
    v_or_b32 v4, v4, v5
    v_lshlrev_b32 v4, 4, v4
    v_lshl_add_u32 v17, v3, 13, v4
    v_add_u32 v4, 4, v3
    v_xor_b32 v4, v4, v2
    v_and_b32 v4, 15, v4
    v_and_b32 v5, 16, v2
    v_or_b32 v4, v4, v5
    v_lshlrev_b32 v4, 4, v4
    v_lshl_add_u32 v18, v3, 13, v4
    v_add_u32 v4, 6, v3
    v_xor_b32 v4, v4, v2
    v_and_b32 v4, 15, v4
    v_and_b32 v5, 16, v2
    v_or_b32 v4, v4, v5
    v_lshlrev_b32 v4, 4, v4
    v_lshl_add_u32 v19, v3, 13, v4
    v_add_u32 v4, 8, v3
    v_xor_b32 v4, v4, v2
    v_and_b32 v4, 15, v4
    v_and_b32 v5, 16, v2
    v_or_b32 v4, v4, v5
    v_lshlrev_b32 v4, 4, v4
    v_lshl_add_u32 v20, v3, 13, v4
    v_add_u32 v4, 10, v3
    v_xor_b32 v4, v4, v2
    v_and_b32 v4, 15, v4
    v_and_b32 v5, 16, v2
    v_or_b32 v4, v4, v5
    v_lshlrev_b32 v4, 4, v4
    v_lshl_add_u32 v21, v3, 13, v4
    v_add_u32 v4, 12, v3
    v_xor_b32 v4, v4, v2
    v_and_b32 v4, 15, v4
    v_and_b32 v5, 16, v2
    v_or_b32 v4, v4, v5
    v_lshlrev_b32 v4, 4, v4
    v_lshl_add_u32 v22, v3, 13, v4
    v_add_u32 v4, 14, v3
    v_xor_b32 v4, v4, v2
    v_and_b32 v4, 15, v4
    v_and_b32 v5, 16, v2
    v_or_b32 v4, v4, v5
    v_lshlrev_b32 v4, 4, v4
    v_lshl_add_u32 v23, v3, 13, v4
    v_add_u32 v4, 0, v3
    v_xor_b32 v4, v4, v2
    v_and_b32 v4, 15, v4
    v_lshlrev_b32 v4, 4, v4
    v_lshl_add_u32 v24, v2, 9, v4
    v_add_u32 v4, 2, v3
    v_xor_b32 v4, v4, v2
    v_and_b32 v4, 15, v4
    v_lshlrev_b32 v4, 4, v4
    v_lshl_add_u32 v25, v2, 9, v4
    v_add_u32 v4, 4, v3
    v_xor_b32 v4, v4, v2
    v_and_b32 v4, 15, v4
    v_lshlrev_b32 v4, 4, v4
    v_lshl_add_u32 v26, v2, 9, v4
    v_add_u32 v4, 6, v3
    v_xor_b32 v4, v4, v2
    v_and_b32 v4, 15, v4
    v_lshlrev_b32 v4, 4, v4
    v_lshl_add_u32 v27, v2, 9, v4
    v_add_u32 v4, 8, v3
    v_xor_b32 v4, v4, v2
    v_and_b32 v4, 15, v4
    v_lshlrev_b32 v4, 4, v4
    v_lshl_add_u32 v28, v2, 9, v4
    v_add_u32 v4, 10, v3
    v_xor_b32 v4, v4, v2
    v_and_b32 v4, 15, v4
    v_lshlrev_b32 v4, 4, v4
    v_lshl_add_u32 v29, v2, 9, v4
    v_add_u32 v4, 12, v3
    v_xor_b32 v4, v4, v2
    v_and_b32 v4, 15, v4
    v_lshlrev_b32 v4, 4, v4
    v_lshl_add_u32 v30, v2, 9, v4
    v_add_u32 v4, 14, v3
    v_xor_b32 v4, v4, v2
    v_and_b32 v4, 15, v4
    v_lshlrev_b32 v4, 4, v4
    v_lshl_add_u32 v31, v2, 9, v4
    s_lshl_b32 s42, s40, 9
    s_lshl_b32 s48, s41, 19
    s_add_u32 s48, s48, s42
    s_lshl_b32 s20, s14, 17
    s_add_u32 s48, s48, s20
    v_lshrrev_b32 v8, 2, v0
    v_lshlrev_b32 v8, 13, v8
    v_and_b32 v9, 3, v0
    v_lshl_add_u32 v8, v9, 7, v8
    buffer_load_dword v10, v8, s[56:59], s48 offen
    s_add_u32 s44, s14, 1
    s_lshl_b32 s44, s44, 15
    s_lshl_b32 s43, s41, 19
    s_add_u32 s43, s43, s42
    s_lshl_b32 s20, s14, 17
    s_add_u32 s43, s43, s20
    s_lshl_b32 s45, s14, 13
    s_add_u32 m0, s45, 0
    s_add_u32 s21, s43, 0
    buffer_load_dwordx4 v16, s[60:63], s21 offen lds
    s_add_u32 m0, s45, 1024
    s_add_u32 s21, s43, 16384
    buffer_load_dwordx4 v17, s[60:63], s21 offen lds
    s_add_u32 m0, s45, 2048
    s_add_u32 s21, s43, 32768
    buffer_load_dwordx4 v18, s[60:63], s21 offen lds
    s_add_u32 m0, s45, 3072
    s_add_u32 s21, s43, 49152
    buffer_load_dwordx4 v19, s[60:63], s21 offen lds
    s_add_u32 m0, s45, 4096
    s_add_u32 s21, s43, 65536
    buffer_load_dwordx4 v20, s[60:63], s21 offen lds
    s_add_u32 m0, s45, 5120
    s_add_u32 s21, s43, 81920
    buffer_load_dwordx4 v21, s[60:63], s21 offen lds
    s_add_u32 m0, s45, 6144
    s_add_u32 s21, s43, 98304
    buffer_load_dwordx4 v22, s[60:63], s21 offen lds
    s_add_u32 m0, s45, 7168
    s_add_u32 s21, s43, 114688
    buffer_load_dwordx4 v23, s[60:63], s21 offen lds
    s_mov_b32 s46, s14
    s_lshl_b32 s47, s46, 19
    s_add_u32 s47, s47, s42
    s_add_u32 m0, s44, 0
    s_add_u32 s21, s47, 0
    buffer_load_dwordx4 v16, s[56:59], s21 offen lds
    s_add_u32 m0, s44, 1024
    s_add_u32 s21, s47, 16384
    buffer_load_dwordx4 v17, s[56:59], s21 offen lds
    s_add_u32 m0, s44, 2048
    s_add_u32 s21, s47, 32768
    buffer_load_dwordx4 v18, s[56:59], s21 offen lds
    s_add_u32 m0, s44, 3072
    s_add_u32 s21, s47, 49152
    buffer_load_dwordx4 v19, s[56:59], s21 offen lds
    s_add_u32 m0, s44, 4096
    s_add_u32 s21, s47, 65536
    buffer_load_dwordx4 v20, s[56:59], s21 offen lds
    s_add_u32 m0, s44, 5120
    s_add_u32 s21, s47, 81920
    buffer_load_dwordx4 v21, s[56:59], s21 offen lds
    s_add_u32 m0, s44, 6144
    s_add_u32 s21, s47, 98304
    buffer_load_dwordx4 v22, s[56:59], s21 offen lds
    s_add_u32 m0, s44, 7168
    s_add_u32 s21, s47, 114688
    buffer_load_dwordx4 v23, s[56:59], s21 offen lds
    s_waitcnt vmcnt(8)
    s_barrier
    ds_read_b128 a[0:3], v24 offset:0
    ds_read_b128 a[4:7], v25 offset:0
    ds_read_b128 a[8:11], v26 offset:0
    ds_read_b128 a[12:15], v27 offset:0
    ds_read_b128 a[16:19], v28 offset:0
    ds_read_b128 a[20:23], v29 offset:0
    ds_read_b128 a[24:27], v30 offset:0
    ds_read_b128 a[28:31], v31 offset:0
    ds_read_b128 a[32:35], v24 offset:256
    ds_read_b128 a[36:39], v25 offset:256
    ds_read_b128 a[40:43], v26 offset:256
    ds_read_b128 a[44:47], v27 offset:256
    ds_read_b128 a[48:51], v28 offset:256
    ds_read_b128 a[52:55], v29 offset:256
    ds_read_b128 a[56:59], v30 offset:256
    ds_read_b128 a[60:63], v31 offset:256
    s_waitcnt lgkmcnt(0)
    ds_read_b128 a[64:67], v24 offset:16384
    ds_read_b128 a[68:71], v25 offset:16384
    ds_read_b128 a[72:75], v26 offset:16384
    ds_read_b128 a[76:79], v27 offset:16384
    ds_read_b128 a[80:83], v28 offset:16384
    ds_read_b128 a[84:87], v29 offset:16384
    ds_read_b128 a[88:91], v30 offset:16384
    ds_read_b128 a[92:95], v31 offset:16384
    ds_read_b128 a[96:99], v24 offset:16640
    ds_read_b128 a[100:103], v25 offset:16640
    ds_read_b128 a[104:107], v26 offset:16640
    ds_read_b128 a[108:111], v27 offset:16640
    ds_read_b128 a[112:115], v28 offset:16640
    ds_read_b128 a[116:119], v29 offset:16640
    ds_read_b128 a[120:123], v30 offset:16640
    ds_read_b128 a[124:127], v31 offset:16640
    s_waitcnt lgkmcnt(0)
    s_add_u32 m0, s44, 8192
    s_add_u32 s21, s47, 131072
    buffer_load_dwordx4 v16, s[56:59], s21 offen lds
    s_add_u32 m0, s44, 9216
    s_add_u32 s21, s47, 147456
    buffer_load_dwordx4 v17, s[56:59], s21 offen lds
    s_add_u32 m0, s44, 10240
    s_add_u32 s21, s47, 163840
    buffer_load_dwordx4 v18, s[56:59], s21 offen lds
    s_add_u32 m0, s44, 11264
    s_add_u32 s21, s47, 180224
    buffer_load_dwordx4 v19, s[56:59], s21 offen lds
    s_add_u32 m0, s44, 12288
    s_add_u32 s21, s47, 196608
    buffer_load_dwordx4 v20, s[56:59], s21 offen lds
    s_add_u32 m0, s44, 13312
    s_add_u32 s21, s47, 212992
    buffer_load_dwordx4 v21, s[56:59], s21 offen lds
    s_add_u32 m0, s44, 14336
    s_add_u32 s21, s47, 229376
    buffer_load_dwordx4 v22, s[56:59], s21 offen lds
    s_add_u32 m0, s44, 15360
    s_add_u32 s21, s47, 245760
    buffer_load_dwordx4 v23, s[56:59], s21 offen lds
    s_add_u32 m0, s44, 16384
    s_add_u32 s21, s47, 262144
    buffer_load_dwordx4 v16, s[56:59], s21 offen lds
    s_add_u32 m0, s44, 17408
    s_add_u32 s21, s47, 278528
    buffer_load_dwordx4 v17, s[56:59], s21 offen lds
    s_add_u32 m0, s44, 18432
    s_add_u32 s21, s47, 294912
    buffer_load_dwordx4 v18, s[56:59], s21 offen lds
    s_add_u32 m0, s44, 19456
    s_add_u32 s21, s47, 311296
    buffer_load_dwordx4 v19, s[56:59], s21 offen lds
    s_add_u32 m0, s44, 20480
    s_add_u32 s21, s47, 327680
    buffer_load_dwordx4 v20, s[56:59], s21 offen lds
    s_add_u32 m0, s44, 21504
    s_add_u32 s21, s47, 344064
    buffer_load_dwordx4 v21, s[56:59], s21 offen lds
    s_add_u32 m0, s44, 22528
    s_add_u32 s21, s47, 360448
    buffer_load_dwordx4 v22, s[56:59], s21 offen lds
    s_add_u32 m0, s44, 23552
    s_add_u32 s21, s47, 376832
    buffer_load_dwordx4 v23, s[56:59], s21 offen lds
    s_add_u32 m0, s44, 24576
    s_add_u32 s21, s47, 393216
    buffer_load_dwordx4 v16, s[56:59], s21 offen lds
    s_add_u32 m0, s44, 25600
    s_add_u32 s21, s47, 409600
    buffer_load_dwordx4 v17, s[56:59], s21 offen lds
    s_add_u32 m0, s44, 26624
    s_add_u32 s21, s47, 425984
    buffer_load_dwordx4 v18, s[56:59], s21 offen lds
    s_add_u32 m0, s44, 27648
    s_add_u32 s21, s47, 442368
    buffer_load_dwordx4 v19, s[56:59], s21 offen lds
    s_add_u32 m0, s44, 28672
    s_add_u32 s21, s47, 458752
    buffer_load_dwordx4 v20, s[56:59], s21 offen lds
    s_add_u32 m0, s44, 29696
    s_add_u32 s21, s47, 475136
    buffer_load_dwordx4 v21, s[56:59], s21 offen lds
    s_add_u32 m0, s44, 30720
    s_add_u32 s21, s47, 491520
    buffer_load_dwordx4 v22, s[56:59], s21 offen lds
    s_add_u32 m0, s44, 31744
    s_add_u32 s21, s47, 507904
    buffer_load_dwordx4 v23, s[56:59], s21 offen lds
    v_add_u32 v24, s44, v24
    v_add_u32 v25, s44, v25
    v_add_u32 v26, s44, v26
    v_add_u32 v27, s44, v27
    v_add_u32 v28, s44, v28
    v_add_u32 v29, s44, v29
    v_add_u32 v30, s44, v30
    v_add_u32 v31, s44, v31
    v_bfe_u32 v7, v0, 4, 1
    v_mul_u32_u24 v7, 14336, v7
    v_lshrrev_b32 v250, 5, v0
    v_lshl_add_u32 v7, v250, 8, v7
    v_and_b32 v250, 15, v0
    v_lshl_add_u32 v7, v250, 4, v7
    s_mul_i32 s45, s40, 401408
    s_mul_i32 s20, s41, 57344
    s_add_u32 s45, s45, s20
    s_add_u32 s45, s45, 2097152
    s_mov_b32 s50, 0
v4g_rb:
    s_waitcnt vmcnt(16)
    ds_read_b128 a[128:131], v24 offset:0
    ds_read_b128 a[132:135], v25 offset:0
    ds_read_b128 a[136:139], v26 offset:0
    ds_read_b128 a[140:143], v27 offset:0
    ds_read_b128 a[144:147], v28 offset:0
    ds_read_b128 a[148:151], v29 offset:0
    ds_read_b128 a[152:155], v30 offset:0
    ds_read_b128 a[156:159], v31 offset:0
    s_waitcnt lgkmcnt(0)
    ds_read_b128 a[160:163], v24 offset:256
    ds_read_b128 a[164:167], v25 offset:256
    ds_read_b128 a[168:171], v26 offset:256
    ds_read_b128 a[172:175], v27 offset:256
    ds_read_b128 a[176:179], v28 offset:256
    ds_read_b128 a[180:183], v29 offset:256
    ds_read_b128 a[184:187], v30 offset:256
    ds_read_b128 a[188:191], v31 offset:256
    s_waitcnt lgkmcnt(0)
    v_mfma_f32_32x32x16_bf16 v[32:47], a[128:131], a[0:3], 0
    v_mfma_f32_32x32x16_bf16 v[48:63], a[128:131], a[64:67], 0
    v_mfma_f32_32x32x16_bf16 v[32:47], a[132:135], a[4:7], v[32:47]
    v_mfma_f32_32x32x16_bf16 v[48:63], a[132:135], a[68:71], v[48:63]
    v_mfma_f32_32x32x16_bf16 v[32:47], a[136:139], a[8:11], v[32:47]
    v_mfma_f32_32x32x16_bf16 v[48:63], a[136:139], a[72:75], v[48:63]
    v_mfma_f32_32x32x16_bf16 v[32:47], a[140:143], a[12:15], v[32:47]
    v_mfma_f32_32x32x16_bf16 v[48:63], a[140:143], a[76:79], v[48:63]
    v_mfma_f32_32x32x16_bf16 v[32:47], a[144:147], a[16:19], v[32:47]
    v_mfma_f32_32x32x16_bf16 v[48:63], a[144:147], a[80:83], v[48:63]
    v_mfma_f32_32x32x16_bf16 v[32:47], a[148:151], a[20:23], v[32:47]
    v_mfma_f32_32x32x16_bf16 v[48:63], a[148:151], a[84:87], v[48:63]
    v_mfma_f32_32x32x16_bf16 v[32:47], a[152:155], a[24:27], v[32:47]
    v_mfma_f32_32x32x16_bf16 v[48:63], a[152:155], a[88:91], v[48:63]
    v_mfma_f32_32x32x16_bf16 v[32:47], a[156:159], a[28:31], v[32:47]
    v_mfma_f32_32x32x16_bf16 v[48:63], a[156:159], a[92:95], v[48:63]
    v_mfma_f32_32x32x16_bf16 v[32:47], a[160:163], a[32:35], v[32:47]
    v_mfma_f32_32x32x16_bf16 v[48:63], a[160:163], a[96:99], v[48:63]
    v_mfma_f32_32x32x16_bf16 v[32:47], a[164:167], a[36:39], v[32:47]
    v_mfma_f32_32x32x16_bf16 v[48:63], a[164:167], a[100:103], v[48:63]
    v_mfma_f32_32x32x16_bf16 v[32:47], a[168:171], a[40:43], v[32:47]
    v_mfma_f32_32x32x16_bf16 v[48:63], a[168:171], a[104:107], v[48:63]
    v_mfma_f32_32x32x16_bf16 v[32:47], a[172:175], a[44:47], v[32:47]
    v_mfma_f32_32x32x16_bf16 v[48:63], a[172:175], a[108:111], v[48:63]
    v_mfma_f32_32x32x16_bf16 v[32:47], a[176:179], a[48:51], v[32:47]
    v_mfma_f32_32x32x16_bf16 v[48:63], a[176:179], a[112:115], v[48:63]
    v_mfma_f32_32x32x16_bf16 v[32:47], a[180:183], a[52:55], v[32:47]
    v_mfma_f32_32x32x16_bf16 v[48:63], a[180:183], a[116:119], v[48:63]
    v_mfma_f32_32x32x16_bf16 v[32:47], a[184:187], a[56:59], v[32:47]
    v_mfma_f32_32x32x16_bf16 v[48:63], a[184:187], a[120:123], v[48:63]
    v_mfma_f32_32x32x16_bf16 v[32:47], a[188:191], a[60:63], v[32:47]
    v_mfma_f32_32x32x16_bf16 v[48:63], a[188:191], a[124:127], v[48:63]
    s_waitcnt vmcnt(0)
    ds_read_b128 a[192:195], v24 offset:16384
    ds_read_b128 a[196:199], v25 offset:16384
    ds_read_b128 a[200:203], v26 offset:16384
    ds_read_b128 a[204:207], v27 offset:16384
    ds_read_b128 a[208:211], v28 offset:16384
    ds_read_b128 a[212:215], v29 offset:16384
    ds_read_b128 a[216:219], v30 offset:16384
    ds_read_b128 a[220:223], v31 offset:16384
    s_waitcnt lgkmcnt(0)
    ds_read_b128 a[224:227], v24 offset:16640
    ds_read_b128 a[228:231], v25 offset:16640
    ds_read_b128 a[232:235], v26 offset:16640
    ds_read_b128 a[236:239], v27 offset:16640
    ds_read_b128 a[240:243], v28 offset:16640
    ds_read_b128 a[244:247], v29 offset:16640
    ds_read_b128 a[248:251], v30 offset:16640
    ds_read_b128 a[252:255], v31 offset:16640
    s_waitcnt lgkmcnt(0)
    s_add_u32 s48, s46, 4
    s_cmp_ge_u32 s48, 7
    s_cbranch_scc1 v4g_nopf
    s_lshl_b32 s47, s48, 19
    s_add_u32 s47, s47, s42
    s_add_u32 m0, s44, 0
    s_add_u32 s21, s47, 0
    buffer_load_dwordx4 v16, s[56:59], s21 offen lds
    s_add_u32 m0, s44, 1024
    s_add_u32 s21, s47, 16384
    buffer_load_dwordx4 v17, s[56:59], s21 offen lds
    s_add_u32 m0, s44, 2048
    s_add_u32 s21, s47, 32768
    buffer_load_dwordx4 v18, s[56:59], s21 offen lds
    s_add_u32 m0, s44, 3072
    s_add_u32 s21, s47, 49152
    buffer_load_dwordx4 v19, s[56:59], s21 offen lds
    s_add_u32 m0, s44, 4096
    s_add_u32 s21, s47, 65536
    buffer_load_dwordx4 v20, s[56:59], s21 offen lds
    s_add_u32 m0, s44, 5120
    s_add_u32 s21, s47, 81920
    buffer_load_dwordx4 v21, s[56:59], s21 offen lds
    s_add_u32 m0, s44, 6144
    s_add_u32 s21, s47, 98304
    buffer_load_dwordx4 v22, s[56:59], s21 offen lds
    s_add_u32 m0, s44, 7168
    s_add_u32 s21, s47, 114688
    buffer_load_dwordx4 v23, s[56:59], s21 offen lds
    s_add_u32 m0, s44, 8192
    s_add_u32 s21, s47, 131072
    buffer_load_dwordx4 v16, s[56:59], s21 offen lds
    s_add_u32 m0, s44, 9216
    s_add_u32 s21, s47, 147456
    buffer_load_dwordx4 v17, s[56:59], s21 offen lds
    s_add_u32 m0, s44, 10240
    s_add_u32 s21, s47, 163840
    buffer_load_dwordx4 v18, s[56:59], s21 offen lds
    s_add_u32 m0, s44, 11264
    s_add_u32 s21, s47, 180224
    buffer_load_dwordx4 v19, s[56:59], s21 offen lds
    s_add_u32 m0, s44, 12288
    s_add_u32 s21, s47, 196608
    buffer_load_dwordx4 v20, s[56:59], s21 offen lds
    s_add_u32 m0, s44, 13312
    s_add_u32 s21, s47, 212992
    buffer_load_dwordx4 v21, s[56:59], s21 offen lds
    s_add_u32 m0, s44, 14336
    s_add_u32 s21, s47, 229376
    buffer_load_dwordx4 v22, s[56:59], s21 offen lds
    s_add_u32 m0, s44, 15360
    s_add_u32 s21, s47, 245760
    buffer_load_dwordx4 v23, s[56:59], s21 offen lds
    s_add_u32 m0, s44, 16384
    s_add_u32 s21, s47, 262144
    buffer_load_dwordx4 v16, s[56:59], s21 offen lds
    s_add_u32 m0, s44, 17408
    s_add_u32 s21, s47, 278528
    buffer_load_dwordx4 v17, s[56:59], s21 offen lds
    s_add_u32 m0, s44, 18432
    s_add_u32 s21, s47, 294912
    buffer_load_dwordx4 v18, s[56:59], s21 offen lds
    s_add_u32 m0, s44, 19456
    s_add_u32 s21, s47, 311296
    buffer_load_dwordx4 v19, s[56:59], s21 offen lds
    s_add_u32 m0, s44, 20480
    s_add_u32 s21, s47, 327680
    buffer_load_dwordx4 v20, s[56:59], s21 offen lds
    s_add_u32 m0, s44, 21504
    s_add_u32 s21, s47, 344064
    buffer_load_dwordx4 v21, s[56:59], s21 offen lds
    s_add_u32 m0, s44, 22528
    s_add_u32 s21, s47, 360448
    buffer_load_dwordx4 v22, s[56:59], s21 offen lds
    s_add_u32 m0, s44, 23552
    s_add_u32 s21, s47, 376832
    buffer_load_dwordx4 v23, s[56:59], s21 offen lds
    s_add_u32 m0, s44, 24576
    s_add_u32 s21, s47, 393216
    buffer_load_dwordx4 v16, s[56:59], s21 offen lds
    s_add_u32 m0, s44, 25600
    s_add_u32 s21, s47, 409600
    buffer_load_dwordx4 v17, s[56:59], s21 offen lds
    s_add_u32 m0, s44, 26624
    s_add_u32 s21, s47, 425984
    buffer_load_dwordx4 v18, s[56:59], s21 offen lds
    s_add_u32 m0, s44, 27648
    s_add_u32 s21, s47, 442368
    buffer_load_dwordx4 v19, s[56:59], s21 offen lds
    s_add_u32 m0, s44, 28672
    s_add_u32 s21, s47, 458752
    buffer_load_dwordx4 v20, s[56:59], s21 offen lds
    s_add_u32 m0, s44, 29696
    s_add_u32 s21, s47, 475136
    buffer_load_dwordx4 v21, s[56:59], s21 offen lds
    s_add_u32 m0, s44, 30720
    s_add_u32 s21, s47, 491520
    buffer_load_dwordx4 v22, s[56:59], s21 offen lds
    s_add_u32 m0, s44, 31744
    s_add_u32 s21, s47, 507904
    buffer_load_dwordx4 v23, s[56:59], s21 offen lds
v4g_nopf:
    v_mfma_f32_32x32x16_bf16 v[64:79], a[192:195], a[0:3], 0
    v_mfma_f32_32x32x16_bf16 v[80:95], a[192:195], a[64:67], 0
    v_mfma_f32_32x32x16_bf16 v[64:79], a[196:199], a[4:7], v[64:79]
    v_mfma_f32_32x32x16_bf16 v[80:95], a[196:199], a[68:71], v[80:95]
    v_mfma_f32_32x32x16_bf16 v[64:79], a[200:203], a[8:11], v[64:79]
    v_mfma_f32_32x32x16_bf16 v[80:95], a[200:203], a[72:75], v[80:95]
    v_mfma_f32_32x32x16_bf16 v[64:79], a[204:207], a[12:15], v[64:79]
    v_mfma_f32_32x32x16_bf16 v[80:95], a[204:207], a[76:79], v[80:95]
    v_mfma_f32_32x32x16_bf16 v[64:79], a[208:211], a[16:19], v[64:79]
    v_mfma_f32_32x32x16_bf16 v[80:95], a[208:211], a[80:83], v[80:95]
    v_mfma_f32_32x32x16_bf16 v[64:79], a[212:215], a[20:23], v[64:79]
    v_mfma_f32_32x32x16_bf16 v[80:95], a[212:215], a[84:87], v[80:95]
    v_mfma_f32_32x32x16_bf16 v[64:79], a[216:219], a[24:27], v[64:79]
    v_mfma_f32_32x32x16_bf16 v[80:95], a[216:219], a[88:91], v[80:95]
    v_mfma_f32_32x32x16_bf16 v[64:79], a[220:223], a[28:31], v[64:79]
    v_mfma_f32_32x32x16_bf16 v[80:95], a[220:223], a[92:95], v[80:95]
    v_mfma_f32_32x32x16_bf16 v[64:79], a[224:227], a[32:35], v[64:79]
    v_mfma_f32_32x32x16_bf16 v[80:95], a[224:227], a[96:99], v[80:95]
    v_mfma_f32_32x32x16_bf16 v[64:79], a[228:231], a[36:39], v[64:79]
    v_mfma_f32_32x32x16_bf16 v[80:95], a[228:231], a[100:103], v[80:95]
    v_mfma_f32_32x32x16_bf16 v[64:79], a[232:235], a[40:43], v[64:79]
    v_mfma_f32_32x32x16_bf16 v[80:95], a[232:235], a[104:107], v[80:95]
    v_mfma_f32_32x32x16_bf16 v[64:79], a[236:239], a[44:47], v[64:79]
    v_mfma_f32_32x32x16_bf16 v[80:95], a[236:239], a[108:111], v[80:95]
    v_mfma_f32_32x32x16_bf16 v[64:79], a[240:243], a[48:51], v[64:79]
    v_mfma_f32_32x32x16_bf16 v[80:95], a[240:243], a[112:115], v[80:95]
    v_mfma_f32_32x32x16_bf16 v[64:79], a[244:247], a[52:55], v[64:79]
    v_mfma_f32_32x32x16_bf16 v[80:95], a[244:247], a[116:119], v[80:95]
    v_mfma_f32_32x32x16_bf16 v[64:79], a[248:251], a[56:59], v[64:79]
    v_mfma_f32_32x32x16_bf16 v[80:95], a[248:251], a[120:123], v[80:95]
    v_mfma_f32_32x32x16_bf16 v[64:79], a[252:255], a[60:63], v[64:79]
    v_mfma_f32_32x32x16_bf16 v[80:95], a[252:255], a[124:127], v[80:95]
    s_mov_b32 s22, 1035512379
    v_mul_f32 v32, s22, v32
    v_mul_f32 v33, s22, v33
    v_mul_f32 v34, s22, v34
    v_mul_f32 v35, s22, v35
    v_mul_f32 v36, s22, v36
    v_mul_f32 v37, s22, v37
    v_mul_f32 v38, s22, v38
    v_mul_f32 v39, s22, v39
    v_mul_f32 v40, s22, v40
    v_mul_f32 v41, s22, v41
    v_mul_f32 v42, s22, v42
    v_mul_f32 v43, s22, v43
    v_mul_f32 v44, s22, v44
    v_mul_f32 v45, s22, v45
    v_mul_f32 v46, s22, v46
    v_mul_f32 v47, s22, v47
    s_lshl_b32 s21, s46, 11
    s_add_u32 s21, s21, s45
    s_add_u32 s21, s21, 0
    v_cvt_pk_bf16_f32 v100, v32, v33
    v_cvt_pk_bf16_f32 v101, v36, v37
    v_cvt_pk_bf16_f32 v102, v34, v35
    v_cvt_pk_bf16_f32 v103, v38, v39
    buffer_store_dwordx4 v[100:103], v7, s[8:11], s21 offen offset:0 sc1
    v_cvt_pk_bf16_f32 v104, v40, v41
    v_cvt_pk_bf16_f32 v105, v44, v45
    v_cvt_pk_bf16_f32 v106, v42, v43
    v_cvt_pk_bf16_f32 v107, v46, v47
    buffer_store_dwordx4 v[104:107], v7, s[8:11], s21 offen offset:512 sc1
    s_mov_b32 s22, 1035512379
    v_mul_f32 v48, s22, v48
    v_mul_f32 v49, s22, v49
    v_mul_f32 v50, s22, v50
    v_mul_f32 v51, s22, v51
    v_mul_f32 v52, s22, v52
    v_mul_f32 v53, s22, v53
    v_mul_f32 v54, s22, v54
    v_mul_f32 v55, s22, v55
    v_mul_f32 v56, s22, v56
    v_mul_f32 v57, s22, v57
    v_mul_f32 v58, s22, v58
    v_mul_f32 v59, s22, v59
    v_mul_f32 v60, s22, v60
    v_mul_f32 v61, s22, v61
    v_mul_f32 v62, s22, v62
    v_mul_f32 v63, s22, v63
    s_lshl_b32 s21, s46, 11
    s_add_u32 s21, s21, s45
    s_add_u32 s21, s21, 28672
    v_cvt_pk_bf16_f32 v108, v48, v49
    v_cvt_pk_bf16_f32 v109, v52, v53
    v_cvt_pk_bf16_f32 v110, v50, v51
    v_cvt_pk_bf16_f32 v111, v54, v55
    buffer_store_dwordx4 v[108:111], v7, s[8:11], s21 offen offset:0 sc1
    v_cvt_pk_bf16_f32 v112, v56, v57
    v_cvt_pk_bf16_f32 v113, v60, v61
    v_cvt_pk_bf16_f32 v114, v58, v59
    v_cvt_pk_bf16_f32 v115, v62, v63
    buffer_store_dwordx4 v[112:115], v7, s[8:11], s21 offen offset:512 sc1
    s_mov_b32 s22, 1035512379
    v_mul_f32 v64, s22, v64
    v_mul_f32 v65, s22, v65
    v_mul_f32 v66, s22, v66
    v_mul_f32 v67, s22, v67
    v_mul_f32 v68, s22, v68
    v_mul_f32 v69, s22, v69
    v_mul_f32 v70, s22, v70
    v_mul_f32 v71, s22, v71
    v_mul_f32 v72, s22, v72
    v_mul_f32 v73, s22, v73
    v_mul_f32 v74, s22, v74
    v_mul_f32 v75, s22, v75
    v_mul_f32 v76, s22, v76
    v_mul_f32 v77, s22, v77
    v_mul_f32 v78, s22, v78
    v_mul_f32 v79, s22, v79
    s_lshl_b32 s21, s46, 11
    s_add_u32 s21, s21, s45
    s_add_u32 s21, s21, 1024
    v_cvt_pk_bf16_f32 v100, v64, v65
    v_cvt_pk_bf16_f32 v101, v68, v69
    v_cvt_pk_bf16_f32 v102, v66, v67
    v_cvt_pk_bf16_f32 v103, v70, v71
    buffer_store_dwordx4 v[100:103], v7, s[8:11], s21 offen offset:0 sc1
    v_cvt_pk_bf16_f32 v104, v72, v73
    v_cvt_pk_bf16_f32 v105, v76, v77
    v_cvt_pk_bf16_f32 v106, v74, v75
    v_cvt_pk_bf16_f32 v107, v78, v79
    buffer_store_dwordx4 v[104:107], v7, s[8:11], s21 offen offset:512 sc1
    s_mov_b32 s22, 1035512379
    v_mul_f32 v80, s22, v80
    v_mul_f32 v81, s22, v81
    v_mul_f32 v82, s22, v82
    v_mul_f32 v83, s22, v83
    v_mul_f32 v84, s22, v84
    v_mul_f32 v85, s22, v85
    v_mul_f32 v86, s22, v86
    v_mul_f32 v87, s22, v87
    v_mul_f32 v88, s22, v88
    v_mul_f32 v89, s22, v89
    v_mul_f32 v90, s22, v90
    v_mul_f32 v91, s22, v91
    v_mul_f32 v92, s22, v92
    v_mul_f32 v93, s22, v93
    v_mul_f32 v94, s22, v94
    v_mul_f32 v95, s22, v95
    s_lshl_b32 s21, s46, 11
    s_add_u32 s21, s21, s45
    s_add_u32 s21, s21, 29696
    v_cvt_pk_bf16_f32 v108, v80, v81
    v_cvt_pk_bf16_f32 v109, v84, v85
    v_cvt_pk_bf16_f32 v110, v82, v83
    v_cvt_pk_bf16_f32 v111, v86, v87
    buffer_store_dwordx4 v[108:111], v7, s[8:11], s21 offen offset:0 sc1
    v_cvt_pk_bf16_f32 v112, v88, v89
    v_cvt_pk_bf16_f32 v113, v92, v93
    v_cvt_pk_bf16_f32 v114, v90, v91
    v_cvt_pk_bf16_f32 v115, v94, v95
    buffer_store_dwordx4 v[112:115], v7, s[8:11], s21 offen offset:512 sc1
    s_cmp_ge_u32 s46, 4
    s_cbranch_scc1 v4g_ps5
v4g_ps5:
    s_cmp_lg_u32 s50, 0
    s_cbranch_scc1 v4g_end
    s_waitcnt vmcnt(0)
    s_barrier
    s_cmp_lg_u32 s14, 0
    s_cbranch_scc1 v4gA_fr
v4gA_z:
    v_mov_b32 v250, 0
    global_load_dword v251, v250, s[6:7] offset:8 sc1
    s_waitcnt vmcnt(0)
    v_readfirstlane_b32 s20, v251
    s_nop 2
    s_cmp_lg_u32 s20, 0
    s_cbranch_scc1 v4gA_zk
    s_sleep 2
    s_sub_u32 s17, s17, 1
    s_cmp_gt_i32 s17, 0
    s_cbranch_scc1 v4gA_z
v4gA_zk:
v4gA_fr:
    s_cmp_lg_u32 s14, 0
    s_cbranch_scc1 v4gA_sg
    s_lshl_b32 s24, s40, 7
    s_add_u32 s24, s24, 20508672
    s_mov_b64 exec, 1
    v_mov_b32 v251, 1
    buffer_atomic_add v251, off, s[8:11], s24
    s_mov_b64 exec, -1
v4gA_sg:
    s_mov_b32 s50, 1
    s_mov_b32 s46, s48
    s_cmp_lt_u32 s46, 7
    s_cbranch_scc1 v4g_rb
v4g_end:
    s_waitcnt vmcnt(0)
    s_barrier
    s_cmp_lg_u32 s14, 0
    s_cbranch_scc1 v4gB_sg
    s_lshl_b32 s24, s40, 7
    s_add_u32 s24, s24, 20510720
    s_mov_b64 exec, 1
    v_mov_b32 v251, 1
    buffer_atomic_add v251, off, s[8:11], s24
    s_mov_b64 exec, -1
v4gB_sg:
    s_branch v4_gwd
v4_w:
    s_load_dwordx2 s[24:25], s[0:1], 32
    s_waitcnt lgkmcnt(0)
    s_mov_b32 s56, s24
    s_and_b32 s57, s25, 0xffff
    s_mov_b32 s58, 3670016
    s_mov_b32 s59, 0x20000
    s_load_dwordx2 s[24:25], s[0:1], 40
    s_waitcnt lgkmcnt(0)
    s_mov_b32 s60, s24
    s_and_b32 s61, s25, 0xffff
    s_mov_b32 s62, 3670016
    s_mov_b32 s63, 0x20000
    v_and_b32 v2, 31, v0
    v_lshrrev_b32 v3, 5, v0
    v_add_u32 v4, 0, v3
    v_xor_b32 v4, v4, v2
    v_and_b32 v4, 15, v4
    v_and_b32 v5, 16, v2
    v_or_b32 v4, v4, v5
    v_lshlrev_b32 v4, 4, v4
    v_lshl_add_u32 v16, v3, 13, v4
    v_add_u32 v4, 2, v3
    v_xor_b32 v4, v4, v2
    v_and_b32 v4, 15, v4
    v_and_b32 v5, 16, v2
    v_or_b32 v4, v4, v5
    v_lshlrev_b32 v4, 4, v4
    v_lshl_add_u32 v17, v3, 13, v4
    v_add_u32 v4, 4, v3
    v_xor_b32 v4, v4, v2
    v_and_b32 v4, 15, v4
    v_and_b32 v5, 16, v2
    v_or_b32 v4, v4, v5
    v_lshlrev_b32 v4, 4, v4
    v_lshl_add_u32 v18, v3, 13, v4
    v_add_u32 v4, 6, v3
    v_xor_b32 v4, v4, v2
    v_and_b32 v4, 15, v4
    v_and_b32 v5, 16, v2
    v_or_b32 v4, v4, v5
    v_lshlrev_b32 v4, 4, v4
    v_lshl_add_u32 v19, v3, 13, v4
    v_add_u32 v4, 8, v3
    v_xor_b32 v4, v4, v2
    v_and_b32 v4, 15, v4
    v_and_b32 v5, 16, v2
    v_or_b32 v4, v4, v5
    v_lshlrev_b32 v4, 4, v4
    v_lshl_add_u32 v20, v3, 13, v4
    v_add_u32 v4, 10, v3
    v_xor_b32 v4, v4, v2
    v_and_b32 v4, 15, v4
    v_and_b32 v5, 16, v2
    v_or_b32 v4, v4, v5
    v_lshlrev_b32 v4, 4, v4
    v_lshl_add_u32 v21, v3, 13, v4
    v_add_u32 v4, 12, v3
    v_xor_b32 v4, v4, v2
    v_and_b32 v4, 15, v4
    v_and_b32 v5, 16, v2
    v_or_b32 v4, v4, v5
    v_lshlrev_b32 v4, 4, v4
    v_lshl_add_u32 v22, v3, 13, v4
    v_add_u32 v4, 14, v3
    v_xor_b32 v4, v4, v2
    v_and_b32 v4, 15, v4
    v_and_b32 v5, 16, v2
    v_or_b32 v4, v4, v5
    v_lshlrev_b32 v4, 4, v4
    v_lshl_add_u32 v23, v3, 13, v4
    v_add_u32 v4, 0, v3
    v_xor_b32 v4, v4, v2
    v_and_b32 v4, 15, v4
    v_lshlrev_b32 v4, 4, v4
    v_lshl_add_u32 v24, v2, 9, v4
    v_add_u32 v4, 2, v3
    v_xor_b32 v4, v4, v2
    v_and_b32 v4, 15, v4
    v_lshlrev_b32 v4, 4, v4
    v_lshl_add_u32 v25, v2, 9, v4
    v_add_u32 v4, 4, v3
    v_xor_b32 v4, v4, v2
    v_and_b32 v4, 15, v4
    v_lshlrev_b32 v4, 4, v4
    v_lshl_add_u32 v26, v2, 9, v4
    v_add_u32 v4, 6, v3
    v_xor_b32 v4, v4, v2
    v_and_b32 v4, 15, v4
    v_lshlrev_b32 v4, 4, v4
    v_lshl_add_u32 v27, v2, 9, v4
    v_add_u32 v4, 8, v3
    v_xor_b32 v4, v4, v2
    v_and_b32 v4, 15, v4
    v_lshlrev_b32 v4, 4, v4
    v_lshl_add_u32 v28, v2, 9, v4
    v_add_u32 v4, 10, v3
    v_xor_b32 v4, v4, v2
    v_and_b32 v4, 15, v4
    v_lshlrev_b32 v4, 4, v4
    v_lshl_add_u32 v29, v2, 9, v4
    v_add_u32 v4, 12, v3
    v_xor_b32 v4, v4, v2
    v_and_b32 v4, 15, v4
    v_lshlrev_b32 v4, 4, v4
    v_lshl_add_u32 v30, v2, 9, v4
    v_add_u32 v4, 14, v3
    v_xor_b32 v4, v4, v2
    v_and_b32 v4, 15, v4
    v_lshlrev_b32 v4, 4, v4
    v_lshl_add_u32 v31, v2, 9, v4
    s_lshl_b32 s42, s40, 9
    s_lshl_b32 s48, s41, 19
    s_add_u32 s48, s48, s42
    s_lshl_b32 s20, s14, 17
    s_add_u32 s48, s48, s20
    v_lshrrev_b32 v8, 2, v0
    v_lshlrev_b32 v8, 13, v8
    v_and_b32 v9, 3, v0
    v_lshl_add_u32 v8, v9, 7, v8
    buffer_load_dword v10, v8, s[56:59], s48 offen
    s_add_u32 s44, s14, 1
    s_lshl_b32 s44, s44, 15
    v_lshrrev_b32 v5, 3, v0
    v_and_b32 v6, 7, v0
    v_mul_u32_u24 v5, 896, v5
    v_lshl_add_u32 v5, v6, 4, v5
    s_mul_i32 s43, s40, 229376
    s_lshl_b32 s20, s41, 7
    s_add_u32 s43, s43, s20
    s_mul_i32 s20, s14, 57344
    s_add_u32 s43, s43, s20
    s_lshl_b32 s45, s14, 13
    s_add_u32 m0, s45, 0
    s_add_u32 s21, s43, 0
    buffer_load_dwordx4 v5, s[60:63], s21 offen lds
    s_add_u32 m0, s45, 1024
    s_add_u32 s21, s43, 7168
    buffer_load_dwordx4 v5, s[60:63], s21 offen lds
    s_add_u32 m0, s45, 2048
    s_add_u32 s21, s43, 14336
    buffer_load_dwordx4 v5, s[60:63], s21 offen lds
    s_add_u32 m0, s45, 3072
    s_add_u32 s21, s43, 21504
    buffer_load_dwordx4 v5, s[60:63], s21 offen lds
    s_add_u32 m0, s45, 4096
    s_add_u32 s21, s43, 28672
    buffer_load_dwordx4 v5, s[60:63], s21 offen lds
    s_add_u32 m0, s45, 5120
    s_add_u32 s21, s43, 35840
    buffer_load_dwordx4 v5, s[60:63], s21 offen lds
    s_add_u32 m0, s45, 6144
    s_add_u32 s21, s43, 43008
    buffer_load_dwordx4 v5, s[60:63], s21 offen lds
    s_add_u32 m0, s45, 7168
    s_add_u32 s21, s43, 50176
    buffer_load_dwordx4 v5, s[60:63], s21 offen lds
    s_mov_b32 s46, s14
    s_lshl_b32 s47, s46, 19
    s_add_u32 s47, s47, s42
    s_add_u32 m0, s44, 0
    s_add_u32 s21, s47, 0
    buffer_load_dwordx4 v16, s[56:59], s21 offen lds
    s_add_u32 m0, s44, 1024
    s_add_u32 s21, s47, 16384
    buffer_load_dwordx4 v17, s[56:59], s21 offen lds
    s_add_u32 m0, s44, 2048
    s_add_u32 s21, s47, 32768
    buffer_load_dwordx4 v18, s[56:59], s21 offen lds
    s_add_u32 m0, s44, 3072
    s_add_u32 s21, s47, 49152
    buffer_load_dwordx4 v19, s[56:59], s21 offen lds
    s_add_u32 m0, s44, 4096
    s_add_u32 s21, s47, 65536
    buffer_load_dwordx4 v20, s[56:59], s21 offen lds
    s_add_u32 m0, s44, 5120
    s_add_u32 s21, s47, 81920
    buffer_load_dwordx4 v21, s[56:59], s21 offen lds
    s_add_u32 m0, s44, 6144
    s_add_u32 s21, s47, 98304
    buffer_load_dwordx4 v22, s[56:59], s21 offen lds
    s_add_u32 m0, s44, 7168
    s_add_u32 s21, s47, 114688
    buffer_load_dwordx4 v23, s[56:59], s21 offen lds
    s_waitcnt vmcnt(8)
    s_barrier
    v_bfe_u32 v5, v0, 2, 2
    v_lshl_add_u32 v5, v3, 3, v5
    v_lshlrev_b32 v5, 7, v5
    v_bfe_u32 v6, v0, 4, 1
    v_lshl_add_u32 v5, v6, 5, v5
    v_and_b32 v6, 3, v0
    v_lshl_add_u32 v5, v6, 3, v5
    ds_read_b64_tr_b16 a[0:1], v5 offset:0
    ds_read_b64_tr_b16 a[2:3], v5 offset:512
    ds_read_b64_tr_b16 a[4:5], v5 offset:2048
    ds_read_b64_tr_b16 a[6:7], v5 offset:2560
    ds_read_b64_tr_b16 a[8:9], v5 offset:4096
    ds_read_b64_tr_b16 a[10:11], v5 offset:4608
    ds_read_b64_tr_b16 a[12:13], v5 offset:6144
    ds_read_b64_tr_b16 a[14:15], v5 offset:6656
    s_waitcnt lgkmcnt(0)
    ds_read_b64_tr_b16 a[16:17], v5 offset:8192
    ds_read_b64_tr_b16 a[18:19], v5 offset:8704
    ds_read_b64_tr_b16 a[20:21], v5 offset:10240
    ds_read_b64_tr_b16 a[22:23], v5 offset:10752
    ds_read_b64_tr_b16 a[24:25], v5 offset:12288
    ds_read_b64_tr_b16 a[26:27], v5 offset:12800
    ds_read_b64_tr_b16 a[28:29], v5 offset:14336
    ds_read_b64_tr_b16 a[30:31], v5 offset:14848
    s_waitcnt lgkmcnt(0)
    ds_read_b64_tr_b16 a[32:33], v5 offset:16384
    ds_read_b64_tr_b16 a[34:35], v5 offset:16896
    ds_read_b64_tr_b16 a[36:37], v5 offset:18432
    ds_read_b64_tr_b16 a[38:39], v5 offset:18944
    ds_read_b64_tr_b16 a[40:41], v5 offset:20480
    ds_read_b64_tr_b16 a[42:43], v5 offset:20992
    ds_read_b64_tr_b16 a[44:45], v5 offset:22528
    ds_read_b64_tr_b16 a[46:47], v5 offset:23040
    s_waitcnt lgkmcnt(0)
    ds_read_b64_tr_b16 a[48:49], v5 offset:24576
    ds_read_b64_tr_b16 a[50:51], v5 offset:25088
    ds_read_b64_tr_b16 a[52:53], v5 offset:26624
    ds_read_b64_tr_b16 a[54:55], v5 offset:27136
    ds_read_b64_tr_b16 a[56:57], v5 offset:28672
    ds_read_b64_tr_b16 a[58:59], v5 offset:29184
    ds_read_b64_tr_b16 a[60:61], v5 offset:30720
    ds_read_b64_tr_b16 a[62:63], v5 offset:31232
    s_waitcnt lgkmcnt(0)
    ds_read_b64_tr_b16 a[64:65], v5 offset:64
    ds_read_b64_tr_b16 a[66:67], v5 offset:576
    ds_read_b64_tr_b16 a[68:69], v5 offset:2112
    ds_read_b64_tr_b16 a[70:71], v5 offset:2624
    ds_read_b64_tr_b16 a[72:73], v5 offset:4160
    ds_read_b64_tr_b16 a[74:75], v5 offset:4672
    ds_read_b64_tr_b16 a[76:77], v5 offset:6208
    ds_read_b64_tr_b16 a[78:79], v5 offset:6720
    s_waitcnt lgkmcnt(0)
    ds_read_b64_tr_b16 a[80:81], v5 offset:8256
    ds_read_b64_tr_b16 a[82:83], v5 offset:8768
    ds_read_b64_tr_b16 a[84:85], v5 offset:10304
    ds_read_b64_tr_b16 a[86:87], v5 offset:10816
    ds_read_b64_tr_b16 a[88:89], v5 offset:12352
    ds_read_b64_tr_b16 a[90:91], v5 offset:12864
    ds_read_b64_tr_b16 a[92:93], v5 offset:14400
    ds_read_b64_tr_b16 a[94:95], v5 offset:14912
    s_waitcnt lgkmcnt(0)
    ds_read_b64_tr_b16 a[96:97], v5 offset:16448
    ds_read_b64_tr_b16 a[98:99], v5 offset:16960
    ds_read_b64_tr_b16 a[100:101], v5 offset:18496
    ds_read_b64_tr_b16 a[102:103], v5 offset:19008
    ds_read_b64_tr_b16 a[104:105], v5 offset:20544
    ds_read_b64_tr_b16 a[106:107], v5 offset:21056
    ds_read_b64_tr_b16 a[108:109], v5 offset:22592
    ds_read_b64_tr_b16 a[110:111], v5 offset:23104
    s_waitcnt lgkmcnt(0)
    ds_read_b64_tr_b16 a[112:113], v5 offset:24640
    ds_read_b64_tr_b16 a[114:115], v5 offset:25152
    ds_read_b64_tr_b16 a[116:117], v5 offset:26688
    ds_read_b64_tr_b16 a[118:119], v5 offset:27200
    ds_read_b64_tr_b16 a[120:121], v5 offset:28736
    ds_read_b64_tr_b16 a[122:123], v5 offset:29248
    ds_read_b64_tr_b16 a[124:125], v5 offset:30784
    ds_read_b64_tr_b16 a[126:127], v5 offset:31296
    s_waitcnt lgkmcnt(0)
    s_add_u32 m0, s44, 8192
    s_add_u32 s21, s47, 131072
    buffer_load_dwordx4 v16, s[56:59], s21 offen lds
    s_add_u32 m0, s44, 9216
    s_add_u32 s21, s47, 147456
    buffer_load_dwordx4 v17, s[56:59], s21 offen lds
    s_add_u32 m0, s44, 10240
    s_add_u32 s21, s47, 163840
    buffer_load_dwordx4 v18, s[56:59], s21 offen lds
    s_add_u32 m0, s44, 11264
    s_add_u32 s21, s47, 180224
    buffer_load_dwordx4 v19, s[56:59], s21 offen lds
    s_add_u32 m0, s44, 12288
    s_add_u32 s21, s47, 196608
    buffer_load_dwordx4 v20, s[56:59], s21 offen lds
    s_add_u32 m0, s44, 13312
    s_add_u32 s21, s47, 212992
    buffer_load_dwordx4 v21, s[56:59], s21 offen lds
    s_add_u32 m0, s44, 14336
    s_add_u32 s21, s47, 229376
    buffer_load_dwordx4 v22, s[56:59], s21 offen lds
    s_add_u32 m0, s44, 15360
    s_add_u32 s21, s47, 245760
    buffer_load_dwordx4 v23, s[56:59], s21 offen lds
    s_add_u32 m0, s44, 16384
    s_add_u32 s21, s47, 262144
    buffer_load_dwordx4 v16, s[56:59], s21 offen lds
    s_add_u32 m0, s44, 17408
    s_add_u32 s21, s47, 278528
    buffer_load_dwordx4 v17, s[56:59], s21 offen lds
    s_add_u32 m0, s44, 18432
    s_add_u32 s21, s47, 294912
    buffer_load_dwordx4 v18, s[56:59], s21 offen lds
    s_add_u32 m0, s44, 19456
    s_add_u32 s21, s47, 311296
    buffer_load_dwordx4 v19, s[56:59], s21 offen lds
    s_add_u32 m0, s44, 20480
    s_add_u32 s21, s47, 327680
    buffer_load_dwordx4 v20, s[56:59], s21 offen lds
    s_add_u32 m0, s44, 21504
    s_add_u32 s21, s47, 344064
    buffer_load_dwordx4 v21, s[56:59], s21 offen lds
    s_add_u32 m0, s44, 22528
    s_add_u32 s21, s47, 360448
    buffer_load_dwordx4 v22, s[56:59], s21 offen lds
    s_add_u32 m0, s44, 23552
    s_add_u32 s21, s47, 376832
    buffer_load_dwordx4 v23, s[56:59], s21 offen lds
    s_add_u32 m0, s44, 24576
    s_add_u32 s21, s47, 393216
    buffer_load_dwordx4 v16, s[56:59], s21 offen lds
    s_add_u32 m0, s44, 25600
    s_add_u32 s21, s47, 409600
    buffer_load_dwordx4 v17, s[56:59], s21 offen lds
    s_add_u32 m0, s44, 26624
    s_add_u32 s21, s47, 425984
    buffer_load_dwordx4 v18, s[56:59], s21 offen lds
    s_add_u32 m0, s44, 27648
    s_add_u32 s21, s47, 442368
    buffer_load_dwordx4 v19, s[56:59], s21 offen lds
    s_add_u32 m0, s44, 28672
    s_add_u32 s21, s47, 458752
    buffer_load_dwordx4 v20, s[56:59], s21 offen lds
    s_add_u32 m0, s44, 29696
    s_add_u32 s21, s47, 475136
    buffer_load_dwordx4 v21, s[56:59], s21 offen lds
    s_add_u32 m0, s44, 30720
    s_add_u32 s21, s47, 491520
    buffer_load_dwordx4 v22, s[56:59], s21 offen lds
    s_add_u32 m0, s44, 31744
    s_add_u32 s21, s47, 507904
    buffer_load_dwordx4 v23, s[56:59], s21 offen lds
    v_add_u32 v24, s44, v24
    v_add_u32 v25, s44, v25
    v_add_u32 v26, s44, v26
    v_add_u32 v27, s44, v27
    v_add_u32 v28, s44, v28
    v_add_u32 v29, s44, v29
    v_add_u32 v30, s44, v30
    v_add_u32 v31, s44, v31
    v_bfe_u32 v7, v0, 4, 1
    v_mul_u32_u24 v7, 14336, v7
    v_lshrrev_b32 v250, 5, v0
    v_lshl_add_u32 v7, v250, 8, v7
    v_and_b32 v250, 15, v0
    v_lshl_add_u32 v7, v250, 4, v7
    s_mul_i32 s45, s40, 401408
    s_mul_i32 s20, s41, 57344
    s_add_u32 s45, s45, s20
    s_add_u32 s45, s45, 9437184
    s_mov_b32 s50, 0
v4w_rb:
    s_waitcnt vmcnt(16)
    ds_read_b128 a[128:131], v24 offset:0
    ds_read_b128 a[132:135], v25 offset:0
    ds_read_b128 a[136:139], v26 offset:0
    ds_read_b128 a[140:143], v27 offset:0
    ds_read_b128 a[144:147], v28 offset:0
    ds_read_b128 a[148:151], v29 offset:0
    ds_read_b128 a[152:155], v30 offset:0
    ds_read_b128 a[156:159], v31 offset:0
    s_waitcnt lgkmcnt(0)
    ds_read_b128 a[160:163], v24 offset:256
    ds_read_b128 a[164:167], v25 offset:256
    ds_read_b128 a[168:171], v26 offset:256
    ds_read_b128 a[172:175], v27 offset:256
    ds_read_b128 a[176:179], v28 offset:256
    ds_read_b128 a[180:183], v29 offset:256
    ds_read_b128 a[184:187], v30 offset:256
    ds_read_b128 a[188:191], v31 offset:256
    s_waitcnt lgkmcnt(0)
    v_mfma_f32_32x32x16_bf16 v[32:47], a[128:131], a[0:3], 0
    v_mfma_f32_32x32x16_bf16 v[48:63], a[128:131], a[64:67], 0
    v_mfma_f32_32x32x16_bf16 v[32:47], a[132:135], a[4:7], v[32:47]
    v_mfma_f32_32x32x16_bf16 v[48:63], a[132:135], a[68:71], v[48:63]
    v_mfma_f32_32x32x16_bf16 v[32:47], a[136:139], a[8:11], v[32:47]
    v_mfma_f32_32x32x16_bf16 v[48:63], a[136:139], a[72:75], v[48:63]
    v_mfma_f32_32x32x16_bf16 v[32:47], a[140:143], a[12:15], v[32:47]
    v_mfma_f32_32x32x16_bf16 v[48:63], a[140:143], a[76:79], v[48:63]
    v_mfma_f32_32x32x16_bf16 v[32:47], a[144:147], a[16:19], v[32:47]
    v_mfma_f32_32x32x16_bf16 v[48:63], a[144:147], a[80:83], v[48:63]
    v_mfma_f32_32x32x16_bf16 v[32:47], a[148:151], a[20:23], v[32:47]
    v_mfma_f32_32x32x16_bf16 v[48:63], a[148:151], a[84:87], v[48:63]
    v_mfma_f32_32x32x16_bf16 v[32:47], a[152:155], a[24:27], v[32:47]
    v_mfma_f32_32x32x16_bf16 v[48:63], a[152:155], a[88:91], v[48:63]
    v_mfma_f32_32x32x16_bf16 v[32:47], a[156:159], a[28:31], v[32:47]
    v_mfma_f32_32x32x16_bf16 v[48:63], a[156:159], a[92:95], v[48:63]
    v_mfma_f32_32x32x16_bf16 v[32:47], a[160:163], a[32:35], v[32:47]
    v_mfma_f32_32x32x16_bf16 v[48:63], a[160:163], a[96:99], v[48:63]
    v_mfma_f32_32x32x16_bf16 v[32:47], a[164:167], a[36:39], v[32:47]
    v_mfma_f32_32x32x16_bf16 v[48:63], a[164:167], a[100:103], v[48:63]
    v_mfma_f32_32x32x16_bf16 v[32:47], a[168:171], a[40:43], v[32:47]
    v_mfma_f32_32x32x16_bf16 v[48:63], a[168:171], a[104:107], v[48:63]
    v_mfma_f32_32x32x16_bf16 v[32:47], a[172:175], a[44:47], v[32:47]
    v_mfma_f32_32x32x16_bf16 v[48:63], a[172:175], a[108:111], v[48:63]
    v_mfma_f32_32x32x16_bf16 v[32:47], a[176:179], a[48:51], v[32:47]
    v_mfma_f32_32x32x16_bf16 v[48:63], a[176:179], a[112:115], v[48:63]
    v_mfma_f32_32x32x16_bf16 v[32:47], a[180:183], a[52:55], v[32:47]
    v_mfma_f32_32x32x16_bf16 v[48:63], a[180:183], a[116:119], v[48:63]
    v_mfma_f32_32x32x16_bf16 v[32:47], a[184:187], a[56:59], v[32:47]
    v_mfma_f32_32x32x16_bf16 v[48:63], a[184:187], a[120:123], v[48:63]
    v_mfma_f32_32x32x16_bf16 v[32:47], a[188:191], a[60:63], v[32:47]
    v_mfma_f32_32x32x16_bf16 v[48:63], a[188:191], a[124:127], v[48:63]
    s_waitcnt vmcnt(0)
    ds_read_b128 a[192:195], v24 offset:16384
    ds_read_b128 a[196:199], v25 offset:16384
    ds_read_b128 a[200:203], v26 offset:16384
    ds_read_b128 a[204:207], v27 offset:16384
    ds_read_b128 a[208:211], v28 offset:16384
    ds_read_b128 a[212:215], v29 offset:16384
    ds_read_b128 a[216:219], v30 offset:16384
    ds_read_b128 a[220:223], v31 offset:16384
    s_waitcnt lgkmcnt(0)
    ds_read_b128 a[224:227], v24 offset:16640
    ds_read_b128 a[228:231], v25 offset:16640
    ds_read_b128 a[232:235], v26 offset:16640
    ds_read_b128 a[236:239], v27 offset:16640
    ds_read_b128 a[240:243], v28 offset:16640
    ds_read_b128 a[244:247], v29 offset:16640
    ds_read_b128 a[248:251], v30 offset:16640
    ds_read_b128 a[252:255], v31 offset:16640
    s_waitcnt lgkmcnt(0)
    s_add_u32 s48, s46, 4
    s_cmp_ge_u32 s48, 7
    s_cbranch_scc1 v4w_nopf
    s_lshl_b32 s47, s48, 19
    s_add_u32 s47, s47, s42
    s_add_u32 m0, s44, 0
    s_add_u32 s21, s47, 0
    buffer_load_dwordx4 v16, s[56:59], s21 offen lds
    s_add_u32 m0, s44, 1024
    s_add_u32 s21, s47, 16384
    buffer_load_dwordx4 v17, s[56:59], s21 offen lds
    s_add_u32 m0, s44, 2048
    s_add_u32 s21, s47, 32768
    buffer_load_dwordx4 v18, s[56:59], s21 offen lds
    s_add_u32 m0, s44, 3072
    s_add_u32 s21, s47, 49152
    buffer_load_dwordx4 v19, s[56:59], s21 offen lds
    s_add_u32 m0, s44, 4096
    s_add_u32 s21, s47, 65536
    buffer_load_dwordx4 v20, s[56:59], s21 offen lds
    s_add_u32 m0, s44, 5120
    s_add_u32 s21, s47, 81920
    buffer_load_dwordx4 v21, s[56:59], s21 offen lds
    s_add_u32 m0, s44, 6144
    s_add_u32 s21, s47, 98304
    buffer_load_dwordx4 v22, s[56:59], s21 offen lds
    s_add_u32 m0, s44, 7168
    s_add_u32 s21, s47, 114688
    buffer_load_dwordx4 v23, s[56:59], s21 offen lds
    s_add_u32 m0, s44, 8192
    s_add_u32 s21, s47, 131072
    buffer_load_dwordx4 v16, s[56:59], s21 offen lds
    s_add_u32 m0, s44, 9216
    s_add_u32 s21, s47, 147456
    buffer_load_dwordx4 v17, s[56:59], s21 offen lds
    s_add_u32 m0, s44, 10240
    s_add_u32 s21, s47, 163840
    buffer_load_dwordx4 v18, s[56:59], s21 offen lds
    s_add_u32 m0, s44, 11264
    s_add_u32 s21, s47, 180224
    buffer_load_dwordx4 v19, s[56:59], s21 offen lds
    s_add_u32 m0, s44, 12288
    s_add_u32 s21, s47, 196608
    buffer_load_dwordx4 v20, s[56:59], s21 offen lds
    s_add_u32 m0, s44, 13312
    s_add_u32 s21, s47, 212992
    buffer_load_dwordx4 v21, s[56:59], s21 offen lds
    s_add_u32 m0, s44, 14336
    s_add_u32 s21, s47, 229376
    buffer_load_dwordx4 v22, s[56:59], s21 offen lds
    s_add_u32 m0, s44, 15360
    s_add_u32 s21, s47, 245760
    buffer_load_dwordx4 v23, s[56:59], s21 offen lds
    s_add_u32 m0, s44, 16384
    s_add_u32 s21, s47, 262144
    buffer_load_dwordx4 v16, s[56:59], s21 offen lds
    s_add_u32 m0, s44, 17408
    s_add_u32 s21, s47, 278528
    buffer_load_dwordx4 v17, s[56:59], s21 offen lds
    s_add_u32 m0, s44, 18432
    s_add_u32 s21, s47, 294912
    buffer_load_dwordx4 v18, s[56:59], s21 offen lds
    s_add_u32 m0, s44, 19456
    s_add_u32 s21, s47, 311296
    buffer_load_dwordx4 v19, s[56:59], s21 offen lds
    s_add_u32 m0, s44, 20480
    s_add_u32 s21, s47, 327680
    buffer_load_dwordx4 v20, s[56:59], s21 offen lds
    s_add_u32 m0, s44, 21504
    s_add_u32 s21, s47, 344064
    buffer_load_dwordx4 v21, s[56:59], s21 offen lds
    s_add_u32 m0, s44, 22528
    s_add_u32 s21, s47, 360448
    buffer_load_dwordx4 v22, s[56:59], s21 offen lds
    s_add_u32 m0, s44, 23552
    s_add_u32 s21, s47, 376832
    buffer_load_dwordx4 v23, s[56:59], s21 offen lds
    s_add_u32 m0, s44, 24576
    s_add_u32 s21, s47, 393216
    buffer_load_dwordx4 v16, s[56:59], s21 offen lds
    s_add_u32 m0, s44, 25600
    s_add_u32 s21, s47, 409600
    buffer_load_dwordx4 v17, s[56:59], s21 offen lds
    s_add_u32 m0, s44, 26624
    s_add_u32 s21, s47, 425984
    buffer_load_dwordx4 v18, s[56:59], s21 offen lds
    s_add_u32 m0, s44, 27648
    s_add_u32 s21, s47, 442368
    buffer_load_dwordx4 v19, s[56:59], s21 offen lds
    s_add_u32 m0, s44, 28672
    s_add_u32 s21, s47, 458752
    buffer_load_dwordx4 v20, s[56:59], s21 offen lds
    s_add_u32 m0, s44, 29696
    s_add_u32 s21, s47, 475136
    buffer_load_dwordx4 v21, s[56:59], s21 offen lds
    s_add_u32 m0, s44, 30720
    s_add_u32 s21, s47, 491520
    buffer_load_dwordx4 v22, s[56:59], s21 offen lds
    s_add_u32 m0, s44, 31744
    s_add_u32 s21, s47, 507904
    buffer_load_dwordx4 v23, s[56:59], s21 offen lds
v4w_nopf:
    v_mfma_f32_32x32x16_bf16 v[64:79], a[192:195], a[0:3], 0
    v_mfma_f32_32x32x16_bf16 v[80:95], a[192:195], a[64:67], 0
    v_mfma_f32_32x32x16_bf16 v[64:79], a[196:199], a[4:7], v[64:79]
    v_mfma_f32_32x32x16_bf16 v[80:95], a[196:199], a[68:71], v[80:95]
    v_mfma_f32_32x32x16_bf16 v[64:79], a[200:203], a[8:11], v[64:79]
    v_mfma_f32_32x32x16_bf16 v[80:95], a[200:203], a[72:75], v[80:95]
    v_mfma_f32_32x32x16_bf16 v[64:79], a[204:207], a[12:15], v[64:79]
    v_mfma_f32_32x32x16_bf16 v[80:95], a[204:207], a[76:79], v[80:95]
    v_mfma_f32_32x32x16_bf16 v[64:79], a[208:211], a[16:19], v[64:79]
    v_mfma_f32_32x32x16_bf16 v[80:95], a[208:211], a[80:83], v[80:95]
    v_mfma_f32_32x32x16_bf16 v[64:79], a[212:215], a[20:23], v[64:79]
    v_mfma_f32_32x32x16_bf16 v[80:95], a[212:215], a[84:87], v[80:95]
    v_mfma_f32_32x32x16_bf16 v[64:79], a[216:219], a[24:27], v[64:79]
    v_mfma_f32_32x32x16_bf16 v[80:95], a[216:219], a[88:91], v[80:95]
    v_mfma_f32_32x32x16_bf16 v[64:79], a[220:223], a[28:31], v[64:79]
    v_mfma_f32_32x32x16_bf16 v[80:95], a[220:223], a[92:95], v[80:95]
    v_mfma_f32_32x32x16_bf16 v[64:79], a[224:227], a[32:35], v[64:79]
    v_mfma_f32_32x32x16_bf16 v[80:95], a[224:227], a[96:99], v[80:95]
    v_mfma_f32_32x32x16_bf16 v[64:79], a[228:231], a[36:39], v[64:79]
    v_mfma_f32_32x32x16_bf16 v[80:95], a[228:231], a[100:103], v[80:95]
    v_mfma_f32_32x32x16_bf16 v[64:79], a[232:235], a[40:43], v[64:79]
    v_mfma_f32_32x32x16_bf16 v[80:95], a[232:235], a[104:107], v[80:95]
    v_mfma_f32_32x32x16_bf16 v[64:79], a[236:239], a[44:47], v[64:79]
    v_mfma_f32_32x32x16_bf16 v[80:95], a[236:239], a[108:111], v[80:95]
    v_mfma_f32_32x32x16_bf16 v[64:79], a[240:243], a[48:51], v[64:79]
    v_mfma_f32_32x32x16_bf16 v[80:95], a[240:243], a[112:115], v[80:95]
    v_mfma_f32_32x32x16_bf16 v[64:79], a[244:247], a[52:55], v[64:79]
    v_mfma_f32_32x32x16_bf16 v[80:95], a[244:247], a[116:119], v[80:95]
    v_mfma_f32_32x32x16_bf16 v[64:79], a[248:251], a[56:59], v[64:79]
    v_mfma_f32_32x32x16_bf16 v[80:95], a[248:251], a[120:123], v[80:95]
    v_mfma_f32_32x32x16_bf16 v[64:79], a[252:255], a[60:63], v[64:79]
    v_mfma_f32_32x32x16_bf16 v[80:95], a[252:255], a[124:127], v[80:95]
    s_lshl_b32 s21, s46, 11
    s_add_u32 s21, s21, s45
    s_add_u32 s21, s21, 0
    v_cvt_pk_bf16_f32 v100, v32, v33
    v_cvt_pk_bf16_f32 v101, v36, v37
    v_cvt_pk_bf16_f32 v102, v34, v35
    v_cvt_pk_bf16_f32 v103, v38, v39
    buffer_store_dwordx4 v[100:103], v7, s[8:11], s21 offen offset:0 sc1
    v_cvt_pk_bf16_f32 v104, v40, v41
    v_cvt_pk_bf16_f32 v105, v44, v45
    v_cvt_pk_bf16_f32 v106, v42, v43
    v_cvt_pk_bf16_f32 v107, v46, v47
    buffer_store_dwordx4 v[104:107], v7, s[8:11], s21 offen offset:512 sc1
    s_lshl_b32 s21, s46, 11
    s_add_u32 s21, s21, s45
    s_add_u32 s21, s21, 28672
    v_cvt_pk_bf16_f32 v108, v48, v49
    v_cvt_pk_bf16_f32 v109, v52, v53
    v_cvt_pk_bf16_f32 v110, v50, v51
    v_cvt_pk_bf16_f32 v111, v54, v55
    buffer_store_dwordx4 v[108:111], v7, s[8:11], s21 offen offset:0 sc1
    v_cvt_pk_bf16_f32 v112, v56, v57
    v_cvt_pk_bf16_f32 v113, v60, v61
    v_cvt_pk_bf16_f32 v114, v58, v59
    v_cvt_pk_bf16_f32 v115, v62, v63
    buffer_store_dwordx4 v[112:115], v7, s[8:11], s21 offen offset:512 sc1
    s_lshl_b32 s21, s46, 11
    s_add_u32 s21, s21, s45
    s_add_u32 s21, s21, 1024
    v_cvt_pk_bf16_f32 v100, v64, v65
    v_cvt_pk_bf16_f32 v101, v68, v69
    v_cvt_pk_bf16_f32 v102, v66, v67
    v_cvt_pk_bf16_f32 v103, v70, v71
    buffer_store_dwordx4 v[100:103], v7, s[8:11], s21 offen offset:0 sc1
    v_cvt_pk_bf16_f32 v104, v72, v73
    v_cvt_pk_bf16_f32 v105, v76, v77
    v_cvt_pk_bf16_f32 v106, v74, v75
    v_cvt_pk_bf16_f32 v107, v78, v79
    buffer_store_dwordx4 v[104:107], v7, s[8:11], s21 offen offset:512 sc1
    s_lshl_b32 s21, s46, 11
    s_add_u32 s21, s21, s45
    s_add_u32 s21, s21, 29696
    v_cvt_pk_bf16_f32 v108, v80, v81
    v_cvt_pk_bf16_f32 v109, v84, v85
    v_cvt_pk_bf16_f32 v110, v82, v83
    v_cvt_pk_bf16_f32 v111, v86, v87
    buffer_store_dwordx4 v[108:111], v7, s[8:11], s21 offen offset:0 sc1
    v_cvt_pk_bf16_f32 v112, v88, v89
    v_cvt_pk_bf16_f32 v113, v92, v93
    v_cvt_pk_bf16_f32 v114, v90, v91
    v_cvt_pk_bf16_f32 v115, v94, v95
    buffer_store_dwordx4 v[112:115], v7, s[8:11], s21 offen offset:512 sc1
    s_cmp_ge_u32 s46, 4
    s_cbranch_scc1 v4w_ps5
v4w_ps5:
    s_cmp_lg_u32 s50, 0
    s_cbranch_scc1 v4w_end
    s_waitcnt vmcnt(0)
    s_barrier
    s_cmp_lg_u32 s14, 0
    s_cbranch_scc1 v4wA_fr
v4wA_z:
    v_mov_b32 v250, 0
    global_load_dword v251, v250, s[6:7] offset:8 sc1
    s_waitcnt vmcnt(0)
    v_readfirstlane_b32 s20, v251
    s_nop 2
    s_cmp_lg_u32 s20, 0
    s_cbranch_scc1 v4wA_zk
    s_sleep 2
    s_sub_u32 s17, s17, 1
    s_cmp_gt_i32 s17, 0
    s_cbranch_scc1 v4wA_z
v4wA_zk:
v4wA_fr:
    s_cmp_lg_u32 s14, 0
    s_cbranch_scc1 v4wA_sg
    s_lshl_b32 s24, s41, 7
    s_add_u32 s24, s24, 20497408
    s_mov_b64 exec, 1
    v_mov_b32 v251, 1
    buffer_atomic_add v251, off, s[8:11], s24
    s_mov_b64 exec, -1
v4wA_sg:
    s_mov_b32 s50, 1
    s_mov_b32 s46, s48
    s_cmp_lt_u32 s46, 7
    s_cbranch_scc1 v4w_rb
v4w_end:
    s_waitcnt vmcnt(0)
    s_barrier
    s_cmp_lg_u32 s14, 0
    s_cbranch_scc1 v4wB_sg
    s_lshl_b32 s24, s41, 7
    s_add_u32 s24, s24, 20498432
    s_mov_b64 exec, 1
    v_mov_b32 v251, 1
    buffer_atomic_add v251, off, s[8:11], s24
    s_mov_b64 exec, -1
v4wB_sg:
v4_gwd:
    s_cmp_lg_u32 s14, 0
    s_cbranch_scc1 e4a1_x
    s_mov_b64 exec, 1
    v_mov_b32 v251, 1
    s_mov_b32 s22, 20462592
    buffer_atomic_add v251, off, s[8:11], s22 sc0
    s_waitcnt vmcnt(0)
    v_readfirstlane_b32 s20, v251
    s_nop 2
    s_cmp_lg_u32 s20, 255
    s_cbranch_scc1 e4a1_n
    s_mov_b64 exec, 0xff
    v_lshlrev_b32 v250, 7, v0
    v_mov_b32 v251, 1
    s_mov_b32 s22, 20496384
    buffer_store_dword v251, v250, s[8:11], s22 offen sc1
e4a1_n:
    s_mov_b64 exec, -1
e4a1_x:
    s_branch ch_worker_entry
e4_chain:
    s_cmp_lg_u32 s13, 0
    s_cbranch_scc1 v4_nz
    v_mov_b32 v12, 0
    v_mov_b32 v13, 0
    v_mov_b32 v14, 0
    v_mov_b32 v15, 0
    s_lshl_b32 s21, s14, 12
    s_add_u32 s21, s21, 20447232
    v_lshlrev_b32 v2, 4, v0
    buffer_store_dwordx4 v[12:15], v2, s[8:11], s21 offen offset:0 sc1
    buffer_store_dwordx4 v[12:15], v2, s[8:11], s21 offen offset:1024 sc1
    buffer_store_dwordx4 v[12:15], v2, s[8:11], s21 offen offset:2048 sc1
    buffer_store_dwordx4 v[12:15], v2, s[8:11], s21 offen offset:3072 sc1
    s_add_u32 s21, s21, 16384
    buffer_store_dwordx4 v[12:15], v2, s[8:11], s21 offen offset:0 sc1
    buffer_store_dwordx4 v[12:15], v2, s[8:11], s21 offen offset:1024 sc1
    buffer_store_dwordx4 v[12:15], v2, s[8:11], s21 offen offset:2048 sc1
    buffer_store_dwordx4 v[12:15], v2, s[8:11], s21 offen offset:3072 sc1
    s_add_u32 s21, s21, 16384
    buffer_store_dwordx4 v[12:15], v2, s[8:11], s21 offen offset:0 sc1
    buffer_store_dwordx4 v[12:15], v2, s[8:11], s21 offen offset:1024 sc1
    buffer_store_dwordx4 v[12:15], v2, s[8:11], s21 offen offset:2048 sc1
    buffer_store_dwordx4 v[12:15], v2, s[8:11], s21 offen offset:3072 sc1
    s_add_u32 s21, s21, 16384
    buffer_store_dwordx4 v[12:15], v2, s[8:11], s21 offen offset:0 sc1
    buffer_store_dwordx4 v[12:15], v2, s[8:11], s21 offen offset:1024 sc1
    buffer_store_dwordx4 v[12:15], v2, s[8:11], s21 offen offset:2048 sc1
    buffer_store_dwordx4 v[12:15], v2, s[8:11], s21 offen offset:3072 sc1
    s_add_u32 s21, s21, 16384
    s_waitcnt vmcnt(0)
    s_barrier
    s_cmp_lg_u32 s14, 0
    s_cbranch_scc1 v4_nz
    s_mov_b64 exec, 1
    v_mov_b32 v2, 8
    v_mov_b32 v3, 1
    global_atomic_add v2, v3, s[6:7]
    s_mov_b64 exec, -1
v4_nz:
    s_load_dwordx2 s[24:25], s[0:1], 0
    s_waitcnt lgkmcnt(0)
    s_mov_b32 s56, s24
    s_and_b32 s57, s25, 0xffff
    s_mov_b32 s58, 1835008
    s_mov_b32 s59, 0x20000
    s_lshl_b32 s40, s13, 2
    s_add_u32 s40, s40, s14
    v_and_b32 v2, 15, v0
    v_lshrrev_b32 v3, 4, v0
    v_mul_u32_u24 v4, 896, v2
    v_mul_u32_u24 v5, 224, v3
    v_add_u32 v4, v4, v5
    s_mul_i32 s20, s40, 14336
    buffer_load_dwordx4 v[16:19], v4, s[56:59], s20 offen offset:0
    buffer_load_dwordx4 v[20:23], v4, s[56:59], s20 offen offset:16
    buffer_load_dwordx4 v[24:27], v4, s[56:59], s20 offen offset:32
    buffer_load_dwordx4 v[28:31], v4, s[56:59], s20 offen offset:48
    buffer_load_dwordx4 v[32:35], v4, s[56:59], s20 offen offset:64
    buffer_load_dwordx4 v[36:39], v4, s[56:59], s20 offen offset:80
    buffer_load_dwordx4 v[40:43], v4, s[56:59], s20 offen offset:96
    buffer_load_dwordx4 v[44:47], v4, s[56:59], s20 offen offset:112
    buffer_load_dwordx4 v[48:51], v4, s[56:59], s20 offen offset:128
    buffer_load_dwordx4 v[52:55], v4, s[56:59], s20 offen offset:144
    buffer_load_dwordx4 v[56:59], v4, s[56:59], s20 offen offset:160
    buffer_load_dwordx4 v[60:63], v4, s[56:59], s20 offen offset:176
    buffer_load_dwordx4 v[64:67], v4, s[56:59], s20 offen offset:192
    buffer_load_dwordx4 v[68:71], v4, s[56:59], s20 offen offset:208
    v_mul_u32_u24 v6, 3584, v3
    v_lshl_add_u32 v6, v2, 4, v6
    s_waitcnt vmcnt(0)
    s_add_u32 s21, s20, 100663296
    v_mov_b32 v200, v16
    v_mov_b32 v201, v20
    v_mov_b32 v202, v17
    v_mov_b32 v203, v21
    v_mov_b32 v204, v18
    v_mov_b32 v205, v22
    v_mov_b32 v206, v19
    v_mov_b32 v207, v23
    buffer_store_dwordx4 v[200:203], v6, s[8:11], s21 offen offset:0 sc1
    buffer_store_dwordx4 v[204:207], v6, s[8:11], s21 offen offset:256 sc1
    v_mov_b32 v208, v24
    v_mov_b32 v209, v28
    v_mov_b32 v210, v25
    v_mov_b32 v211, v29
    v_mov_b32 v212, v26
    v_mov_b32 v213, v30
    v_mov_b32 v214, v27
    v_mov_b32 v215, v31
    buffer_store_dwordx4 v[208:211], v6, s[8:11], s21 offen offset:512 sc1
    buffer_store_dwordx4 v[212:215], v6, s[8:11], s21 offen offset:768 sc1
    v_mov_b32 v200, v32
    v_mov_b32 v201, v36
    v_mov_b32 v202, v33
    v_mov_b32 v203, v37
    v_mov_b32 v204, v34
    v_mov_b32 v205, v38
    v_mov_b32 v206, v35
    v_mov_b32 v207, v39
    buffer_store_dwordx4 v[200:203], v6, s[8:11], s21 offen offset:1024 sc1
    buffer_store_dwordx4 v[204:207], v6, s[8:11], s21 offen offset:1280 sc1
    v_mov_b32 v208, v40
    v_mov_b32 v209, v44
    v_mov_b32 v210, v41
    v_mov_b32 v211, v45
    v_mov_b32 v212, v42
    v_mov_b32 v213, v46
    v_mov_b32 v214, v43
    v_mov_b32 v215, v47
    buffer_store_dwordx4 v[208:211], v6, s[8:11], s21 offen offset:1536 sc1
    buffer_store_dwordx4 v[212:215], v6, s[8:11], s21 offen offset:1792 sc1
    v_mov_b32 v200, v48
    v_mov_b32 v201, v52
    v_mov_b32 v202, v49
    v_mov_b32 v203, v53
    v_mov_b32 v204, v50
    v_mov_b32 v205, v54
    v_mov_b32 v206, v51
    v_mov_b32 v207, v55
    buffer_store_dwordx4 v[200:203], v6, s[8:11], s21 offen offset:2048 sc1
    buffer_store_dwordx4 v[204:207], v6, s[8:11], s21 offen offset:2304 sc1
    v_mov_b32 v208, v56
    v_mov_b32 v209, v60
    v_mov_b32 v210, v57
    v_mov_b32 v211, v61
    v_mov_b32 v212, v58
    v_mov_b32 v213, v62
    v_mov_b32 v214, v59
    v_mov_b32 v215, v63
    buffer_store_dwordx4 v[208:211], v6, s[8:11], s21 offen offset:2560 sc1
    buffer_store_dwordx4 v[212:215], v6, s[8:11], s21 offen offset:2816 sc1
    v_mov_b32 v200, v64
    v_mov_b32 v201, v68
    v_mov_b32 v202, v65
    v_mov_b32 v203, v69
    v_mov_b32 v204, v66
    v_mov_b32 v205, v70
    v_mov_b32 v206, v67
    v_mov_b32 v207, v71
    buffer_store_dwordx4 v[200:203], v6, s[8:11], s21 offen offset:3072 sc1
    buffer_store_dwordx4 v[204:207], v6, s[8:11], s21 offen offset:3328 sc1
    v_lshlrev_b32 v80, 16, v16
    v_and_b32 v81, 0xffff0000, v16
    v_lshlrev_b32 v82, 16, v17
    v_and_b32 v83, 0xffff0000, v17
    v_lshlrev_b32 v84, 16, v18
    v_and_b32 v85, 0xffff0000, v18
    v_lshlrev_b32 v86, 16, v19
    v_and_b32 v87, 0xffff0000, v19
    v_lshlrev_b32 v88, 16, v20
    v_and_b32 v89, 0xffff0000, v20
    v_lshlrev_b32 v90, 16, v21
    v_and_b32 v91, 0xffff0000, v21
    v_lshlrev_b32 v92, 16, v22
    v_and_b32 v93, 0xffff0000, v22
    v_lshlrev_b32 v94, 16, v23
    v_and_b32 v95, 0xffff0000, v23
    v_lshlrev_b32 v96, 16, v24
    v_and_b32 v97, 0xffff0000, v24
    v_lshlrev_b32 v98, 16, v25
    v_and_b32 v99, 0xffff0000, v25
    v_lshlrev_b32 v100, 16, v26
    v_and_b32 v101, 0xffff0000, v26
    v_lshlrev_b32 v102, 16, v27
    v_and_b32 v103, 0xffff0000, v27
    v_lshlrev_b32 v104, 16, v28
    v_and_b32 v105, 0xffff0000, v28
    v_lshlrev_b32 v106, 16, v29
    v_and_b32 v107, 0xffff0000, v29
    v_lshlrev_b32 v108, 16, v30
    v_and_b32 v109, 0xffff0000, v30
    v_lshlrev_b32 v110, 16, v31
    v_and_b32 v111, 0xffff0000, v31
    v_lshlrev_b32 v112, 16, v32
    v_and_b32 v113, 0xffff0000, v32
    v_lshlrev_b32 v114, 16, v33
    v_and_b32 v115, 0xffff0000, v33
    v_lshlrev_b32 v116, 16, v34
    v_and_b32 v117, 0xffff0000, v34
    v_lshlrev_b32 v118, 16, v35
    v_and_b32 v119, 0xffff0000, v35
    v_lshlrev_b32 v120, 16, v36
    v_and_b32 v121, 0xffff0000, v36
    v_lshlrev_b32 v122, 16, v37
    v_and_b32 v123, 0xffff0000, v37
    v_lshlrev_b32 v124, 16, v38
    v_and_b32 v125, 0xffff0000, v38
    v_lshlrev_b32 v126, 16, v39
    v_and_b32 v127, 0xffff0000, v39
    v_lshlrev_b32 v128, 16, v40
    v_and_b32 v129, 0xffff0000, v40
    v_lshlrev_b32 v130, 16, v41
    v_and_b32 v131, 0xffff0000, v41
    v_lshlrev_b32 v132, 16, v42
    v_and_b32 v133, 0xffff0000, v42
    v_lshlrev_b32 v134, 16, v43
    v_and_b32 v135, 0xffff0000, v43
    v_lshlrev_b32 v136, 16, v44
    v_and_b32 v137, 0xffff0000, v44
    v_lshlrev_b32 v138, 16, v45
    v_and_b32 v139, 0xffff0000, v45
    v_lshlrev_b32 v140, 16, v46
    v_and_b32 v141, 0xffff0000, v46
    v_lshlrev_b32 v142, 16, v47
    v_and_b32 v143, 0xffff0000, v47
    v_lshlrev_b32 v144, 16, v48
    v_and_b32 v145, 0xffff0000, v48
    v_lshlrev_b32 v146, 16, v49
    v_and_b32 v147, 0xffff0000, v49
    v_lshlrev_b32 v148, 16, v50
    v_and_b32 v149, 0xffff0000, v50
    v_lshlrev_b32 v150, 16, v51
    v_and_b32 v151, 0xffff0000, v51
    v_lshlrev_b32 v152, 16, v52
    v_and_b32 v153, 0xffff0000, v52
    v_lshlrev_b32 v154, 16, v53
    v_and_b32 v155, 0xffff0000, v53
    v_lshlrev_b32 v156, 16, v54
    v_and_b32 v157, 0xffff0000, v54
    v_lshlrev_b32 v158, 16, v55
    v_and_b32 v159, 0xffff0000, v55
    v_lshlrev_b32 v160, 16, v56
    v_and_b32 v161, 0xffff0000, v56
    v_lshlrev_b32 v162, 16, v57
    v_and_b32 v163, 0xffff0000, v57
    v_lshlrev_b32 v164, 16, v58
    v_and_b32 v165, 0xffff0000, v58
    v_lshlrev_b32 v166, 16, v59
    v_and_b32 v167, 0xffff0000, v59
    v_lshlrev_b32 v168, 16, v60
    v_and_b32 v169, 0xffff0000, v60
    v_lshlrev_b32 v170, 16, v61
    v_and_b32 v171, 0xffff0000, v61
    v_lshlrev_b32 v172, 16, v62
    v_and_b32 v173, 0xffff0000, v62
    v_lshlrev_b32 v174, 16, v63
    v_and_b32 v175, 0xffff0000, v63
    v_lshlrev_b32 v176, 16, v64
    v_and_b32 v177, 0xffff0000, v64
    v_lshlrev_b32 v178, 16, v65
    v_and_b32 v179, 0xffff0000, v65
    v_lshlrev_b32 v180, 16, v66
    v_and_b32 v181, 0xffff0000, v66
    v_lshlrev_b32 v182, 16, v67
    v_and_b32 v183, 0xffff0000, v67
    v_lshlrev_b32 v184, 16, v68
    v_and_b32 v185, 0xffff0000, v68
    v_lshlrev_b32 v186, 16, v69
    v_and_b32 v187, 0xffff0000, v69
    v_lshlrev_b32 v188, 16, v70
    v_and_b32 v189, 0xffff0000, v70
    v_lshlrev_b32 v190, 16, v71
    v_and_b32 v191, 0xffff0000, v71
    v_add_f32 v8, v80, v81
    v_add_f32 v9, v82, v83
    v_add_f32 v8, v8, v84
    v_add_f32 v9, v9, v85
    v_add_f32 v8, v8, v86
    v_add_f32 v9, v9, v87
    v_add_f32 v8, v8, v88
    v_add_f32 v9, v9, v89
    v_add_f32 v8, v8, v90
    v_add_f32 v9, v9, v91
    v_add_f32 v8, v8, v92
    v_add_f32 v9, v9, v93
    v_add_f32 v8, v8, v94
    v_add_f32 v9, v9, v95
    v_add_f32 v8, v8, v96
    v_add_f32 v9, v9, v97
    v_add_f32 v8, v8, v98
    v_add_f32 v9, v9, v99
    v_add_f32 v8, v8, v100
    v_add_f32 v9, v9, v101
    v_add_f32 v8, v8, v102
    v_add_f32 v9, v9, v103
    v_add_f32 v8, v8, v104
    v_add_f32 v9, v9, v105
    v_add_f32 v8, v8, v106
    v_add_f32 v9, v9, v107
    v_add_f32 v8, v8, v108
    v_add_f32 v9, v9, v109
    v_add_f32 v8, v8, v110
    v_add_f32 v9, v9, v111
    v_add_f32 v8, v8, v112
    v_add_f32 v9, v9, v113
    v_add_f32 v8, v8, v114
    v_add_f32 v9, v9, v115
    v_add_f32 v8, v8, v116
    v_add_f32 v9, v9, v117
    v_add_f32 v8, v8, v118
    v_add_f32 v9, v9, v119
    v_add_f32 v8, v8, v120
    v_add_f32 v9, v9, v121
    v_add_f32 v8, v8, v122
    v_add_f32 v9, v9, v123
    v_add_f32 v8, v8, v124
    v_add_f32 v9, v9, v125
    v_add_f32 v8, v8, v126
    v_add_f32 v9, v9, v127
    v_add_f32 v8, v8, v128
    v_add_f32 v9, v9, v129
    v_add_f32 v8, v8, v130
    v_add_f32 v9, v9, v131
    v_add_f32 v8, v8, v132
    v_add_f32 v9, v9, v133
    v_add_f32 v8, v8, v134
    v_add_f32 v9, v9, v135
    v_add_f32 v8, v8, v136
    v_add_f32 v9, v9, v137
    v_add_f32 v8, v8, v138
    v_add_f32 v9, v9, v139
    v_add_f32 v8, v8, v140
    v_add_f32 v9, v9, v141
    v_add_f32 v8, v8, v142
    v_add_f32 v9, v9, v143
    v_add_f32 v8, v8, v144
    v_add_f32 v9, v9, v145
    v_add_f32 v8, v8, v146
    v_add_f32 v9, v9, v147
    v_add_f32 v8, v8, v148
    v_add_f32 v9, v9, v149
    v_add_f32 v8, v8, v150
    v_add_f32 v9, v9, v151
    v_add_f32 v8, v8, v152
    v_add_f32 v9, v9, v153
    v_add_f32 v8, v8, v154
    v_add_f32 v9, v9, v155
    v_add_f32 v8, v8, v156
    v_add_f32 v9, v9, v157
    v_add_f32 v8, v8, v158
    v_add_f32 v9, v9, v159
    v_add_f32 v8, v8, v160
    v_add_f32 v9, v9, v161
    v_add_f32 v8, v8, v162
    v_add_f32 v9, v9, v163
    v_add_f32 v8, v8, v164
    v_add_f32 v9, v9, v165
    v_add_f32 v8, v8, v166
    v_add_f32 v9, v9, v167
    v_add_f32 v8, v8, v168
    v_add_f32 v9, v9, v169
    v_add_f32 v8, v8, v170
    v_add_f32 v9, v9, v171
    v_add_f32 v8, v8, v172
    v_add_f32 v9, v9, v173
    v_add_f32 v8, v8, v174
    v_add_f32 v9, v9, v175
    v_add_f32 v8, v8, v176
    v_add_f32 v9, v9, v177
    v_add_f32 v8, v8, v178
    v_add_f32 v9, v9, v179
    v_add_f32 v8, v8, v180
    v_add_f32 v9, v9, v181
    v_add_f32 v8, v8, v182
    v_add_f32 v9, v9, v183
    v_add_f32 v8, v8, v184
    v_add_f32 v9, v9, v185
    v_add_f32 v8, v8, v186
    v_add_f32 v9, v9, v187
    v_add_f32 v8, v8, v188
    v_add_f32 v9, v9, v189
    v_add_f32 v8, v8, v190
    v_add_f32 v9, v9, v191
    v_add_f32 v8, v8, v9
    v_mov_b32 v10, v8
    s_nop 1
    v_permlane32_swap_b32 v10, v8
    v_add_f32 v8, v8, v10
    v_mov_b32 v10, v8
    s_nop 1
    v_permlane16_swap_b32 v10, v8
    v_add_f32 v8, v8, v10
    v_mul_f32 v8, 991054117, v8
    v_sub_f32 v80, v80, v8
    v_sub_f32 v81, v81, v8
    v_sub_f32 v82, v82, v8
    v_sub_f32 v83, v83, v8
    v_sub_f32 v84, v84, v8
    v_sub_f32 v85, v85, v8
    v_sub_f32 v86, v86, v8
    v_sub_f32 v87, v87, v8
    v_sub_f32 v88, v88, v8
    v_sub_f32 v89, v89, v8
    v_sub_f32 v90, v90, v8
    v_sub_f32 v91, v91, v8
    v_sub_f32 v92, v92, v8
    v_sub_f32 v93, v93, v8
    v_sub_f32 v94, v94, v8
    v_sub_f32 v95, v95, v8
    v_sub_f32 v96, v96, v8
    v_sub_f32 v97, v97, v8
    v_sub_f32 v98, v98, v8
    v_sub_f32 v99, v99, v8
    v_sub_f32 v100, v100, v8
    v_sub_f32 v101, v101, v8
    v_sub_f32 v102, v102, v8
    v_sub_f32 v103, v103, v8
    v_sub_f32 v104, v104, v8
    v_sub_f32 v105, v105, v8
    v_sub_f32 v106, v106, v8
    v_sub_f32 v107, v107, v8
    v_sub_f32 v108, v108, v8
    v_sub_f32 v109, v109, v8
    v_sub_f32 v110, v110, v8
    v_sub_f32 v111, v111, v8
    v_sub_f32 v112, v112, v8
    v_sub_f32 v113, v113, v8
    v_sub_f32 v114, v114, v8
    v_sub_f32 v115, v115, v8
    v_sub_f32 v116, v116, v8
    v_sub_f32 v117, v117, v8
    v_sub_f32 v118, v118, v8
    v_sub_f32 v119, v119, v8
    v_sub_f32 v120, v120, v8
    v_sub_f32 v121, v121, v8
    v_sub_f32 v122, v122, v8
    v_sub_f32 v123, v123, v8
    v_sub_f32 v124, v124, v8
    v_sub_f32 v125, v125, v8
    v_sub_f32 v126, v126, v8
    v_sub_f32 v127, v127, v8
    v_sub_f32 v128, v128, v8
    v_sub_f32 v129, v129, v8
    v_sub_f32 v130, v130, v8
    v_sub_f32 v131, v131, v8
    v_sub_f32 v132, v132, v8
    v_sub_f32 v133, v133, v8
    v_sub_f32 v134, v134, v8
    v_sub_f32 v135, v135, v8
    v_sub_f32 v136, v136, v8
    v_sub_f32 v137, v137, v8
    v_sub_f32 v138, v138, v8
    v_sub_f32 v139, v139, v8
    v_sub_f32 v140, v140, v8
    v_sub_f32 v141, v141, v8
    v_sub_f32 v142, v142, v8
    v_sub_f32 v143, v143, v8
    v_sub_f32 v144, v144, v8
    v_sub_f32 v145, v145, v8
    v_sub_f32 v146, v146, v8
    v_sub_f32 v147, v147, v8
    v_sub_f32 v148, v148, v8
    v_sub_f32 v149, v149, v8
    v_sub_f32 v150, v150, v8
    v_sub_f32 v151, v151, v8
    v_sub_f32 v152, v152, v8
    v_sub_f32 v153, v153, v8
    v_sub_f32 v154, v154, v8
    v_sub_f32 v155, v155, v8
    v_sub_f32 v156, v156, v8
    v_sub_f32 v157, v157, v8
    v_sub_f32 v158, v158, v8
    v_sub_f32 v159, v159, v8
    v_sub_f32 v160, v160, v8
    v_sub_f32 v161, v161, v8
    v_sub_f32 v162, v162, v8
    v_sub_f32 v163, v163, v8
    v_sub_f32 v164, v164, v8
    v_sub_f32 v165, v165, v8
    v_sub_f32 v166, v166, v8
    v_sub_f32 v167, v167, v8
    v_sub_f32 v168, v168, v8
    v_sub_f32 v169, v169, v8
    v_sub_f32 v170, v170, v8
    v_sub_f32 v171, v171, v8
    v_sub_f32 v172, v172, v8
    v_sub_f32 v173, v173, v8
    v_sub_f32 v174, v174, v8
    v_sub_f32 v175, v175, v8
    v_sub_f32 v176, v176, v8
    v_sub_f32 v177, v177, v8
    v_sub_f32 v178, v178, v8
    v_sub_f32 v179, v179, v8
    v_sub_f32 v180, v180, v8
    v_sub_f32 v181, v181, v8
    v_sub_f32 v182, v182, v8
    v_sub_f32 v183, v183, v8
    v_sub_f32 v184, v184, v8
    v_sub_f32 v185, v185, v8
    v_sub_f32 v186, v186, v8
    v_sub_f32 v187, v187, v8
    v_sub_f32 v188, v188, v8
    v_sub_f32 v189, v189, v8
    v_sub_f32 v190, v190, v8
    v_sub_f32 v191, v191, v8
    v_mul_f32 v9, v80, v80
    v_mul_f32 v11, v81, v81
    v_fmac_f32 v9, v82, v82
    v_fmac_f32 v11, v83, v83
    v_fmac_f32 v9, v84, v84
    v_fmac_f32 v11, v85, v85
    v_fmac_f32 v9, v86, v86
    v_fmac_f32 v11, v87, v87
    v_fmac_f32 v9, v88, v88
    v_fmac_f32 v11, v89, v89
    v_fmac_f32 v9, v90, v90
    v_fmac_f32 v11, v91, v91
    v_fmac_f32 v9, v92, v92
    v_fmac_f32 v11, v93, v93
    v_fmac_f32 v9, v94, v94
    v_fmac_f32 v11, v95, v95
    v_fmac_f32 v9, v96, v96
    v_fmac_f32 v11, v97, v97
    v_fmac_f32 v9, v98, v98
    v_fmac_f32 v11, v99, v99
    v_fmac_f32 v9, v100, v100
    v_fmac_f32 v11, v101, v101
    v_fmac_f32 v9, v102, v102
    v_fmac_f32 v11, v103, v103
    v_fmac_f32 v9, v104, v104
    v_fmac_f32 v11, v105, v105
    v_fmac_f32 v9, v106, v106
    v_fmac_f32 v11, v107, v107
    v_fmac_f32 v9, v108, v108
    v_fmac_f32 v11, v109, v109
    v_fmac_f32 v9, v110, v110
    v_fmac_f32 v11, v111, v111
    v_fmac_f32 v9, v112, v112
    v_fmac_f32 v11, v113, v113
    v_fmac_f32 v9, v114, v114
    v_fmac_f32 v11, v115, v115
    v_fmac_f32 v9, v116, v116
    v_fmac_f32 v11, v117, v117
    v_fmac_f32 v9, v118, v118
    v_fmac_f32 v11, v119, v119
    v_fmac_f32 v9, v120, v120
    v_fmac_f32 v11, v121, v121
    v_fmac_f32 v9, v122, v122
    v_fmac_f32 v11, v123, v123
    v_fmac_f32 v9, v124, v124
    v_fmac_f32 v11, v125, v125
    v_fmac_f32 v9, v126, v126
    v_fmac_f32 v11, v127, v127
    v_fmac_f32 v9, v128, v128
    v_fmac_f32 v11, v129, v129
    v_fmac_f32 v9, v130, v130
    v_fmac_f32 v11, v131, v131
    v_fmac_f32 v9, v132, v132
    v_fmac_f32 v11, v133, v133
    v_fmac_f32 v9, v134, v134
    v_fmac_f32 v11, v135, v135
    v_fmac_f32 v9, v136, v136
    v_fmac_f32 v11, v137, v137
    v_fmac_f32 v9, v138, v138
    v_fmac_f32 v11, v139, v139
    v_fmac_f32 v9, v140, v140
    v_fmac_f32 v11, v141, v141
    v_fmac_f32 v9, v142, v142
    v_fmac_f32 v11, v143, v143
    v_fmac_f32 v9, v144, v144
    v_fmac_f32 v11, v145, v145
    v_fmac_f32 v9, v146, v146
    v_fmac_f32 v11, v147, v147
    v_fmac_f32 v9, v148, v148
    v_fmac_f32 v11, v149, v149
    v_fmac_f32 v9, v150, v150
    v_fmac_f32 v11, v151, v151
    v_fmac_f32 v9, v152, v152
    v_fmac_f32 v11, v153, v153
    v_fmac_f32 v9, v154, v154
    v_fmac_f32 v11, v155, v155
    v_fmac_f32 v9, v156, v156
    v_fmac_f32 v11, v157, v157
    v_fmac_f32 v9, v158, v158
    v_fmac_f32 v11, v159, v159
    v_fmac_f32 v9, v160, v160
    v_fmac_f32 v11, v161, v161
    v_fmac_f32 v9, v162, v162
    v_fmac_f32 v11, v163, v163
    v_fmac_f32 v9, v164, v164
    v_fmac_f32 v11, v165, v165
    v_fmac_f32 v9, v166, v166
    v_fmac_f32 v11, v167, v167
    v_fmac_f32 v9, v168, v168
    v_fmac_f32 v11, v169, v169
    v_fmac_f32 v9, v170, v170
    v_fmac_f32 v11, v171, v171
    v_fmac_f32 v9, v172, v172
    v_fmac_f32 v11, v173, v173
    v_fmac_f32 v9, v174, v174
    v_fmac_f32 v11, v175, v175
    v_fmac_f32 v9, v176, v176
    v_fmac_f32 v11, v177, v177
    v_fmac_f32 v9, v178, v178
    v_fmac_f32 v11, v179, v179
    v_fmac_f32 v9, v180, v180
    v_fmac_f32 v11, v181, v181
    v_fmac_f32 v9, v182, v182
    v_fmac_f32 v11, v183, v183
    v_fmac_f32 v9, v184, v184
    v_fmac_f32 v11, v185, v185
    v_fmac_f32 v9, v186, v186
    v_fmac_f32 v11, v187, v187
    v_fmac_f32 v9, v188, v188
    v_fmac_f32 v11, v189, v189
    v_fmac_f32 v9, v190, v190
    v_fmac_f32 v11, v191, v191
    v_add_f32 v9, v9, v11
    v_mov_b32 v10, v9
    s_nop 1
    v_permlane32_swap_b32 v10, v9
    v_add_f32 v9, v9, v10
    v_mov_b32 v10, v9
    s_nop 1
    v_permlane16_swap_b32 v10, v9
    v_add_f32 v9, v9, v10
    v_mov_b32 v10, 925353388
    v_fmac_f32 v10, 991054117, v9
    v_rsq_f32 v10, v10
    s_nop 0
    v_mul_f32 v80, v80, v10
    v_mul_f32 v81, v81, v10
    v_mul_f32 v82, v82, v10
    v_mul_f32 v83, v83, v10
    v_mul_f32 v84, v84, v10
    v_mul_f32 v85, v85, v10
    v_mul_f32 v86, v86, v10
    v_mul_f32 v87, v87, v10
    v_mul_f32 v88, v88, v10
    v_mul_f32 v89, v89, v10
    v_mul_f32 v90, v90, v10
    v_mul_f32 v91, v91, v10
    v_mul_f32 v92, v92, v10
    v_mul_f32 v93, v93, v10
    v_mul_f32 v94, v94, v10
    v_mul_f32 v95, v95, v10
    v_mul_f32 v96, v96, v10
    v_mul_f32 v97, v97, v10
    v_mul_f32 v98, v98, v10
    v_mul_f32 v99, v99, v10
    v_mul_f32 v100, v100, v10
    v_mul_f32 v101, v101, v10
    v_mul_f32 v102, v102, v10
    v_mul_f32 v103, v103, v10
    v_mul_f32 v104, v104, v10
    v_mul_f32 v105, v105, v10
    v_mul_f32 v106, v106, v10
    v_mul_f32 v107, v107, v10
    v_mul_f32 v108, v108, v10
    v_mul_f32 v109, v109, v10
    v_mul_f32 v110, v110, v10
    v_mul_f32 v111, v111, v10
    v_mul_f32 v112, v112, v10
    v_mul_f32 v113, v113, v10
    v_mul_f32 v114, v114, v10
    v_mul_f32 v115, v115, v10
    v_mul_f32 v116, v116, v10
    v_mul_f32 v117, v117, v10
    v_mul_f32 v118, v118, v10
    v_mul_f32 v119, v119, v10
    v_mul_f32 v120, v120, v10
    v_mul_f32 v121, v121, v10
    v_mul_f32 v122, v122, v10
    v_mul_f32 v123, v123, v10
    v_mul_f32 v124, v124, v10
    v_mul_f32 v125, v125, v10
    v_mul_f32 v126, v126, v10
    v_mul_f32 v127, v127, v10
    v_mul_f32 v128, v128, v10
    v_mul_f32 v129, v129, v10
    v_mul_f32 v130, v130, v10
    v_mul_f32 v131, v131, v10
    v_mul_f32 v132, v132, v10
    v_mul_f32 v133, v133, v10
    v_mul_f32 v134, v134, v10
    v_mul_f32 v135, v135, v10
    v_mul_f32 v136, v136, v10
    v_mul_f32 v137, v137, v10
    v_mul_f32 v138, v138, v10
    v_mul_f32 v139, v139, v10
    v_mul_f32 v140, v140, v10
    v_mul_f32 v141, v141, v10
    v_mul_f32 v142, v142, v10
    v_mul_f32 v143, v143, v10
    v_mul_f32 v144, v144, v10
    v_mul_f32 v145, v145, v10
    v_mul_f32 v146, v146, v10
    v_mul_f32 v147, v147, v10
    v_mul_f32 v148, v148, v10
    v_mul_f32 v149, v149, v10
    v_mul_f32 v150, v150, v10
    v_mul_f32 v151, v151, v10
    v_mul_f32 v152, v152, v10
    v_mul_f32 v153, v153, v10
    v_mul_f32 v154, v154, v10
    v_mul_f32 v155, v155, v10
    v_mul_f32 v156, v156, v10
    v_mul_f32 v157, v157, v10
    v_mul_f32 v158, v158, v10
    v_mul_f32 v159, v159, v10
    v_mul_f32 v160, v160, v10
    v_mul_f32 v161, v161, v10
    v_mul_f32 v162, v162, v10
    v_mul_f32 v163, v163, v10
    v_mul_f32 v164, v164, v10
    v_mul_f32 v165, v165, v10
    v_mul_f32 v166, v166, v10
    v_mul_f32 v167, v167, v10
    v_mul_f32 v168, v168, v10
    v_mul_f32 v169, v169, v10
    v_mul_f32 v170, v170, v10
    v_mul_f32 v171, v171, v10
    v_mul_f32 v172, v172, v10
    v_mul_f32 v173, v173, v10
    v_mul_f32 v174, v174, v10
    v_mul_f32 v175, v175, v10
    v_mul_f32 v176, v176, v10
    v_mul_f32 v177, v177, v10
    v_mul_f32 v178, v178, v10
    v_mul_f32 v179, v179, v10
    v_mul_f32 v180, v180, v10
    v_mul_f32 v181, v181, v10
    v_mul_f32 v182, v182, v10
    v_mul_f32 v183, v183, v10
    v_mul_f32 v184, v184, v10
    v_mul_f32 v185, v185, v10
    v_mul_f32 v186, v186, v10
    v_mul_f32 v187, v187, v10
    v_mul_f32 v188, v188, v10
    v_mul_f32 v189, v189, v10
    v_mul_f32 v190, v190, v10
    v_mul_f32 v191, v191, v10
    s_add_u32 s21, s20, 0
    v_cvt_pk_bf16_f32 v200, v80, v81
    v_cvt_pk_bf16_f32 v201, v88, v89
    v_cvt_pk_bf16_f32 v202, v82, v83
    v_cvt_pk_bf16_f32 v203, v90, v91
    v_cvt_pk_bf16_f32 v204, v84, v85
    v_cvt_pk_bf16_f32 v205, v92, v93
    v_cvt_pk_bf16_f32 v206, v86, v87
    v_cvt_pk_bf16_f32 v207, v94, v95
    buffer_store_dwordx4 v[200:203], v6, s[8:11], s21 offen offset:0 sc1
    buffer_store_dwordx4 v[204:207], v6, s[8:11], s21 offen offset:256 sc1
    v_cvt_pk_bf16_f32 v208, v96, v97
    v_cvt_pk_bf16_f32 v209, v104, v105
    v_cvt_pk_bf16_f32 v210, v98, v99
    v_cvt_pk_bf16_f32 v211, v106, v107
    v_cvt_pk_bf16_f32 v212, v100, v101
    v_cvt_pk_bf16_f32 v213, v108, v109
    v_cvt_pk_bf16_f32 v214, v102, v103
    v_cvt_pk_bf16_f32 v215, v110, v111
    buffer_store_dwordx4 v[208:211], v6, s[8:11], s21 offen offset:512 sc1
    buffer_store_dwordx4 v[212:215], v6, s[8:11], s21 offen offset:768 sc1
    v_cvt_pk_bf16_f32 v200, v112, v113
    v_cvt_pk_bf16_f32 v201, v120, v121
    v_cvt_pk_bf16_f32 v202, v114, v115
    v_cvt_pk_bf16_f32 v203, v122, v123
    v_cvt_pk_bf16_f32 v204, v116, v117
    v_cvt_pk_bf16_f32 v205, v124, v125
    v_cvt_pk_bf16_f32 v206, v118, v119
    v_cvt_pk_bf16_f32 v207, v126, v127
    buffer_store_dwordx4 v[200:203], v6, s[8:11], s21 offen offset:1024 sc1
    buffer_store_dwordx4 v[204:207], v6, s[8:11], s21 offen offset:1280 sc1
    v_cvt_pk_bf16_f32 v208, v128, v129
    v_cvt_pk_bf16_f32 v209, v136, v137
    v_cvt_pk_bf16_f32 v210, v130, v131
    v_cvt_pk_bf16_f32 v211, v138, v139
    v_cvt_pk_bf16_f32 v212, v132, v133
    v_cvt_pk_bf16_f32 v213, v140, v141
    v_cvt_pk_bf16_f32 v214, v134, v135
    v_cvt_pk_bf16_f32 v215, v142, v143
    buffer_store_dwordx4 v[208:211], v6, s[8:11], s21 offen offset:1536 sc1
    buffer_store_dwordx4 v[212:215], v6, s[8:11], s21 offen offset:1792 sc1
    v_cvt_pk_bf16_f32 v200, v144, v145
    v_cvt_pk_bf16_f32 v201, v152, v153
    v_cvt_pk_bf16_f32 v202, v146, v147
    v_cvt_pk_bf16_f32 v203, v154, v155
    v_cvt_pk_bf16_f32 v204, v148, v149
    v_cvt_pk_bf16_f32 v205, v156, v157
    v_cvt_pk_bf16_f32 v206, v150, v151
    v_cvt_pk_bf16_f32 v207, v158, v159
    buffer_store_dwordx4 v[200:203], v6, s[8:11], s21 offen offset:2048 sc1
    buffer_store_dwordx4 v[204:207], v6, s[8:11], s21 offen offset:2304 sc1
    v_cvt_pk_bf16_f32 v208, v160, v161
    v_cvt_pk_bf16_f32 v209, v168, v169
    v_cvt_pk_bf16_f32 v210, v162, v163
    v_cvt_pk_bf16_f32 v211, v170, v171
    v_cvt_pk_bf16_f32 v212, v164, v165
    v_cvt_pk_bf16_f32 v213, v172, v173
    v_cvt_pk_bf16_f32 v214, v166, v167
    v_cvt_pk_bf16_f32 v215, v174, v175
    buffer_store_dwordx4 v[208:211], v6, s[8:11], s21 offen offset:2560 sc1
    buffer_store_dwordx4 v[212:215], v6, s[8:11], s21 offen offset:2816 sc1
    v_cvt_pk_bf16_f32 v200, v176, v177
    v_cvt_pk_bf16_f32 v201, v184, v185
    v_cvt_pk_bf16_f32 v202, v178, v179
    v_cvt_pk_bf16_f32 v203, v186, v187
    v_cvt_pk_bf16_f32 v204, v180, v181
    v_cvt_pk_bf16_f32 v205, v188, v189
    v_cvt_pk_bf16_f32 v206, v182, v183
    v_cvt_pk_bf16_f32 v207, v190, v191
    buffer_store_dwordx4 v[200:203], v6, s[8:11], s21 offen offset:3072 sc1
    buffer_store_dwordx4 v[204:207], v6, s[8:11], s21 offen offset:3328 sc1
    v_mov_b32 v12, -1
    v_mov_b32 v13, -1
    v_mov_b32 v14, -1
    v_mov_b32 v15, -1
    s_lshl_b32 s20, s13, 8
    s_lshl_b32 s21, s14, 6
    s_add_u32 s20, s20, s21
    v_add_u32 v2, s20, v0
    v_lshlrev_b32 v2, 4, v2
    s_mov_b32 s21, 16784384
    buffer_store_dwordx4 v[12:15], v2, s[8:11], s21 offen sc1
    s_mov_b32 s21, 16915456
    buffer_store_dwordx4 v[12:15], v2, s[8:11], s21 offen sc1
    s_mov_b32 s21, 17046528
    buffer_store_dwordx4 v[12:15], v2, s[8:11], s21 offen sc1
    v_cmp_gt_u32 vcc, 58368, v2
    s_and_saveexec_b64 s[22:23], vcc
    s_cbranch_execz v4l_p1061c00
    s_mov_b32 s21, 17177600
    buffer_store_dwordx4 v[12:15], v2, s[8:11], s21 offen sc1
v4l_p1061c00:
    s_mov_b64 exec, s[22:23]
    s_mov_b32 s21, 17825792
    buffer_store_dwordx4 v[12:15], v2, s[8:11], s21 offen sc1
    s_mov_b32 s21, 17956864
    buffer_store_dwordx4 v[12:15], v2, s[8:11], s21 offen sc1
    s_mov_b32 s21, 18087936
    buffer_store_dwordx4 v[12:15], v2, s[8:11], s21 offen sc1
    s_mov_b32 s21, 18219008
    buffer_store_dwordx4 v[12:15], v2, s[8:11], s21 offen sc1
    s_mov_b32 s21, 18350080
    buffer_store_dwordx4 v[12:15], v2, s[8:11], s21 offen sc1
    v_cmp_gt_u32 vcc, 8192, v2
    s_and_saveexec_b64 s[22:23], vcc
    s_cbranch_execz v4l_p10f1000
    s_mov_b32 s21, 17764352
    buffer_store_dwordx4 v[12:15], v2, s[8:11], s21 offen sc1
v4l_p10f1000:
    s_mov_b64 exec, s[22:23]
    s_mov_b32 s21, 127991808
    buffer_store_dwordx4 v[12:15], v2, s[8:11], s21 offen sc1
    s_mov_b32 s21, 128122880
    buffer_store_dwordx4 v[12:15], v2, s[8:11], s21 offen sc1
    s_mov_b32 s21, 17308672
    buffer_store_dwordx4 v[12:15], v2, s[8:11], s21 offen sc1
    s_mov_b32 s21, 17439744
    buffer_store_dwordx4 v[12:15], v2, s[8:11], s21 offen sc1
    s_mov_b32 s21, 17570816
    buffer_store_dwordx4 v[12:15], v2, s[8:11], s21 offen sc1
    v_cmp_gt_u32 vcc, 58368, v2
    s_and_saveexec_b64 s[22:23], vcc
    s_cbranch_execz v4l_p10e1c00
    s_mov_b32 s21, 17701888
    buffer_store_dwordx4 v[12:15], v2, s[8:11], s21 offen sc1
v4l_p10e1c00:
    s_mov_b64 exec, s[22:23]
    s_mov_b32 s21, 18874368
    buffer_store_dwordx4 v[12:15], v2, s[8:11], s21 offen sc1
    s_mov_b32 s21, 19005440
    buffer_store_dwordx4 v[12:15], v2, s[8:11], s21 offen sc1
    s_mov_b32 s21, 19136512
    buffer_store_dwordx4 v[12:15], v2, s[8:11], s21 offen sc1
    s_mov_b32 s21, 19267584
    buffer_store_dwordx4 v[12:15], v2, s[8:11], s21 offen sc1
    s_mov_b32 s21, 19398656
    buffer_store_dwordx4 v[12:15], v2, s[8:11], s21 offen sc1
    s_cmp_lg_u32 s13, 31
    s_cbranch_scc1 v4_nm
    s_cmp_lg_u32 s14, 0
    s_cbranch_scc1 v4_nm
    s_load_dwordx2 s[24:25], s[0:1], 8
    s_waitcnt lgkmcnt(0)
    s_mov_b32 s56, s24
    s_and_b32 s57, s25, 0xffff
    s_mov_b32 s58, 7168
    s_mov_b32 s59, 0x20000
    v_add_u32 v2, 0, v0
    v_and_b32 v3, 7, v2
    v_lshrrev_b32 v4, 3, v2
    v_mul_u32_u24 v3, 896, v3
    v_lshl_add_u32 v3, v4, 4, v3
    buffer_load_dwordx4 v[16:19], v3, s[56:59], 0 offen
    v_add_u32 v2, 64, v0
    v_and_b32 v3, 7, v2
    v_lshrrev_b32 v4, 3, v2
    v_mul_u32_u24 v3, 896, v3
    v_lshl_add_u32 v3, v4, 4, v3
    buffer_load_dwordx4 v[20:23], v3, s[56:59], 0 offen
    v_add_u32 v2, 128, v0
    v_and_b32 v3, 7, v2
    v_lshrrev_b32 v4, 3, v2
    v_mul_u32_u24 v3, 896, v3
    v_lshl_add_u32 v3, v4, 4, v3
    buffer_load_dwordx4 v[24:27], v3, s[56:59], 0 offen
    v_add_u32 v2, 192, v0
    v_and_b32 v3, 7, v2
    v_lshrrev_b32 v4, 3, v2
    v_mul_u32_u24 v3, 896, v3
    v_lshl_add_u32 v3, v4, 4, v3
    buffer_load_dwordx4 v[28:31], v3, s[56:59], 0 offen
    v_add_u32 v2, 256, v0
    v_and_b32 v3, 7, v2
    v_lshrrev_b32 v4, 3, v2
    v_mul_u32_u24 v3, 896, v3
    v_lshl_add_u32 v3, v4, 4, v3
    buffer_load_dwordx4 v[32:35], v3, s[56:59], 0 offen
    v_add_u32 v2, 320, v0
    v_and_b32 v3, 7, v2
    v_lshrrev_b32 v4, 3, v2
    v_mul_u32_u24 v3, 896, v3
    v_lshl_add_u32 v3, v4, 4, v3
    buffer_load_dwordx4 v[36:39], v3, s[56:59], 0 offen
    v_add_u32 v2, 384, v0
    v_and_b32 v3, 7, v2
    v_lshrrev_b32 v4, 3, v2
    v_mul_u32_u24 v3, 896, v3
    v_lshl_add_u32 v3, v4, 4, v3
    buffer_load_dwordx4 v[40:43], v3, s[56:59], 0 offen
    v_lshlrev_b32 v2, 4, v0
    s_waitcnt vmcnt(0)
    s_mov_b32 s21, 16777216
    buffer_store_dwordx4 v[16:19], v2, s[8:11], s21 offen sc1
    s_mov_b32 s21, 17301504
    buffer_store_dwordx4 v[16:19], v2, s[8:11], s21 offen sc1
    s_mov_b32 s21, 16778240
    buffer_store_dwordx4 v[20:23], v2, s[8:11], s21 offen sc1
    s_mov_b32 s21, 17302528
    buffer_store_dwordx4 v[20:23], v2, s[8:11], s21 offen sc1
    s_mov_b32 s21, 16779264
    buffer_store_dwordx4 v[24:27], v2, s[8:11], s21 offen sc1
    s_mov_b32 s21, 17303552
    buffer_store_dwordx4 v[24:27], v2, s[8:11], s21 offen sc1
    s_mov_b32 s21, 16780288
    buffer_store_dwordx4 v[28:31], v2, s[8:11], s21 offen sc1
    s_mov_b32 s21, 17304576
    buffer_store_dwordx4 v[28:31], v2, s[8:11], s21 offen sc1
    s_mov_b32 s21, 16781312
    buffer_store_dwordx4 v[32:35], v2, s[8:11], s21 offen sc1
    s_mov_b32 s21, 17305600
    buffer_store_dwordx4 v[32:35], v2, s[8:11], s21 offen sc1
    s_mov_b32 s21, 16782336
    buffer_store_dwordx4 v[36:39], v2, s[8:11], s21 offen sc1
    s_mov_b32 s21, 17306624
    buffer_store_dwordx4 v[36:39], v2, s[8:11], s21 offen sc1
    s_mov_b32 s21, 16783360
    buffer_store_dwordx4 v[40:43], v2, s[8:11], s21 offen sc1
    s_mov_b32 s21, 17307648
    buffer_store_dwordx4 v[40:43], v2, s[8:11], s21 offen sc1
v4_nm:
    s_waitcnt vmcnt(0)
    s_barrier
    s_cmp_lg_u32 s14, 0
    s_cbranch_scc1 v4_xs
v4_z2:
    v_mov_b32 v250, 0
    global_load_dword v251, v250, s[6:7] offset:8 sc1
    s_waitcnt vmcnt(0)
    v_readfirstlane_b32 s20, v251
    s_nop 2
    s_cmp_lg_u32 s20, 0
    s_cbranch_scc1 v4_z2k
    s_sleep 2
    s_sub_u32 s17, s17, 1
    s_cmp_gt_i32 s17, 0
    s_cbranch_scc1 v4_z2
v4_z2k:
v4_xs:
    s_cmp_lg_u32 s14, 0
    s_cbranch_scc1 v4x_sg
    s_mov_b32 s24, 20499456
    s_mov_b64 exec, 1
    v_mov_b32 v251, 1
    buffer_atomic_add v251, off, s[8:11], s24
    s_mov_b64 exec, -1
v4x_sg:
    s_cmp_lg_u32 s14, 0
    s_cbranch_scc1 e4a2_x
    s_mov_b64 exec, 1
    v_mov_b32 v251, 1
    s_mov_b32 s22, 20462592
    buffer_atomic_add v251, off, s[8:11], s22 sc0
    s_waitcnt vmcnt(0)
    v_readfirstlane_b32 s20, v251
    s_nop 2
    s_cmp_lg_u32 s20, 255
    s_cbranch_scc1 e4a2_n
    s_mov_b64 exec, 0xff
    v_lshlrev_b32 v250, 7, v0
    v_mov_b32 v251, 1
    s_mov_b32 s22, 20496384
    buffer_store_dword v251, v250, s[8:11], s22 offen sc1
e4a2_n:
    s_mov_b64 exec, -1
e4a2_x:
    s_cmp_ge_u32 s13, 32
    s_cbranch_scc1 ch_worker_entry
    v_and_b32 v0, 63, v0
    v_lshlrev_b32 v1, 4, v0
    v_mov_b32 v2, 0x4444
    v_mov_b32 v3, 0xeeee
    v_and_b32 v4, 8, v0
    v_cmp_ne_u32 vcc, 0, v4
    s_nop 1
    v_cndmask_b32 v2, v2, v3, vcc
    s_cmp_ge_u32 s13, 16
    s_cbranch_scc1 ch_output
    s_lshl_b32 s20, s14, 11
    v_add_u32 v3, s20, v1
    s_cmp_ge_u32 s14, 3
    s_cselect_b32 s28, 7168, 0
    v_subrev_u32 v4, s28, v3
    s_cmp_ge_u32 s14, 2
    s_cselect_b32 s28, 7168, 0
    v_subrev_u32 v10, s28, v3
    s_cmp_ge_u32 s14, 1
    s_cselect_b32 s28, 7168, 0
    v_lshrrev_b32 v17, 4, v0
    v_and_b32 v18, 15, v0
    s_mul_i32 s21, s14, 3584
    s_add_u32 s21, s21, 15360
    v_lshlrev_b32 v5, 5, v18
    v_lshl_add_u32 v5, v17, 3, v5
    v_add_u32 v5, s21, v5
    v_bfe_u32 v19, v0, 2, 2
    v_and_b32 v116, 3, v0
    v_and_b32 v117, 1, v19
    v_lshrrev_b32 v118, 1, v19
    v_lshl_add_u32 v117, v118, 3, v117
    v_and_b32 v118, 1, v17
    v_lshl_add_u32 v119, v118, 2, v117
    v_lshlrev_b32 v119, 5, v119
    v_lshl_add_u32 v119, v116, 3, v119
    v_lshrrev_b32 v6, 1, v17
    v_lshl_add_u32 v6, v6, 9, v119
    v_add_u32 v6, s21, v6
    v_lshrrev_b32 v119, 1, v17
    v_lshlrev_b32 v119, 2, v119
    v_lshl_add_u32 v119, v118, 1, v119
    v_add_u32 v119, v119, v117
    v_lshlrev_b32 v119, 5, v119
    v_lshl_add_u32 v119, v116, 3, v119
    s_add_u32 s22, s21, 3072
    v_add_u32 v7, s22, v119
    s_mul_i32 s22, s14, 1792
    v_and_b32 v116, 7, v0
    v_lshlrev_b32 v116, 4, v116
    v_lshrrev_b32 v119, 1, v17
    v_lshl_add_u32 v8, v119, 8, v116
    v_lshl_add_u32 v8, v118, 3, v8
    v_add_u32 v8, s22, v8
    v_lshl_add_u32 v9, v119, 3, v116
    v_lshl_add_u32 v9, v118, 2, v9
    s_add_u32 s22, s22, 1536
    v_add_u32 v9, s22, v9
    v_lshlrev_b32 v11, 4, v18
    v_lshl_add_u32 v11, v119, 8, v11
    v_lshl_add_u32 v11, v118, 3, v11
    v_and_b32 v116, 7, v0
    s_lshl_b32 s22, s14, 10
    s_add_u32 s22, s22, 29696
    v_lshlrev_b32 v12, 7, v116
    v_lshl_add_u32 v12, v17, 4, v12
    v_add_u32 v12, s22, v12
    v_and_b32 v117, 8, v18
    v_lshl_add_u32 v12, v117, 3, v12
    s_lshl_b32 s22, s14, 8
    s_add_u32 s22, s22, 33792
    v_lshlrev_b32 v13, 5, v116
    v_lshl_add_u32 v13, v17, 4, v13
    v_add_u32 v13, s22, v13
    v_lshlrev_b32 v14, 2, v0
    v_lshrrev_b32 v116, 3, v0
    v_and_b32 v117, 7, v0
    v_lshrrev_b32 v118, 1, v117
    v_and_b32 v119, 1, v117
    v_lshl_add_u32 v15, v118, 3, v116
    v_lshlrev_b32 v15, 4, v15
    v_lshl_add_u32 v15, v119, 3, v15
    s_lshl_b32 s22, s13, 9
    v_add_u32 v15, s22, v15
    v_lshlrev_b32 v16, 4, v116
    v_lshl_add_u32 v16, v118, 2, v16
    s_lshl_b32 s22, s13, 7
    s_add_u32 s22, s22, 8192
    v_add_u32 v16, s22, v16
    s_cmp_ge_u32 s14, 1
    s_cselect_b32 s28, 7168, 0
    v_subrev_u32 v0, s28, v3
    s_lshl_b32 s40, s14, 1
    s_add_u32 s40, s40, 0
    s_cmp_ge_u32 s40, 7
    s_cselect_b32 s28, 7, 0
    s_sub_u32 s40, s40, s28
    s_lshl_b32 s40, s40, 11
    s_lshl_b32 s41, s14, 1
    s_add_u32 s41, s41, 1
    s_cmp_ge_u32 s41, 7
    s_cselect_b32 s28, 7, 0
    s_sub_u32 s41, s41, s28
    s_lshl_b32 s41, s41, 11
    s_lshl_b32 s42, s14, 1
    s_add_u32 s42, s42, 2
    s_cmp_ge_u32 s42, 7
    s_cselect_b32 s28, 7, 0
    s_sub_u32 s42, s42, s28
    s_lshl_b32 s42, s42, 11
    s_lshl_b32 s43, s14, 1
    s_add_u32 s43, s43, 3
    s_cmp_ge_u32 s43, 7
    s_cselect_b32 s28, 7, 0
    s_sub_u32 s43, s43, s28
    s_lshl_b32 s43, s43, 11
    s_lshl_b32 s44, s14, 1
    s_add_u32 s44, s44, 4
    s_cmp_ge_u32 s44, 7
    s_cselect_b32 s28, 7, 0
    s_sub_u32 s44, s44, s28
    s_lshl_b32 s44, s44, 11
    s_lshl_b32 s45, s14, 1
    s_add_u32 s45, s45, 5
    s_cmp_ge_u32 s45, 7
    s_cselect_b32 s28, 7, 0
    s_sub_u32 s45, s45, s28
    s_lshl_b32 s45, s45, 11
    s_lshl_b32 s46, s14, 1
    s_add_u32 s46, s46, 6
    s_cmp_ge_u32 s46, 7
    s_cselect_b32 s28, 7, 0
    s_sub_u32 s46, s46, s28
    s_lshl_b32 s46, s46, 11
    s_mul_i32 s20, s13, 401408
    s_add_u32 s20, s20, 2097152
    s_mul_i32 s21, s14, 100352
    s_add_u32 s20, s20, s21
    s_mov_b32 s58, s20
    s_lshl_b32 s22, s13, 7
    s_add_u32 s22, s22, 20508672
    s_cmp_lg_u32 s14, 0
    s_cbranch_scc1 sc_wg0_ok
sc_wg0:
    buffer_load_dword v19, off, s[8:11], s22 sc1
    s_waitcnt vmcnt(0)
    v_readfirstlane_b32 s20, v19
    s_nop 2
    s_cmp_ge_u32 s20, 7
    s_cbranch_scc1 sc_wg0_ok
    s_sleep 2
    s_sub_u32 s17, s17, 1
    s_cmp_gt_i32 s17, 0
    s_cbranch_scc1 sc_wg0
sc_wg0_ok:
    s_barrier
    s_cmp_lt_u32 s40, 8192
    s_cbranch_scc0 sc_wk0_0
    s_add_u32 s21, s58, s40
    buffer_load_dwordx4 a[0:3], v1, s[8:11], s21 offen
    buffer_load_dwordx4 a[4:7], v1, s[8:11], s21 offen offset:1024
    s_add_u32 s21, s58, s40
    s_add_u32 s21, s21, 14336
    buffer_load_dwordx4 a[56:59], v1, s[8:11], s21 offen
    buffer_load_dwordx4 a[60:63], v1, s[8:11], s21 offen offset:1024
    s_add_u32 s21, s58, s40
    s_add_u32 s21, s21, 28672
    buffer_load_dwordx4 a[112:115], v1, s[8:11], s21 offen
    buffer_load_dwordx4 a[116:119], v1, s[8:11], s21 offen offset:1024
    s_add_u32 s21, s58, s40
    s_add_u32 s21, s21, 43008
    buffer_load_dwordx4 a[168:171], v1, s[8:11], s21 offen
    buffer_load_dwordx4 a[172:175], v1, s[8:11], s21 offen offset:1024
    s_add_u32 s21, s58, s40
    s_add_u32 s21, s21, 57344
    buffer_load_dwordx4 a[224:227], v1, s[8:11], s21 offen
    buffer_load_dwordx4 a[228:231], v1, s[8:11], s21 offen offset:1024
    s_add_u32 s21, s58, s40
    s_add_u32 s21, s21, 71680
    buffer_load_dwordx4 v[144:147], v1, s[8:11], s21 offen
    buffer_load_dwordx4 v[148:151], v1, s[8:11], s21 offen offset:1024
    s_add_u32 s21, s58, s40
    s_add_u32 s21, s21, 86016
    buffer_load_dwordx4 v[200:203], v1, s[8:11], s21 offen
    buffer_load_dwordx4 v[204:207], v1, s[8:11], s21 offen offset:1024
    s_waitcnt vmcnt(30)
sc_wk0_0:
    s_cmp_lt_u32 s41, 8192
    s_cbranch_scc0 sc_wk0_1
    s_add_u32 s21, s58, s41
    buffer_load_dwordx4 a[8:11], v1, s[8:11], s21 offen
    buffer_load_dwordx4 a[12:15], v1, s[8:11], s21 offen offset:1024
    s_add_u32 s21, s58, s41
    s_add_u32 s21, s21, 14336
    buffer_load_dwordx4 a[64:67], v1, s[8:11], s21 offen
    buffer_load_dwordx4 a[68:71], v1, s[8:11], s21 offen offset:1024
    s_add_u32 s21, s58, s41
    s_add_u32 s21, s21, 28672
    buffer_load_dwordx4 a[120:123], v1, s[8:11], s21 offen
    buffer_load_dwordx4 a[124:127], v1, s[8:11], s21 offen offset:1024
    s_add_u32 s21, s58, s41
    s_add_u32 s21, s21, 43008
    buffer_load_dwordx4 a[176:179], v1, s[8:11], s21 offen
    buffer_load_dwordx4 a[180:183], v1, s[8:11], s21 offen offset:1024
    s_add_u32 s21, s58, s41
    s_add_u32 s21, s21, 57344
    buffer_load_dwordx4 a[232:235], v1, s[8:11], s21 offen
    buffer_load_dwordx4 a[236:239], v1, s[8:11], s21 offen offset:1024
    s_add_u32 s21, s58, s41
    s_add_u32 s21, s21, 71680
    buffer_load_dwordx4 v[152:155], v1, s[8:11], s21 offen
    buffer_load_dwordx4 v[156:159], v1, s[8:11], s21 offen offset:1024
    s_add_u32 s21, s58, s41
    s_add_u32 s21, s21, 86016
    buffer_load_dwordx4 v[208:211], v1, s[8:11], s21 offen
    buffer_load_dwordx4 v[212:215], v1, s[8:11], s21 offen offset:1024
    s_waitcnt vmcnt(30)
sc_wk0_1:
    s_cmp_lt_u32 s42, 8192
    s_cbranch_scc0 sc_wk0_2
    s_add_u32 s21, s58, s42
    buffer_load_dwordx4 a[16:19], v1, s[8:11], s21 offen
    buffer_load_dwordx4 a[20:23], v1, s[8:11], s21 offen offset:1024
    s_add_u32 s21, s58, s42
    s_add_u32 s21, s21, 14336
    buffer_load_dwordx4 a[72:75], v1, s[8:11], s21 offen
    buffer_load_dwordx4 a[76:79], v1, s[8:11], s21 offen offset:1024
    s_add_u32 s21, s58, s42
    s_add_u32 s21, s21, 28672
    buffer_load_dwordx4 a[128:131], v1, s[8:11], s21 offen
    buffer_load_dwordx4 a[132:135], v1, s[8:11], s21 offen offset:1024
    s_add_u32 s21, s58, s42
    s_add_u32 s21, s21, 43008
    buffer_load_dwordx4 a[184:187], v1, s[8:11], s21 offen
    buffer_load_dwordx4 a[188:191], v1, s[8:11], s21 offen offset:1024
    s_add_u32 s21, s58, s42
    s_add_u32 s21, s21, 57344
    buffer_load_dwordx4 a[240:243], v1, s[8:11], s21 offen
    buffer_load_dwordx4 a[244:247], v1, s[8:11], s21 offen offset:1024
    s_add_u32 s21, s58, s42
    s_add_u32 s21, s21, 71680
    buffer_load_dwordx4 v[160:163], v1, s[8:11], s21 offen
    buffer_load_dwordx4 v[164:167], v1, s[8:11], s21 offen offset:1024
    s_add_u32 s21, s58, s42
    s_add_u32 s21, s21, 86016
    buffer_load_dwordx4 v[216:219], v1, s[8:11], s21 offen
    buffer_load_dwordx4 v[220:223], v1, s[8:11], s21 offen offset:1024
    s_waitcnt vmcnt(30)
sc_wk0_2:
    s_cmp_lt_u32 s43, 8192
    s_cbranch_scc0 sc_wk0_3
    s_add_u32 s21, s58, s43
    buffer_load_dwordx4 a[24:27], v1, s[8:11], s21 offen
    buffer_load_dwordx4 a[28:31], v1, s[8:11], s21 offen offset:1024
    s_add_u32 s21, s58, s43
    s_add_u32 s21, s21, 14336
    buffer_load_dwordx4 a[80:83], v1, s[8:11], s21 offen
    buffer_load_dwordx4 a[84:87], v1, s[8:11], s21 offen offset:1024
    s_add_u32 s21, s58, s43
    s_add_u32 s21, s21, 28672
    buffer_load_dwordx4 a[136:139], v1, s[8:11], s21 offen
    buffer_load_dwordx4 a[140:143], v1, s[8:11], s21 offen offset:1024
    s_add_u32 s21, s58, s43
    s_add_u32 s21, s21, 43008
    buffer_load_dwordx4 a[192:195], v1, s[8:11], s21 offen
    buffer_load_dwordx4 a[196:199], v1, s[8:11], s21 offen offset:1024
    s_add_u32 s21, s58, s43
    s_add_u32 s21, s21, 57344
    buffer_load_dwordx4 a[248:251], v1, s[8:11], s21 offen
    buffer_load_dwordx4 a[252:255], v1, s[8:11], s21 offen offset:1024
    s_add_u32 s21, s58, s43
    s_add_u32 s21, s21, 71680
    buffer_load_dwordx4 v[168:171], v1, s[8:11], s21 offen
    buffer_load_dwordx4 v[172:175], v1, s[8:11], s21 offen offset:1024
    s_add_u32 s21, s58, s43
    s_add_u32 s21, s21, 86016
    buffer_load_dwordx4 v[224:227], v1, s[8:11], s21 offen
    buffer_load_dwordx4 v[228:231], v1, s[8:11], s21 offen offset:1024
    s_waitcnt vmcnt(30)
sc_wk0_3:
    s_cmp_lt_u32 s44, 8192
    s_cbranch_scc0 sc_wk0_4
    s_add_u32 s21, s58, s44
    buffer_load_dwordx4 a[32:35], v1, s[8:11], s21 offen
    buffer_load_dwordx4 a[36:39], v1, s[8:11], s21 offen offset:1024
    s_add_u32 s21, s58, s44
    s_add_u32 s21, s21, 14336
    buffer_load_dwordx4 a[88:91], v1, s[8:11], s21 offen
    buffer_load_dwordx4 a[92:95], v1, s[8:11], s21 offen offset:1024
    s_add_u32 s21, s58, s44
    s_add_u32 s21, s21, 28672
    buffer_load_dwordx4 a[144:147], v1, s[8:11], s21 offen
    buffer_load_dwordx4 a[148:151], v1, s[8:11], s21 offen offset:1024
    s_add_u32 s21, s58, s44
    s_add_u32 s21, s21, 43008
    buffer_load_dwordx4 a[200:203], v1, s[8:11], s21 offen
    buffer_load_dwordx4 a[204:207], v1, s[8:11], s21 offen offset:1024
    s_add_u32 s21, s58, s44
    s_add_u32 s21, s21, 57344
    buffer_load_dwordx4 v[120:123], v1, s[8:11], s21 offen
    buffer_load_dwordx4 v[124:127], v1, s[8:11], s21 offen offset:1024
    s_add_u32 s21, s58, s44
    s_add_u32 s21, s21, 71680
    buffer_load_dwordx4 v[176:179], v1, s[8:11], s21 offen
    buffer_load_dwordx4 v[180:183], v1, s[8:11], s21 offen offset:1024
    s_add_u32 s21, s58, s44
    s_add_u32 s21, s21, 86016
    buffer_load_dwordx4 v[232:235], v1, s[8:11], s21 offen
    buffer_load_dwordx4 v[236:239], v1, s[8:11], s21 offen offset:1024
    s_waitcnt vmcnt(30)
sc_wk0_4:
    s_cmp_lt_u32 s45, 8192
    s_cbranch_scc0 sc_wk0_5
    s_add_u32 s21, s58, s45
    buffer_load_dwordx4 a[40:43], v1, s[8:11], s21 offen
    buffer_load_dwordx4 a[44:47], v1, s[8:11], s21 offen offset:1024
    s_add_u32 s21, s58, s45
    s_add_u32 s21, s21, 14336
    buffer_load_dwordx4 a[96:99], v1, s[8:11], s21 offen
    buffer_load_dwordx4 a[100:103], v1, s[8:11], s21 offen offset:1024
    s_add_u32 s21, s58, s45
    s_add_u32 s21, s21, 28672
    buffer_load_dwordx4 a[152:155], v1, s[8:11], s21 offen
    buffer_load_dwordx4 a[156:159], v1, s[8:11], s21 offen offset:1024
    s_add_u32 s21, s58, s45
    s_add_u32 s21, s21, 43008
    buffer_load_dwordx4 a[208:211], v1, s[8:11], s21 offen
    buffer_load_dwordx4 a[212:215], v1, s[8:11], s21 offen offset:1024
    s_add_u32 s21, s58, s45
    s_add_u32 s21, s21, 57344
    buffer_load_dwordx4 v[128:131], v1, s[8:11], s21 offen
    buffer_load_dwordx4 v[132:135], v1, s[8:11], s21 offen offset:1024
    s_add_u32 s21, s58, s45
    s_add_u32 s21, s21, 71680
    buffer_load_dwordx4 v[184:187], v1, s[8:11], s21 offen
    buffer_load_dwordx4 v[188:191], v1, s[8:11], s21 offen offset:1024
    s_add_u32 s21, s58, s45
    s_add_u32 s21, s21, 86016
    buffer_load_dwordx4 v[240:243], v1, s[8:11], s21 offen
    buffer_load_dwordx4 v[244:247], v1, s[8:11], s21 offen offset:1024
    s_waitcnt vmcnt(30)
sc_wk0_5:
    s_cmp_lt_u32 s46, 8192
    s_cbranch_scc0 sc_wk0_6
    s_add_u32 s21, s58, s46
    buffer_load_dwordx4 a[48:51], v1, s[8:11], s21 offen
    buffer_load_dwordx4 a[52:55], v1, s[8:11], s21 offen offset:1024
    s_add_u32 s21, s58, s46
    s_add_u32 s21, s21, 14336
    buffer_load_dwordx4 a[104:107], v1, s[8:11], s21 offen
    buffer_load_dwordx4 a[108:111], v1, s[8:11], s21 offen offset:1024
    s_add_u32 s21, s58, s46
    s_add_u32 s21, s21, 28672
    buffer_load_dwordx4 a[160:163], v1, s[8:11], s21 offen
    buffer_load_dwordx4 a[164:167], v1, s[8:11], s21 offen offset:1024
    s_add_u32 s21, s58, s46
    s_add_u32 s21, s21, 43008
    buffer_load_dwordx4 a[216:219], v1, s[8:11], s21 offen
    buffer_load_dwordx4 a[220:223], v1, s[8:11], s21 offen offset:1024
    s_add_u32 s21, s58, s46
    s_add_u32 s21, s21, 57344
    buffer_load_dwordx4 v[136:139], v1, s[8:11], s21 offen
    buffer_load_dwordx4 v[140:143], v1, s[8:11], s21 offen offset:1024
    s_add_u32 s21, s58, s46
    s_add_u32 s21, s21, 71680
    buffer_load_dwordx4 v[192:195], v1, s[8:11], s21 offen
    buffer_load_dwordx4 v[196:199], v1, s[8:11], s21 offen offset:1024
    s_add_u32 s21, s58, s46
    s_add_u32 s21, s21, 86016
    buffer_load_dwordx4 v[248:251], v1, s[8:11], s21 offen
    buffer_load_dwordx4 v[252:255], v1, s[8:11], s21 offen offset:1024
    s_waitcnt vmcnt(30)
sc_wk0_6:
    s_lshl_b32 s22, s13, 7
    s_add_u32 s22, s22, 20510720
    s_cmp_lg_u32 s14, 0
    s_cbranch_scc1 sc_wg1_ok
sc_wg1:
    buffer_load_dword v19, off, s[8:11], s22 sc1
    s_waitcnt vmcnt(0)
    v_readfirstlane_b32 s20, v19
    s_nop 2
    s_cmp_ge_u32 s20, 7
    s_cbranch_scc1 sc_wg1_ok
    s_sleep 2
    s_sub_u32 s17, s17, 1
    s_cmp_gt_i32 s17, 0
    s_cbranch_scc1 sc_wg1
sc_wg1_ok:
    s_barrier
    s_cmp_lt_u32 s40, 8192
    s_cbranch_scc1 sc_wk1_0
    s_add_u32 s21, s58, s40
    buffer_load_dwordx4 a[0:3], v1, s[8:11], s21 offen
    buffer_load_dwordx4 a[4:7], v1, s[8:11], s21 offen offset:1024
    s_add_u32 s21, s58, s40
    s_add_u32 s21, s21, 14336
    buffer_load_dwordx4 a[56:59], v1, s[8:11], s21 offen
    buffer_load_dwordx4 a[60:63], v1, s[8:11], s21 offen offset:1024
    s_add_u32 s21, s58, s40
    s_add_u32 s21, s21, 28672
    buffer_load_dwordx4 a[112:115], v1, s[8:11], s21 offen
    buffer_load_dwordx4 a[116:119], v1, s[8:11], s21 offen offset:1024
    s_add_u32 s21, s58, s40
    s_add_u32 s21, s21, 43008
    buffer_load_dwordx4 a[168:171], v1, s[8:11], s21 offen
    buffer_load_dwordx4 a[172:175], v1, s[8:11], s21 offen offset:1024
    s_add_u32 s21, s58, s40
    s_add_u32 s21, s21, 57344
    buffer_load_dwordx4 a[224:227], v1, s[8:11], s21 offen
    buffer_load_dwordx4 a[228:231], v1, s[8:11], s21 offen offset:1024
    s_add_u32 s21, s58, s40
    s_add_u32 s21, s21, 71680
    buffer_load_dwordx4 v[144:147], v1, s[8:11], s21 offen
    buffer_load_dwordx4 v[148:151], v1, s[8:11], s21 offen offset:1024
    s_add_u32 s21, s58, s40
    s_add_u32 s21, s21, 86016
    buffer_load_dwordx4 v[200:203], v1, s[8:11], s21 offen
    buffer_load_dwordx4 v[204:207], v1, s[8:11], s21 offen offset:1024
    s_waitcnt vmcnt(30)
sc_wk1_0:
    s_cmp_lt_u32 s41, 8192
    s_cbranch_scc1 sc_wk1_1
    s_add_u32 s21, s58, s41
    buffer_load_dwordx4 a[8:11], v1, s[8:11], s21 offen
    buffer_load_dwordx4 a[12:15], v1, s[8:11], s21 offen offset:1024
    s_add_u32 s21, s58, s41
    s_add_u32 s21, s21, 14336
    buffer_load_dwordx4 a[64:67], v1, s[8:11], s21 offen
    buffer_load_dwordx4 a[68:71], v1, s[8:11], s21 offen offset:1024
    s_add_u32 s21, s58, s41
    s_add_u32 s21, s21, 28672
    buffer_load_dwordx4 a[120:123], v1, s[8:11], s21 offen
    buffer_load_dwordx4 a[124:127], v1, s[8:11], s21 offen offset:1024
    s_add_u32 s21, s58, s41
    s_add_u32 s21, s21, 43008
    buffer_load_dwordx4 a[176:179], v1, s[8:11], s21 offen
    buffer_load_dwordx4 a[180:183], v1, s[8:11], s21 offen offset:1024
    s_add_u32 s21, s58, s41
    s_add_u32 s21, s21, 57344
    buffer_load_dwordx4 a[232:235], v1, s[8:11], s21 offen
    buffer_load_dwordx4 a[236:239], v1, s[8:11], s21 offen offset:1024
    s_add_u32 s21, s58, s41
    s_add_u32 s21, s21, 71680
    buffer_load_dwordx4 v[152:155], v1, s[8:11], s21 offen
    buffer_load_dwordx4 v[156:159], v1, s[8:11], s21 offen offset:1024
    s_add_u32 s21, s58, s41
    s_add_u32 s21, s21, 86016
    buffer_load_dwordx4 v[208:211], v1, s[8:11], s21 offen
    buffer_load_dwordx4 v[212:215], v1, s[8:11], s21 offen offset:1024
    s_waitcnt vmcnt(30)
sc_wk1_1:
    s_cmp_lt_u32 s42, 8192
    s_cbranch_scc1 sc_wk1_2
    s_add_u32 s21, s58, s42
    buffer_load_dwordx4 a[16:19], v1, s[8:11], s21 offen
    buffer_load_dwordx4 a[20:23], v1, s[8:11], s21 offen offset:1024
    s_add_u32 s21, s58, s42
    s_add_u32 s21, s21, 14336
    buffer_load_dwordx4 a[72:75], v1, s[8:11], s21 offen
    buffer_load_dwordx4 a[76:79], v1, s[8:11], s21 offen offset:1024
    s_add_u32 s21, s58, s42
    s_add_u32 s21, s21, 28672
    buffer_load_dwordx4 a[128:131], v1, s[8:11], s21 offen
    buffer_load_dwordx4 a[132:135], v1, s[8:11], s21 offen offset:1024
    s_add_u32 s21, s58, s42
    s_add_u32 s21, s21, 43008
    buffer_load_dwordx4 a[184:187], v1, s[8:11], s21 offen
    buffer_load_dwordx4 a[188:191], v1, s[8:11], s21 offen offset:1024
    s_add_u32 s21, s58, s42
    s_add_u32 s21, s21, 57344
    buffer_load_dwordx4 a[240:243], v1, s[8:11], s21 offen
    buffer_load_dwordx4 a[244:247], v1, s[8:11], s21 offen offset:1024
    s_add_u32 s21, s58, s42
    s_add_u32 s21, s21, 71680
    buffer_load_dwordx4 v[160:163], v1, s[8:11], s21 offen
    buffer_load_dwordx4 v[164:167], v1, s[8:11], s21 offen offset:1024
    s_add_u32 s21, s58, s42
    s_add_u32 s21, s21, 86016
    buffer_load_dwordx4 v[216:219], v1, s[8:11], s21 offen
    buffer_load_dwordx4 v[220:223], v1, s[8:11], s21 offen offset:1024
    s_waitcnt vmcnt(30)
sc_wk1_2:
    s_cmp_lt_u32 s43, 8192
    s_cbranch_scc1 sc_wk1_3
    s_add_u32 s21, s58, s43
    buffer_load_dwordx4 a[24:27], v1, s[8:11], s21 offen
    buffer_load_dwordx4 a[28:31], v1, s[8:11], s21 offen offset:1024
    s_add_u32 s21, s58, s43
    s_add_u32 s21, s21, 14336
    buffer_load_dwordx4 a[80:83], v1, s[8:11], s21 offen
    buffer_load_dwordx4 a[84:87], v1, s[8:11], s21 offen offset:1024
    s_add_u32 s21, s58, s43
    s_add_u32 s21, s21, 28672
    buffer_load_dwordx4 a[136:139], v1, s[8:11], s21 offen
    buffer_load_dwordx4 a[140:143], v1, s[8:11], s21 offen offset:1024
    s_add_u32 s21, s58, s43
    s_add_u32 s21, s21, 43008
    buffer_load_dwordx4 a[192:195], v1, s[8:11], s21 offen
    buffer_load_dwordx4 a[196:199], v1, s[8:11], s21 offen offset:1024
    s_add_u32 s21, s58, s43
    s_add_u32 s21, s21, 57344
    buffer_load_dwordx4 a[248:251], v1, s[8:11], s21 offen
    buffer_load_dwordx4 a[252:255], v1, s[8:11], s21 offen offset:1024
    s_add_u32 s21, s58, s43
    s_add_u32 s21, s21, 71680
    buffer_load_dwordx4 v[168:171], v1, s[8:11], s21 offen
    buffer_load_dwordx4 v[172:175], v1, s[8:11], s21 offen offset:1024
    s_add_u32 s21, s58, s43
    s_add_u32 s21, s21, 86016
    buffer_load_dwordx4 v[224:227], v1, s[8:11], s21 offen
    buffer_load_dwordx4 v[228:231], v1, s[8:11], s21 offen offset:1024
    s_waitcnt vmcnt(30)
sc_wk1_3:
    s_cmp_lt_u32 s44, 8192
    s_cbranch_scc1 sc_wk1_4
    s_add_u32 s21, s58, s44
    buffer_load_dwordx4 a[32:35], v1, s[8:11], s21 offen
    buffer_load_dwordx4 a[36:39], v1, s[8:11], s21 offen offset:1024
    s_add_u32 s21, s58, s44
    s_add_u32 s21, s21, 14336
    buffer_load_dwordx4 a[88:91], v1, s[8:11], s21 offen
    buffer_load_dwordx4 a[92:95], v1, s[8:11], s21 offen offset:1024
    s_add_u32 s21, s58, s44
    s_add_u32 s21, s21, 28672
    buffer_load_dwordx4 a[144:147], v1, s[8:11], s21 offen
    buffer_load_dwordx4 a[148:151], v1, s[8:11], s21 offen offset:1024
    s_add_u32 s21, s58, s44
    s_add_u32 s21, s21, 43008
    buffer_load_dwordx4 a[200:203], v1, s[8:11], s21 offen
    buffer_load_dwordx4 a[204:207], v1, s[8:11], s21 offen offset:1024
    s_add_u32 s21, s58, s44
    s_add_u32 s21, s21, 57344
    buffer_load_dwordx4 v[120:123], v1, s[8:11], s21 offen
    buffer_load_dwordx4 v[124:127], v1, s[8:11], s21 offen offset:1024
    s_add_u32 s21, s58, s44
    s_add_u32 s21, s21, 71680
    buffer_load_dwordx4 v[176:179], v1, s[8:11], s21 offen
    buffer_load_dwordx4 v[180:183], v1, s[8:11], s21 offen offset:1024
    s_add_u32 s21, s58, s44
    s_add_u32 s21, s21, 86016
    buffer_load_dwordx4 v[232:235], v1, s[8:11], s21 offen
    buffer_load_dwordx4 v[236:239], v1, s[8:11], s21 offen offset:1024
    s_waitcnt vmcnt(30)
sc_wk1_4:
    s_cmp_lt_u32 s45, 8192
    s_cbranch_scc1 sc_wk1_5
    s_add_u32 s21, s58, s45
    buffer_load_dwordx4 a[40:43], v1, s[8:11], s21 offen
    buffer_load_dwordx4 a[44:47], v1, s[8:11], s21 offen offset:1024
    s_add_u32 s21, s58, s45
    s_add_u32 s21, s21, 14336
    buffer_load_dwordx4 a[96:99], v1, s[8:11], s21 offen
    buffer_load_dwordx4 a[100:103], v1, s[8:11], s21 offen offset:1024
    s_add_u32 s21, s58, s45
    s_add_u32 s21, s21, 28672
    buffer_load_dwordx4 a[152:155], v1, s[8:11], s21 offen
    buffer_load_dwordx4 a[156:159], v1, s[8:11], s21 offen offset:1024
    s_add_u32 s21, s58, s45
    s_add_u32 s21, s21, 43008
    buffer_load_dwordx4 a[208:211], v1, s[8:11], s21 offen
    buffer_load_dwordx4 a[212:215], v1, s[8:11], s21 offen offset:1024
    s_add_u32 s21, s58, s45
    s_add_u32 s21, s21, 57344
    buffer_load_dwordx4 v[128:131], v1, s[8:11], s21 offen
    buffer_load_dwordx4 v[132:135], v1, s[8:11], s21 offen offset:1024
    s_add_u32 s21, s58, s45
    s_add_u32 s21, s21, 71680
    buffer_load_dwordx4 v[184:187], v1, s[8:11], s21 offen
    buffer_load_dwordx4 v[188:191], v1, s[8:11], s21 offen offset:1024
    s_add_u32 s21, s58, s45
    s_add_u32 s21, s21, 86016
    buffer_load_dwordx4 v[240:243], v1, s[8:11], s21 offen
    buffer_load_dwordx4 v[244:247], v1, s[8:11], s21 offen offset:1024
    s_waitcnt vmcnt(30)
sc_wk1_5:
    s_cmp_lt_u32 s46, 8192
    s_cbranch_scc1 sc_wk1_6
    s_add_u32 s21, s58, s46
    buffer_load_dwordx4 a[48:51], v1, s[8:11], s21 offen
    buffer_load_dwordx4 a[52:55], v1, s[8:11], s21 offen offset:1024
    s_add_u32 s21, s58, s46
    s_add_u32 s21, s21, 14336
    buffer_load_dwordx4 a[104:107], v1, s[8:11], s21 offen
    buffer_load_dwordx4 a[108:111], v1, s[8:11], s21 offen offset:1024
    s_add_u32 s21, s58, s46
    s_add_u32 s21, s21, 28672
    buffer_load_dwordx4 a[160:163], v1, s[8:11], s21 offen
    buffer_load_dwordx4 a[164:167], v1, s[8:11], s21 offen offset:1024
    s_add_u32 s21, s58, s46
    s_add_u32 s21, s21, 43008
    buffer_load_dwordx4 a[216:219], v1, s[8:11], s21 offen
    buffer_load_dwordx4 a[220:223], v1, s[8:11], s21 offen offset:1024
    s_add_u32 s21, s58, s46
    s_add_u32 s21, s21, 57344
    buffer_load_dwordx4 v[136:139], v1, s[8:11], s21 offen
    buffer_load_dwordx4 v[140:143], v1, s[8:11], s21 offen offset:1024
    s_add_u32 s21, s58, s46
    s_add_u32 s21, s21, 71680
    buffer_load_dwordx4 v[192:195], v1, s[8:11], s21 offen
    buffer_load_dwordx4 v[196:199], v1, s[8:11], s21 offen offset:1024
    s_add_u32 s21, s58, s46
    s_add_u32 s21, s21, 86016
    buffer_load_dwordx4 v[248:251], v1, s[8:11], s21 offen
    buffer_load_dwordx4 v[252:255], v1, s[8:11], s21 offen offset:1024
    s_waitcnt vmcnt(30)
sc_wk1_6:
    s_mov_b32 s22, 20499456
    s_cmp_lg_u32 s14, 0
    s_cbranch_scc1 sc_wx_ok
sc_wx:
    buffer_load_dword v19, off, s[8:11], s22 sc1
    s_waitcnt vmcnt(0)
    v_readfirstlane_b32 s20, v19
    s_nop 2
    s_cmp_ge_u32 s20, 32
    s_cbranch_scc1 sc_wx_ok
    s_sleep 2
    s_sub_u32 s17, s17, 1
    s_cmp_gt_i32 s17, 0
    s_cbranch_scc1 sc_wx
sc_wx_ok:
    s_barrier
    s_lshr_b32 s47, s40, 1
    s_lshr_b32 s48, s41, 1
    s_mul_i32 s49, s14, 3584
    s_add_u32 s49, s49, 0
    s_add_u32 s21, s49, 0
    buffer_load_dwordx4 v[76:79], v1, s[8:11], s21 offen offset:0
    buffer_load_dwordx4 v[80:83], v1, s[8:11], s21 offen offset:1024
    buffer_load_dwordx4 v[84:87], v1, s[8:11], s21 offen offset:2048
    buffer_load_dwordx2 v[88:89], v11, s[8:11], s21 offen offset:3072
    s_add_u32 s21, s49, 14336
    buffer_load_dwordx4 v[90:93], v1, s[8:11], s21 offen offset:0
    buffer_load_dwordx4 v[94:97], v1, s[8:11], s21 offen offset:1024
    buffer_load_dwordx4 v[98:101], v1, s[8:11], s21 offen offset:2048
    buffer_load_dwordx2 v[102:103], v11, s[8:11], s21 offen offset:3072
    s_add_u32 s49, s49, 28672
    s_cmp_lg_u32 s14, 0
    s_cbranch_scc1 sc_mode_wait
    s_mov_b64 exec, 1
    v_mov_b32 v17, 0
sc_mode_poll:
    global_load_dwordx2 v[18:19], v17, s[6:7] sc1
    s_waitcnt vmcnt(0)
    v_readfirstlane_b32 s20, v18
    v_readfirstlane_b32 s21, v19
    s_nop 2
    s_add_u32 s21, s21, s20
    s_cmp_ge_u32 s21, 32
    s_cselect_b32 s21, 256, 0
    s_mov_b32 s15, 0
    s_cmp_ge_u32 s20, 32
    s_cbranch_scc1 sc_mode_pub
    s_mov_b32 s15, 1
    s_cmp_ge_u32 s21, 256
    s_cbranch_scc1 sc_mode_pub
    s_sleep 2
    s_sub_u32 s17, s17, 1
    s_cmp_gt_i32 s17, 0
    s_cbranch_scc1 sc_mode_poll
sc_mode_pub:
    s_mov_b64 exec, 1
    v_mov_b32 v18, s15
    v_mov_b32 v19, 105476
    ds_write_b32 v19, v18
    s_waitcnt lgkmcnt(0)
    s_mov_b64 exec, -1
sc_mode_wait:
    s_barrier
    v_mov_b32 v19, 105476
    ds_read_b32 v18, v19
    s_waitcnt lgkmcnt(0)
    v_readfirstlane_b32 s15, v18
    s_nop 3
    s_mul_i32 s30, s15, 524288
    s_add_u32 s30, s30, 16777216
    s_mul_i32 s31, s15, 1048576
    s_add_u32 s31, s31, 17825792
    s_waitcnt vmcnt(0)
    s_mov_b32 s16, 0
    s_add_u32 s25, s30, s47
    s_add_u32 s26, s30, s48
    s_mov_b32 s27, 17825792
    s_mov_b32 s29, 18874368
    s_cmp_eq_u32 s14, 0
    s_cselect_b32 s100, 26, 26
    s_sub_u32 s53, s14, 1
    s_mul_i32 s53, s53, 10
    s_min_u32 s53, s53, 18
    s_lshl_b32 s53, s53, 10
    s_mul_i32 s54, s13, 28672
    s_add_u32 s53, s53, s54
    s_add_u32 s54, s53, 66650112
    s_add_u32 s53, s53, 38666240
    v_mov_b32 v48, 0
    v_mov_b32 v49, 0
    v_mov_b32 v50, 0
    v_mov_b32 v51, 0
    v_mov_b32 v52, 0
    v_mov_b32 v53, 0
    v_mov_b32 v54, 0
    v_mov_b32 v55, 0
    v_mov_b32 v56, 0
    v_mov_b32 v57, 0
    v_mov_b32 v58, 0
    v_mov_b32 v59, 0
    v_mov_b32 v60, 0
    v_mov_b32 v61, 0
    v_mov_b32 v62, 0
    v_mov_b32 v63, 0
    v_mov_b32 v64, 0
    v_mov_b32 v65, 0
    v_mov_b32 v66, 0
    v_mov_b32 v67, 0
    v_mov_b32 v68, 0
    v_mov_b32 v69, 0
    v_mov_b32 v70, 0
    v_mov_b32 v71, 0
    v_mov_b32 v72, 0
    v_mov_b32 v73, 0
    v_mov_b32 v74, 0
    v_mov_b32 v75, 0
    v_mov_b32 v111, 0
    s_nop 1
sc_loop:
    buffer_load_dwordx4 v[20:23], v1, s[8:11], s25 offen sc1
    buffer_load_dwordx4 v[24:27], v1, s[8:11], s26 offen sc1
    s_sleep 2
sc_pollm:
    buffer_load_dwordx4 v[20:23], v1, s[8:11], s25 offen sc1
    buffer_load_dwordx4 v[24:27], v1, s[8:11], s26 offen sc1
    s_waitcnt vmcnt(2)
    v_max3_u32 v104, v20, v21, v22
    v_max3_u32 v105, v23, v24, v25
    v_max3_u32 v104, v104, v105, v26
    v_max_u32 v104, v104, v27
    v_cmp_eq_u32 vcc, -1, v104
    s_cbranch_vccz sc_pollm_ok
    s_sub_u32 s17, s17, 1
    s_cmp_gt_i32 s17, 0
    s_cbranch_scc1 sc_pollm
sc_pollm_ok:
    ds_write_b128 v3, v[20:23]
    v_smfmac_f32_16x16x64_bf16 v[48:51], v[20:23], a[0:7], v2
    ds_write_b128 v3, v[24:27] offset:1024
    v_smfmac_f32_16x16x64_bf16 v[52:55], v[20:23], a[56:63], v2
    v_smfmac_f32_16x16x64_bf16 v[56:59], v[20:23], a[112:119], v2
    v_smfmac_f32_16x16x64_bf16 v[60:63], v[20:23], a[168:175], v2
    v_smfmac_f32_16x16x64_bf16 v[64:67], v[20:23], a[224:231], v2
    v_smfmac_f32_16x16x64_bf16 v[68:71], v[20:23], v[144:151], v2
    v_smfmac_f32_16x16x64_bf16 v[72:75], v[20:23], v[200:207], v2
    s_waitcnt lgkmcnt(0)
    s_barrier
    ds_read_b128 v[28:31], v4 offset:2048
    v_smfmac_f32_16x16x64_bf16 v[48:51], v[24:27], a[8:15], v2
    ds_read_b128 v[32:35], v10 offset:3072
    v_smfmac_f32_16x16x64_bf16 v[52:55], v[24:27], a[64:71], v2
    ds_read_b128 v[36:39], v10 offset:4096
    v_smfmac_f32_16x16x64_bf16 v[56:59], v[24:27], a[120:127], v2
    ds_read_b128 v[40:43], v0 offset:5120
    v_smfmac_f32_16x16x64_bf16 v[60:63], v[24:27], a[176:183], v2
    ds_read_b128 v[44:47], v0 offset:6144
    v_smfmac_f32_16x16x64_bf16 v[64:67], v[24:27], a[232:239], v2
    ds_read2_b32 v[18:19], v9 offset0:0 offset1:32
    v_smfmac_f32_16x16x64_bf16 v[68:71], v[24:27], v[152:159], v2
    v_smfmac_f32_16x16x64_bf16 v[72:75], v[24:27], v[208:215], v2
    s_waitcnt lgkmcnt(5)
    v_smfmac_f32_16x16x64_bf16 v[48:51], v[28:31], a[16:23], v2
    v_add_u32 v17, 1024, v8
    s_waitcnt lgkmcnt(4)
    v_smfmac_f32_16x16x64_bf16 v[48:51], v[32:35], a[24:31], v2
    s_waitcnt lgkmcnt(3)
    v_smfmac_f32_16x16x64_bf16 v[48:51], v[36:39], a[32:39], v2
    s_waitcnt lgkmcnt(2)
    v_smfmac_f32_16x16x64_bf16 v[48:51], v[40:43], a[40:47], v2
    s_waitcnt lgkmcnt(1)
    v_smfmac_f32_16x16x64_bf16 v[48:51], v[44:47], a[48:55], v2
    v_smfmac_f32_16x16x64_bf16 v[52:55], v[28:31], a[72:79], v2
    s_nop 0
    v_smfmac_f32_16x16x64_bf16 v[52:55], v[32:35], a[80:87], v2
    s_nop 0
    v_smfmac_f32_16x16x64_bf16 v[52:55], v[36:39], a[88:95], v2
    s_nop 0
    v_smfmac_f32_16x16x64_bf16 v[52:55], v[40:43], a[96:103], v2
    s_nop 0
    v_cvt_pk_bf16_f32 v116, v48, v49
    v_smfmac_f32_16x16x64_bf16 v[52:55], v[44:47], a[104:111], v2
    v_cvt_pk_bf16_f32 v117, v50, v51
    v_smfmac_f32_16x16x64_bf16 v[56:59], v[28:31], a[128:135], v2
    ds_write_b64 v5, v[116:117] offset:0
    v_smfmac_f32_16x16x64_bf16 v[56:59], v[32:35], a[136:143], v2
    s_nop 0
    v_smfmac_f32_16x16x64_bf16 v[56:59], v[36:39], a[144:151], v2
    s_nop 0
    v_smfmac_f32_16x16x64_bf16 v[56:59], v[40:43], a[152:159], v2
    v_cvt_pk_bf16_f32 v118, v52, v53
    v_smfmac_f32_16x16x64_bf16 v[56:59], v[44:47], a[160:167], v2
    v_cvt_pk_bf16_f32 v119, v54, v55
    v_smfmac_f32_16x16x64_bf16 v[60:63], v[28:31], a[184:191], v2
    ds_write_b64 v5, v[118:119] offset:512
    v_smfmac_f32_16x16x64_bf16 v[60:63], v[32:35], a[192:199], v2
    ds_read_b64_tr_b16 v[48:49], v6 offset:0
    v_smfmac_f32_16x16x64_bf16 v[60:63], v[36:39], a[200:207], v2
    ds_read_b64_tr_b16 v[50:51], v6 offset:64
    v_smfmac_f32_16x16x64_bf16 v[60:63], v[40:43], a[208:215], v2
    ds_read2_b32 v[52:53], v8 offset0:0 offset1:32
    v_smfmac_f32_16x16x64_bf16 v[60:63], v[44:47], a[216:223], v2
    ds_read2_b32 v[54:55], v8 offset0:1 offset1:33
    v_smfmac_f32_16x16x64_bf16 v[64:67], v[28:31], a[240:247], v2
    v_cvt_pk_bf16_f32 v116, v56, v57
    v_smfmac_f32_16x16x64_bf16 v[64:67], v[32:35], a[248:255], v2
    v_cvt_pk_bf16_f32 v117, v58, v59
    v_smfmac_f32_16x16x64_bf16 v[64:67], v[36:39], v[120:127], v2
    ds_write_b64 v5, v[116:117] offset:1024
    v_smfmac_f32_16x16x64_bf16 v[64:67], v[40:43], v[128:135], v2
    v_cvt_pk_bf16_f32 v118, v60, v61
    v_smfmac_f32_16x16x64_bf16 v[64:67], v[44:47], v[136:143], v2
    v_cvt_pk_bf16_f32 v119, v62, v63
    v_smfmac_f32_16x16x64_bf16 v[68:71], v[28:31], v[160:167], v2
    ds_write_b64 v5, v[118:119] offset:1536
    v_smfmac_f32_16x16x64_bf16 v[68:71], v[32:35], v[168:175], v2
    ds_read_b64_tr_b16 v[56:57], v6 offset:1024
    v_smfmac_f32_16x16x64_bf16 v[68:71], v[36:39], v[176:183], v2
    ds_read_b64_tr_b16 v[58:59], v6 offset:1088
    v_smfmac_f32_16x16x64_bf16 v[68:71], v[40:43], v[184:191], v2
    ds_read2_b32 v[60:61], v8 offset0:128 offset1:160
    v_smfmac_f32_16x16x64_bf16 v[68:71], v[44:47], v[192:199], v2
    ds_read2_b32 v[62:63], v8 offset0:129 offset1:161
    v_smfmac_f32_16x16x64_bf16 v[72:75], v[28:31], v[216:223], v2
    v_cvt_pk_bf16_f32 v116, v64, v65
    v_smfmac_f32_16x16x64_bf16 v[72:75], v[32:35], v[224:231], v2
    v_cvt_pk_bf16_f32 v117, v66, v67
    v_smfmac_f32_16x16x64_bf16 v[72:75], v[36:39], v[232:239], v2
    ds_write_b64 v5, v[116:117] offset:2048
    v_smfmac_f32_16x16x64_bf16 v[72:75], v[40:43], v[240:247], v2
    v_cvt_pk_bf16_f32 v118, v68, v69
    v_smfmac_f32_16x16x64_bf16 v[72:75], v[44:47], v[248:255], v2
    v_cvt_pk_bf16_f32 v119, v70, v71
    s_waitcnt lgkmcnt(1)
    v_mfma_f32_16x16x32_bf16 v[108:111], v[76:79], v[48:51], 0
    ds_write_b64 v5, v[118:119] offset:2560
    v_mfma_f32_16x16x32_bf16 v[112:115], v[90:93], v[48:51], 0
    ds_read_b64_tr_b16 v[64:65], v6 offset:2048
    ds_read_b64_tr_b16 v[66:67], v6 offset:2112
    ds_read2_b32 v[68:69], v17 offset0:0 offset1:32
    ds_read2_b32 v[70:71], v17 offset0:1 offset1:33
    v_cvt_pk_bf16_f32 v116, v72, v73
    v_cvt_pk_bf16_f32 v117, v74, v75
    ds_write_b64 v5, v[116:117] offset:3072
    ds_read_b64_tr_b16 v[72:73], v7
    v_mfma_f32_16x16x32_bf16 v[104:107], v[52:55], v[48:51], 0
    v_mfma_f32_16x16x32_bf16 v[108:111], v[80:83], v[56:59], v[108:111]
    v_mfma_f32_16x16x32_bf16 v[112:115], v[94:97], v[56:59], v[112:115]
    v_mfma_f32_16x16x32_bf16 v[104:107], v[60:63], v[56:59], v[104:107]
    s_waitcnt lgkmcnt(2)
    v_mfma_f32_16x16x32_bf16 v[108:111], v[84:87], v[64:67], v[108:111]
    v_mfma_f32_16x16x32_bf16 v[112:115], v[98:101], v[64:67], v[112:115]
    v_mfma_f32_16x16x32_bf16 v[104:107], v[68:71], v[64:67], v[104:107]
    s_waitcnt lgkmcnt(0)
    v_mfma_f32_16x16x16_bf16 v[108:111], v[88:89], v[72:73], v[108:111]
    v_mfma_f32_16x16x16_bf16 v[112:115], v[102:103], v[72:73], v[112:115]
    v_mfma_f32_16x16x16_bf16 v[104:107], v[18:19], v[72:73], v[104:107]
    s_nop 5
    v_add_f32_dpp v108, v108, v108 row_ror:8 row_mask:0xf bank_mask:0x3
    v_add_f32_dpp v109, v109, v109 row_ror:8 row_mask:0xf bank_mask:0x3
    v_add_f32_dpp v110, v110, v110 row_ror:8 row_mask:0xf bank_mask:0x3
    v_add_f32_dpp v111, v111, v111 row_ror:8 row_mask:0xf bank_mask:0x3
    v_add_f32_dpp v108, v112, v112 row_ror:8 row_mask:0xf bank_mask:0xc
    v_add_f32_dpp v109, v113, v113 row_ror:8 row_mask:0xf bank_mask:0xc
    v_add_f32_dpp v110, v114, v114 row_ror:8 row_mask:0xf bank_mask:0xc
    v_add_f32_dpp v111, v115, v115 row_ror:8 row_mask:0xf bank_mask:0xc
    ds_write_b128 v12, v[108:111]
    v_add_f32_dpp v104, v104, v104 row_ror:8 row_mask:0xf bank_mask:0xf
    v_add_f32_dpp v105, v105, v105 row_ror:8 row_mask:0xf bank_mask:0xf
    v_add_f32_dpp v106, v106, v106 row_ror:8 row_mask:0xf bank_mask:0xf
    v_add_f32_dpp v107, v107, v107 row_ror:8 row_mask:0xf bank_mask:0xf
    s_mov_b32 exec_lo, 0x00ff00ff
    s_mov_b32 exec_hi, 0
    ds_write_b128 v13, v[104:107]
    s_mov_b64 exec, -1
    s_waitcnt lgkmcnt(0)
    s_barrier
    s_cmp_lg_u32 s14, 0
    s_cbranch_scc1 sc_next
    s_waitcnt vmcnt(0)
    ds_read_b128 v[20:23], v1 offset:29696
    ds_read_b128 v[24:27], v1 offset:30720
    ds_read_b128 v[28:31], v1 offset:31744
    ds_read_b128 v[32:35], v1 offset:32768
    ds_read_b32 v36, v14 offset:33792
    ds_read_b32 v37, v14 offset:34048
    ds_read_b32 v38, v14 offset:34304
    ds_read_b32 v39, v14 offset:34560
    s_waitcnt lgkmcnt(6)
    v_pk_add_f32 v[20:21], v[20:21], v[24:25]
    v_pk_add_f32 v[22:23], v[22:23], v[26:27]
    s_waitcnt lgkmcnt(4)
    v_pk_add_f32 v[28:29], v[28:29], v[32:33]
    v_pk_add_f32 v[30:31], v[30:31], v[34:35]
    s_waitcnt lgkmcnt(0)
    v_pk_add_f32 v[36:37], v[36:37], v[38:39]
    v_pk_add_f32 v[20:21], v[20:21], v[28:29]
    v_pk_add_f32 v[22:23], v[22:23], v[30:31]
    v_add_f32 v36, v36, v37
    v_max3_f32 v39, v20, v21, v22
    v_max3_f32 v39, v39, v23, v36
    v_sub_f32 v20, v20, v39
    v_sub_f32 v21, v21, v39
    v_max_f32_dpp v40, v39, v39 quad_perm:[1,0,3,2] row_mask:0xf bank_mask:0xf
    v_sub_f32 v22, v22, v39
    v_sub_f32 v23, v23, v39
    v_max_f32_dpp v40, v40, v40 quad_perm:[2,3,0,1] row_mask:0xf bank_mask:0xf
    v_sub_f32 v36, v36, v39
    v_exp_f32 v20, v20
    v_max_f32_dpp v40, v40, v40 row_half_mirror row_mask:0xf bank_mask:0xf
    v_exp_f32 v21, v21
    v_sub_f32 v42, v39, v40
    v_exp_f32 v22, v22
    v_exp_f32 v23, v23
    v_exp_f32 v36, v36
    v_exp_f32 v42, v42
    v_pk_add_f32 v[44:45], v[20:21], v[22:23]
    v_add_f32 v41, v44, v45
    v_add_f32 v41, v41, v36
    v_mul_f32 v41, v41, v42
    v_mul_f32 v20, v20, v42
    v_mul_f32 v21, v21, v42
    v_add_f32_dpp v41, v41, v41 quad_perm:[1,0,3,2] row_mask:0xf bank_mask:0xf
    v_mul_f32 v22, v22, v42
    v_mul_f32 v23, v23, v42
    v_add_f32_dpp v41, v41, v41 quad_perm:[2,3,0,1] row_mask:0xf bank_mask:0xf
    v_mul_f32 v36, v36, v42
    s_nop 0
    v_add_f32_dpp v41, v41, v41 row_half_mirror row_mask:0xf bank_mask:0xf
    v_rcp_f32 v41, v41
    s_nop 0
    v_mul_f32 v20, v20, v41
    v_mul_f32 v21, v21, v41
    v_mul_f32 v22, v22, v41
    v_mul_f32 v23, v23, v41
    v_mul_f32 v36, v36, v41
    v_cvt_pk_bf16_f32 v44, v20, v21
    v_cvt_pk_bf16_f32 v45, v22, v23
    v_mov_b32_dpp v43, v36 quad_perm:[1,0,3,2] row_mask:0xf bank_mask:0xf
    buffer_store_dwordx2 v[44:45], v15, s[8:11], s27 offen
    v_cvt_pk_bf16_f32 v46, v36, v43
    s_mov_b32 exec_lo, 0x55555555
    s_mov_b32 exec_hi, 0x55555555
    buffer_store_dword v46, v16, s[8:11], s27 offen
    s_cmp_eq_u32 s15, 0
    s_cbranch_scc1 sc_nogs
    buffer_store_dword v46, v16, s[8:11], s29 offen sc1
    s_mov_b64 exec, -1
    buffer_store_dwordx2 v[44:45], v15, s[8:11], s29 offen sc1
sc_nogs:
    s_mov_b64 exec, -1
    s_barrier
    s_add_u32 s21, s49, 0
    buffer_load_dwordx4 v[76:79], v1, s[8:11], s21 offen offset:0
    buffer_load_dwordx4 v[80:83], v1, s[8:11], s21 offen offset:1024
    buffer_load_dwordx4 v[84:87], v1, s[8:11], s21 offen offset:2048
    buffer_load_dwordx2 v[88:89], v11, s[8:11], s21 offen offset:3072
    s_add_u32 s21, s49, 14336
    buffer_load_dwordx4 v[90:93], v1, s[8:11], s21 offen offset:0
    buffer_load_dwordx4 v[94:97], v1, s[8:11], s21 offen offset:1024
    buffer_load_dwordx4 v[98:101], v1, s[8:11], s21 offen offset:2048
    buffer_load_dwordx2 v[102:103], v11, s[8:11], s21 offen offset:3072
    s_add_u32 s49, s49, 28672
    v_mov_b32 v48, 0
    v_mov_b32 v49, 0
    v_mov_b32 v50, 0
    v_mov_b32 v51, 0
    v_mov_b32 v52, 0
    v_mov_b32 v53, 0
    v_mov_b32 v54, 0
    v_mov_b32 v55, 0
    v_mov_b32 v56, 0
    v_mov_b32 v57, 0
    v_mov_b32 v58, 0
    v_mov_b32 v59, 0
    v_mov_b32 v60, 0
    v_mov_b32 v61, 0
    v_mov_b32 v62, 0
    v_mov_b32 v63, 0
    v_mov_b32 v64, 0
    v_mov_b32 v65, 0
    v_mov_b32 v66, 0
    v_mov_b32 v67, 0
    v_mov_b32 v68, 0
    v_mov_b32 v69, 0
    v_mov_b32 v70, 0
    v_mov_b32 v71, 0
    v_mov_b32 v72, 0
    v_mov_b32 v73, 0
    v_mov_b32 v74, 0
    v_mov_b32 v75, 0
    s_sleep 11
    s_branch sc_next2
sc_next:
    v_mov_b32 v48, 0
    v_mov_b32 v49, 0
    v_mov_b32 v50, 0
    v_mov_b32 v51, 0
    v_mov_b32 v52, 0
    v_mov_b32 v53, 0
    v_mov_b32 v54, 0
    v_mov_b32 v55, 0
    v_mov_b32 v56, 0
    v_mov_b32 v57, 0
    v_mov_b32 v58, 0
    v_mov_b32 v59, 0
    v_mov_b32 v60, 0
    v_mov_b32 v61, 0
    v_mov_b32 v62, 0
    v_mov_b32 v63, 0
    v_mov_b32 v64, 0
    v_mov_b32 v65, 0
    v_mov_b32 v66, 0
    v_mov_b32 v67, 0
    v_mov_b32 v68, 0
    v_mov_b32 v69, 0
    v_mov_b32 v70, 0
    v_mov_b32 v71, 0
    v_mov_b32 v72, 0
    v_mov_b32 v73, 0
    v_mov_b32 v74, 0
    v_mov_b32 v75, 0
    s_barrier
    s_add_u32 s21, s49, 0
    buffer_load_dwordx4 v[76:79], v1, s[8:11], s21 offen offset:0
    buffer_load_dwordx4 v[80:83], v1, s[8:11], s21 offen offset:1024
    buffer_load_dwordx4 v[84:87], v1, s[8:11], s21 offen offset:2048
    buffer_load_dwordx2 v[88:89], v11, s[8:11], s21 offen offset:3072
    s_add_u32 s21, s49, 14336
    buffer_load_dwordx4 v[90:93], v1, s[8:11], s21 offen offset:0
    buffer_load_dwordx4 v[94:97], v1, s[8:11], s21 offen offset:1024
    buffer_load_dwordx4 v[98:101], v1, s[8:11], s21 offen offset:2048
    buffer_load_dwordx2 v[102:103], v11, s[8:11], s21 offen offset:3072
    s_add_u32 s49, s49, 28672
    s_sleep 12
sc_next2:
    s_add_u32 s25, s25, 7168
    s_add_u32 s26, s26, 7168
    s_add_u32 s27, s27, 10240
    s_add_u32 s29, s29, 10240
    s_add_u32 s16, s16, 1
    s_cmp_lt_u32 s16, 63
    s_cbranch_scc1 sc_loop
    s_endpgm
ch_output:
    s_cmp_eq_u32 s13, 30
    s_cbranch_scc1 ch_pref
    s_cmp_eq_u32 s13, 31
    s_cbranch_scc1 ch_pub
    s_sub_u32 s33, s13, 16
    s_lshl_b32 s20, s14, 11
    v_add_u32 v3, s20, v1
    s_mul_i32 s20, s14, 20480
    s_add_u32 s34, s20, 15360
    v_add_u32 v4, s34, v1
    v_lshrrev_b32 v9, 4, v0
    v_and_b32 v10, 15, v0
    v_lshrrev_b32 v11, 1, v9
    v_bfe_u32 v12, v0, 3, 1
    v_lshl_add_u32 v12, v11, 1, v12
    v_and_b32 v13, 7, v0
    v_lshlrev_b32 v13, 4, v13
    v_lshl_add_u32 v5, v12, 7, v13
    s_lshl_b32 s20, s14, 11
    s_add_u32 s20, s20, 97280
    v_lshlrev_b32 v6, 10, v11
    v_lshl_add_u32 v6, v10, 5, v6
    v_and_b32 v12, 1, v9
    v_lshl_add_u32 v6, v12, 4, v6
    v_add_u32 v6, s20, v6
    s_lshl_b32 s20, s14, 8
    s_add_u32 s20, s20, 97280
    v_lshlrev_b32 v7, 2, v0
    v_add_u32 v7, s20, v7
    v_and_b32 v12, 7, v0
    v_lshlrev_b32 v8, 4, v12
    v_lshl_add_u32 v8, v9, 2, v8
    s_lshl_b32 s20, s33, 9
    s_lshl_b32 s21, s14, 7
    s_add_u32 s20, s20, s21
    v_add_u32 v8, s20, v8
    s_cmp_ge_u32 s14, 3
    s_cselect_b32 s28, 7168, 0
    v_subrev_u32 v9, s28, v3
    s_cmp_ge_u32 s14, 2
    s_cselect_b32 s28, 7168, 0
    v_subrev_u32 v10, s28, v3
    s_cmp_ge_u32 s14, 1
    s_cselect_b32 s28, 7168, 0
    s_cmp_ge_u32 s14, 1
    s_cselect_b32 s28, 7168, 0
    v_subrev_u32 v0, s28, v3
    s_lshl_b32 s40, s14, 1
    s_add_u32 s40, s40, 0
    s_cmp_ge_u32 s40, 7
    s_cselect_b32 s28, 7, 0
    s_sub_u32 s40, s40, s28
    s_lshl_b32 s40, s40, 11
    s_lshl_b32 s41, s14, 1
    s_add_u32 s41, s41, 1
    s_cmp_ge_u32 s41, 7
    s_cselect_b32 s28, 7, 0
    s_sub_u32 s41, s41, s28
    s_lshl_b32 s41, s41, 11
    s_lshl_b32 s42, s14, 1
    s_add_u32 s42, s42, 2
    s_cmp_ge_u32 s42, 7
    s_cselect_b32 s28, 7, 0
    s_sub_u32 s42, s42, s28
    s_lshl_b32 s42, s42, 11
    s_lshl_b32 s43, s14, 1
    s_add_u32 s43, s43, 3
    s_cmp_ge_u32 s43, 7
    s_cselect_b32 s28, 7, 0
    s_sub_u32 s43, s43, s28
    s_lshl_b32 s43, s43, 11
    s_lshl_b32 s44, s14, 1
    s_add_u32 s44, s44, 4
    s_cmp_ge_u32 s44, 7
    s_cselect_b32 s28, 7, 0
    s_sub_u32 s44, s44, s28
    s_lshl_b32 s44, s44, 11
    s_lshl_b32 s45, s14, 1
    s_add_u32 s45, s45, 5
    s_cmp_ge_u32 s45, 7
    s_cselect_b32 s28, 7, 0
    s_sub_u32 s45, s45, s28
    s_lshl_b32 s45, s45, 11
    s_lshl_b32 s46, s14, 1
    s_add_u32 s46, s46, 6
    s_cmp_ge_u32 s46, 7
    s_cselect_b32 s28, 7, 0
    s_sub_u32 s46, s46, s28
    s_lshl_b32 s46, s46, 11
    s_mul_i32 s20, s14, 1605632
    s_add_u32 s20, s20, 9437184
    s_mul_i32 s21, s33, 28672
    s_add_u32 s20, s20, s21
    s_mov_b32 s58, s20
    s_lshr_b32 s22, s33, 1
    s_lshl_b32 s22, s22, 7
    s_add_u32 s22, s22, 20497408
    s_cmp_lg_u32 s14, 0
    s_cbranch_scc1 ou_ww0_ok
ou_ww0:
    buffer_load_dword v19, off, s[8:11], s22 sc1
    s_waitcnt vmcnt(0)
    v_readfirstlane_b32 s20, v19
    s_nop 2
    s_cmp_ge_u32 s20, 16
    s_cbranch_scc1 ou_ww0_ok
    s_sleep 2
    s_sub_u32 s17, s17, 1
    s_cmp_gt_i32 s17, 0
    s_cbranch_scc1 ou_ww0
ou_ww0_ok:
    s_barrier
    s_cmp_lt_u32 s40, 8192
    s_cbranch_scc0 ou_wk0_0
    s_add_u32 s21, s58, s40
    s_add_u32 s21, s21, 0
    buffer_load_dwordx4 a[0:3], v1, s[8:11], s21 offen
    buffer_load_dwordx4 a[4:7], v1, s[8:11], s21 offen offset:1024
    s_add_u32 s21, s58, s40
    s_add_u32 s21, s21, 14336
    buffer_load_dwordx4 a[48:51], v1, s[8:11], s21 offen
    buffer_load_dwordx4 a[52:55], v1, s[8:11], s21 offen offset:1024
    s_add_u32 s21, s58, s40
    s_add_u32 s21, s21, 401408
    buffer_load_dwordx4 a[96:99], v1, s[8:11], s21 offen
    buffer_load_dwordx4 a[100:103], v1, s[8:11], s21 offen offset:1024
    s_add_u32 s21, s58, s40
    s_add_u32 s21, s21, 415744
    buffer_load_dwordx4 a[144:147], v1, s[8:11], s21 offen
    buffer_load_dwordx4 a[148:151], v1, s[8:11], s21 offen offset:1024
    s_add_u32 s21, s58, s40
    s_add_u32 s21, s21, 802816
    buffer_load_dwordx4 a[192:195], v1, s[8:11], s21 offen
    buffer_load_dwordx4 a[196:199], v1, s[8:11], s21 offen offset:1024
    s_add_u32 s21, s58, s40
    s_add_u32 s21, s21, 817152
    buffer_load_dwordx4 a[240:243], v1, s[8:11], s21 offen
    buffer_load_dwordx4 a[244:247], v1, s[8:11], s21 offen offset:1024
    s_add_u32 s21, s58, s40
    s_add_u32 s21, s21, 1204224
    buffer_load_dwordx4 v[160:163], v1, s[8:11], s21 offen
    buffer_load_dwordx4 v[164:167], v1, s[8:11], s21 offen offset:1024
    s_add_u32 s21, s58, s40
    s_add_u32 s21, s21, 1218560
    buffer_load_dwordx4 v[208:211], v1, s[8:11], s21 offen
    buffer_load_dwordx4 v[212:215], v1, s[8:11], s21 offen offset:1024
    s_waitcnt vmcnt(30)
ou_wk0_0:
    s_cmp_lt_u32 s41, 8192
    s_cbranch_scc0 ou_wk0_1
    s_add_u32 s21, s58, s41
    s_add_u32 s21, s21, 0
    buffer_load_dwordx4 a[8:11], v1, s[8:11], s21 offen
    buffer_load_dwordx4 a[12:15], v1, s[8:11], s21 offen offset:1024
    s_add_u32 s21, s58, s41
    s_add_u32 s21, s21, 14336
    buffer_load_dwordx4 a[56:59], v1, s[8:11], s21 offen
    buffer_load_dwordx4 a[60:63], v1, s[8:11], s21 offen offset:1024
    s_add_u32 s21, s58, s41
    s_add_u32 s21, s21, 401408
    buffer_load_dwordx4 a[104:107], v1, s[8:11], s21 offen
    buffer_load_dwordx4 a[108:111], v1, s[8:11], s21 offen offset:1024
    s_add_u32 s21, s58, s41
    s_add_u32 s21, s21, 415744
    buffer_load_dwordx4 a[152:155], v1, s[8:11], s21 offen
    buffer_load_dwordx4 a[156:159], v1, s[8:11], s21 offen offset:1024
    s_add_u32 s21, s58, s41
    s_add_u32 s21, s21, 802816
    buffer_load_dwordx4 a[200:203], v1, s[8:11], s21 offen
    buffer_load_dwordx4 a[204:207], v1, s[8:11], s21 offen offset:1024
    s_add_u32 s21, s58, s41
    s_add_u32 s21, s21, 817152
    buffer_load_dwordx4 a[248:251], v1, s[8:11], s21 offen
    buffer_load_dwordx4 a[252:255], v1, s[8:11], s21 offen offset:1024
    s_add_u32 s21, s58, s41
    s_add_u32 s21, s21, 1204224
    buffer_load_dwordx4 v[168:171], v1, s[8:11], s21 offen
    buffer_load_dwordx4 v[172:175], v1, s[8:11], s21 offen offset:1024
    s_add_u32 s21, s58, s41
    s_add_u32 s21, s21, 1218560
    buffer_load_dwordx4 v[216:219], v1, s[8:11], s21 offen
    buffer_load_dwordx4 v[220:223], v1, s[8:11], s21 offen offset:1024
    s_waitcnt vmcnt(30)
ou_wk0_1:
    s_cmp_lt_u32 s42, 8192
    s_cbranch_scc0 ou_wk0_2
    s_add_u32 s21, s58, s42
    s_add_u32 s21, s21, 0
    buffer_load_dwordx4 a[16:19], v1, s[8:11], s21 offen
    buffer_load_dwordx4 a[20:23], v1, s[8:11], s21 offen offset:1024
    s_add_u32 s21, s58, s42
    s_add_u32 s21, s21, 14336
    buffer_load_dwordx4 a[64:67], v1, s[8:11], s21 offen
    buffer_load_dwordx4 a[68:71], v1, s[8:11], s21 offen offset:1024
    s_add_u32 s21, s58, s42
    s_add_u32 s21, s21, 401408
    buffer_load_dwordx4 a[112:115], v1, s[8:11], s21 offen
    buffer_load_dwordx4 a[116:119], v1, s[8:11], s21 offen offset:1024
    s_add_u32 s21, s58, s42
    s_add_u32 s21, s21, 415744
    buffer_load_dwordx4 a[160:163], v1, s[8:11], s21 offen
    buffer_load_dwordx4 a[164:167], v1, s[8:11], s21 offen offset:1024
    s_add_u32 s21, s58, s42
    s_add_u32 s21, s21, 802816
    buffer_load_dwordx4 a[208:211], v1, s[8:11], s21 offen
    buffer_load_dwordx4 a[212:215], v1, s[8:11], s21 offen offset:1024
    s_add_u32 s21, s58, s42
    s_add_u32 s21, s21, 817152
    buffer_load_dwordx4 v[128:131], v1, s[8:11], s21 offen
    buffer_load_dwordx4 v[132:135], v1, s[8:11], s21 offen offset:1024
    s_add_u32 s21, s58, s42
    s_add_u32 s21, s21, 1204224
    buffer_load_dwordx4 v[176:179], v1, s[8:11], s21 offen
    buffer_load_dwordx4 v[180:183], v1, s[8:11], s21 offen offset:1024
    s_add_u32 s21, s58, s42
    s_add_u32 s21, s21, 1218560
    buffer_load_dwordx4 v[224:227], v1, s[8:11], s21 offen
    buffer_load_dwordx4 v[228:231], v1, s[8:11], s21 offen offset:1024
    s_waitcnt vmcnt(30)
ou_wk0_2:
    s_cmp_lt_u32 s43, 8192
    s_cbranch_scc0 ou_wk0_3
    s_add_u32 s21, s58, s43
    s_add_u32 s21, s21, 0
    buffer_load_dwordx4 a[24:27], v1, s[8:11], s21 offen
    buffer_load_dwordx4 a[28:31], v1, s[8:11], s21 offen offset:1024
    s_add_u32 s21, s58, s43
    s_add_u32 s21, s21, 14336
    buffer_load_dwordx4 a[72:75], v1, s[8:11], s21 offen
    buffer_load_dwordx4 a[76:79], v1, s[8:11], s21 offen offset:1024
    s_add_u32 s21, s58, s43
    s_add_u32 s21, s21, 401408
    buffer_load_dwordx4 a[120:123], v1, s[8:11], s21 offen
    buffer_load_dwordx4 a[124:127], v1, s[8:11], s21 offen offset:1024
    s_add_u32 s21, s58, s43
    s_add_u32 s21, s21, 415744
    buffer_load_dwordx4 a[168:171], v1, s[8:11], s21 offen
    buffer_load_dwordx4 a[172:175], v1, s[8:11], s21 offen offset:1024
    s_add_u32 s21, s58, s43
    s_add_u32 s21, s21, 802816
    buffer_load_dwordx4 a[216:219], v1, s[8:11], s21 offen
    buffer_load_dwordx4 a[220:223], v1, s[8:11], s21 offen offset:1024
    s_add_u32 s21, s58, s43
    s_add_u32 s21, s21, 817152
    buffer_load_dwordx4 v[136:139], v1, s[8:11], s21 offen
    buffer_load_dwordx4 v[140:143], v1, s[8:11], s21 offen offset:1024
    s_add_u32 s21, s58, s43
    s_add_u32 s21, s21, 1204224
    buffer_load_dwordx4 v[184:187], v1, s[8:11], s21 offen
    buffer_load_dwordx4 v[188:191], v1, s[8:11], s21 offen offset:1024
    s_add_u32 s21, s58, s43
    s_add_u32 s21, s21, 1218560
    buffer_load_dwordx4 v[232:235], v1, s[8:11], s21 offen
    buffer_load_dwordx4 v[236:239], v1, s[8:11], s21 offen offset:1024
    s_waitcnt vmcnt(30)
ou_wk0_3:
    s_cmp_lt_u32 s44, 8192
    s_cbranch_scc0 ou_wk0_4
    s_add_u32 s21, s58, s44
    s_add_u32 s21, s21, 0
    buffer_load_dwordx4 a[32:35], v1, s[8:11], s21 offen
    buffer_load_dwordx4 a[36:39], v1, s[8:11], s21 offen offset:1024
    s_add_u32 s21, s58, s44
    s_add_u32 s21, s21, 14336
    buffer_load_dwordx4 a[80:83], v1, s[8:11], s21 offen
    buffer_load_dwordx4 a[84:87], v1, s[8:11], s21 offen offset:1024
    s_add_u32 s21, s58, s44
    s_add_u32 s21, s21, 401408
    buffer_load_dwordx4 a[128:131], v1, s[8:11], s21 offen
    buffer_load_dwordx4 a[132:135], v1, s[8:11], s21 offen offset:1024
    s_add_u32 s21, s58, s44
    s_add_u32 s21, s21, 415744
    buffer_load_dwordx4 a[176:179], v1, s[8:11], s21 offen
    buffer_load_dwordx4 a[180:183], v1, s[8:11], s21 offen offset:1024
    s_add_u32 s21, s58, s44
    s_add_u32 s21, s21, 802816
    buffer_load_dwordx4 a[224:227], v1, s[8:11], s21 offen
    buffer_load_dwordx4 a[228:231], v1, s[8:11], s21 offen offset:1024
    s_add_u32 s21, s58, s44
    s_add_u32 s21, s21, 817152
    buffer_load_dwordx4 v[144:147], v1, s[8:11], s21 offen
    buffer_load_dwordx4 v[148:151], v1, s[8:11], s21 offen offset:1024
    s_add_u32 s21, s58, s44
    s_add_u32 s21, s21, 1204224
    buffer_load_dwordx4 v[192:195], v1, s[8:11], s21 offen
    buffer_load_dwordx4 v[196:199], v1, s[8:11], s21 offen offset:1024
    s_add_u32 s21, s58, s44
    s_add_u32 s21, s21, 1218560
    buffer_load_dwordx4 v[240:243], v1, s[8:11], s21 offen
    buffer_load_dwordx4 v[244:247], v1, s[8:11], s21 offen offset:1024
    s_waitcnt vmcnt(30)
ou_wk0_4:
    s_cmp_lt_u32 s45, 8192
    s_cbranch_scc0 ou_wk0_5
    s_add_u32 s21, s58, s45
    s_add_u32 s21, s21, 0
    buffer_load_dwordx4 a[40:43], v1, s[8:11], s21 offen
    buffer_load_dwordx4 a[44:47], v1, s[8:11], s21 offen offset:1024
    s_add_u32 s21, s58, s45
    s_add_u32 s21, s21, 14336
    buffer_load_dwordx4 a[88:91], v1, s[8:11], s21 offen
    buffer_load_dwordx4 a[92:95], v1, s[8:11], s21 offen offset:1024
    s_add_u32 s21, s58, s45
    s_add_u32 s21, s21, 401408
    buffer_load_dwordx4 a[136:139], v1, s[8:11], s21 offen
    buffer_load_dwordx4 a[140:143], v1, s[8:11], s21 offen offset:1024
    s_add_u32 s21, s58, s45
    s_add_u32 s21, s21, 415744
    buffer_load_dwordx4 a[184:187], v1, s[8:11], s21 offen
    buffer_load_dwordx4 a[188:191], v1, s[8:11], s21 offen offset:1024
    s_add_u32 s21, s58, s45
    s_add_u32 s21, s21, 802816
    buffer_load_dwordx4 a[232:235], v1, s[8:11], s21 offen
    buffer_load_dwordx4 a[236:239], v1, s[8:11], s21 offen offset:1024
    s_add_u32 s21, s58, s45
    s_add_u32 s21, s21, 817152
    buffer_load_dwordx4 v[152:155], v1, s[8:11], s21 offen
    buffer_load_dwordx4 v[156:159], v1, s[8:11], s21 offen offset:1024
    s_add_u32 s21, s58, s45
    s_add_u32 s21, s21, 1204224
    buffer_load_dwordx4 v[200:203], v1, s[8:11], s21 offen
    buffer_load_dwordx4 v[204:207], v1, s[8:11], s21 offen offset:1024
    s_add_u32 s21, s58, s45
    s_add_u32 s21, s21, 1218560
    buffer_load_dwordx4 v[248:251], v1, s[8:11], s21 offen
    buffer_load_dwordx4 v[252:255], v1, s[8:11], s21 offen offset:1024
    s_waitcnt vmcnt(30)
ou_wk0_5:
    s_cmp_lt_u32 s46, 8192
    s_cbranch_scc0 ou_wk0_6
    s_add_u32 s21, s58, s46
    s_add_u32 s21, s21, 0
    s_add_u32 m0, s34, 0
    s_nop 0
    buffer_load_dwordx4 v1, s[8:11], s21 offen lds
    buffer_load_dwordx4 v1, s[8:11], s21 offen offset:1024 lds
    s_add_u32 s21, s58, s46
    s_add_u32 s21, s21, 14336
    s_add_u32 m0, s34, 2048
    s_nop 0
    buffer_load_dwordx4 v1, s[8:11], s21 offen lds
    buffer_load_dwordx4 v1, s[8:11], s21 offen offset:1024 lds
    s_add_u32 s21, s58, s46
    s_add_u32 s21, s21, 401408
    s_add_u32 m0, s34, 4096
    s_nop 0
    buffer_load_dwordx4 v1, s[8:11], s21 offen lds
    buffer_load_dwordx4 v1, s[8:11], s21 offen offset:1024 lds
    s_add_u32 s21, s58, s46
    s_add_u32 s21, s21, 415744
    s_add_u32 m0, s34, 6144
    s_nop 0
    buffer_load_dwordx4 v1, s[8:11], s21 offen lds
    buffer_load_dwordx4 v1, s[8:11], s21 offen offset:1024 lds
    s_add_u32 s21, s58, s46
    s_add_u32 s21, s21, 802816
    s_add_u32 m0, s34, 8192
    s_nop 0
    buffer_load_dwordx4 v1, s[8:11], s21 offen lds
    buffer_load_dwordx4 v1, s[8:11], s21 offen offset:1024 lds
    s_add_u32 s21, s58, s46
    s_add_u32 s21, s21, 817152
    s_add_u32 m0, s34, 10240
    s_nop 0
    buffer_load_dwordx4 v1, s[8:11], s21 offen lds
    buffer_load_dwordx4 v1, s[8:11], s21 offen offset:1024 lds
    s_add_u32 s21, s58, s46
    s_add_u32 s21, s21, 1204224
    s_add_u32 m0, s34, 12288
    s_nop 0
    buffer_load_dwordx4 v1, s[8:11], s21 offen lds
    buffer_load_dwordx4 v1, s[8:11], s21 offen offset:1024 lds
    s_add_u32 s21, s58, s46
    s_add_u32 s21, s21, 1218560
    s_add_u32 m0, s34, 14336
    s_nop 0
    buffer_load_dwordx4 v1, s[8:11], s21 offen lds
    buffer_load_dwordx4 v1, s[8:11], s21 offen offset:1024 lds
    s_waitcnt vmcnt(30)
ou_wk0_6:
    s_lshr_b32 s22, s33, 1
    s_lshl_b32 s22, s22, 7
    s_add_u32 s22, s22, 20498432
    s_cmp_lg_u32 s14, 0
    s_cbranch_scc1 ou_ww1_ok
ou_ww1:
    buffer_load_dword v19, off, s[8:11], s22 sc1
    s_waitcnt vmcnt(0)
    v_readfirstlane_b32 s20, v19
    s_nop 2
    s_cmp_ge_u32 s20, 16
    s_cbranch_scc1 ou_ww1_ok
    s_sleep 2
    s_sub_u32 s17, s17, 1
    s_cmp_gt_i32 s17, 0
    s_cbranch_scc1 ou_ww1
ou_ww1_ok:
    s_barrier
    s_cmp_lt_u32 s40, 8192
    s_cbranch_scc1 ou_wk1_0
    s_add_u32 s21, s58, s40
    s_add_u32 s21, s21, 0
    buffer_load_dwordx4 a[0:3], v1, s[8:11], s21 offen
    buffer_load_dwordx4 a[4:7], v1, s[8:11], s21 offen offset:1024
    s_add_u32 s21, s58, s40
    s_add_u32 s21, s21, 14336
    buffer_load_dwordx4 a[48:51], v1, s[8:11], s21 offen
    buffer_load_dwordx4 a[52:55], v1, s[8:11], s21 offen offset:1024
    s_add_u32 s21, s58, s40
    s_add_u32 s21, s21, 401408
    buffer_load_dwordx4 a[96:99], v1, s[8:11], s21 offen
    buffer_load_dwordx4 a[100:103], v1, s[8:11], s21 offen offset:1024
    s_add_u32 s21, s58, s40
    s_add_u32 s21, s21, 415744
    buffer_load_dwordx4 a[144:147], v1, s[8:11], s21 offen
    buffer_load_dwordx4 a[148:151], v1, s[8:11], s21 offen offset:1024
    s_add_u32 s21, s58, s40
    s_add_u32 s21, s21, 802816
    buffer_load_dwordx4 a[192:195], v1, s[8:11], s21 offen
    buffer_load_dwordx4 a[196:199], v1, s[8:11], s21 offen offset:1024
    s_add_u32 s21, s58, s40
    s_add_u32 s21, s21, 817152
    buffer_load_dwordx4 a[240:243], v1, s[8:11], s21 offen
    buffer_load_dwordx4 a[244:247], v1, s[8:11], s21 offen offset:1024
    s_add_u32 s21, s58, s40
    s_add_u32 s21, s21, 1204224
    buffer_load_dwordx4 v[160:163], v1, s[8:11], s21 offen
    buffer_load_dwordx4 v[164:167], v1, s[8:11], s21 offen offset:1024
    s_add_u32 s21, s58, s40
    s_add_u32 s21, s21, 1218560
    buffer_load_dwordx4 v[208:211], v1, s[8:11], s21 offen
    buffer_load_dwordx4 v[212:215], v1, s[8:11], s21 offen offset:1024
    s_waitcnt vmcnt(30)
ou_wk1_0:
    s_cmp_lt_u32 s41, 8192
    s_cbranch_scc1 ou_wk1_1
    s_add_u32 s21, s58, s41
    s_add_u32 s21, s21, 0
    buffer_load_dwordx4 a[8:11], v1, s[8:11], s21 offen
    buffer_load_dwordx4 a[12:15], v1, s[8:11], s21 offen offset:1024
    s_add_u32 s21, s58, s41
    s_add_u32 s21, s21, 14336
    buffer_load_dwordx4 a[56:59], v1, s[8:11], s21 offen
    buffer_load_dwordx4 a[60:63], v1, s[8:11], s21 offen offset:1024
    s_add_u32 s21, s58, s41
    s_add_u32 s21, s21, 401408
    buffer_load_dwordx4 a[104:107], v1, s[8:11], s21 offen
    buffer_load_dwordx4 a[108:111], v1, s[8:11], s21 offen offset:1024
    s_add_u32 s21, s58, s41
    s_add_u32 s21, s21, 415744
    buffer_load_dwordx4 a[152:155], v1, s[8:11], s21 offen
    buffer_load_dwordx4 a[156:159], v1, s[8:11], s21 offen offset:1024
    s_add_u32 s21, s58, s41
    s_add_u32 s21, s21, 802816
    buffer_load_dwordx4 a[200:203], v1, s[8:11], s21 offen
    buffer_load_dwordx4 a[204:207], v1, s[8:11], s21 offen offset:1024
    s_add_u32 s21, s58, s41
    s_add_u32 s21, s21, 817152
    buffer_load_dwordx4 a[248:251], v1, s[8:11], s21 offen
    buffer_load_dwordx4 a[252:255], v1, s[8:11], s21 offen offset:1024
    s_add_u32 s21, s58, s41
    s_add_u32 s21, s21, 1204224
    buffer_load_dwordx4 v[168:171], v1, s[8:11], s21 offen
    buffer_load_dwordx4 v[172:175], v1, s[8:11], s21 offen offset:1024
    s_add_u32 s21, s58, s41
    s_add_u32 s21, s21, 1218560
    buffer_load_dwordx4 v[216:219], v1, s[8:11], s21 offen
    buffer_load_dwordx4 v[220:223], v1, s[8:11], s21 offen offset:1024
    s_waitcnt vmcnt(30)
ou_wk1_1:
    s_cmp_lt_u32 s42, 8192
    s_cbranch_scc1 ou_wk1_2
    s_add_u32 s21, s58, s42
    s_add_u32 s21, s21, 0
    buffer_load_dwordx4 a[16:19], v1, s[8:11], s21 offen
    buffer_load_dwordx4 a[20:23], v1, s[8:11], s21 offen offset:1024
    s_add_u32 s21, s58, s42
    s_add_u32 s21, s21, 14336
    buffer_load_dwordx4 a[64:67], v1, s[8:11], s21 offen
    buffer_load_dwordx4 a[68:71], v1, s[8:11], s21 offen offset:1024
    s_add_u32 s21, s58, s42
    s_add_u32 s21, s21, 401408
    buffer_load_dwordx4 a[112:115], v1, s[8:11], s21 offen
    buffer_load_dwordx4 a[116:119], v1, s[8:11], s21 offen offset:1024
    s_add_u32 s21, s58, s42
    s_add_u32 s21, s21, 415744
    buffer_load_dwordx4 a[160:163], v1, s[8:11], s21 offen
    buffer_load_dwordx4 a[164:167], v1, s[8:11], s21 offen offset:1024
    s_add_u32 s21, s58, s42
    s_add_u32 s21, s21, 802816
    buffer_load_dwordx4 a[208:211], v1, s[8:11], s21 offen
    buffer_load_dwordx4 a[212:215], v1, s[8:11], s21 offen offset:1024
    s_add_u32 s21, s58, s42
    s_add_u32 s21, s21, 817152
    buffer_load_dwordx4 v[128:131], v1, s[8:11], s21 offen
    buffer_load_dwordx4 v[132:135], v1, s[8:11], s21 offen offset:1024
    s_add_u32 s21, s58, s42
    s_add_u32 s21, s21, 1204224
    buffer_load_dwordx4 v[176:179], v1, s[8:11], s21 offen
    buffer_load_dwordx4 v[180:183], v1, s[8:11], s21 offen offset:1024
    s_add_u32 s21, s58, s42
    s_add_u32 s21, s21, 1218560
    buffer_load_dwordx4 v[224:227], v1, s[8:11], s21 offen
    buffer_load_dwordx4 v[228:231], v1, s[8:11], s21 offen offset:1024
    s_waitcnt vmcnt(30)
ou_wk1_2:
    s_cmp_lt_u32 s43, 8192
    s_cbranch_scc1 ou_wk1_3
    s_add_u32 s21, s58, s43
    s_add_u32 s21, s21, 0
    buffer_load_dwordx4 a[24:27], v1, s[8:11], s21 offen
    buffer_load_dwordx4 a[28:31], v1, s[8:11], s21 offen offset:1024
    s_add_u32 s21, s58, s43
    s_add_u32 s21, s21, 14336
    buffer_load_dwordx4 a[72:75], v1, s[8:11], s21 offen
    buffer_load_dwordx4 a[76:79], v1, s[8:11], s21 offen offset:1024
    s_add_u32 s21, s58, s43
    s_add_u32 s21, s21, 401408
    buffer_load_dwordx4 a[120:123], v1, s[8:11], s21 offen
    buffer_load_dwordx4 a[124:127], v1, s[8:11], s21 offen offset:1024
    s_add_u32 s21, s58, s43
    s_add_u32 s21, s21, 415744
    buffer_load_dwordx4 a[168:171], v1, s[8:11], s21 offen
    buffer_load_dwordx4 a[172:175], v1, s[8:11], s21 offen offset:1024
    s_add_u32 s21, s58, s43
    s_add_u32 s21, s21, 802816
    buffer_load_dwordx4 a[216:219], v1, s[8:11], s21 offen
    buffer_load_dwordx4 a[220:223], v1, s[8:11], s21 offen offset:1024
    s_add_u32 s21, s58, s43
    s_add_u32 s21, s21, 817152
    buffer_load_dwordx4 v[136:139], v1, s[8:11], s21 offen
    buffer_load_dwordx4 v[140:143], v1, s[8:11], s21 offen offset:1024
    s_add_u32 s21, s58, s43
    s_add_u32 s21, s21, 1204224
    buffer_load_dwordx4 v[184:187], v1, s[8:11], s21 offen
    buffer_load_dwordx4 v[188:191], v1, s[8:11], s21 offen offset:1024
    s_add_u32 s21, s58, s43
    s_add_u32 s21, s21, 1218560
    buffer_load_dwordx4 v[232:235], v1, s[8:11], s21 offen
    buffer_load_dwordx4 v[236:239], v1, s[8:11], s21 offen offset:1024
    s_waitcnt vmcnt(30)
ou_wk1_3:
    s_cmp_lt_u32 s44, 8192
    s_cbranch_scc1 ou_wk1_4
    s_add_u32 s21, s58, s44
    s_add_u32 s21, s21, 0
    buffer_load_dwordx4 a[32:35], v1, s[8:11], s21 offen
    buffer_load_dwordx4 a[36:39], v1, s[8:11], s21 offen offset:1024
    s_add_u32 s21, s58, s44
    s_add_u32 s21, s21, 14336
    buffer_load_dwordx4 a[80:83], v1, s[8:11], s21 offen
    buffer_load_dwordx4 a[84:87], v1, s[8:11], s21 offen offset:1024
    s_add_u32 s21, s58, s44
    s_add_u32 s21, s21, 401408
    buffer_load_dwordx4 a[128:131], v1, s[8:11], s21 offen
    buffer_load_dwordx4 a[132:135], v1, s[8:11], s21 offen offset:1024
    s_add_u32 s21, s58, s44
    s_add_u32 s21, s21, 415744
    buffer_load_dwordx4 a[176:179], v1, s[8:11], s21 offen
    buffer_load_dwordx4 a[180:183], v1, s[8:11], s21 offen offset:1024
    s_add_u32 s21, s58, s44
    s_add_u32 s21, s21, 802816
    buffer_load_dwordx4 a[224:227], v1, s[8:11], s21 offen
    buffer_load_dwordx4 a[228:231], v1, s[8:11], s21 offen offset:1024
    s_add_u32 s21, s58, s44
    s_add_u32 s21, s21, 817152
    buffer_load_dwordx4 v[144:147], v1, s[8:11], s21 offen
    buffer_load_dwordx4 v[148:151], v1, s[8:11], s21 offen offset:1024
    s_add_u32 s21, s58, s44
    s_add_u32 s21, s21, 1204224
    buffer_load_dwordx4 v[192:195], v1, s[8:11], s21 offen
    buffer_load_dwordx4 v[196:199], v1, s[8:11], s21 offen offset:1024
    s_add_u32 s21, s58, s44
    s_add_u32 s21, s21, 1218560
    buffer_load_dwordx4 v[240:243], v1, s[8:11], s21 offen
    buffer_load_dwordx4 v[244:247], v1, s[8:11], s21 offen offset:1024
    s_waitcnt vmcnt(30)
ou_wk1_4:
    s_cmp_lt_u32 s45, 8192
    s_cbranch_scc1 ou_wk1_5
    s_add_u32 s21, s58, s45
    s_add_u32 s21, s21, 0
    buffer_load_dwordx4 a[40:43], v1, s[8:11], s21 offen
    buffer_load_dwordx4 a[44:47], v1, s[8:11], s21 offen offset:1024
    s_add_u32 s21, s58, s45
    s_add_u32 s21, s21, 14336
    buffer_load_dwordx4 a[88:91], v1, s[8:11], s21 offen
    buffer_load_dwordx4 a[92:95], v1, s[8:11], s21 offen offset:1024
    s_add_u32 s21, s58, s45
    s_add_u32 s21, s21, 401408
    buffer_load_dwordx4 a[136:139], v1, s[8:11], s21 offen
    buffer_load_dwordx4 a[140:143], v1, s[8:11], s21 offen offset:1024
    s_add_u32 s21, s58, s45
    s_add_u32 s21, s21, 415744
    buffer_load_dwordx4 a[184:187], v1, s[8:11], s21 offen
    buffer_load_dwordx4 a[188:191], v1, s[8:11], s21 offen offset:1024
    s_add_u32 s21, s58, s45
    s_add_u32 s21, s21, 802816
    buffer_load_dwordx4 a[232:235], v1, s[8:11], s21 offen
    buffer_load_dwordx4 a[236:239], v1, s[8:11], s21 offen offset:1024
    s_add_u32 s21, s58, s45
    s_add_u32 s21, s21, 817152
    buffer_load_dwordx4 v[152:155], v1, s[8:11], s21 offen
    buffer_load_dwordx4 v[156:159], v1, s[8:11], s21 offen offset:1024
    s_add_u32 s21, s58, s45
    s_add_u32 s21, s21, 1204224
    buffer_load_dwordx4 v[200:203], v1, s[8:11], s21 offen
    buffer_load_dwordx4 v[204:207], v1, s[8:11], s21 offen offset:1024
    s_add_u32 s21, s58, s45
    s_add_u32 s21, s21, 1218560
    buffer_load_dwordx4 v[248:251], v1, s[8:11], s21 offen
    buffer_load_dwordx4 v[252:255], v1, s[8:11], s21 offen offset:1024
    s_waitcnt vmcnt(30)
ou_wk1_5:
    s_cmp_lt_u32 s46, 8192
    s_cbranch_scc1 ou_wk1_6
    s_add_u32 s21, s58, s46
    s_add_u32 s21, s21, 0
    s_add_u32 m0, s34, 0
    s_nop 0
    buffer_load_dwordx4 v1, s[8:11], s21 offen lds
    buffer_load_dwordx4 v1, s[8:11], s21 offen offset:1024 lds
    s_add_u32 s21, s58, s46
    s_add_u32 s21, s21, 14336
    s_add_u32 m0, s34, 2048
    s_nop 0
    buffer_load_dwordx4 v1, s[8:11], s21 offen lds
    buffer_load_dwordx4 v1, s[8:11], s21 offen offset:1024 lds
    s_add_u32 s21, s58, s46
    s_add_u32 s21, s21, 401408
    s_add_u32 m0, s34, 4096
    s_nop 0
    buffer_load_dwordx4 v1, s[8:11], s21 offen lds
    buffer_load_dwordx4 v1, s[8:11], s21 offen offset:1024 lds
    s_add_u32 s21, s58, s46
    s_add_u32 s21, s21, 415744
    s_add_u32 m0, s34, 6144
    s_nop 0
    buffer_load_dwordx4 v1, s[8:11], s21 offen lds
    buffer_load_dwordx4 v1, s[8:11], s21 offen offset:1024 lds
    s_add_u32 s21, s58, s46
    s_add_u32 s21, s21, 802816
    s_add_u32 m0, s34, 8192
    s_nop 0
    buffer_load_dwordx4 v1, s[8:11], s21 offen lds
    buffer_load_dwordx4 v1, s[8:11], s21 offen offset:1024 lds
    s_add_u32 s21, s58, s46
    s_add_u32 s21, s21, 817152
    s_add_u32 m0, s34, 10240
    s_nop 0
    buffer_load_dwordx4 v1, s[8:11], s21 offen lds
    buffer_load_dwordx4 v1, s[8:11], s21 offen offset:1024 lds
    s_add_u32 s21, s58, s46
    s_add_u32 s21, s21, 1204224
    s_add_u32 m0, s34, 12288
    s_nop 0
    buffer_load_dwordx4 v1, s[8:11], s21 offen lds
    buffer_load_dwordx4 v1, s[8:11], s21 offen offset:1024 lds
    s_add_u32 s21, s58, s46
    s_add_u32 s21, s21, 1218560
    s_add_u32 m0, s34, 14336
    s_nop 0
    buffer_load_dwordx4 v1, s[8:11], s21 offen lds
    buffer_load_dwordx4 v1, s[8:11], s21 offen offset:1024 lds
    s_waitcnt vmcnt(30)
ou_wk1_6:
    s_mov_b32 s22, 20499456
    s_cmp_lg_u32 s14, 0
    s_cbranch_scc1 ou_wx_ok
ou_wx:
    buffer_load_dword v19, off, s[8:11], s22 sc1
    s_waitcnt vmcnt(0)
    v_readfirstlane_b32 s20, v19
    s_nop 2
    s_cmp_ge_u32 s20, 32
    s_cbranch_scc1 ou_wx_ok
    s_sleep 2
    s_sub_u32 s17, s17, 1
    s_cmp_gt_i32 s17, 0
    s_cbranch_scc1 ou_wx
ou_wx_ok:
    s_barrier
    s_lshr_b32 s47, s40, 1
    s_lshr_b32 s48, s41, 1
    s_cmp_lg_u32 s14, 0
    s_cbranch_scc1 ou_mode_wait
    s_mov_b64 exec, 1
    v_mov_b32 v17, 0
ou_mode_poll:
    global_load_dwordx2 v[18:19], v17, s[6:7] sc1
    s_waitcnt vmcnt(0)
    v_readfirstlane_b32 s20, v18
    v_readfirstlane_b32 s21, v19
    s_nop 2
    s_add_u32 s21, s21, s20
    s_cmp_ge_u32 s21, 32
    s_cselect_b32 s21, 256, 0
    s_mov_b32 s15, 0
    s_cmp_ge_u32 s20, 32
    s_cbranch_scc1 ou_mode_pub
    s_mov_b32 s15, 1
    s_cmp_ge_u32 s21, 256
    s_cbranch_scc1 ou_mode_pub
    s_sleep 2
    s_sub_u32 s17, s17, 1
    s_cmp_gt_i32 s17, 0
    s_cbranch_scc1 ou_mode_poll
ou_mode_pub:
    s_mov_b64 exec, 1
    v_mov_b32 v18, s15
    v_mov_b32 v19, 105476
    ds_write_b32 v19, v18
    s_waitcnt lgkmcnt(0)
    s_mov_b64 exec, -1
ou_mode_wait:
    s_barrier
    v_mov_b32 v19, 105476
    ds_read_b32 v18, v19
    s_waitcnt lgkmcnt(0)
    v_readfirstlane_b32 s15, v18
    s_nop 3
    s_mul_i32 s30, s15, 524288
    s_add_u32 s30, s30, 16777216
    s_mul_i32 s31, s15, 1048576
    s_add_u32 s31, s31, 17825792
    s_waitcnt vmcnt(0)
    s_barrier
    s_mov_b32 s16, 0
    s_add_u32 s25, s30, s47
    s_add_u32 s26, s30, s48
    s_lshl_b32 s20, s14, 11
    s_add_u32 s35, s31, s20
    s_lshl_b32 s20, s14, 9
    s_add_u32 s36, s31, s20
    s_add_u32 s36, s36, 8192
    s_mul_i32 s37, s14, 114688
    s_add_u32 s37, s37, 37748736
    s_lshl_b32 s20, s33, 11
    s_add_u32 s37, s37, s20
    s_lshl_b32 s38, s33, 2
    s_add_u32 s38, s38, s14
    s_lshl_b32 s38, s38, 12
    s_add_u32 s38, s38, 20971520
    s_lshl_b32 s20, s33, 2
    s_add_u32 s20, s20, s14
    s_min_u32 s55, s20, 9
    s_lshl_b32 s55, s55, 10
    s_add_u32 s55, s55, s31
    s_add_u32 s55, s55, 10240
    s_min_u32 s56, s20, 6
    s_lshl_b32 s56, s56, 10
    s_add_u32 s56, s56, s30
    s_add_u32 s56, s56, 14336
    s_cmp_lg_u32 s15, 0
    s_cselect_b32 s55, 0, s55
    s_cmp_lg_u32 s15, 0
    s_cselect_b32 s56, 0, s56
    s_mov_b32 m0, 106496
    s_mov_b32 s39, 16784384
    s_mov_b32 s32, 17308672
    v_mov_b32 v104, 0
    s_mov_b32 s57, 224
    s_mov_b32 s60, 20460544
    s_mov_b32 s61, 0
    s_mov_b32 s100, 2
    s_mov_b32 s101, 14
    s_mov_b32 s21, 20460544
ou_vs:
    buffer_load_dword v104, off, s[8:11], s21 sc1
    s_waitcnt vmcnt(0)
    v_readfirstlane_b32 s20, v104
    s_nop 2
    s_cmp_ge_u32 s20, 224
    s_cbranch_scc1 ou_vsk
    s_sleep 4
    s_sub_u32 s17, s17, 1
    s_cmp_gt_i32 s17, 0
    s_cbranch_scc1 ou_vs
ou_vsk:
    v_mov_b32 v104, 224
    s_nop 1
ou_loop:
    s_waitcnt vmcnt(1)
    v_mov_b32 v40, 0
    v_mov_b32 v41, 0
    v_mov_b32 v42, 0
    v_mov_b32 v43, 0
    v_mov_b32 v44, 0
    v_mov_b32 v45, 0
    v_mov_b32 v46, 0
    v_mov_b32 v47, 0
    v_mov_b32 v48, 0
    v_mov_b32 v49, 0
    v_mov_b32 v50, 0
    v_mov_b32 v51, 0
    v_mov_b32 v52, 0
    v_mov_b32 v53, 0
    v_mov_b32 v54, 0
    v_mov_b32 v55, 0
    v_mov_b32 v56, 0
    v_mov_b32 v57, 0
    v_mov_b32 v58, 0
    v_mov_b32 v59, 0
    v_mov_b32 v60, 0
    v_mov_b32 v61, 0
    v_mov_b32 v62, 0
    v_mov_b32 v63, 0
    v_mov_b32 v64, 0
    v_mov_b32 v65, 0
    v_mov_b32 v66, 0
    v_mov_b32 v67, 0
    v_mov_b32 v68, 0
    v_mov_b32 v69, 0
    v_mov_b32 v70, 0
    v_mov_b32 v71, 0
    v_mov_b32 v120, 0
    v_mov_b32 v121, 0
    v_mov_b32 v122, 0
    v_mov_b32 v123, 0
    v_mov_b32 v124, 0
    v_mov_b32 v125, 0
    v_mov_b32 v126, 0
    v_mov_b32 v127, 0
    buffer_load_dwordx4 v[12:15], v1, s[8:11], s25 offen sc1
    buffer_load_dwordx4 v[16:19], v1, s[8:11], s26 offen sc1
    s_sleep 2
ou_pollm:
    buffer_load_dwordx4 v[12:15], v1, s[8:11], s25 offen sc1
    buffer_load_dwordx4 v[16:19], v1, s[8:11], s26 offen sc1
    s_waitcnt vmcnt(2)
    v_max3_u32 v112, v12, v13, v14
    v_max3_u32 v113, v15, v16, v17
    v_max3_u32 v112, v112, v113, v18
    v_max_u32 v112, v112, v19
    v_cmp_eq_u32 vcc, -1, v112
    s_cbranch_vccz ou_pollm_ok
    s_sub_u32 s17, s17, 1
    s_cmp_gt_i32 s17, 0
    s_cbranch_scc1 ou_pollm
ou_pollm_ok:
    v_readfirstlane_b32 s20, v104
    s_nop 2
    s_cmp_ge_u32 s20, s57
    s_cbranch_scc1 ou_vook0
ou_vospin0:
    buffer_load_dword v104, off, s[8:11], s60 sc1
    s_waitcnt vmcnt(0)
    v_readfirstlane_b32 s20, v104
    s_nop 2
    s_cmp_ge_u32 s20, s57
    s_cbranch_scc1 ou_vook0
    s_sleep 2
    s_sub_u32 s17, s17, 1
    s_cmp_gt_i32 s17, 0
    s_cbranch_scc1 ou_vospin0
ou_vook0:
    ds_write_b128 v3, v[12:15]
    ds_write_b128 v3, v[16:19] offset:1024
    s_add_u32 s21, s37, 0
    buffer_load_dwordx4 v[72:75], v1, s[8:11], s21 offen offset:0 sc1
    buffer_load_dwordx4 v[80:83], v1, s[8:11], s21 offen offset:1024 sc1
    s_add_u32 s21, s37, 28672
    buffer_load_dwordx4 v[76:79], v1, s[8:11], s21 offen offset:0 sc1
    buffer_load_dwordx4 v[84:87], v1, s[8:11], s21 offen offset:1024 sc1
    s_add_u32 s21, s37, 57344
    buffer_load_dwordx4 v[88:91], v1, s[8:11], s21 offen offset:0 sc1
    buffer_load_dwordx4 v[96:99], v1, s[8:11], s21 offen offset:1024 sc1
    s_add_u32 s21, s37, 86016
    buffer_load_dwordx4 v[92:95], v1, s[8:11], s21 offen offset:0 sc1
    buffer_load_dwordx4 v[100:103], v1, s[8:11], s21 offen offset:1024 sc1
    v_smfmac_f32_16x16x64_bf16 v[40:43], v[12:15], a[0:7], v2
    v_smfmac_f32_16x16x64_bf16 v[44:47], v[12:15], a[48:55], v2
    v_smfmac_f32_16x16x64_bf16 v[48:51], v[12:15], a[96:103], v2
    v_smfmac_f32_16x16x64_bf16 v[52:55], v[12:15], a[144:151], v2
    v_smfmac_f32_16x16x64_bf16 v[56:59], v[12:15], a[192:199], v2
    v_smfmac_f32_16x16x64_bf16 v[60:63], v[12:15], a[240:247], v2
    v_smfmac_f32_16x16x64_bf16 v[64:67], v[12:15], v[160:167], v2
    v_smfmac_f32_16x16x64_bf16 v[68:71], v[12:15], v[208:215], v2
    s_waitcnt lgkmcnt(0)
    s_barrier
    s_sub_u32 s59, s38, 229376
    s_sub_u32 s21, s32, 7168
    s_cmp_eq_u32 s16, 0
    s_cselect_b32 s59, s38, s59
    s_cselect_b32 s58, 17780736, s21
    ds_read_b128 v[20:23], v9 offset:2048
    v_smfmac_f32_16x16x64_bf16 v[40:43], v[16:19], a[8:15], v2
    ds_read_b128 v[24:27], v10 offset:3072
    v_smfmac_f32_16x16x64_bf16 v[44:47], v[16:19], a[56:63], v2
    ds_read_b128 v[28:31], v10 offset:4096
    v_smfmac_f32_16x16x64_bf16 v[48:51], v[16:19], a[104:111], v2
    ds_read_b128 v[32:35], v0 offset:5120
    v_smfmac_f32_16x16x64_bf16 v[52:55], v[16:19], a[152:159], v2
    ds_read_b128 v[36:39], v0 offset:6144
    v_smfmac_f32_16x16x64_bf16 v[56:59], v[16:19], a[200:207], v2
    ds_read_b128 v[104:107], v4 offset:0
    v_smfmac_f32_16x16x64_bf16 v[60:63], v[16:19], a[248:255], v2
    ds_read_b128 v[108:111], v4 offset:1024
    v_smfmac_f32_16x16x64_bf16 v[64:67], v[16:19], v[168:175], v2
    ds_read_b128 v[112:115], v4 offset:2048
    v_smfmac_f32_16x16x64_bf16 v[68:71], v[16:19], v[216:223], v2
    ds_read_b128 v[116:119], v4 offset:3072
    s_waitcnt lgkmcnt(8)
    v_smfmac_f32_16x16x64_bf16 v[40:43], v[20:23], a[16:23], v2
    ds_read_b128 v[120:123], v4 offset:16384
    v_smfmac_f32_16x16x64_bf16 v[44:47], v[20:23], a[64:71], v2
    s_mov_b32 exec_lo, 0x00ff00ff
    s_mov_b32 exec_hi, 0x00ff00ff
    buffer_store_dword v11, v8, s[8:11], s58 offen sc1
    s_mov_b64 exec, -1
    v_smfmac_f32_16x16x64_bf16 v[48:51], v[20:23], a[112:119], v2
    ds_read_b128 v[124:127], v4 offset:17408
    v_smfmac_f32_16x16x64_bf16 v[52:55], v[20:23], a[160:167], v2
    s_waitcnt lgkmcnt(4)
    v_smfmac_f32_16x16x64_bf16 v[40:43], v[36:39], v[104:111], v2
    v_smfmac_f32_16x16x64_bf16 v[56:59], v[20:23], a[208:215], v2
    ds_read_b128 v[104:107], v4 offset:4096
    v_smfmac_f32_16x16x64_bf16 v[60:63], v[20:23], v[128:135], v2
    ds_read_b128 v[108:111], v4 offset:5120
    s_waitcnt lgkmcnt(3)
    buffer_store_dwordx4 v[120:123], v1, s[8:11], s59 offen offset:0 sc1
    v_smfmac_f32_16x16x64_bf16 v[64:67], v[20:23], v[176:183], v2
    v_smfmac_f32_16x16x64_bf16 v[68:71], v[20:23], v[224:231], v2
    ds_read_b128 v[120:123], v4 offset:18432
    s_waitcnt lgkmcnt(5)
    v_smfmac_f32_16x16x64_bf16 v[44:47], v[36:39], v[112:119], v2
    s_waitcnt lgkmcnt(12)
    v_smfmac_f32_16x16x64_bf16 v[40:43], v[24:27], a[24:31], v2
    ds_read_b128 v[112:115], v4 offset:6144
    v_smfmac_f32_16x16x64_bf16 v[44:47], v[24:27], a[72:79], v2
    ds_read_b128 v[116:119], v4 offset:7168
    s_waitcnt lgkmcnt(5)
    buffer_store_dwordx4 v[124:127], v1, s[8:11], s59 offen offset:1024 sc1
    v_smfmac_f32_16x16x64_bf16 v[48:51], v[24:27], a[120:127], v2
    v_smfmac_f32_16x16x64_bf16 v[52:55], v[24:27], a[168:175], v2
    ds_read_b128 v[124:127], v4 offset:19456
    s_waitcnt lgkmcnt(4)
    v_smfmac_f32_16x16x64_bf16 v[48:51], v[36:39], v[104:111], v2
    v_smfmac_f32_16x16x64_bf16 v[56:59], v[24:27], a[216:223], v2
    ds_read_b128 v[104:107], v4 offset:8192
    v_smfmac_f32_16x16x64_bf16 v[60:63], v[24:27], v[136:143], v2
    ds_read_b128 v[108:111], v4 offset:9216
    s_waitcnt lgkmcnt(5)
    buffer_store_dwordx4 v[120:123], v1, s[8:11], s59 offen offset:2048 sc1
    v_smfmac_f32_16x16x64_bf16 v[64:67], v[24:27], v[184:191], v2
    v_smfmac_f32_16x16x64_bf16 v[68:71], v[24:27], v[232:239], v2
    s_waitcnt lgkmcnt(3)
    v_smfmac_f32_16x16x64_bf16 v[52:55], v[36:39], v[112:119], v2
    s_waitcnt lgkmcnt(15)
    v_smfmac_f32_16x16x64_bf16 v[40:43], v[28:31], a[32:39], v2
    ds_read_b128 v[112:115], v4 offset:10240
    v_smfmac_f32_16x16x64_bf16 v[44:47], v[28:31], a[80:87], v2
    ds_read_b128 v[116:119], v4 offset:11264
    s_waitcnt lgkmcnt(4)
    buffer_store_dwordx4 v[124:127], v1, s[8:11], s59 offen offset:3072 sc1
    v_smfmac_f32_16x16x64_bf16 v[48:51], v[28:31], a[128:135], v2
    v_smfmac_f32_16x16x64_bf16 v[52:55], v[28:31], a[176:183], v2
    s_waitcnt lgkmcnt(2)
    v_smfmac_f32_16x16x64_bf16 v[56:59], v[36:39], v[104:111], v2
    v_smfmac_f32_16x16x64_bf16 v[56:59], v[28:31], a[224:231], v2
    ds_read_b128 v[104:107], v4 offset:12288
    v_smfmac_f32_16x16x64_bf16 v[60:63], v[28:31], v[144:151], v2
    ds_read_b128 v[108:111], v4 offset:13312
    v_smfmac_f32_16x16x64_bf16 v[64:67], v[28:31], v[192:199], v2
    v_smfmac_f32_16x16x64_bf16 v[68:71], v[28:31], v[240:247], v2
    s_waitcnt lgkmcnt(2)
    v_smfmac_f32_16x16x64_bf16 v[60:63], v[36:39], v[112:119], v2
    s_waitcnt lgkmcnt(15)
    v_smfmac_f32_16x16x64_bf16 v[40:43], v[32:35], a[40:47], v2
    ds_read_b128 v[112:115], v4 offset:14336
    v_smfmac_f32_16x16x64_bf16 v[44:47], v[32:35], a[88:95], v2
    ds_read_b128 v[116:119], v4 offset:15360
    v_smfmac_f32_16x16x64_bf16 v[48:51], v[32:35], a[136:143], v2
    v_smfmac_f32_16x16x64_bf16 v[52:55], v[32:35], a[184:191], v2
    s_waitcnt lgkmcnt(2)
    v_smfmac_f32_16x16x64_bf16 v[64:67], v[36:39], v[104:111], v2
    v_smfmac_f32_16x16x64_bf16 v[56:59], v[32:35], a[232:239], v2
    v_smfmac_f32_16x16x64_bf16 v[60:63], v[32:35], v[152:159], v2
    v_smfmac_f32_16x16x64_bf16 v[64:67], v[32:35], v[200:207], v2
    v_smfmac_f32_16x16x64_bf16 v[68:71], v[32:35], v[248:255], v2
    s_waitcnt lgkmcnt(0)
    v_smfmac_f32_16x16x64_bf16 v[68:71], v[36:39], v[112:119], v2
    v_mov_b32 v120, 0
    v_mov_b32 v121, 0
    v_mov_b32 v122, 0
    v_mov_b32 v123, 0
    v_mov_b32 v124, 0
    v_mov_b32 v125, 0
    v_mov_b32 v126, 0
    v_mov_b32 v127, 0
    s_waitcnt vmcnt(13)
    v_cvt_pk_bf16_f32 v12, v40, v41
    v_cvt_pk_bf16_f32 v13, v48, v49
    v_cvt_pk_bf16_f32 v14, v42, v43
    v_cvt_pk_bf16_f32 v15, v50, v51
    v_cvt_pk_bf16_f32 v16, v56, v57
    v_cvt_pk_bf16_f32 v17, v64, v65
    v_cvt_pk_bf16_f32 v18, v58, v59
    v_cvt_pk_bf16_f32 v19, v66, v67
    v_cvt_pk_bf16_f32 v20, v44, v45
    v_cvt_pk_bf16_f32 v21, v52, v53
    v_cvt_pk_bf16_f32 v22, v46, v47
    v_cvt_pk_bf16_f32 v23, v54, v55
    v_cvt_pk_bf16_f32 v24, v60, v61
    v_cvt_pk_bf16_f32 v25, v68, v69
    v_cvt_pk_bf16_f32 v26, v62, v63
    v_cvt_pk_bf16_f32 v27, v70, v71
    ds_write_b128 v4, v[12:15] offset:16384
    ds_write_b128 v4, v[16:19] offset:17408
    ds_write_b128 v4, v[20:23] offset:18432
    ds_write_b128 v4, v[24:27] offset:19456
    s_cmp_ge_u32 s16, 63
    s_cbranch_scc1 ou_done
    s_add_u32 s21, s16, 1
    s_lshr_b32 s21, s21, 2
    s_lshl_b32 s21, s21, 7
    s_add_u32 s60, s21, 20447232
    s_mov_b32 s57, 16
    s_add_u32 s22, s21, 20460544
    s_cmp_lt_u32 s16, 7
    s_cselect_b32 s60, s22, s60
    s_cselect_b32 s57, 224, 16
    buffer_load_dword v104, off, s[8:11], s60 sc1
    s_sleep 4
    buffer_load_dwordx4 v[40:43], v1, s[8:11], s35 offen sc1
    buffer_load_dwordx4 v[44:47], v1, s[8:11], s35 offen offset:1024 sc1
    buffer_load_dwordx4 v[48:51], v5, s[8:11], s36 offen sc1
    s_sleep 2
ou_pollp:
    buffer_load_dwordx4 v[40:43], v1, s[8:11], s35 offen sc1
    buffer_load_dwordx4 v[44:47], v1, s[8:11], s35 offen offset:1024 sc1
    buffer_load_dwordx4 v[48:51], v5, s[8:11], s36 offen sc1
    s_waitcnt vmcnt(3)
    v_max3_u32 v52, v40, v41, v42
    v_max3_u32 v53, v43, v44, v45
    v_max3_u32 v54, v46, v47, v48
    v_max3_u32 v55, v49, v50, v51
    v_max3_u32 v52, v52, v53, v54
    v_max_u32 v52, v52, v55
    v_cmp_eq_u32 vcc, -1, v52
    s_cbranch_vccz ou_pollp_ok
    s_sub_u32 s17, s17, 1
    s_cmp_gt_i32 s17, 0
    s_cbranch_scc1 ou_pollp
ou_pollp_ok:
    v_smfmac_f32_16x16x64_bf16 v[120:123], v[40:43], v[72:79], v2
    v_smfmac_f32_16x16x64_bf16 v[124:127], v[40:43], v[80:87], v2
    v_smfmac_f32_16x16x64_bf16 v[120:123], v[44:47], v[88:95], v2
    v_smfmac_f32_16x16x64_bf16 v[124:127], v[44:47], v[96:103], v2
    v_smfmac_f32_16x16x64_bf16 v[120:123], v[48:51], v[12:19], v2
    v_smfmac_f32_16x16x64_bf16 v[124:127], v[48:51], v[20:27], v2
    s_nop 6
    ds_write_b128 v6, v[120:123] offset:0
    ds_write_b128 v6, v[124:127] offset:512
    s_waitcnt lgkmcnt(0)
    s_barrier
    ds_read2st64_b32 v[52:53], v7 offset0:0 offset1:4
    ds_read2st64_b32 v[54:55], v7 offset0:8 offset1:12
    ds_read2st64_b32 v[56:57], v7 offset0:16 offset1:20
    ds_read2st64_b32 v[58:59], v7 offset0:24 offset1:28
    s_waitcnt lgkmcnt(2)
    v_pk_add_f32 v[52:53], v[52:53], v[54:55]
    s_waitcnt lgkmcnt(0)
    v_pk_add_f32 v[56:57], v[56:57], v[58:59]
    v_pk_add_f32 v[52:53], v[52:53], v[56:57]
    v_add_f32 v52, v52, v53
    s_nop 1
    v_mov_b32_dpp v53, v52 row_ror:8 row_mask:0xf bank_mask:0xf
    v_cvt_pk_bf16_f32 v11, v52, v53
    s_mov_b32 exec_lo, 0x00ff00ff
    s_mov_b32 exec_hi, 0x00ff00ff
    buffer_store_dword v11, v8, s[8:11], s39 offen
    s_cmp_eq_u32 s15, 0
    s_cbranch_scc1 ou_nosl
    buffer_store_dword v11, v8, s[8:11], s32 offen sc1
    s_waitcnt vmcnt(0)
ou_nosl:
    s_mov_b64 exec, -1
    s_add_u32 s25, s25, 7168
    s_add_u32 s26, s26, 7168
    s_add_u32 s35, s35, 10240
    s_add_u32 s36, s36, 10240
    s_add_u32 s37, s37, 458752
    s_add_u32 s38, s38, 229376
    s_add_u32 s39, s39, 7168
    s_add_u32 s32, s32, 7168
    s_add_u32 s55, s55, 10240
    s_add_u32 s56, s56, 7168
    s_add_u32 s16, s16, 1
    s_branch ou_loop
ou_done:
    buffer_store_dwordx4 v[12:15], v1, s[8:11], s38 offen offset:0 sc1
    buffer_store_dwordx4 v[16:19], v1, s[8:11], s38 offen offset:1024 sc1
    buffer_store_dwordx4 v[20:23], v1, s[8:11], s38 offen offset:2048 sc1
    buffer_store_dwordx4 v[24:27], v1, s[8:11], s38 offen offset:3072 sc1
    s_waitcnt vmcnt(0)
    s_lshl_b32 s20, s33, 2
    s_add_u32 s20, s20, s14
    s_lshl_b32 s20, s20, 7
    s_add_u32 s20, s20, 17764352
    v_mov_b32 v11, 0
    s_mov_b64 exec, 1
    buffer_store_dword v11, off, s[8:11], s20 sc1
    s_mov_b64 exec, -1
    s_endpgm
ch_pref:
    s_mov_b32 s22, 20499456
    s_cmp_lg_u32 s14, 0
    s_cbranch_scc1 pf_wx_ok
pf_wx:
    buffer_load_dword v19, off, s[8:11], s22 sc1
    s_waitcnt vmcnt(0)
    v_readfirstlane_b32 s20, v19
    s_nop 2
    s_cmp_ge_u32 s20, 32
    s_cbranch_scc1 pf_wx_ok
    s_sleep 2
    s_sub_u32 s17, s17, 1
    s_cmp_gt_i32 s17, 0
    s_cbranch_scc1 pf_wx
pf_wx_ok:
    s_barrier
    s_cmp_lg_u32 s14, 0
    s_cbranch_scc1 pf_mode_wait
    s_mov_b64 exec, 1
    v_mov_b32 v17, 0
pf_mode_poll:
    global_load_dwordx2 v[18:19], v17, s[6:7] sc1
    s_waitcnt vmcnt(0)
    v_readfirstlane_b32 s20, v18
    v_readfirstlane_b32 s21, v19
    s_nop 2
    s_add_u32 s21, s21, s20
    s_cmp_ge_u32 s21, 32
    s_cselect_b32 s21, 256, 0
    s_mov_b32 s15, 0
    s_cmp_ge_u32 s20, 32
    s_cbranch_scc1 pf_mode_pub
    s_mov_b32 s15, 1
    s_cmp_ge_u32 s21, 256
    s_cbranch_scc1 pf_mode_pub
    s_sleep 2
    s_sub_u32 s17, s17, 1
    s_cmp_gt_i32 s17, 0
    s_cbranch_scc1 pf_mode_poll
pf_mode_pub:
    s_mov_b64 exec, 1
    v_mov_b32 v18, s15
    v_mov_b32 v19, 105476
    ds_write_b32 v19, v18
    s_waitcnt lgkmcnt(0)
    s_mov_b64 exec, -1
pf_mode_wait:
    s_barrier
    v_mov_b32 v19, 105476
    ds_read_b32 v18, v19
    s_waitcnt lgkmcnt(0)
    v_readfirstlane_b32 s15, v18
    s_nop 3
    s_mul_i32 s30, s15, 524288
    s_add_u32 s30, s30, 16777216
    s_mul_i32 s31, s15, 1048576
    s_add_u32 s31, s31, 17825792
    s_mov_b32 s40, s14
ch_pf2:
    s_cmp_lg_u32 s15, 0
    s_cbranch_scc1 ch_exit
    v_lshlrev_b32 v3, 7, v0
    v_mov_b32 v4, 0
    s_mul_i32 s41, s40, 65536
    s_add_u32 s41, s41, 37748736
    s_mov_b32 s43, 0
    s_mov_b32 s43, 1
    s_mov_b32 s16, 0
    s_mov_b32 s44, s30
pf_loop:
pf_poll:
    buffer_load_dword v6, v4, s[8:11], s44 offen sc1
    s_waitcnt vmcnt(0)
    v_cmp_eq_u32 vcc, -1, v6
    s_cbranch_vccz pf_ok
    s_sleep 4
    s_sub_u32 s17, s17, 1
    s_cmp_gt_i32 s17, 0
    s_cbranch_scc1 pf_poll
pf_ok:
    s_cmp_lg_u32 s40, 0
    s_cbranch_scc1 pf_n4
    s_add_u32 s42, s16, 1
    s_mul_i32 s42, s42, 10240
    s_add_u32 s42, s42, s31
    buffer_load_dword v5, v3, s[8:11], s42 offen
    buffer_load_dword v5, v3, s[8:11], s42 offen offset:2048
pf_n4:
    s_cmp_lg_u32 s40, 1
    s_cbranch_scc1 pf_n5
    s_add_u32 s42, s44, 14336
    buffer_load_dword v5, v3, s[8:11], s42 offen
pf_n5:
    s_add_u32 s43, s16, 2
    s_min_u32 s43, s43, 63
    s_add_u32 s44, s44, 7168
    s_add_u32 s16, s16, 1
    s_cmp_lt_u32 s16, 62
    s_cbranch_scc1 pf_loop
    s_waitcnt vmcnt(0)
    s_endpgm
ch_pub:
    s_mov_b32 s22, 20499456
    s_cmp_lg_u32 s14, 0
    s_cbranch_scc1 pb_wx_ok
pb_wx:
    buffer_load_dword v19, off, s[8:11], s22 sc1
    s_waitcnt vmcnt(0)
    v_readfirstlane_b32 s20, v19
    s_nop 2
    s_cmp_ge_u32 s20, 32
    s_cbranch_scc1 pb_wx_ok
    s_sleep 2
    s_sub_u32 s17, s17, 1
    s_cmp_gt_i32 s17, 0
    s_cbranch_scc1 pb_wx
pb_wx_ok:
    s_barrier
    s_cmp_lg_u32 s14, 0
    s_cbranch_scc1 pb_mode_wait
    s_mov_b64 exec, 1
    v_mov_b32 v17, 0
pb_mode_poll:
    global_load_dwordx2 v[18:19], v17, s[6:7] sc1
    s_waitcnt vmcnt(0)
    v_readfirstlane_b32 s20, v18
    v_readfirstlane_b32 s21, v19
    s_nop 2
    s_add_u32 s21, s21, s20
    s_cmp_ge_u32 s21, 32
    s_cselect_b32 s21, 256, 0
    s_mov_b32 s15, 0
    s_cmp_ge_u32 s20, 32
    s_cbranch_scc1 pb_mode_pub
    s_mov_b32 s15, 1
    s_cmp_ge_u32 s21, 256
    s_cbranch_scc1 pb_mode_pub
    s_sleep 2
    s_sub_u32 s17, s17, 1
    s_cmp_gt_i32 s17, 0
    s_cbranch_scc1 pb_mode_poll
pb_mode_pub:
    s_mov_b64 exec, 1
    v_mov_b32 v18, s15
    v_mov_b32 v19, 105476
    ds_write_b32 v19, v18
    s_waitcnt lgkmcnt(0)
    s_mov_b64 exec, -1
pb_mode_wait:
    s_barrier
    v_mov_b32 v19, 105476
    ds_read_b32 v18, v19
    s_waitcnt lgkmcnt(0)
    v_readfirstlane_b32 s15, v18
    s_nop 3
    s_mul_i32 s30, s15, 524288
    s_add_u32 s30, s30, 16777216
    s_mul_i32 s31, s15, 1048576
    s_add_u32 s31, s31, 17825792
    s_add_u32 s40, s14, 3
    s_cmp_lg_u32 s14, 0
    s_cbranch_scc1 ch_exit
    v_lshlrev_b32 v3, 7, v0
    v_min_u32 v3, 7040, v3
    s_mov_b32 s16, 1
    s_add_u32 s44, s30, 7168
pb_loop:
pb_poll:
    buffer_load_dword v6, v3, s[8:11], s44 offen sc1
    s_waitcnt vmcnt(0)
    v_cmp_eq_u32 vcc, -1, v6
    s_cbranch_vccz pb_ok
    s_sleep 3
    s_sub_u32 s17, s17, 1
    s_cmp_gt_i32 s17, 0
    s_cbranch_scc1 pb_poll
pb_ok:
    s_sub_u32 s46, s16, 1
    s_cmp_eq_u32 s16, 64
    s_cselect_b32 s46, 64, s46
    v_mov_b32 v7, s46
    s_mov_b32 s45, 20459520
    s_mov_b64 exec, 1
    buffer_store_dword v7, off, s[8:11], s45 sc1
    s_mov_b64 exec, -1
    s_add_u32 s44, s44, 7168
    s_add_u32 s16, s16, 1
    s_cmp_lt_u32 s16, 64
    s_cbranch_scc1 pb_loop
    s_cmp_gt_u32 s16, 64
    s_cbranch_scc1 ch_exit
    s_mov_b32 s44, 17764352
    s_branch pb_loop
ch_worker_entry:
    v_and_b32 v0, 63, v0
    s_and_b32 s27, s12, 7
    s_lshl_b32 s27, s27, 7
    s_add_u32 s27, s27, 20496384
    s_waitcnt vmcnt(0)
    s_cmp_lg_u32 s14, 0
    s_cbranch_scc1 v4_go_ok
v4_go:
    buffer_load_dword v251, off, s[8:11], s27 sc1
    s_waitcnt vmcnt(0)
    v_readfirstlane_b32 s26, v251
    s_nop 2
    s_cmp_ge_u32 s26, 1
    s_cbranch_scc1 v4_go_ok
    s_sleep 1
    s_sub_u32 s17, s17, 1
    s_cmp_gt_i32 s17, 0
    s_cbranch_scc1 v4_go
v4_go_ok:
    s_barrier
    s_getpc_b64 s[20:21]
ctch1:
    s_sub_u32 s20, s20, ctch1-main_kernel
    s_subb_u32 s21, s21, 0
    v_lshlrev_b32 v248, 7, v0
    s_lshl_b32 s22, s14, 13
    v_add_u32 v248, s22, v248
    v_min_u32 v246, main_code_end-main_kernel-4, v248
    global_load_dword v247, v246, s[20:21]
    v_add_u32 v248, 0x8000, v248
    v_min_u32 v246, main_code_end-main_kernel-4, v248
    global_load_dword v247, v246, s[20:21]
    v_add_u32 v248, 0x8000, v248
    v_min_u32 v246, main_code_end-main_kernel-4, v248
    global_load_dword v247, v246, s[20:21]
    v_add_u32 v248, 0x8000, v248
st_next:
    s_mov_b32 s30, 20460288
    s_cmp_lg_u32 s14, 0
    s_cbranch_scc1 stc_cw
    s_mov_b64 exec, 1
    v_mov_b32 v251, 1
    buffer_atomic_add v251, off, s[8:11], s30 sc0
    v_mov_b32 v250, 143360
    s_waitcnt vmcnt(0)
    ds_write_b32 v250, v251
    s_waitcnt lgkmcnt(0)
    s_mov_b64 exec, -1
stc_cw:
    s_barrier
    v_mov_b32 v250, 143360
    ds_read_b32 v251, v250
    s_waitcnt lgkmcnt(0)
    v_readfirstlane_b32 s29, v251
    s_barrier
    s_nop 3
    s_cmp_ge_u32 s29, 448
    s_cbranch_scc1 st_skip
    s_cmp_ge_u32 s29, 224
    s_cselect_b32 s40, 1, 0
    s_mul_i32 s20, s40, 224
    s_sub_u32 s29, s29, s20
    s_mul_hi_u32 s41, s29, 306783379
    s_mul_i32 s20, s41, 14
    s_sub_u32 s42, s29, s20
    v_lshlrev_b32 v1, 4, v0
    v_bfe_u32 v2, v0, 4, 1
    v_mul_u32_u24 v2, 14336, v2
    v_lshrrev_b32 v250, 5, v0
    v_lshl_add_u32 v2, v250, 8, v2
    v_and_b32 v250, 15, v0
    v_lshl_add_u32 v2, v250, 4, v2
    v_bfe_u32 v3, v0, 4, 1
    v_mul_u32_u24 v3, 1024, v3
    v_lshrrev_b32 v250, 5, v0
    v_lshl_add_u32 v3, v250, 8, v3
    v_and_b32 v250, 15, v0
    v_lshl_add_u32 v3, v250, 4, v3
    s_mul_i32 s43, s41, 401408
    s_mul_i32 s20, s42, 28672
    s_add_u32 s43, s43, s20
    s_mul_i32 s44, s14, 7168
    s_add_u32 s43, s43, s44
    s_add_u32 s43, s43, 9437184
    s_add_u32 m0, s44, 0
    s_add_u32 s21, s43, 0
    buffer_load_dwordx4 v1, s[8:11], s21 offen lds
    s_add_u32 m0, s44, 1024
    s_add_u32 s21, s43, 1024
    buffer_load_dwordx4 v1, s[8:11], s21 offen lds
    s_add_u32 m0, s44, 2048
    s_add_u32 s21, s43, 2048
    buffer_load_dwordx4 v1, s[8:11], s21 offen lds
    s_add_u32 m0, s44, 3072
    s_add_u32 s21, s43, 3072
    buffer_load_dwordx4 v1, s[8:11], s21 offen lds
    s_add_u32 m0, s44, 4096
    s_add_u32 s21, s43, 4096
    buffer_load_dwordx4 v1, s[8:11], s21 offen lds
    s_add_u32 m0, s44, 5120
    s_add_u32 s21, s43, 5120
    buffer_load_dwordx4 v1, s[8:11], s21 offen lds
    s_add_u32 m0, s44, 6144
    s_add_u32 s21, s43, 6144
    buffer_load_dwordx4 v1, s[8:11], s21 offen lds
    s_lshl_b32 s45, s14, 1
    s_lshl_b32 s20, s40, 3
    s_add_u32 s45, s45, s20
    s_mul_i32 s46, s45, 14336
    s_add_u32 s22, s46, 0
    buffer_load_dwordx4 a[0:3], v2, s[8:11], s22 offen offset:0
    buffer_load_dwordx4 a[4:7], v2, s[8:11], s22 offen offset:512
    buffer_load_dwordx4 a[8:11], v2, s[8:11], s22 offen offset:1024
    buffer_load_dwordx4 a[12:15], v2, s[8:11], s22 offen offset:1536
    buffer_load_dwordx4 a[16:19], v2, s[8:11], s22 offen offset:2048
    buffer_load_dwordx4 a[20:23], v2, s[8:11], s22 offen offset:2560
    buffer_load_dwordx4 a[24:27], v2, s[8:11], s22 offen offset:3072
    buffer_load_dwordx4 a[28:31], v2, s[8:11], s22 offen offset:3584
    s_add_u32 s22, s46, 4096
    buffer_load_dwordx4 a[32:35], v2, s[8:11], s22 offen offset:0
    buffer_load_dwordx4 a[36:39], v2, s[8:11], s22 offen offset:512
    buffer_load_dwordx4 a[40:43], v2, s[8:11], s22 offen offset:1024
    buffer_load_dwordx4 a[44:47], v2, s[8:11], s22 offen offset:1536
    buffer_load_dwordx4 a[48:51], v2, s[8:11], s22 offen offset:2048
    buffer_load_dwordx4 a[52:55], v2, s[8:11], s22 offen offset:2560
    buffer_load_dwordx4 a[56:59], v2, s[8:11], s22 offen offset:3072
    buffer_load_dwordx4 a[60:63], v2, s[8:11], s22 offen offset:3584
    s_add_u32 s22, s46, 8192
    buffer_load_dwordx4 a[64:67], v2, s[8:11], s22 offen offset:0
    buffer_load_dwordx4 a[68:71], v2, s[8:11], s22 offen offset:512
    buffer_load_dwordx4 a[72:75], v2, s[8:11], s22 offen offset:1024
    buffer_load_dwordx4 a[76:79], v2, s[8:11], s22 offen offset:1536
    buffer_load_dwordx4 a[80:83], v2, s[8:11], s22 offen offset:2048
    buffer_load_dwordx4 a[84:87], v2, s[8:11], s22 offen offset:2560
    buffer_load_dwordx4 a[88:91], v2, s[8:11], s22 offen offset:3072
    buffer_load_dwordx4 a[92:95], v2, s[8:11], s22 offen offset:3584
    s_add_u32 s22, s46, 12288
    buffer_load_dwordx4 a[96:99], v2, s[8:11], s22 offen offset:0
    buffer_load_dwordx4 a[100:103], v2, s[8:11], s22 offen offset:512
    buffer_load_dwordx4 a[104:107], v2, s[8:11], s22 offen offset:1024
    buffer_load_dwordx4 a[108:111], v2, s[8:11], s22 offen offset:1536
    s_waitcnt vmcnt(0)
    s_barrier
    ds_read_b128 v[16:19], v2 offset:0
    ds_read_b128 v[20:23], v2 offset:512
    ds_read_b128 v[24:27], v2 offset:1024
    ds_read_b128 v[28:31], v2 offset:1536
    ds_read_b128 v[32:35], v2 offset:2048
    ds_read_b128 v[36:39], v2 offset:2560
    ds_read_b128 v[40:43], v2 offset:3072
    ds_read_b128 v[44:47], v2 offset:3584
    s_waitcnt lgkmcnt(4)
    ds_read_b128 v[48:51], v2 offset:4096
    ds_read_b128 v[52:55], v2 offset:4608
    ds_read_b128 v[56:59], v2 offset:5120
    ds_read_b128 v[60:63], v2 offset:5632
    ds_read_b128 v[64:67], v2 offset:6144
    ds_read_b128 v[68:71], v2 offset:6656
    ds_read_b128 v[72:75], v2 offset:7168
    ds_read_b128 v[76:79], v2 offset:7680
    s_waitcnt lgkmcnt(4)
    ds_read_b128 v[80:83], v2 offset:8192
    ds_read_b128 v[84:87], v2 offset:8704
    ds_read_b128 v[88:91], v2 offset:9216
    ds_read_b128 v[92:95], v2 offset:9728
    ds_read_b128 v[96:99], v2 offset:10240
    ds_read_b128 v[100:103], v2 offset:10752
    ds_read_b128 v[104:107], v2 offset:11264
    ds_read_b128 v[108:111], v2 offset:11776
    s_waitcnt lgkmcnt(4)
    ds_read_b128 v[112:115], v2 offset:12288
    ds_read_b128 v[116:119], v2 offset:12800
    ds_read_b128 v[120:123], v2 offset:13312
    ds_read_b128 v[124:127], v2 offset:13824
    s_waitcnt lgkmcnt(0)
    v_mfma_f32_32x32x16_bf16 v[128:143], a[0:3], v[16:19], 0
    v_mfma_f32_32x32x16_bf16 v[128:143], a[4:7], v[20:23], v[128:143]
    v_mfma_f32_32x32x16_bf16 v[128:143], a[8:11], v[24:27], v[128:143]
    v_mfma_f32_32x32x16_bf16 v[128:143], a[12:15], v[28:31], v[128:143]
    v_mfma_f32_32x32x16_bf16 v[128:143], a[16:19], v[32:35], v[128:143]
    v_mfma_f32_32x32x16_bf16 v[128:143], a[20:23], v[36:39], v[128:143]
    v_mfma_f32_32x32x16_bf16 v[128:143], a[24:27], v[40:43], v[128:143]
    v_mfma_f32_32x32x16_bf16 v[128:143], a[28:31], v[44:47], v[128:143]
    v_mfma_f32_32x32x16_bf16 v[128:143], a[32:35], v[48:51], v[128:143]
    v_mfma_f32_32x32x16_bf16 v[128:143], a[36:39], v[52:55], v[128:143]
    v_mfma_f32_32x32x16_bf16 v[128:143], a[40:43], v[56:59], v[128:143]
    v_mfma_f32_32x32x16_bf16 v[128:143], a[44:47], v[60:63], v[128:143]
    v_mfma_f32_32x32x16_bf16 v[128:143], a[48:51], v[64:67], v[128:143]
    v_mfma_f32_32x32x16_bf16 v[128:143], a[52:55], v[68:71], v[128:143]
    v_mfma_f32_32x32x16_bf16 v[128:143], a[56:59], v[72:75], v[128:143]
    v_mfma_f32_32x32x16_bf16 v[128:143], a[60:63], v[76:79], v[128:143]
    v_mfma_f32_32x32x16_bf16 v[128:143], a[64:67], v[80:83], v[128:143]
    v_mfma_f32_32x32x16_bf16 v[128:143], a[68:71], v[84:87], v[128:143]
    v_mfma_f32_32x32x16_bf16 v[128:143], a[72:75], v[88:91], v[128:143]
    v_mfma_f32_32x32x16_bf16 v[128:143], a[76:79], v[92:95], v[128:143]
    v_mfma_f32_32x32x16_bf16 v[128:143], a[80:83], v[96:99], v[128:143]
    v_mfma_f32_32x32x16_bf16 v[128:143], a[84:87], v[100:103], v[128:143]
    v_mfma_f32_32x32x16_bf16 v[128:143], a[88:91], v[104:107], v[128:143]
    v_mfma_f32_32x32x16_bf16 v[128:143], a[92:95], v[108:111], v[128:143]
    v_mfma_f32_32x32x16_bf16 v[128:143], a[96:99], v[112:115], v[128:143]
    v_mfma_f32_32x32x16_bf16 v[128:143], a[100:103], v[116:119], v[128:143]
    v_mfma_f32_32x32x16_bf16 v[128:143], a[104:107], v[120:123], v[128:143]
    v_mfma_f32_32x32x16_bf16 v[128:143], a[108:111], v[124:127], v[128:143]
    s_lshl_b32 s48, s40, 2
    s_add_u32 s48, s48, s14
    s_lshl_b32 s48, s48, 4
    s_add_u32 s48, s48, s41
    s_mul_i32 s49, s48, 28672
    s_lshl_b32 s20, s42, 11
    s_add_u32 s49, s49, s20
    s_add_u32 s49, s49, 37748736
    s_nop 3
    v_cvt_pk_bf16_f32 v144, v128, v129
    v_cvt_pk_bf16_f32 v145, v132, v133
    v_cvt_pk_bf16_f32 v146, v130, v131
    v_cvt_pk_bf16_f32 v147, v134, v135
    buffer_store_dwordx4 v[144:147], v3, s[8:11], s49 offen offset:0 sc1
    v_cvt_pk_bf16_f32 v148, v136, v137
    v_cvt_pk_bf16_f32 v149, v140, v141
    v_cvt_pk_bf16_f32 v150, v138, v139
    v_cvt_pk_bf16_f32 v151, v142, v143
    buffer_store_dwordx4 v[148:151], v3, s[8:11], s49 offen offset:512 sc1
    s_waitcnt vmcnt(0)
    s_barrier
    s_cmp_lg_u32 s14, 0
    s_cbranch_scc1 stt_sg
    s_lshl_b32 s24, s40, 7
    s_add_u32 s24, s24, 20460544
    s_mov_b64 exec, 1
    v_mov_b32 v251, 1
    buffer_atomic_add v251, off, s[8:11], s24
    s_mov_b64 exec, -1
stt_sg:
    s_barrier
    s_branch st_next
st_skip:
    s_add_u32 s90, s12, 6
    s_cmp_ge_u32 s90, 7
    s_cselect_b32 s20, 7, 0
    s_sub_u32 s90, s90, s20
    s_cmp_ge_u32 s90, 7
    s_cselect_b32 s20, 7, 0
    s_sub_u32 s90, s90, s20
    s_cmp_ge_u32 s90, 7
    s_cselect_b32 s20, 7, 0
    s_sub_u32 s90, s90, s20
    s_mov_b32 s91, 0
wkv_next:
    s_lshl_b32 s92, s90, 7
    s_add_u32 s92, s92, 20451328
    s_cmp_lg_u32 s14, 0
    s_cbranch_scc1 wkv_cw
    s_mov_b64 exec, 1
    v_mov_b32 v251, 1
    buffer_atomic_add v251, off, s[8:11], s92 sc0
    v_mov_b32 v250, 143360
    s_waitcnt vmcnt(0)
    ds_write_b32 v250, v251
    s_waitcnt lgkmcnt(0)
    s_mov_b64 exec, -1
wkv_cw:
    s_barrier
    v_mov_b32 v250, 143360
    ds_read_b32 v251, v250
    s_waitcnt lgkmcnt(0)
    v_readfirstlane_b32 s93, v251
    s_barrier
    s_nop 3
    s_cmp_lt_u32 s90, 2
    s_cselect_b32 s94, 42, 28
    s_cmp_lt_u32 s93, s94
    s_cbranch_scc1 wkv_run
    s_add_u32 s91, s91, 1
    s_cmp_ge_u32 s91, 7
    s_cbranch_scc1 wkv_done
    s_add_u32 s90, s90, 1
    s_cmp_ge_u32 s90, 7
    s_cselect_b32 s20, 7, 0
    s_sub_u32 s90, s90, s20
    s_branch wkv_next
wkv_run:
    s_lshr_b32 s40, s93, 1
    s_and_b32 s41, s93, 1
    s_cmp_lt_u32 s90, 2
    s_cbranch_scc0 wkv_two
    s_mul_hi_u32 s40, s93, 1431655766
    s_mul_i32 s20, s40, 3
    s_sub_u32 s41, s93, s20
wkv_two:
    s_add_u32 s40, s40, 2
    s_mul_i32 s41, s41, 7
    s_add_u32 s41, s41, s90
    v_lshlrev_b32 v1, 4, v0
    v_bfe_u32 v2, v0, 4, 1
    v_mul_u32_u24 v2, 14336, v2
    v_lshrrev_b32 v250, 5, v0
    v_lshl_add_u32 v2, v250, 8, v2
    v_and_b32 v250, 15, v0
    v_lshl_add_u32 v2, v250, 4, v2
    v_bfe_u32 v3, v0, 4, 1
    v_mul_u32_u24 v3, 1024, v3
    v_lshrrev_b32 v250, 5, v0
    v_lshl_add_u32 v3, v250, 8, v3
    v_and_b32 v250, 15, v0
    v_lshl_add_u32 v3, v250, 4, v3
    v_mov_b32 v4, v2
    v_add_u32 v5, 57344, v2
    v_add_u32 v6, 114688, v2
    s_mul_i32 s42, s41, 401408
    s_mul_i32 s20, s14, 7168
    s_add_u32 s42, s42, s20
    s_add_u32 s43, s42, 9437184
    s_add_u32 s42, s42, 2097152
    s_mov_b32 s44, s20
    s_lshl_b32 s45, s40, 3
    s_lshl_b32 s20, s14, 1
    s_add_u32 s45, s45, s20
    s_mul_i32 s46, s45, 14336
    s_lshl_b32 s47, s41, 7
    s_add_u32 s47, s47, s45
    s_mul_i32 s47, s47, 14336
    s_add_u32 s47, s47, 67108864
    s_lshl_b32 s48, s40, 2
    s_add_u32 s48, s48, s14
    s_lshl_b32 s48, s48, 4
    s_add_u32 s48, s48, s41
    s_mul_i32 s49, s48, 28672
    s_add_u32 s49, s49, 37748736
    s_lshl_b32 s50, s48, 12
    s_add_u32 s50, s50, 96468992
    s_add_u32 s22, s46, 0
    buffer_load_dwordx4 a[0:3], v2, s[8:11], s22 offen offset:0
    buffer_load_dwordx4 a[4:7], v2, s[8:11], s22 offen offset:512
    buffer_load_dwordx4 a[8:11], v2, s[8:11], s22 offen offset:1024
    buffer_load_dwordx4 a[12:15], v2, s[8:11], s22 offen offset:1536
    buffer_load_dwordx4 a[16:19], v2, s[8:11], s22 offen offset:2048
    buffer_load_dwordx4 a[20:23], v2, s[8:11], s22 offen offset:2560
    buffer_load_dwordx4 a[24:27], v2, s[8:11], s22 offen offset:3072
    buffer_load_dwordx4 a[28:31], v2, s[8:11], s22 offen offset:3584
    s_add_u32 s22, s46, 4096
    buffer_load_dwordx4 a[32:35], v2, s[8:11], s22 offen offset:0
    buffer_load_dwordx4 a[36:39], v2, s[8:11], s22 offen offset:512
    buffer_load_dwordx4 a[40:43], v2, s[8:11], s22 offen offset:1024
    buffer_load_dwordx4 a[44:47], v2, s[8:11], s22 offen offset:1536
    buffer_load_dwordx4 a[48:51], v2, s[8:11], s22 offen offset:2048
    buffer_load_dwordx4 a[52:55], v2, s[8:11], s22 offen offset:2560
    buffer_load_dwordx4 a[56:59], v2, s[8:11], s22 offen offset:3072
    buffer_load_dwordx4 a[60:63], v2, s[8:11], s22 offen offset:3584
    s_add_u32 s22, s46, 8192
    buffer_load_dwordx4 a[64:67], v2, s[8:11], s22 offen offset:0
    buffer_load_dwordx4 a[68:71], v2, s[8:11], s22 offen offset:512
    buffer_load_dwordx4 a[72:75], v2, s[8:11], s22 offen offset:1024
    buffer_load_dwordx4 a[76:79], v2, s[8:11], s22 offen offset:1536
    buffer_load_dwordx4 a[80:83], v2, s[8:11], s22 offen offset:2048
    buffer_load_dwordx4 a[84:87], v2, s[8:11], s22 offen offset:2560
    buffer_load_dwordx4 a[88:91], v2, s[8:11], s22 offen offset:3072
    buffer_load_dwordx4 a[92:95], v2, s[8:11], s22 offen offset:3584
    s_add_u32 s22, s46, 12288
    buffer_load_dwordx4 a[96:99], v2, s[8:11], s22 offen offset:0
    buffer_load_dwordx4 a[100:103], v2, s[8:11], s22 offen offset:512
    buffer_load_dwordx4 a[104:107], v2, s[8:11], s22 offen offset:1024
    buffer_load_dwordx4 a[108:111], v2, s[8:11], s22 offen offset:1536
    s_add_u32 m0, s44, 0
    s_add_u32 s21, s43, 0
    buffer_load_dwordx4 v1, s[8:11], s21 offen offset:0 lds
    buffer_load_dwordx4 v1, s[8:11], s21 offen offset:1024 lds
    buffer_load_dwordx4 v1, s[8:11], s21 offen offset:2048 lds
    buffer_load_dwordx4 v1, s[8:11], s21 offen offset:3072 lds
    s_add_u32 m0, s44, 4096
    s_add_u32 s21, s43, 4096
    buffer_load_dwordx4 v1, s[8:11], s21 offen offset:0 lds
    buffer_load_dwordx4 v1, s[8:11], s21 offen offset:1024 lds
    buffer_load_dwordx4 v1, s[8:11], s21 offen offset:2048 lds
    s_add_u32 m0, s44, 28672
    s_add_u32 s21, s43, 28672
    buffer_load_dwordx4 v1, s[8:11], s21 offen offset:0 lds
    buffer_load_dwordx4 v1, s[8:11], s21 offen offset:1024 lds
    buffer_load_dwordx4 v1, s[8:11], s21 offen offset:2048 lds
    buffer_load_dwordx4 v1, s[8:11], s21 offen offset:3072 lds
    s_add_u32 m0, s44, 32768
    s_add_u32 s21, s43, 32768
    buffer_load_dwordx4 v1, s[8:11], s21 offen offset:0 lds
    buffer_load_dwordx4 v1, s[8:11], s21 offen offset:1024 lds
    buffer_load_dwordx4 v1, s[8:11], s21 offen offset:2048 lds
    s_add_u32 m0, s44, 57344
    s_add_u32 s21, s43, 57344
    buffer_load_dwordx4 v1, s[8:11], s21 offen offset:0 lds
    buffer_load_dwordx4 v1, s[8:11], s21 offen offset:1024 lds
    buffer_load_dwordx4 v1, s[8:11], s21 offen offset:2048 lds
    buffer_load_dwordx4 v1, s[8:11], s21 offen offset:3072 lds
    s_add_u32 m0, s44, 61440
    s_add_u32 s21, s43, 61440
    buffer_load_dwordx4 v1, s[8:11], s21 offen offset:0 lds
    buffer_load_dwordx4 v1, s[8:11], s21 offen offset:1024 lds
    buffer_load_dwordx4 v1, s[8:11], s21 offen offset:2048 lds
    s_waitcnt vmcnt(14)
    s_barrier
    ds_read_b128 v[8:11], v4 offset:0
    ds_read_b128 v[12:15], v4 offset:512
    ds_read_b128 v[16:19], v4 offset:1024
    ds_read_b128 v[20:23], v4 offset:1536
    ds_read_b128 v[24:27], v4 offset:2048
    s_waitcnt lgkmcnt(4)
    v_mfma_f32_32x32x16_bf16 v[32:47], a[0:3], v[8:11], 0
    ds_read_b128 v[28:31], v4 offset:2560
    s_waitcnt lgkmcnt(4)
    v_mfma_f32_32x32x16_bf16 v[32:47], a[4:7], v[12:15], v[32:47]
    ds_read_b128 v[8:11], v4 offset:3072
    s_add_u32 m0, s44, 86016
    s_add_u32 s21, s43, 86016
    buffer_load_dwordx4 v1, s[8:11], s21 offen lds
    s_waitcnt lgkmcnt(4)
    v_mfma_f32_32x32x16_bf16 v[32:47], a[8:11], v[16:19], v[32:47]
    ds_read_b128 v[12:15], v4 offset:3584
    s_waitcnt lgkmcnt(4)
    v_mfma_f32_32x32x16_bf16 v[32:47], a[12:15], v[20:23], v[32:47]
    ds_read_b128 v[16:19], v4 offset:4096
    s_waitcnt lgkmcnt(4)
    v_mfma_f32_32x32x16_bf16 v[32:47], a[16:19], v[24:27], v[32:47]
    ds_read_b128 v[20:23], v4 offset:4608
    s_waitcnt lgkmcnt(4)
    v_mfma_f32_32x32x16_bf16 v[32:47], a[20:23], v[28:31], v[32:47]
    ds_read_b128 v[24:27], v4 offset:5120
    s_add_u32 m0, s44, 87040
    s_add_u32 s21, s43, 87040
    buffer_load_dwordx4 v1, s[8:11], s21 offen lds
    s_waitcnt lgkmcnt(4)
    v_mfma_f32_32x32x16_bf16 v[32:47], a[24:27], v[8:11], v[32:47]
    ds_read_b128 v[28:31], v4 offset:5632
    s_waitcnt lgkmcnt(4)
    v_mfma_f32_32x32x16_bf16 v[32:47], a[28:31], v[12:15], v[32:47]
    ds_read_b128 v[8:11], v4 offset:6144
    s_waitcnt lgkmcnt(4)
    v_mfma_f32_32x32x16_bf16 v[32:47], a[32:35], v[16:19], v[32:47]
    ds_read_b128 v[12:15], v4 offset:6656
    s_waitcnt lgkmcnt(4)
    v_mfma_f32_32x32x16_bf16 v[32:47], a[36:39], v[20:23], v[32:47]
    ds_read_b128 v[16:19], v4 offset:7168
    s_add_u32 m0, s44, 88064
    s_add_u32 s21, s43, 88064
    buffer_load_dwordx4 v1, s[8:11], s21 offen lds
    s_waitcnt lgkmcnt(4)
    v_mfma_f32_32x32x16_bf16 v[32:47], a[40:43], v[24:27], v[32:47]
    ds_read_b128 v[20:23], v4 offset:7680
    s_waitcnt lgkmcnt(4)
    v_mfma_f32_32x32x16_bf16 v[32:47], a[44:47], v[28:31], v[32:47]
    ds_read_b128 v[24:27], v4 offset:8192
    s_waitcnt lgkmcnt(4)
    v_mfma_f32_32x32x16_bf16 v[32:47], a[48:51], v[8:11], v[32:47]
    ds_read_b128 v[28:31], v4 offset:8704
    s_waitcnt lgkmcnt(4)
    v_mfma_f32_32x32x16_bf16 v[32:47], a[52:55], v[12:15], v[32:47]
    ds_read_b128 v[8:11], v4 offset:9216
    s_add_u32 m0, s44, 89088
    s_add_u32 s21, s43, 89088
    buffer_load_dwordx4 v1, s[8:11], s21 offen lds
    s_waitcnt lgkmcnt(4)
    v_mfma_f32_32x32x16_bf16 v[32:47], a[56:59], v[16:19], v[32:47]
    ds_read_b128 v[12:15], v4 offset:9728
    s_waitcnt lgkmcnt(4)
    v_mfma_f32_32x32x16_bf16 v[32:47], a[60:63], v[20:23], v[32:47]
    ds_read_b128 v[16:19], v4 offset:10240
    s_waitcnt lgkmcnt(4)
    v_mfma_f32_32x32x16_bf16 v[32:47], a[64:67], v[24:27], v[32:47]
    ds_read_b128 v[20:23], v4 offset:10752
    s_waitcnt lgkmcnt(4)
    v_mfma_f32_32x32x16_bf16 v[32:47], a[68:71], v[28:31], v[32:47]
    ds_read_b128 v[24:27], v4 offset:11264
    s_add_u32 m0, s44, 90112
    s_add_u32 s21, s43, 90112
    buffer_load_dwordx4 v1, s[8:11], s21 offen lds
    s_waitcnt lgkmcnt(4)
    v_mfma_f32_32x32x16_bf16 v[32:47], a[72:75], v[8:11], v[32:47]
    ds_read_b128 v[28:31], v4 offset:11776
    s_waitcnt lgkmcnt(4)
    v_mfma_f32_32x32x16_bf16 v[32:47], a[76:79], v[12:15], v[32:47]
    ds_read_b128 v[8:11], v4 offset:12288
    s_waitcnt lgkmcnt(4)
    v_mfma_f32_32x32x16_bf16 v[32:47], a[80:83], v[16:19], v[32:47]
    ds_read_b128 v[12:15], v4 offset:12800
    s_waitcnt lgkmcnt(4)
    v_mfma_f32_32x32x16_bf16 v[32:47], a[84:87], v[20:23], v[32:47]
    ds_read_b128 v[16:19], v4 offset:13312
    s_add_u32 m0, s44, 91136
    s_add_u32 s21, s43, 91136
    buffer_load_dwordx4 v1, s[8:11], s21 offen lds
    s_waitcnt lgkmcnt(4)
    v_mfma_f32_32x32x16_bf16 v[32:47], a[88:91], v[24:27], v[32:47]
    ds_read_b128 v[20:23], v4 offset:13824
    s_waitcnt lgkmcnt(4)
    v_mfma_f32_32x32x16_bf16 v[32:47], a[92:95], v[28:31], v[32:47]
    s_waitcnt vmcnt(13)
    s_barrier
    ds_read_b128 v[24:27], v4 offset:28672
    s_waitcnt lgkmcnt(4)
    v_mfma_f32_32x32x16_bf16 v[32:47], a[96:99], v[8:11], v[32:47]
    ds_read_b128 v[28:31], v4 offset:29184
    s_waitcnt lgkmcnt(4)
    v_mfma_f32_32x32x16_bf16 v[32:47], a[100:103], v[12:15], v[32:47]
    ds_read_b128 v[8:11], v4 offset:29696
    s_add_u32 m0, s44, 92160
    s_add_u32 s21, s43, 92160
    buffer_load_dwordx4 v1, s[8:11], s21 offen lds
    s_waitcnt lgkmcnt(4)
    v_mfma_f32_32x32x16_bf16 v[32:47], a[104:107], v[16:19], v[32:47]
    ds_read_b128 v[12:15], v4 offset:30208
    s_waitcnt lgkmcnt(4)
    v_mfma_f32_32x32x16_bf16 v[32:47], a[108:111], v[20:23], v[32:47]
    ds_read_b128 v[16:19], v4 offset:30720
    s_waitcnt lgkmcnt(4)
    v_mfma_f32_32x32x16_bf16 v[48:63], a[0:3], v[24:27], 0
    ds_read_b128 v[20:23], v4 offset:31232
    s_waitcnt lgkmcnt(4)
    v_mfma_f32_32x32x16_bf16 v[48:63], a[4:7], v[28:31], v[48:63]
    ds_read_b128 v[24:27], v4 offset:31744
    s_add_u32 m0, s44, 114688
    s_add_u32 s21, s43, 114688
    buffer_load_dwordx4 v1, s[8:11], s21 offen lds
    s_waitcnt lgkmcnt(4)
    v_mfma_f32_32x32x16_bf16 v[48:63], a[8:11], v[8:11], v[48:63]
    ds_read_b128 v[28:31], v4 offset:32256
    s_waitcnt lgkmcnt(4)
    v_mfma_f32_32x32x16_bf16 v[48:63], a[12:15], v[12:15], v[48:63]
    ds_read_b128 v[8:11], v4 offset:32768
    s_waitcnt lgkmcnt(4)
    v_mfma_f32_32x32x16_bf16 v[48:63], a[16:19], v[16:19], v[48:63]
    ds_read_b128 v[12:15], v4 offset:33280
    s_waitcnt lgkmcnt(4)
    v_mfma_f32_32x32x16_bf16 v[48:63], a[20:23], v[20:23], v[48:63]
    ds_read_b128 v[16:19], v4 offset:33792
    s_add_u32 m0, s44, 115712
    s_add_u32 s21, s43, 115712
    buffer_load_dwordx4 v1, s[8:11], s21 offen lds
    s_waitcnt lgkmcnt(4)
    v_mfma_f32_32x32x16_bf16 v[48:63], a[24:27], v[24:27], v[48:63]
    ds_read_b128 v[20:23], v4 offset:34304
    v_cvt_pk_bf16_f32 v80, v32, v33
    v_cvt_pk_bf16_f32 v81, v36, v37
    s_waitcnt lgkmcnt(4)
    v_mfma_f32_32x32x16_bf16 v[48:63], a[28:31], v[28:31], v[48:63]
    ds_read_b128 v[24:27], v4 offset:34816
    v_cvt_pk_bf16_f32 v82, v34, v35
    v_cvt_pk_bf16_f32 v83, v38, v39
    s_waitcnt lgkmcnt(4)
    v_mfma_f32_32x32x16_bf16 v[48:63], a[32:35], v[8:11], v[48:63]
    ds_read_b128 v[28:31], v4 offset:35328
    v_cvt_pk_bf16_f32 v88, v40, v41
    v_cvt_pk_bf16_f32 v89, v44, v45
    s_waitcnt lgkmcnt(4)
    v_mfma_f32_32x32x16_bf16 v[48:63], a[36:39], v[12:15], v[48:63]
    ds_read_b128 v[8:11], v4 offset:35840
    s_add_u32 m0, s44, 116736
    s_add_u32 s21, s43, 116736
    buffer_load_dwordx4 v1, s[8:11], s21 offen lds
    v_cvt_pk_bf16_f32 v90, v42, v43
    v_cvt_pk_bf16_f32 v91, v46, v47
    s_waitcnt lgkmcnt(4)
    v_mfma_f32_32x32x16_bf16 v[48:63], a[40:43], v[16:19], v[48:63]
    ds_read_b128 v[12:15], v4 offset:36352
    s_add_u32 s23, s49, 0
    buffer_store_dwordx4 v[80:83], v3, s[8:11], s23 offen sc1
    s_waitcnt lgkmcnt(4)
    v_mfma_f32_32x32x16_bf16 v[48:63], a[44:47], v[20:23], v[48:63]
    ds_read_b128 v[16:19], v4 offset:36864
    s_add_u32 s23, s49, 512
    buffer_store_dwordx4 v[88:91], v3, s[8:11], s23 offen sc1
    s_waitcnt lgkmcnt(4)
    v_mfma_f32_32x32x16_bf16 v[48:63], a[48:51], v[24:27], v[48:63]
    ds_read_b128 v[20:23], v4 offset:37376
    s_waitcnt lgkmcnt(4)
    v_mfma_f32_32x32x16_bf16 v[48:63], a[52:55], v[28:31], v[48:63]
    ds_read_b128 v[24:27], v4 offset:37888
    s_add_u32 m0, s44, 117760
    s_add_u32 s21, s43, 117760
    buffer_load_dwordx4 v1, s[8:11], s21 offen lds
    s_waitcnt lgkmcnt(4)
    v_mfma_f32_32x32x16_bf16 v[48:63], a[56:59], v[8:11], v[48:63]
    ds_read_b128 v[28:31], v4 offset:38400
    s_waitcnt lgkmcnt(4)
    v_mfma_f32_32x32x16_bf16 v[48:63], a[60:63], v[12:15], v[48:63]
    ds_read_b128 v[8:11], v4 offset:38912
    s_waitcnt lgkmcnt(4)
    v_mfma_f32_32x32x16_bf16 v[48:63], a[64:67], v[16:19], v[48:63]
    ds_read_b128 v[12:15], v4 offset:39424
    s_waitcnt lgkmcnt(4)
    v_mfma_f32_32x32x16_bf16 v[48:63], a[68:71], v[20:23], v[48:63]
    ds_read_b128 v[16:19], v4 offset:39936
    s_add_u32 m0, s44, 118784
    s_add_u32 s21, s43, 118784
    buffer_load_dwordx4 v1, s[8:11], s21 offen lds
    s_waitcnt lgkmcnt(4)
    v_mfma_f32_32x32x16_bf16 v[48:63], a[72:75], v[24:27], v[48:63]
    ds_read_b128 v[20:23], v4 offset:40448
    s_waitcnt lgkmcnt(4)
    v_mfma_f32_32x32x16_bf16 v[48:63], a[76:79], v[28:31], v[48:63]
    ds_read_b128 v[24:27], v4 offset:40960
    s_waitcnt lgkmcnt(4)
    v_mfma_f32_32x32x16_bf16 v[48:63], a[80:83], v[8:11], v[48:63]
    ds_read_b128 v[28:31], v4 offset:41472
    s_waitcnt lgkmcnt(4)
    v_mfma_f32_32x32x16_bf16 v[48:63], a[84:87], v[12:15], v[48:63]
    ds_read_b128 v[8:11], v4 offset:41984
    s_add_u32 m0, s44, 119808
    s_add_u32 s21, s43, 119808
    buffer_load_dwordx4 v1, s[8:11], s21 offen lds
    s_waitcnt lgkmcnt(4)
    v_mfma_f32_32x32x16_bf16 v[48:63], a[88:91], v[16:19], v[48:63]
    ds_read_b128 v[12:15], v4 offset:42496
    s_waitcnt lgkmcnt(4)
    v_mfma_f32_32x32x16_bf16 v[48:63], a[92:95], v[20:23], v[48:63]
    s_waitcnt vmcnt(15)
    s_barrier
    ds_read_b128 v[16:19], v5 offset:0
    s_waitcnt lgkmcnt(4)
    v_mfma_f32_32x32x16_bf16 v[48:63], a[96:99], v[24:27], v[48:63]
    ds_read_b128 v[20:23], v5 offset:512
    s_waitcnt lgkmcnt(4)
    v_mfma_f32_32x32x16_bf16 v[48:63], a[100:103], v[28:31], v[48:63]
    ds_read_b128 v[24:27], v5 offset:1024
    s_add_u32 m0, s44, 120832
    s_add_u32 s21, s43, 120832
    buffer_load_dwordx4 v1, s[8:11], s21 offen lds
    s_waitcnt lgkmcnt(4)
    v_mfma_f32_32x32x16_bf16 v[48:63], a[104:107], v[8:11], v[48:63]
    ds_read_b128 v[28:31], v5 offset:1536
    s_waitcnt lgkmcnt(4)
    v_mfma_f32_32x32x16_bf16 v[48:63], a[108:111], v[12:15], v[48:63]
    ds_read_b128 v[8:11], v5 offset:2048
    s_waitcnt lgkmcnt(4)
    v_mfma_f32_32x32x16_bf16 v[32:47], a[0:3], v[16:19], 0
    ds_read_b128 v[12:15], v5 offset:2560
    s_waitcnt lgkmcnt(4)
    v_mfma_f32_32x32x16_bf16 v[32:47], a[4:7], v[20:23], v[32:47]
    ds_read_b128 v[16:19], v5 offset:3072
    s_add_u32 m0, s44, 0
    s_add_u32 s21, s43, 143360
    buffer_load_dwordx4 v1, s[8:11], s21 offen lds
    s_waitcnt lgkmcnt(4)
    v_mfma_f32_32x32x16_bf16 v[32:47], a[8:11], v[24:27], v[32:47]
    ds_read_b128 v[20:23], v5 offset:3584
    s_waitcnt lgkmcnt(4)
    v_mfma_f32_32x32x16_bf16 v[32:47], a[12:15], v[28:31], v[32:47]
    ds_read_b128 v[24:27], v5 offset:4096
    s_waitcnt lgkmcnt(4)
    v_mfma_f32_32x32x16_bf16 v[32:47], a[16:19], v[8:11], v[32:47]
    ds_read_b128 v[28:31], v5 offset:4608
    s_waitcnt lgkmcnt(4)
    v_mfma_f32_32x32x16_bf16 v[32:47], a[20:23], v[12:15], v[32:47]
    ds_read_b128 v[8:11], v5 offset:5120
    s_add_u32 m0, s44, 1024
    s_add_u32 s21, s43, 144384
    buffer_load_dwordx4 v1, s[8:11], s21 offen lds
    s_waitcnt lgkmcnt(4)
    v_mfma_f32_32x32x16_bf16 v[32:47], a[24:27], v[16:19], v[32:47]
    ds_read_b128 v[12:15], v5 offset:5632
    v_cvt_pk_bf16_f32 v80, v48, v49
    v_cvt_pk_bf16_f32 v81, v52, v53
    s_waitcnt lgkmcnt(4)
    v_mfma_f32_32x32x16_bf16 v[32:47], a[28:31], v[20:23], v[32:47]
    ds_read_b128 v[16:19], v5 offset:6144
    v_cvt_pk_bf16_f32 v82, v50, v51
    v_cvt_pk_bf16_f32 v83, v54, v55
    s_waitcnt lgkmcnt(4)
    v_mfma_f32_32x32x16_bf16 v[32:47], a[32:35], v[24:27], v[32:47]
    ds_read_b128 v[20:23], v5 offset:6656
    v_cvt_pk_bf16_f32 v88, v56, v57
    v_cvt_pk_bf16_f32 v89, v60, v61
    s_waitcnt lgkmcnt(4)
    v_mfma_f32_32x32x16_bf16 v[32:47], a[36:39], v[28:31], v[32:47]
    ds_read_b128 v[24:27], v5 offset:7168
    s_add_u32 m0, s44, 2048
    s_add_u32 s21, s43, 145408
    buffer_load_dwordx4 v1, s[8:11], s21 offen lds
    v_cvt_pk_bf16_f32 v90, v58, v59
    v_cvt_pk_bf16_f32 v91, v62, v63
    s_waitcnt lgkmcnt(4)
    v_mfma_f32_32x32x16_bf16 v[32:47], a[40:43], v[8:11], v[32:47]
    ds_read_b128 v[28:31], v5 offset:7680
    s_add_u32 s23, s49, 2048
    buffer_store_dwordx4 v[80:83], v3, s[8:11], s23 offen sc1
    s_waitcnt lgkmcnt(4)
    v_mfma_f32_32x32x16_bf16 v[32:47], a[44:47], v[12:15], v[32:47]
    ds_read_b128 v[8:11], v5 offset:8192
    s_add_u32 s23, s49, 2560
    buffer_store_dwordx4 v[88:91], v3, s[8:11], s23 offen sc1
    s_waitcnt lgkmcnt(4)
    v_mfma_f32_32x32x16_bf16 v[32:47], a[48:51], v[16:19], v[32:47]
    ds_read_b128 v[12:15], v5 offset:8704
    s_waitcnt lgkmcnt(4)
    v_mfma_f32_32x32x16_bf16 v[32:47], a[52:55], v[20:23], v[32:47]
    ds_read_b128 v[16:19], v5 offset:9216
    s_add_u32 m0, s44, 3072
    s_add_u32 s21, s43, 146432
    buffer_load_dwordx4 v1, s[8:11], s21 offen lds
    s_waitcnt lgkmcnt(4)
    v_mfma_f32_32x32x16_bf16 v[32:47], a[56:59], v[24:27], v[32:47]
    ds_read_b128 v[20:23], v5 offset:9728
    s_waitcnt lgkmcnt(4)
    v_mfma_f32_32x32x16_bf16 v[32:47], a[60:63], v[28:31], v[32:47]
    ds_read_b128 v[24:27], v5 offset:10240
    s_waitcnt lgkmcnt(4)
    v_mfma_f32_32x32x16_bf16 v[32:47], a[64:67], v[8:11], v[32:47]
    ds_read_b128 v[28:31], v5 offset:10752
    s_waitcnt lgkmcnt(4)
    v_mfma_f32_32x32x16_bf16 v[32:47], a[68:71], v[12:15], v[32:47]
    ds_read_b128 v[8:11], v5 offset:11264
    s_add_u32 m0, s44, 4096
    s_add_u32 s21, s43, 147456
    buffer_load_dwordx4 v1, s[8:11], s21 offen lds
    s_waitcnt lgkmcnt(4)
    v_mfma_f32_32x32x16_bf16 v[32:47], a[72:75], v[16:19], v[32:47]
    ds_read_b128 v[12:15], v5 offset:11776
    s_waitcnt lgkmcnt(4)
    v_mfma_f32_32x32x16_bf16 v[32:47], a[76:79], v[20:23], v[32:47]
    ds_read_b128 v[16:19], v5 offset:12288
    s_waitcnt lgkmcnt(4)
    v_mfma_f32_32x32x16_bf16 v[32:47], a[80:83], v[24:27], v[32:47]
    ds_read_b128 v[20:23], v5 offset:12800
    s_waitcnt lgkmcnt(4)
    v_mfma_f32_32x32x16_bf16 v[32:47], a[84:87], v[28:31], v[32:47]
    ds_read_b128 v[24:27], v5 offset:13312
    s_add_u32 m0, s44, 5120
    s_add_u32 s21, s43, 148480
    buffer_load_dwordx4 v1, s[8:11], s21 offen lds
    s_waitcnt lgkmcnt(4)
    v_mfma_f32_32x32x16_bf16 v[32:47], a[88:91], v[8:11], v[32:47]
    ds_read_b128 v[28:31], v5 offset:13824
    s_waitcnt lgkmcnt(4)
    v_mfma_f32_32x32x16_bf16 v[32:47], a[92:95], v[12:15], v[32:47]
    s_waitcnt vmcnt(17)
    s_barrier
    ds_read_b128 v[8:11], v5 offset:28672
    s_waitcnt lgkmcnt(4)
    v_mfma_f32_32x32x16_bf16 v[32:47], a[96:99], v[16:19], v[32:47]
    ds_read_b128 v[12:15], v5 offset:29184
    s_waitcnt lgkmcnt(4)
    v_mfma_f32_32x32x16_bf16 v[32:47], a[100:103], v[20:23], v[32:47]
    ds_read_b128 v[16:19], v5 offset:29696
    s_add_u32 m0, s44, 6144
    s_add_u32 s21, s43, 149504
    buffer_load_dwordx4 v1, s[8:11], s21 offen lds
    s_waitcnt lgkmcnt(4)
    v_mfma_f32_32x32x16_bf16 v[32:47], a[104:107], v[24:27], v[32:47]
    ds_read_b128 v[20:23], v5 offset:30208
    s_waitcnt lgkmcnt(4)
    v_mfma_f32_32x32x16_bf16 v[32:47], a[108:111], v[28:31], v[32:47]
    ds_read_b128 v[24:27], v5 offset:30720
    s_waitcnt lgkmcnt(4)
    v_mfma_f32_32x32x16_bf16 v[48:63], a[0:3], v[8:11], 0
    ds_read_b128 v[28:31], v5 offset:31232
    s_waitcnt lgkmcnt(4)
    v_mfma_f32_32x32x16_bf16 v[48:63], a[4:7], v[12:15], v[48:63]
    ds_read_b128 v[8:11], v5 offset:31744
    s_add_u32 m0, s44, 28672
    s_add_u32 s21, s43, 172032
    buffer_load_dwordx4 v1, s[8:11], s21 offen lds
    s_waitcnt lgkmcnt(4)
    v_mfma_f32_32x32x16_bf16 v[48:63], a[8:11], v[16:19], v[48:63]
    ds_read_b128 v[12:15], v5 offset:32256
    s_waitcnt lgkmcnt(4)
    v_mfma_f32_32x32x16_bf16 v[48:63], a[12:15], v[20:23], v[48:63]
    ds_read_b128 v[16:19], v5 offset:32768
    s_waitcnt lgkmcnt(4)
    v_mfma_f32_32x32x16_bf16 v[48:63], a[16:19], v[24:27], v[48:63]
    ds_read_b128 v[20:23], v5 offset:33280
    s_waitcnt lgkmcnt(4)
    v_mfma_f32_32x32x16_bf16 v[48:63], a[20:23], v[28:31], v[48:63]
    ds_read_b128 v[24:27], v5 offset:33792
    s_add_u32 m0, s44, 29696
    s_add_u32 s21, s43, 173056
    buffer_load_dwordx4 v1, s[8:11], s21 offen lds
    s_waitcnt lgkmcnt(4)
    v_mfma_f32_32x32x16_bf16 v[48:63], a[24:27], v[8:11], v[48:63]
    ds_read_b128 v[28:31], v5 offset:34304
    v_cvt_pk_bf16_f32 v80, v32, v33
    v_cvt_pk_bf16_f32 v81, v36, v37
    s_waitcnt lgkmcnt(4)
    v_mfma_f32_32x32x16_bf16 v[48:63], a[28:31], v[12:15], v[48:63]
    ds_read_b128 v[8:11], v5 offset:34816
    v_cvt_pk_bf16_f32 v82, v34, v35
    v_cvt_pk_bf16_f32 v83, v38, v39
    s_waitcnt lgkmcnt(4)
    v_mfma_f32_32x32x16_bf16 v[48:63], a[32:35], v[16:19], v[48:63]
    ds_read_b128 v[12:15], v5 offset:35328
    v_cvt_pk_bf16_f32 v88, v40, v41
    v_cvt_pk_bf16_f32 v89, v44, v45
    s_waitcnt lgkmcnt(4)
    v_mfma_f32_32x32x16_bf16 v[48:63], a[36:39], v[20:23], v[48:63]
    ds_read_b128 v[16:19], v5 offset:35840
    s_add_u32 m0, s44, 30720
    s_add_u32 s21, s43, 174080
    buffer_load_dwordx4 v1, s[8:11], s21 offen lds
    v_cvt_pk_bf16_f32 v90, v42, v43
    v_cvt_pk_bf16_f32 v91, v46, v47
    s_waitcnt lgkmcnt(4)
    v_mfma_f32_32x32x16_bf16 v[48:63], a[40:43], v[24:27], v[48:63]
    ds_read_b128 v[20:23], v5 offset:36352
    s_add_u32 s23, s49, 4096
    buffer_store_dwordx4 v[80:83], v3, s[8:11], s23 offen sc1
    s_waitcnt lgkmcnt(4)
    v_mfma_f32_32x32x16_bf16 v[48:63], a[44:47], v[28:31], v[48:63]
    ds_read_b128 v[24:27], v5 offset:36864
    s_add_u32 s23, s49, 4608
    buffer_store_dwordx4 v[88:91], v3, s[8:11], s23 offen sc1
    s_waitcnt lgkmcnt(4)
    v_mfma_f32_32x32x16_bf16 v[48:63], a[48:51], v[8:11], v[48:63]
    ds_read_b128 v[28:31], v5 offset:37376
    s_waitcnt lgkmcnt(4)
    v_mfma_f32_32x32x16_bf16 v[48:63], a[52:55], v[12:15], v[48:63]
    ds_read_b128 v[8:11], v5 offset:37888
    s_add_u32 m0, s44, 31744
    s_add_u32 s21, s43, 175104
    buffer_load_dwordx4 v1, s[8:11], s21 offen lds
    s_waitcnt lgkmcnt(4)
    v_mfma_f32_32x32x16_bf16 v[48:63], a[56:59], v[16:19], v[48:63]
    ds_read_b128 v[12:15], v5 offset:38400
    s_waitcnt lgkmcnt(4)
    v_mfma_f32_32x32x16_bf16 v[48:63], a[60:63], v[20:23], v[48:63]
    ds_read_b128 v[16:19], v5 offset:38912
    s_waitcnt lgkmcnt(4)
    v_mfma_f32_32x32x16_bf16 v[48:63], a[64:67], v[24:27], v[48:63]
    ds_read_b128 v[20:23], v5 offset:39424
    s_waitcnt lgkmcnt(4)
    v_mfma_f32_32x32x16_bf16 v[48:63], a[68:71], v[28:31], v[48:63]
    ds_read_b128 v[24:27], v5 offset:39936
    s_add_u32 m0, s44, 32768
    s_add_u32 s21, s43, 176128
    buffer_load_dwordx4 v1, s[8:11], s21 offen lds
    s_waitcnt lgkmcnt(4)
    v_mfma_f32_32x32x16_bf16 v[48:63], a[72:75], v[8:11], v[48:63]
    ds_read_b128 v[28:31], v5 offset:40448
    s_waitcnt lgkmcnt(4)
    v_mfma_f32_32x32x16_bf16 v[48:63], a[76:79], v[12:15], v[48:63]
    ds_read_b128 v[8:11], v5 offset:40960
    s_waitcnt lgkmcnt(4)
    v_mfma_f32_32x32x16_bf16 v[48:63], a[80:83], v[16:19], v[48:63]
    ds_read_b128 v[12:15], v5 offset:41472
    s_waitcnt lgkmcnt(4)
    v_mfma_f32_32x32x16_bf16 v[48:63], a[84:87], v[20:23], v[48:63]
    ds_read_b128 v[16:19], v5 offset:41984
    s_add_u32 m0, s44, 33792
    s_add_u32 s21, s43, 177152
    buffer_load_dwordx4 v1, s[8:11], s21 offen lds
    s_waitcnt lgkmcnt(4)
    v_mfma_f32_32x32x16_bf16 v[48:63], a[88:91], v[24:27], v[48:63]
    ds_read_b128 v[20:23], v5 offset:42496
    s_waitcnt lgkmcnt(4)
    v_mfma_f32_32x32x16_bf16 v[48:63], a[92:95], v[28:31], v[48:63]
    s_waitcnt vmcnt(17)
    s_barrier
    ds_read_b128 v[24:27], v6 offset:0
    s_waitcnt lgkmcnt(4)
    v_mfma_f32_32x32x16_bf16 v[48:63], a[96:99], v[8:11], v[48:63]
    ds_read_b128 v[28:31], v6 offset:512
    s_waitcnt lgkmcnt(4)
    v_mfma_f32_32x32x16_bf16 v[48:63], a[100:103], v[12:15], v[48:63]
    ds_read_b128 v[8:11], v6 offset:1024
    s_add_u32 m0, s44, 34816
    s_add_u32 s21, s43, 178176
    buffer_load_dwordx4 v1, s[8:11], s21 offen lds
    s_waitcnt lgkmcnt(4)
    v_mfma_f32_32x32x16_bf16 v[48:63], a[104:107], v[16:19], v[48:63]
    ds_read_b128 v[12:15], v6 offset:1536
    s_waitcnt lgkmcnt(4)
    v_mfma_f32_32x32x16_bf16 v[48:63], a[108:111], v[20:23], v[48:63]
    ds_read_b128 v[16:19], v6 offset:2048
    s_waitcnt lgkmcnt(4)
    v_mfma_f32_32x32x16_bf16 v[32:47], a[0:3], v[24:27], 0
    ds_read_b128 v[20:23], v6 offset:2560
    s_waitcnt lgkmcnt(4)
    v_mfma_f32_32x32x16_bf16 v[32:47], a[4:7], v[28:31], v[32:47]
    ds_read_b128 v[24:27], v6 offset:3072
    s_add_u32 m0, s44, 57344
    s_add_u32 s21, s43, 200704
    buffer_load_dwordx4 v1, s[8:11], s21 offen lds
    s_waitcnt lgkmcnt(4)
    v_mfma_f32_32x32x16_bf16 v[32:47], a[8:11], v[8:11], v[32:47]
    ds_read_b128 v[28:31], v6 offset:3584
    s_waitcnt lgkmcnt(4)
    v_mfma_f32_32x32x16_bf16 v[32:47], a[12:15], v[12:15], v[32:47]
    ds_read_b128 v[8:11], v6 offset:4096
    s_waitcnt lgkmcnt(4)
    v_mfma_f32_32x32x16_bf16 v[32:47], a[16:19], v[16:19], v[32:47]
    ds_read_b128 v[12:15], v6 offset:4608
    s_waitcnt lgkmcnt(4)
    v_mfma_f32_32x32x16_bf16 v[32:47], a[20:23], v[20:23], v[32:47]
    ds_read_b128 v[16:19], v6 offset:5120
    s_add_u32 m0, s44, 58368
    s_add_u32 s21, s43, 201728
    buffer_load_dwordx4 v1, s[8:11], s21 offen lds
    s_waitcnt lgkmcnt(4)
    v_mfma_f32_32x32x16_bf16 v[32:47], a[24:27], v[24:27], v[32:47]
    ds_read_b128 v[20:23], v6 offset:5632
    v_cvt_pk_bf16_f32 v80, v48, v49
    v_cvt_pk_bf16_f32 v81, v52, v53
    s_waitcnt lgkmcnt(4)
    v_mfma_f32_32x32x16_bf16 v[32:47], a[28:31], v[28:31], v[32:47]
    ds_read_b128 v[24:27], v6 offset:6144
    v_cvt_pk_bf16_f32 v82, v50, v51
    v_cvt_pk_bf16_f32 v83, v54, v55
    s_waitcnt lgkmcnt(4)
    v_mfma_f32_32x32x16_bf16 v[32:47], a[32:35], v[8:11], v[32:47]
    ds_read_b128 v[28:31], v6 offset:6656
    v_cvt_pk_bf16_f32 v88, v56, v57
    v_cvt_pk_bf16_f32 v89, v60, v61
    s_waitcnt lgkmcnt(4)
    v_mfma_f32_32x32x16_bf16 v[32:47], a[36:39], v[12:15], v[32:47]
    ds_read_b128 v[8:11], v6 offset:7168
    s_add_u32 m0, s44, 59392
    s_add_u32 s21, s43, 202752
    buffer_load_dwordx4 v1, s[8:11], s21 offen lds
    v_cvt_pk_bf16_f32 v90, v58, v59
    v_cvt_pk_bf16_f32 v91, v62, v63
    s_waitcnt lgkmcnt(4)
    v_mfma_f32_32x32x16_bf16 v[32:47], a[40:43], v[16:19], v[32:47]
    ds_read_b128 v[12:15], v6 offset:7680
    s_add_u32 s23, s49, 6144
    buffer_store_dwordx4 v[80:83], v3, s[8:11], s23 offen sc1
    s_waitcnt lgkmcnt(4)
    v_mfma_f32_32x32x16_bf16 v[32:47], a[44:47], v[20:23], v[32:47]
    ds_read_b128 v[16:19], v6 offset:8192
    s_add_u32 s23, s49, 6656
    buffer_store_dwordx4 v[88:91], v3, s[8:11], s23 offen sc1
    s_waitcnt lgkmcnt(4)
    v_mfma_f32_32x32x16_bf16 v[32:47], a[48:51], v[24:27], v[32:47]
    ds_read_b128 v[20:23], v6 offset:8704
    s_waitcnt lgkmcnt(4)
    v_mfma_f32_32x32x16_bf16 v[32:47], a[52:55], v[28:31], v[32:47]
    ds_read_b128 v[24:27], v6 offset:9216
    s_add_u32 m0, s44, 60416
    s_add_u32 s21, s43, 203776
    buffer_load_dwordx4 v1, s[8:11], s21 offen lds
    s_waitcnt lgkmcnt(4)
    v_mfma_f32_32x32x16_bf16 v[32:47], a[56:59], v[8:11], v[32:47]
    ds_read_b128 v[28:31], v6 offset:9728
    s_waitcnt lgkmcnt(4)
    v_mfma_f32_32x32x16_bf16 v[32:47], a[60:63], v[12:15], v[32:47]
    ds_read_b128 v[8:11], v6 offset:10240
    s_waitcnt lgkmcnt(4)
    v_mfma_f32_32x32x16_bf16 v[32:47], a[64:67], v[16:19], v[32:47]
    ds_read_b128 v[12:15], v6 offset:10752
    s_waitcnt lgkmcnt(4)
    v_mfma_f32_32x32x16_bf16 v[32:47], a[68:71], v[20:23], v[32:47]
    ds_read_b128 v[16:19], v6 offset:11264
    s_add_u32 m0, s44, 61440
    s_add_u32 s21, s43, 204800
    buffer_load_dwordx4 v1, s[8:11], s21 offen lds
    s_waitcnt lgkmcnt(4)
    v_mfma_f32_32x32x16_bf16 v[32:47], a[72:75], v[24:27], v[32:47]
    ds_read_b128 v[20:23], v6 offset:11776
    s_waitcnt lgkmcnt(4)
    v_mfma_f32_32x32x16_bf16 v[32:47], a[76:79], v[28:31], v[32:47]
    ds_read_b128 v[24:27], v6 offset:12288
    s_waitcnt lgkmcnt(4)
    v_mfma_f32_32x32x16_bf16 v[32:47], a[80:83], v[8:11], v[32:47]
    ds_read_b128 v[28:31], v6 offset:12800
    s_waitcnt lgkmcnt(4)
    v_mfma_f32_32x32x16_bf16 v[32:47], a[84:87], v[12:15], v[32:47]
    ds_read_b128 v[8:11], v6 offset:13312
    s_add_u32 m0, s44, 62464
    s_add_u32 s21, s43, 205824
    buffer_load_dwordx4 v1, s[8:11], s21 offen lds
    s_waitcnt lgkmcnt(4)
    v_mfma_f32_32x32x16_bf16 v[32:47], a[88:91], v[16:19], v[32:47]
    ds_read_b128 v[12:15], v6 offset:13824
    s_waitcnt lgkmcnt(4)
    v_mfma_f32_32x32x16_bf16 v[32:47], a[92:95], v[20:23], v[32:47]
    s_waitcnt vmcnt(17)
    s_barrier
    ds_read_b128 v[16:19], v4 offset:0
    s_waitcnt lgkmcnt(4)
    v_mfma_f32_32x32x16_bf16 v[32:47], a[96:99], v[24:27], v[32:47]
    ds_read_b128 v[20:23], v4 offset:512
    s_waitcnt lgkmcnt(4)
    v_mfma_f32_32x32x16_bf16 v[32:47], a[100:103], v[28:31], v[32:47]
    ds_read_b128 v[24:27], v4 offset:1024
    s_add_u32 m0, s44, 63488
    s_add_u32 s21, s43, 206848
    buffer_load_dwordx4 v1, s[8:11], s21 offen lds
    s_waitcnt lgkmcnt(4)
    v_mfma_f32_32x32x16_bf16 v[32:47], a[104:107], v[8:11], v[32:47]
    ds_read_b128 v[28:31], v4 offset:1536
    s_waitcnt lgkmcnt(4)
    v_mfma_f32_32x32x16_bf16 v[32:47], a[108:111], v[12:15], v[32:47]
    ds_read_b128 v[8:11], v4 offset:2048
    s_waitcnt lgkmcnt(4)
    v_mfma_f32_32x32x16_bf16 v[48:63], a[0:3], v[16:19], 0
    ds_read_b128 v[12:15], v4 offset:2560
    s_waitcnt lgkmcnt(4)
    v_mfma_f32_32x32x16_bf16 v[48:63], a[4:7], v[20:23], v[48:63]
    ds_read_b128 v[16:19], v4 offset:3072
    s_add_u32 m0, s44, 86016
    s_add_u32 s21, s43, 229376
    buffer_load_dwordx4 v1, s[8:11], s21 offen lds
    s_waitcnt lgkmcnt(4)
    v_mfma_f32_32x32x16_bf16 v[48:63], a[8:11], v[24:27], v[48:63]
    ds_read_b128 v[20:23], v4 offset:3584
    s_waitcnt lgkmcnt(4)
    v_mfma_f32_32x32x16_bf16 v[48:63], a[12:15], v[28:31], v[48:63]
    ds_read_b128 v[24:27], v4 offset:4096
    s_waitcnt lgkmcnt(4)
    v_mfma_f32_32x32x16_bf16 v[48:63], a[16:19], v[8:11], v[48:63]
    ds_read_b128 v[28:31], v4 offset:4608
    s_waitcnt lgkmcnt(4)
    v_mfma_f32_32x32x16_bf16 v[48:63], a[20:23], v[12:15], v[48:63]
    ds_read_b128 v[8:11], v4 offset:5120
    s_add_u32 m0, s44, 87040
    s_add_u32 s21, s43, 230400
    buffer_load_dwordx4 v1, s[8:11], s21 offen lds
    s_waitcnt lgkmcnt(4)
    v_mfma_f32_32x32x16_bf16 v[48:63], a[24:27], v[16:19], v[48:63]
    ds_read_b128 v[12:15], v4 offset:5632
    v_cvt_pk_bf16_f32 v80, v32, v33
    v_cvt_pk_bf16_f32 v81, v36, v37
    s_waitcnt lgkmcnt(4)
    v_mfma_f32_32x32x16_bf16 v[48:63], a[28:31], v[20:23], v[48:63]
    ds_read_b128 v[16:19], v4 offset:6144
    v_cvt_pk_bf16_f32 v82, v34, v35
    v_cvt_pk_bf16_f32 v83, v38, v39
    s_waitcnt lgkmcnt(4)
    v_mfma_f32_32x32x16_bf16 v[48:63], a[32:35], v[24:27], v[48:63]
    ds_read_b128 v[20:23], v4 offset:6656
    v_cvt_pk_bf16_f32 v88, v40, v41
    v_cvt_pk_bf16_f32 v89, v44, v45
    s_waitcnt lgkmcnt(4)
    v_mfma_f32_32x32x16_bf16 v[48:63], a[36:39], v[28:31], v[48:63]
    ds_read_b128 v[24:27], v4 offset:7168
    s_add_u32 m0, s44, 88064
    s_add_u32 s21, s43, 231424
    buffer_load_dwordx4 v1, s[8:11], s21 offen lds
    v_cvt_pk_bf16_f32 v90, v42, v43
    v_cvt_pk_bf16_f32 v91, v46, v47
    s_waitcnt lgkmcnt(4)
    v_mfma_f32_32x32x16_bf16 v[48:63], a[40:43], v[8:11], v[48:63]
    ds_read_b128 v[28:31], v4 offset:7680
    s_add_u32 s23, s49, 8192
    buffer_store_dwordx4 v[80:83], v3, s[8:11], s23 offen sc1
    s_waitcnt lgkmcnt(4)
    v_mfma_f32_32x32x16_bf16 v[48:63], a[44:47], v[12:15], v[48:63]
    ds_read_b128 v[8:11], v4 offset:8192
    s_add_u32 s23, s49, 8704
    buffer_store_dwordx4 v[88:91], v3, s[8:11], s23 offen sc1
    s_waitcnt lgkmcnt(4)
    v_mfma_f32_32x32x16_bf16 v[48:63], a[48:51], v[16:19], v[48:63]
    ds_read_b128 v[12:15], v4 offset:8704
    s_waitcnt lgkmcnt(4)
    v_mfma_f32_32x32x16_bf16 v[48:63], a[52:55], v[20:23], v[48:63]
    ds_read_b128 v[16:19], v4 offset:9216
    s_add_u32 m0, s44, 89088
    s_add_u32 s21, s43, 232448
    buffer_load_dwordx4 v1, s[8:11], s21 offen lds
    s_waitcnt lgkmcnt(4)
    v_mfma_f32_32x32x16_bf16 v[48:63], a[56:59], v[24:27], v[48:63]
    ds_read_b128 v[20:23], v4 offset:9728
    s_waitcnt lgkmcnt(4)
    v_mfma_f32_32x32x16_bf16 v[48:63], a[60:63], v[28:31], v[48:63]
    ds_read_b128 v[24:27], v4 offset:10240
    s_waitcnt lgkmcnt(4)
    v_mfma_f32_32x32x16_bf16 v[48:63], a[64:67], v[8:11], v[48:63]
    ds_read_b128 v[28:31], v4 offset:10752
    s_waitcnt lgkmcnt(4)
    v_mfma_f32_32x32x16_bf16 v[48:63], a[68:71], v[12:15], v[48:63]
    ds_read_b128 v[8:11], v4 offset:11264
    s_add_u32 m0, s44, 90112
    s_add_u32 s21, s43, 233472
    buffer_load_dwordx4 v1, s[8:11], s21 offen lds
    s_waitcnt lgkmcnt(4)
    v_mfma_f32_32x32x16_bf16 v[48:63], a[72:75], v[16:19], v[48:63]
    ds_read_b128 v[12:15], v4 offset:11776
    s_waitcnt lgkmcnt(4)
    v_mfma_f32_32x32x16_bf16 v[48:63], a[76:79], v[20:23], v[48:63]
    ds_read_b128 v[16:19], v4 offset:12288
    s_waitcnt lgkmcnt(4)
    v_mfma_f32_32x32x16_bf16 v[48:63], a[80:83], v[24:27], v[48:63]
    ds_read_b128 v[20:23], v4 offset:12800
    s_waitcnt lgkmcnt(4)
    v_mfma_f32_32x32x16_bf16 v[48:63], a[84:87], v[28:31], v[48:63]
    ds_read_b128 v[24:27], v4 offset:13312
    s_add_u32 m0, s44, 91136
    s_add_u32 s21, s43, 234496
    buffer_load_dwordx4 v1, s[8:11], s21 offen lds
    s_waitcnt lgkmcnt(4)
    v_mfma_f32_32x32x16_bf16 v[48:63], a[88:91], v[8:11], v[48:63]
    ds_read_b128 v[28:31], v4 offset:13824
    s_waitcnt lgkmcnt(4)
    v_mfma_f32_32x32x16_bf16 v[48:63], a[92:95], v[12:15], v[48:63]
    s_waitcnt vmcnt(17)
    s_barrier
    ds_read_b128 v[8:11], v4 offset:28672
    s_waitcnt lgkmcnt(4)
    v_mfma_f32_32x32x16_bf16 v[48:63], a[96:99], v[16:19], v[48:63]
    ds_read_b128 v[12:15], v4 offset:29184
    s_waitcnt lgkmcnt(4)
    v_mfma_f32_32x32x16_bf16 v[48:63], a[100:103], v[20:23], v[48:63]
    ds_read_b128 v[16:19], v4 offset:29696
    s_add_u32 m0, s44, 92160
    s_add_u32 s21, s43, 235520
    buffer_load_dwordx4 v1, s[8:11], s21 offen lds
    s_waitcnt lgkmcnt(4)
    v_mfma_f32_32x32x16_bf16 v[48:63], a[104:107], v[24:27], v[48:63]
    ds_read_b128 v[20:23], v4 offset:30208
    s_waitcnt lgkmcnt(4)
    v_mfma_f32_32x32x16_bf16 v[48:63], a[108:111], v[28:31], v[48:63]
    ds_read_b128 v[24:27], v4 offset:30720
    s_waitcnt lgkmcnt(4)
    v_mfma_f32_32x32x16_bf16 v[32:47], a[0:3], v[8:11], 0
    ds_read_b128 v[28:31], v4 offset:31232
    s_waitcnt lgkmcnt(4)
    v_mfma_f32_32x32x16_bf16 v[32:47], a[4:7], v[12:15], v[32:47]
    ds_read_b128 v[8:11], v4 offset:31744
    s_add_u32 m0, s44, 114688
    s_add_u32 s21, s43, 258048
    buffer_load_dwordx4 v1, s[8:11], s21 offen lds
    s_waitcnt lgkmcnt(4)
    v_mfma_f32_32x32x16_bf16 v[32:47], a[8:11], v[16:19], v[32:47]
    ds_read_b128 v[12:15], v4 offset:32256
    s_waitcnt lgkmcnt(4)
    v_mfma_f32_32x32x16_bf16 v[32:47], a[12:15], v[20:23], v[32:47]
    ds_read_b128 v[16:19], v4 offset:32768
    s_waitcnt lgkmcnt(4)
    v_mfma_f32_32x32x16_bf16 v[32:47], a[16:19], v[24:27], v[32:47]
    ds_read_b128 v[20:23], v4 offset:33280
    s_waitcnt lgkmcnt(4)
    v_mfma_f32_32x32x16_bf16 v[32:47], a[20:23], v[28:31], v[32:47]
    ds_read_b128 v[24:27], v4 offset:33792
    s_add_u32 m0, s44, 115712
    s_add_u32 s21, s43, 259072
    buffer_load_dwordx4 v1, s[8:11], s21 offen lds
    s_waitcnt lgkmcnt(4)
    v_mfma_f32_32x32x16_bf16 v[32:47], a[24:27], v[8:11], v[32:47]
    ds_read_b128 v[28:31], v4 offset:34304
    v_cvt_pk_bf16_f32 v80, v48, v49
    v_cvt_pk_bf16_f32 v81, v52, v53
    s_waitcnt lgkmcnt(4)
    v_mfma_f32_32x32x16_bf16 v[32:47], a[28:31], v[12:15], v[32:47]
    ds_read_b128 v[8:11], v4 offset:34816
    v_cvt_pk_bf16_f32 v82, v50, v51
    v_cvt_pk_bf16_f32 v83, v54, v55
    s_waitcnt lgkmcnt(4)
    v_mfma_f32_32x32x16_bf16 v[32:47], a[32:35], v[16:19], v[32:47]
    ds_read_b128 v[12:15], v4 offset:35328
    v_cvt_pk_bf16_f32 v88, v56, v57
    v_cvt_pk_bf16_f32 v89, v60, v61
    s_waitcnt lgkmcnt(4)
    v_mfma_f32_32x32x16_bf16 v[32:47], a[36:39], v[20:23], v[32:47]
    ds_read_b128 v[16:19], v4 offset:35840
    s_add_u32 m0, s44, 116736
    s_add_u32 s21, s43, 260096
    buffer_load_dwordx4 v1, s[8:11], s21 offen lds
    v_cvt_pk_bf16_f32 v90, v58, v59
    v_cvt_pk_bf16_f32 v91, v62, v63
    s_waitcnt lgkmcnt(4)
    v_mfma_f32_32x32x16_bf16 v[32:47], a[40:43], v[24:27], v[32:47]
    ds_read_b128 v[20:23], v4 offset:36352
    s_add_u32 s23, s49, 10240
    buffer_store_dwordx4 v[80:83], v3, s[8:11], s23 offen sc1
    s_waitcnt lgkmcnt(4)
    v_mfma_f32_32x32x16_bf16 v[32:47], a[44:47], v[28:31], v[32:47]
    ds_read_b128 v[24:27], v4 offset:36864
    s_add_u32 s23, s49, 10752
    buffer_store_dwordx4 v[88:91], v3, s[8:11], s23 offen sc1
    s_waitcnt lgkmcnt(4)
    v_mfma_f32_32x32x16_bf16 v[32:47], a[48:51], v[8:11], v[32:47]
    ds_read_b128 v[28:31], v4 offset:37376
    s_waitcnt lgkmcnt(4)
    v_mfma_f32_32x32x16_bf16 v[32:47], a[52:55], v[12:15], v[32:47]
    ds_read_b128 v[8:11], v4 offset:37888
    s_add_u32 m0, s44, 117760
    s_add_u32 s21, s43, 261120
    buffer_load_dwordx4 v1, s[8:11], s21 offen lds
    s_waitcnt lgkmcnt(4)
    v_mfma_f32_32x32x16_bf16 v[32:47], a[56:59], v[16:19], v[32:47]
    ds_read_b128 v[12:15], v4 offset:38400
    s_waitcnt lgkmcnt(4)
    v_mfma_f32_32x32x16_bf16 v[32:47], a[60:63], v[20:23], v[32:47]
    ds_read_b128 v[16:19], v4 offset:38912
    s_waitcnt lgkmcnt(4)
    v_mfma_f32_32x32x16_bf16 v[32:47], a[64:67], v[24:27], v[32:47]
    ds_read_b128 v[20:23], v4 offset:39424
    s_waitcnt lgkmcnt(4)
    v_mfma_f32_32x32x16_bf16 v[32:47], a[68:71], v[28:31], v[32:47]
    ds_read_b128 v[24:27], v4 offset:39936
    s_add_u32 m0, s44, 118784
    s_add_u32 s21, s43, 262144
    buffer_load_dwordx4 v1, s[8:11], s21 offen lds
    s_waitcnt lgkmcnt(4)
    v_mfma_f32_32x32x16_bf16 v[32:47], a[72:75], v[8:11], v[32:47]
    ds_read_b128 v[28:31], v4 offset:40448
    s_waitcnt lgkmcnt(4)
    v_mfma_f32_32x32x16_bf16 v[32:47], a[76:79], v[12:15], v[32:47]
    ds_read_b128 v[8:11], v4 offset:40960
    s_waitcnt lgkmcnt(4)
    v_mfma_f32_32x32x16_bf16 v[32:47], a[80:83], v[16:19], v[32:47]
    ds_read_b128 v[12:15], v4 offset:41472
    s_waitcnt lgkmcnt(4)
    v_mfma_f32_32x32x16_bf16 v[32:47], a[84:87], v[20:23], v[32:47]
    ds_read_b128 v[16:19], v4 offset:41984
    s_add_u32 m0, s44, 119808
    s_add_u32 s21, s43, 263168
    buffer_load_dwordx4 v1, s[8:11], s21 offen lds
    s_waitcnt lgkmcnt(4)
    v_mfma_f32_32x32x16_bf16 v[32:47], a[88:91], v[24:27], v[32:47]
    ds_read_b128 v[20:23], v4 offset:42496
    s_waitcnt lgkmcnt(4)
    v_mfma_f32_32x32x16_bf16 v[32:47], a[92:95], v[28:31], v[32:47]
    s_waitcnt vmcnt(17)
    s_barrier
    ds_read_b128 v[24:27], v5 offset:0
    s_waitcnt lgkmcnt(4)
    v_mfma_f32_32x32x16_bf16 v[32:47], a[96:99], v[8:11], v[32:47]
    ds_read_b128 v[28:31], v5 offset:512
    s_waitcnt lgkmcnt(4)
    v_mfma_f32_32x32x16_bf16 v[32:47], a[100:103], v[12:15], v[32:47]
    ds_read_b128 v[8:11], v5 offset:1024
    s_add_u32 m0, s44, 120832
    s_add_u32 s21, s43, 264192
    buffer_load_dwordx4 v1, s[8:11], s21 offen lds
    s_waitcnt lgkmcnt(4)
    v_mfma_f32_32x32x16_bf16 v[32:47], a[104:107], v[16:19], v[32:47]
    ds_read_b128 v[12:15], v5 offset:1536
    s_waitcnt lgkmcnt(4)
    v_mfma_f32_32x32x16_bf16 v[32:47], a[108:111], v[20:23], v[32:47]
    ds_read_b128 v[16:19], v5 offset:2048
    s_waitcnt lgkmcnt(4)
    v_mfma_f32_32x32x16_bf16 v[48:63], a[0:3], v[24:27], 0
    ds_read_b128 v[20:23], v5 offset:2560
    s_waitcnt lgkmcnt(4)
    v_mfma_f32_32x32x16_bf16 v[48:63], a[4:7], v[28:31], v[48:63]
    ds_read_b128 v[24:27], v5 offset:3072
    s_add_u32 m0, s44, 0
    s_add_u32 s21, s43, 286720
    buffer_load_dwordx4 v1, s[8:11], s21 offen lds
    s_waitcnt lgkmcnt(4)
    v_mfma_f32_32x32x16_bf16 v[48:63], a[8:11], v[8:11], v[48:63]
    ds_read_b128 v[28:31], v5 offset:3584
    s_waitcnt lgkmcnt(4)
    v_mfma_f32_32x32x16_bf16 v[48:63], a[12:15], v[12:15], v[48:63]
    ds_read_b128 v[8:11], v5 offset:4096
    s_waitcnt lgkmcnt(4)
    v_mfma_f32_32x32x16_bf16 v[48:63], a[16:19], v[16:19], v[48:63]
    ds_read_b128 v[12:15], v5 offset:4608
    s_waitcnt lgkmcnt(4)
    v_mfma_f32_32x32x16_bf16 v[48:63], a[20:23], v[20:23], v[48:63]
    ds_read_b128 v[16:19], v5 offset:5120
    s_add_u32 m0, s44, 1024
    s_add_u32 s21, s43, 287744
    buffer_load_dwordx4 v1, s[8:11], s21 offen lds
    s_waitcnt lgkmcnt(4)
    v_mfma_f32_32x32x16_bf16 v[48:63], a[24:27], v[24:27], v[48:63]
    ds_read_b128 v[20:23], v5 offset:5632
    v_cvt_pk_bf16_f32 v80, v32, v33
    v_cvt_pk_bf16_f32 v81, v36, v37
    s_waitcnt lgkmcnt(4)
    v_mfma_f32_32x32x16_bf16 v[48:63], a[28:31], v[28:31], v[48:63]
    ds_read_b128 v[24:27], v5 offset:6144
    v_cvt_pk_bf16_f32 v82, v34, v35
    v_cvt_pk_bf16_f32 v83, v38, v39
    s_waitcnt lgkmcnt(4)
    v_mfma_f32_32x32x16_bf16 v[48:63], a[32:35], v[8:11], v[48:63]
    ds_read_b128 v[28:31], v5 offset:6656
    v_cvt_pk_bf16_f32 v88, v40, v41
    v_cvt_pk_bf16_f32 v89, v44, v45
    s_waitcnt lgkmcnt(4)
    v_mfma_f32_32x32x16_bf16 v[48:63], a[36:39], v[12:15], v[48:63]
    ds_read_b128 v[8:11], v5 offset:7168
    s_add_u32 m0, s44, 2048
    s_add_u32 s21, s43, 288768
    buffer_load_dwordx4 v1, s[8:11], s21 offen lds
    v_cvt_pk_bf16_f32 v90, v42, v43
    v_cvt_pk_bf16_f32 v91, v46, v47
    s_waitcnt lgkmcnt(4)
    v_mfma_f32_32x32x16_bf16 v[48:63], a[40:43], v[16:19], v[48:63]
    ds_read_b128 v[12:15], v5 offset:7680
    s_add_u32 s23, s49, 12288
    buffer_store_dwordx4 v[80:83], v3, s[8:11], s23 offen sc1
    s_waitcnt lgkmcnt(4)
    v_mfma_f32_32x32x16_bf16 v[48:63], a[44:47], v[20:23], v[48:63]
    ds_read_b128 v[16:19], v5 offset:8192
    s_add_u32 s23, s49, 12800
    buffer_store_dwordx4 v[88:91], v3, s[8:11], s23 offen sc1
    s_waitcnt lgkmcnt(4)
    v_mfma_f32_32x32x16_bf16 v[48:63], a[48:51], v[24:27], v[48:63]
    ds_read_b128 v[20:23], v5 offset:8704
    s_waitcnt lgkmcnt(4)
    v_mfma_f32_32x32x16_bf16 v[48:63], a[52:55], v[28:31], v[48:63]
    ds_read_b128 v[24:27], v5 offset:9216
    s_add_u32 m0, s44, 3072
    s_add_u32 s21, s43, 289792
    buffer_load_dwordx4 v1, s[8:11], s21 offen lds
    s_waitcnt lgkmcnt(4)
    v_mfma_f32_32x32x16_bf16 v[48:63], a[56:59], v[8:11], v[48:63]
    ds_read_b128 v[28:31], v5 offset:9728
    s_waitcnt lgkmcnt(4)
    v_mfma_f32_32x32x16_bf16 v[48:63], a[60:63], v[12:15], v[48:63]
    ds_read_b128 v[8:11], v5 offset:10240
    s_waitcnt lgkmcnt(4)
    v_mfma_f32_32x32x16_bf16 v[48:63], a[64:67], v[16:19], v[48:63]
    ds_read_b128 v[12:15], v5 offset:10752
    s_waitcnt lgkmcnt(4)
    v_mfma_f32_32x32x16_bf16 v[48:63], a[68:71], v[20:23], v[48:63]
    ds_read_b128 v[16:19], v5 offset:11264
    s_add_u32 m0, s44, 4096
    s_add_u32 s21, s43, 290816
    buffer_load_dwordx4 v1, s[8:11], s21 offen lds
    s_waitcnt lgkmcnt(4)
    v_mfma_f32_32x32x16_bf16 v[48:63], a[72:75], v[24:27], v[48:63]
    ds_read_b128 v[20:23], v5 offset:11776
    s_waitcnt lgkmcnt(4)
    v_mfma_f32_32x32x16_bf16 v[48:63], a[76:79], v[28:31], v[48:63]
    ds_read_b128 v[24:27], v5 offset:12288
    s_waitcnt lgkmcnt(4)
    v_mfma_f32_32x32x16_bf16 v[48:63], a[80:83], v[8:11], v[48:63]
    ds_read_b128 v[28:31], v5 offset:12800
    s_waitcnt lgkmcnt(4)
    v_mfma_f32_32x32x16_bf16 v[48:63], a[84:87], v[12:15], v[48:63]
    ds_read_b128 v[8:11], v5 offset:13312
    s_add_u32 m0, s44, 5120
    s_add_u32 s21, s43, 291840
    buffer_load_dwordx4 v1, s[8:11], s21 offen lds
    s_waitcnt lgkmcnt(4)
    v_mfma_f32_32x32x16_bf16 v[48:63], a[88:91], v[16:19], v[48:63]
    ds_read_b128 v[12:15], v5 offset:13824
    s_waitcnt lgkmcnt(4)
    v_mfma_f32_32x32x16_bf16 v[48:63], a[92:95], v[20:23], v[48:63]
    s_waitcnt vmcnt(17)
    s_barrier
    ds_read_b128 v[16:19], v5 offset:28672
    s_waitcnt lgkmcnt(4)
    v_mfma_f32_32x32x16_bf16 v[48:63], a[96:99], v[24:27], v[48:63]
    ds_read_b128 v[20:23], v5 offset:29184
    s_waitcnt lgkmcnt(4)
    v_mfma_f32_32x32x16_bf16 v[48:63], a[100:103], v[28:31], v[48:63]
    ds_read_b128 v[24:27], v5 offset:29696
    s_add_u32 m0, s44, 6144
    s_add_u32 s21, s43, 292864
    buffer_load_dwordx4 v1, s[8:11], s21 offen lds
    s_waitcnt lgkmcnt(4)
    v_mfma_f32_32x32x16_bf16 v[48:63], a[104:107], v[8:11], v[48:63]
    ds_read_b128 v[28:31], v5 offset:30208
    s_waitcnt lgkmcnt(4)
    v_mfma_f32_32x32x16_bf16 v[48:63], a[108:111], v[12:15], v[48:63]
    ds_read_b128 v[8:11], v5 offset:30720
    s_waitcnt lgkmcnt(4)
    v_mfma_f32_32x32x16_bf16 v[32:47], a[0:3], v[16:19], 0
    ds_read_b128 v[12:15], v5 offset:31232
    s_waitcnt lgkmcnt(4)
    v_mfma_f32_32x32x16_bf16 v[32:47], a[4:7], v[20:23], v[32:47]
    ds_read_b128 v[16:19], v5 offset:31744
    s_add_u32 m0, s44, 28672
    s_add_u32 s21, s43, 315392
    buffer_load_dwordx4 v1, s[8:11], s21 offen lds
    s_waitcnt lgkmcnt(4)
    v_mfma_f32_32x32x16_bf16 v[32:47], a[8:11], v[24:27], v[32:47]
    ds_read_b128 v[20:23], v5 offset:32256
    s_waitcnt lgkmcnt(4)
    v_mfma_f32_32x32x16_bf16 v[32:47], a[12:15], v[28:31], v[32:47]
    ds_read_b128 v[24:27], v5 offset:32768
    s_waitcnt lgkmcnt(4)
    v_mfma_f32_32x32x16_bf16 v[32:47], a[16:19], v[8:11], v[32:47]
    ds_read_b128 v[28:31], v5 offset:33280
    s_waitcnt lgkmcnt(4)
    v_mfma_f32_32x32x16_bf16 v[32:47], a[20:23], v[12:15], v[32:47]
    ds_read_b128 v[8:11], v5 offset:33792
    s_add_u32 m0, s44, 29696
    s_add_u32 s21, s43, 316416
    buffer_load_dwordx4 v1, s[8:11], s21 offen lds
    s_waitcnt lgkmcnt(4)
    v_mfma_f32_32x32x16_bf16 v[32:47], a[24:27], v[16:19], v[32:47]
    ds_read_b128 v[12:15], v5 offset:34304
    v_cvt_pk_bf16_f32 v80, v48, v49
    v_cvt_pk_bf16_f32 v81, v52, v53
    s_waitcnt lgkmcnt(4)
    v_mfma_f32_32x32x16_bf16 v[32:47], a[28:31], v[20:23], v[32:47]
    ds_read_b128 v[16:19], v5 offset:34816
    v_cvt_pk_bf16_f32 v82, v50, v51
    v_cvt_pk_bf16_f32 v83, v54, v55
    s_waitcnt lgkmcnt(4)
    v_mfma_f32_32x32x16_bf16 v[32:47], a[32:35], v[24:27], v[32:47]
    ds_read_b128 v[20:23], v5 offset:35328
    v_cvt_pk_bf16_f32 v88, v56, v57
    v_cvt_pk_bf16_f32 v89, v60, v61
    s_waitcnt lgkmcnt(4)
    v_mfma_f32_32x32x16_bf16 v[32:47], a[36:39], v[28:31], v[32:47]
    ds_read_b128 v[24:27], v5 offset:35840
    s_add_u32 m0, s44, 30720
    s_add_u32 s21, s43, 317440
    buffer_load_dwordx4 v1, s[8:11], s21 offen lds
    v_cvt_pk_bf16_f32 v90, v58, v59
    v_cvt_pk_bf16_f32 v91, v62, v63
    s_waitcnt lgkmcnt(4)
    v_mfma_f32_32x32x16_bf16 v[32:47], a[40:43], v[8:11], v[32:47]
    ds_read_b128 v[28:31], v5 offset:36352
    s_add_u32 s23, s49, 14336
    buffer_store_dwordx4 v[80:83], v3, s[8:11], s23 offen sc1
    s_waitcnt lgkmcnt(4)
    v_mfma_f32_32x32x16_bf16 v[32:47], a[44:47], v[12:15], v[32:47]
    ds_read_b128 v[8:11], v5 offset:36864
    s_add_u32 s23, s49, 14848
    buffer_store_dwordx4 v[88:91], v3, s[8:11], s23 offen sc1
    s_waitcnt lgkmcnt(4)
    v_mfma_f32_32x32x16_bf16 v[32:47], a[48:51], v[16:19], v[32:47]
    ds_read_b128 v[12:15], v5 offset:37376
    s_waitcnt lgkmcnt(4)
    v_mfma_f32_32x32x16_bf16 v[32:47], a[52:55], v[20:23], v[32:47]
    ds_read_b128 v[16:19], v5 offset:37888
    s_add_u32 m0, s44, 31744
    s_add_u32 s21, s43, 318464
    buffer_load_dwordx4 v1, s[8:11], s21 offen lds
    s_waitcnt lgkmcnt(4)
    v_mfma_f32_32x32x16_bf16 v[32:47], a[56:59], v[24:27], v[32:47]
    ds_read_b128 v[20:23], v5 offset:38400
    s_waitcnt lgkmcnt(4)
    v_mfma_f32_32x32x16_bf16 v[32:47], a[60:63], v[28:31], v[32:47]
    ds_read_b128 v[24:27], v5 offset:38912
    s_waitcnt lgkmcnt(4)
    v_mfma_f32_32x32x16_bf16 v[32:47], a[64:67], v[8:11], v[32:47]
    ds_read_b128 v[28:31], v5 offset:39424
    s_waitcnt lgkmcnt(4)
    v_mfma_f32_32x32x16_bf16 v[32:47], a[68:71], v[12:15], v[32:47]
    ds_read_b128 v[8:11], v5 offset:39936
    s_add_u32 m0, s44, 32768
    s_add_u32 s21, s43, 319488
    buffer_load_dwordx4 v1, s[8:11], s21 offen lds
    s_waitcnt lgkmcnt(4)
    v_mfma_f32_32x32x16_bf16 v[32:47], a[72:75], v[16:19], v[32:47]
    ds_read_b128 v[12:15], v5 offset:40448
    s_waitcnt lgkmcnt(4)
    v_mfma_f32_32x32x16_bf16 v[32:47], a[76:79], v[20:23], v[32:47]
    ds_read_b128 v[16:19], v5 offset:40960
    s_waitcnt lgkmcnt(4)
    v_mfma_f32_32x32x16_bf16 v[32:47], a[80:83], v[24:27], v[32:47]
    ds_read_b128 v[20:23], v5 offset:41472
    s_waitcnt lgkmcnt(4)
    v_mfma_f32_32x32x16_bf16 v[32:47], a[84:87], v[28:31], v[32:47]
    ds_read_b128 v[24:27], v5 offset:41984
    s_add_u32 m0, s44, 33792
    s_add_u32 s21, s43, 320512
    buffer_load_dwordx4 v1, s[8:11], s21 offen lds
    s_waitcnt lgkmcnt(4)
    v_mfma_f32_32x32x16_bf16 v[32:47], a[88:91], v[8:11], v[32:47]
    ds_read_b128 v[28:31], v5 offset:42496
    s_waitcnt lgkmcnt(4)
    v_mfma_f32_32x32x16_bf16 v[32:47], a[92:95], v[12:15], v[32:47]
    s_waitcnt vmcnt(17)
    s_barrier
    ds_read_b128 v[8:11], v6 offset:0
    s_waitcnt lgkmcnt(4)
    v_mfma_f32_32x32x16_bf16 v[32:47], a[96:99], v[16:19], v[32:47]
    ds_read_b128 v[12:15], v6 offset:512
    s_waitcnt lgkmcnt(4)
    v_mfma_f32_32x32x16_bf16 v[32:47], a[100:103], v[20:23], v[32:47]
    ds_read_b128 v[16:19], v6 offset:1024
    s_add_u32 m0, s44, 34816
    s_add_u32 s21, s43, 321536
    buffer_load_dwordx4 v1, s[8:11], s21 offen lds
    s_waitcnt lgkmcnt(4)
    v_mfma_f32_32x32x16_bf16 v[32:47], a[104:107], v[24:27], v[32:47]
    ds_read_b128 v[20:23], v6 offset:1536
    s_waitcnt lgkmcnt(4)
    v_mfma_f32_32x32x16_bf16 v[32:47], a[108:111], v[28:31], v[32:47]
    ds_read_b128 v[24:27], v6 offset:2048
    s_waitcnt lgkmcnt(4)
    v_mfma_f32_32x32x16_bf16 v[48:63], a[0:3], v[8:11], 0
    ds_read_b128 v[28:31], v6 offset:2560
    s_waitcnt lgkmcnt(4)
    v_mfma_f32_32x32x16_bf16 v[48:63], a[4:7], v[12:15], v[48:63]
    ds_read_b128 v[8:11], v6 offset:3072
    s_add_u32 m0, s44, 57344
    s_add_u32 s21, s43, 344064
    buffer_load_dwordx4 v1, s[8:11], s21 offen lds
    s_waitcnt lgkmcnt(4)
    v_mfma_f32_32x32x16_bf16 v[48:63], a[8:11], v[16:19], v[48:63]
    ds_read_b128 v[12:15], v6 offset:3584
    s_waitcnt lgkmcnt(4)
    v_mfma_f32_32x32x16_bf16 v[48:63], a[12:15], v[20:23], v[48:63]
    ds_read_b128 v[16:19], v6 offset:4096
    s_waitcnt lgkmcnt(4)
    v_mfma_f32_32x32x16_bf16 v[48:63], a[16:19], v[24:27], v[48:63]
    ds_read_b128 v[20:23], v6 offset:4608
    s_waitcnt lgkmcnt(4)
    v_mfma_f32_32x32x16_bf16 v[48:63], a[20:23], v[28:31], v[48:63]
    ds_read_b128 v[24:27], v6 offset:5120
    s_add_u32 m0, s44, 58368
    s_add_u32 s21, s43, 345088
    buffer_load_dwordx4 v1, s[8:11], s21 offen lds
    s_waitcnt lgkmcnt(4)
    v_mfma_f32_32x32x16_bf16 v[48:63], a[24:27], v[8:11], v[48:63]
    ds_read_b128 v[28:31], v6 offset:5632
    v_cvt_pk_bf16_f32 v80, v32, v33
    v_cvt_pk_bf16_f32 v81, v36, v37
    s_waitcnt lgkmcnt(4)
    v_mfma_f32_32x32x16_bf16 v[48:63], a[28:31], v[12:15], v[48:63]
    ds_read_b128 v[8:11], v6 offset:6144
    v_cvt_pk_bf16_f32 v82, v34, v35
    v_cvt_pk_bf16_f32 v83, v38, v39
    s_waitcnt lgkmcnt(4)
    v_mfma_f32_32x32x16_bf16 v[48:63], a[32:35], v[16:19], v[48:63]
    ds_read_b128 v[12:15], v6 offset:6656
    v_cvt_pk_bf16_f32 v88, v40, v41
    v_cvt_pk_bf16_f32 v89, v44, v45
    s_waitcnt lgkmcnt(4)
    v_mfma_f32_32x32x16_bf16 v[48:63], a[36:39], v[20:23], v[48:63]
    ds_read_b128 v[16:19], v6 offset:7168
    s_add_u32 m0, s44, 59392
    s_add_u32 s21, s43, 346112
    buffer_load_dwordx4 v1, s[8:11], s21 offen lds
    v_cvt_pk_bf16_f32 v90, v42, v43
    v_cvt_pk_bf16_f32 v91, v46, v47
    s_waitcnt lgkmcnt(4)
    v_mfma_f32_32x32x16_bf16 v[48:63], a[40:43], v[24:27], v[48:63]
    ds_read_b128 v[20:23], v6 offset:7680
    s_add_u32 s23, s49, 16384
    buffer_store_dwordx4 v[80:83], v3, s[8:11], s23 offen sc1
    s_waitcnt lgkmcnt(4)
    v_mfma_f32_32x32x16_bf16 v[48:63], a[44:47], v[28:31], v[48:63]
    ds_read_b128 v[24:27], v6 offset:8192
    s_add_u32 s23, s49, 16896
    buffer_store_dwordx4 v[88:91], v3, s[8:11], s23 offen sc1
    s_waitcnt lgkmcnt(4)
    v_mfma_f32_32x32x16_bf16 v[48:63], a[48:51], v[8:11], v[48:63]
    ds_read_b128 v[28:31], v6 offset:8704
    s_waitcnt lgkmcnt(4)
    v_mfma_f32_32x32x16_bf16 v[48:63], a[52:55], v[12:15], v[48:63]
    ds_read_b128 v[8:11], v6 offset:9216
    s_add_u32 m0, s44, 60416
    s_add_u32 s21, s43, 347136
    buffer_load_dwordx4 v1, s[8:11], s21 offen lds
    s_waitcnt lgkmcnt(4)
    v_mfma_f32_32x32x16_bf16 v[48:63], a[56:59], v[16:19], v[48:63]
    ds_read_b128 v[12:15], v6 offset:9728
    s_waitcnt lgkmcnt(4)
    v_mfma_f32_32x32x16_bf16 v[48:63], a[60:63], v[20:23], v[48:63]
    ds_read_b128 v[16:19], v6 offset:10240
    s_waitcnt lgkmcnt(4)
    v_mfma_f32_32x32x16_bf16 v[48:63], a[64:67], v[24:27], v[48:63]
    ds_read_b128 v[20:23], v6 offset:10752
    s_waitcnt lgkmcnt(4)
    v_mfma_f32_32x32x16_bf16 v[48:63], a[68:71], v[28:31], v[48:63]
    ds_read_b128 v[24:27], v6 offset:11264
    s_add_u32 m0, s44, 61440
    s_add_u32 s21, s43, 348160
    buffer_load_dwordx4 v1, s[8:11], s21 offen lds
    s_waitcnt lgkmcnt(4)
    v_mfma_f32_32x32x16_bf16 v[48:63], a[72:75], v[8:11], v[48:63]
    ds_read_b128 v[28:31], v6 offset:11776
    s_waitcnt lgkmcnt(4)
    v_mfma_f32_32x32x16_bf16 v[48:63], a[76:79], v[12:15], v[48:63]
    ds_read_b128 v[8:11], v6 offset:12288
    s_waitcnt lgkmcnt(4)
    v_mfma_f32_32x32x16_bf16 v[48:63], a[80:83], v[16:19], v[48:63]
    ds_read_b128 v[12:15], v6 offset:12800
    s_waitcnt lgkmcnt(4)
    v_mfma_f32_32x32x16_bf16 v[48:63], a[84:87], v[20:23], v[48:63]
    ds_read_b128 v[16:19], v6 offset:13312
    s_add_u32 m0, s44, 62464
    s_add_u32 s21, s43, 349184
    buffer_load_dwordx4 v1, s[8:11], s21 offen lds
    s_waitcnt lgkmcnt(4)
    v_mfma_f32_32x32x16_bf16 v[48:63], a[88:91], v[24:27], v[48:63]
    ds_read_b128 v[20:23], v6 offset:13824
    s_waitcnt lgkmcnt(4)
    v_mfma_f32_32x32x16_bf16 v[48:63], a[92:95], v[28:31], v[48:63]
    s_waitcnt vmcnt(17)
    s_barrier
    ds_read_b128 v[24:27], v4 offset:0
    s_waitcnt lgkmcnt(4)
    v_mfma_f32_32x32x16_bf16 v[48:63], a[96:99], v[8:11], v[48:63]
    ds_read_b128 v[28:31], v4 offset:512
    s_waitcnt lgkmcnt(4)
    v_mfma_f32_32x32x16_bf16 v[48:63], a[100:103], v[12:15], v[48:63]
    ds_read_b128 v[8:11], v4 offset:1024
    s_add_u32 m0, s44, 63488
    s_add_u32 s21, s43, 350208
    buffer_load_dwordx4 v1, s[8:11], s21 offen lds
    s_waitcnt lgkmcnt(4)
    v_mfma_f32_32x32x16_bf16 v[48:63], a[104:107], v[16:19], v[48:63]
    ds_read_b128 v[12:15], v4 offset:1536
    s_waitcnt lgkmcnt(4)
    v_mfma_f32_32x32x16_bf16 v[48:63], a[108:111], v[20:23], v[48:63]
    ds_read_b128 v[16:19], v4 offset:2048
    s_waitcnt lgkmcnt(4)
    v_mfma_f32_32x32x16_bf16 v[32:47], a[0:3], v[24:27], 0
    ds_read_b128 v[20:23], v4 offset:2560
    s_waitcnt lgkmcnt(4)
    v_mfma_f32_32x32x16_bf16 v[32:47], a[4:7], v[28:31], v[32:47]
    ds_read_b128 v[24:27], v4 offset:3072
    s_add_u32 m0, s44, 86016
    s_add_u32 s21, s43, 372736
    buffer_load_dwordx4 v1, s[8:11], s21 offen lds
    s_waitcnt lgkmcnt(4)
    v_mfma_f32_32x32x16_bf16 v[32:47], a[8:11], v[8:11], v[32:47]
    ds_read_b128 v[28:31], v4 offset:3584
    s_waitcnt lgkmcnt(4)
    v_mfma_f32_32x32x16_bf16 v[32:47], a[12:15], v[12:15], v[32:47]
    ds_read_b128 v[8:11], v4 offset:4096
    s_waitcnt lgkmcnt(4)
    v_mfma_f32_32x32x16_bf16 v[32:47], a[16:19], v[16:19], v[32:47]
    ds_read_b128 v[12:15], v4 offset:4608
    s_waitcnt lgkmcnt(4)
    v_mfma_f32_32x32x16_bf16 v[32:47], a[20:23], v[20:23], v[32:47]
    ds_read_b128 v[16:19], v4 offset:5120
    s_add_u32 m0, s44, 87040
    s_add_u32 s21, s43, 373760
    buffer_load_dwordx4 v1, s[8:11], s21 offen lds
    s_waitcnt lgkmcnt(4)
    v_mfma_f32_32x32x16_bf16 v[32:47], a[24:27], v[24:27], v[32:47]
    ds_read_b128 v[20:23], v4 offset:5632
    v_cvt_pk_bf16_f32 v80, v48, v49
    v_cvt_pk_bf16_f32 v81, v52, v53
    s_waitcnt lgkmcnt(4)
    v_mfma_f32_32x32x16_bf16 v[32:47], a[28:31], v[28:31], v[32:47]
    ds_read_b128 v[24:27], v4 offset:6144
    v_cvt_pk_bf16_f32 v82, v50, v51
    v_cvt_pk_bf16_f32 v83, v54, v55
    s_waitcnt lgkmcnt(4)
    v_mfma_f32_32x32x16_bf16 v[32:47], a[32:35], v[8:11], v[32:47]
    ds_read_b128 v[28:31], v4 offset:6656
    v_cvt_pk_bf16_f32 v88, v56, v57
    v_cvt_pk_bf16_f32 v89, v60, v61
    s_waitcnt lgkmcnt(4)
    v_mfma_f32_32x32x16_bf16 v[32:47], a[36:39], v[12:15], v[32:47]
    ds_read_b128 v[8:11], v4 offset:7168
    s_add_u32 m0, s44, 88064
    s_add_u32 s21, s43, 374784
    buffer_load_dwordx4 v1, s[8:11], s21 offen lds
    v_cvt_pk_bf16_f32 v90, v58, v59
    v_cvt_pk_bf16_f32 v91, v62, v63
    s_waitcnt lgkmcnt(4)
    v_mfma_f32_32x32x16_bf16 v[32:47], a[40:43], v[16:19], v[32:47]
    ds_read_b128 v[12:15], v4 offset:7680
    s_add_u32 s23, s49, 18432
    buffer_store_dwordx4 v[80:83], v3, s[8:11], s23 offen sc1
    s_waitcnt lgkmcnt(4)
    v_mfma_f32_32x32x16_bf16 v[32:47], a[44:47], v[20:23], v[32:47]
    ds_read_b128 v[16:19], v4 offset:8192
    s_add_u32 s23, s49, 18944
    buffer_store_dwordx4 v[88:91], v3, s[8:11], s23 offen sc1
    s_waitcnt lgkmcnt(4)
    v_mfma_f32_32x32x16_bf16 v[32:47], a[48:51], v[24:27], v[32:47]
    ds_read_b128 v[20:23], v4 offset:8704
    s_waitcnt lgkmcnt(4)
    v_mfma_f32_32x32x16_bf16 v[32:47], a[52:55], v[28:31], v[32:47]
    ds_read_b128 v[24:27], v4 offset:9216
    s_add_u32 m0, s44, 89088
    s_add_u32 s21, s43, 375808
    buffer_load_dwordx4 v1, s[8:11], s21 offen lds
    s_waitcnt lgkmcnt(4)
    v_mfma_f32_32x32x16_bf16 v[32:47], a[56:59], v[8:11], v[32:47]
    ds_read_b128 v[28:31], v4 offset:9728
    s_waitcnt lgkmcnt(4)
    v_mfma_f32_32x32x16_bf16 v[32:47], a[60:63], v[12:15], v[32:47]
    ds_read_b128 v[8:11], v4 offset:10240
    s_waitcnt lgkmcnt(4)
    v_mfma_f32_32x32x16_bf16 v[32:47], a[64:67], v[16:19], v[32:47]
    ds_read_b128 v[12:15], v4 offset:10752
    s_waitcnt lgkmcnt(4)
    v_mfma_f32_32x32x16_bf16 v[32:47], a[68:71], v[20:23], v[32:47]
    ds_read_b128 v[16:19], v4 offset:11264
    s_add_u32 m0, s44, 90112
    s_add_u32 s21, s43, 376832
    buffer_load_dwordx4 v1, s[8:11], s21 offen lds
    s_waitcnt lgkmcnt(4)
    v_mfma_f32_32x32x16_bf16 v[32:47], a[72:75], v[24:27], v[32:47]
    ds_read_b128 v[20:23], v4 offset:11776
    s_waitcnt lgkmcnt(4)
    v_mfma_f32_32x32x16_bf16 v[32:47], a[76:79], v[28:31], v[32:47]
    ds_read_b128 v[24:27], v4 offset:12288
    s_waitcnt lgkmcnt(4)
    v_mfma_f32_32x32x16_bf16 v[32:47], a[80:83], v[8:11], v[32:47]
    ds_read_b128 v[28:31], v4 offset:12800
    s_waitcnt lgkmcnt(4)
    v_mfma_f32_32x32x16_bf16 v[32:47], a[84:87], v[12:15], v[32:47]
    ds_read_b128 v[8:11], v4 offset:13312
    s_add_u32 m0, s44, 91136
    s_add_u32 s21, s43, 377856
    buffer_load_dwordx4 v1, s[8:11], s21 offen lds
    s_waitcnt lgkmcnt(4)
    v_mfma_f32_32x32x16_bf16 v[32:47], a[88:91], v[16:19], v[32:47]
    ds_read_b128 v[12:15], v4 offset:13824
    s_waitcnt lgkmcnt(4)
    v_mfma_f32_32x32x16_bf16 v[32:47], a[92:95], v[20:23], v[32:47]
    s_waitcnt vmcnt(17)
    s_barrier
    ds_read_b128 v[16:19], v4 offset:28672
    s_waitcnt lgkmcnt(4)
    v_mfma_f32_32x32x16_bf16 v[32:47], a[96:99], v[24:27], v[32:47]
    ds_read_b128 v[20:23], v4 offset:29184
    s_waitcnt lgkmcnt(4)
    v_mfma_f32_32x32x16_bf16 v[32:47], a[100:103], v[28:31], v[32:47]
    ds_read_b128 v[24:27], v4 offset:29696
    s_add_u32 m0, s44, 92160
    s_add_u32 s21, s43, 378880
    buffer_load_dwordx4 v1, s[8:11], s21 offen lds
    s_waitcnt lgkmcnt(4)
    v_mfma_f32_32x32x16_bf16 v[32:47], a[104:107], v[8:11], v[32:47]
    ds_read_b128 v[28:31], v4 offset:30208
    s_waitcnt lgkmcnt(4)
    v_mfma_f32_32x32x16_bf16 v[32:47], a[108:111], v[12:15], v[32:47]
    ds_read_b128 v[8:11], v4 offset:30720
    s_waitcnt lgkmcnt(4)
    v_mfma_f32_32x32x16_bf16 v[48:63], a[0:3], v[16:19], 0
    ds_read_b128 v[12:15], v4 offset:31232
    s_waitcnt lgkmcnt(4)
    v_mfma_f32_32x32x16_bf16 v[48:63], a[4:7], v[20:23], v[48:63]
    ds_read_b128 v[16:19], v4 offset:31744
    s_add_u32 m0, s44, 114688
    s_add_u32 s21, s43, 372736
    buffer_load_dwordx4 v1, s[8:11], s21 offen lds
    s_waitcnt lgkmcnt(4)
    v_mfma_f32_32x32x16_bf16 v[48:63], a[8:11], v[24:27], v[48:63]
    ds_read_b128 v[20:23], v4 offset:32256
    s_waitcnt lgkmcnt(4)
    v_mfma_f32_32x32x16_bf16 v[48:63], a[12:15], v[28:31], v[48:63]
    ds_read_b128 v[24:27], v4 offset:32768
    s_waitcnt lgkmcnt(4)
    v_mfma_f32_32x32x16_bf16 v[48:63], a[16:19], v[8:11], v[48:63]
    ds_read_b128 v[28:31], v4 offset:33280
    s_waitcnt lgkmcnt(4)
    v_mfma_f32_32x32x16_bf16 v[48:63], a[20:23], v[12:15], v[48:63]
    ds_read_b128 v[8:11], v4 offset:33792
    s_add_u32 m0, s44, 115712
    s_add_u32 s21, s43, 373760
    buffer_load_dwordx4 v1, s[8:11], s21 offen lds
    s_waitcnt lgkmcnt(4)
    v_mfma_f32_32x32x16_bf16 v[48:63], a[24:27], v[16:19], v[48:63]
    ds_read_b128 v[12:15], v4 offset:34304
    v_cvt_pk_bf16_f32 v80, v32, v33
    v_cvt_pk_bf16_f32 v81, v36, v37
    s_waitcnt lgkmcnt(4)
    v_mfma_f32_32x32x16_bf16 v[48:63], a[28:31], v[20:23], v[48:63]
    ds_read_b128 v[16:19], v4 offset:34816
    v_cvt_pk_bf16_f32 v82, v34, v35
    v_cvt_pk_bf16_f32 v83, v38, v39
    s_waitcnt lgkmcnt(4)
    v_mfma_f32_32x32x16_bf16 v[48:63], a[32:35], v[24:27], v[48:63]
    ds_read_b128 v[20:23], v4 offset:35328
    v_cvt_pk_bf16_f32 v88, v40, v41
    v_cvt_pk_bf16_f32 v89, v44, v45
    s_waitcnt lgkmcnt(4)
    v_mfma_f32_32x32x16_bf16 v[48:63], a[36:39], v[28:31], v[48:63]
    ds_read_b128 v[24:27], v4 offset:35840
    s_add_u32 m0, s44, 116736
    s_add_u32 s21, s43, 374784
    buffer_load_dwordx4 v1, s[8:11], s21 offen lds
    v_cvt_pk_bf16_f32 v90, v42, v43
    v_cvt_pk_bf16_f32 v91, v46, v47
    s_waitcnt lgkmcnt(4)
    v_mfma_f32_32x32x16_bf16 v[48:63], a[40:43], v[8:11], v[48:63]
    ds_read_b128 v[28:31], v4 offset:36352
    s_add_u32 s23, s49, 20480
    buffer_store_dwordx4 v[80:83], v3, s[8:11], s23 offen sc1
    s_waitcnt lgkmcnt(4)
    v_mfma_f32_32x32x16_bf16 v[48:63], a[44:47], v[12:15], v[48:63]
    ds_read_b128 v[8:11], v4 offset:36864
    s_add_u32 s23, s49, 20992
    buffer_store_dwordx4 v[88:91], v3, s[8:11], s23 offen sc1
    s_waitcnt lgkmcnt(4)
    v_mfma_f32_32x32x16_bf16 v[48:63], a[48:51], v[16:19], v[48:63]
    ds_read_b128 v[12:15], v4 offset:37376
    s_waitcnt lgkmcnt(4)
    v_mfma_f32_32x32x16_bf16 v[48:63], a[52:55], v[20:23], v[48:63]
    ds_read_b128 v[16:19], v4 offset:37888
    s_add_u32 m0, s44, 117760
    s_add_u32 s21, s43, 375808
    buffer_load_dwordx4 v1, s[8:11], s21 offen lds
    s_waitcnt lgkmcnt(4)
    v_mfma_f32_32x32x16_bf16 v[48:63], a[56:59], v[24:27], v[48:63]
    ds_read_b128 v[20:23], v4 offset:38400
    s_waitcnt lgkmcnt(4)
    v_mfma_f32_32x32x16_bf16 v[48:63], a[60:63], v[28:31], v[48:63]
    ds_read_b128 v[24:27], v4 offset:38912
    s_waitcnt lgkmcnt(4)
    v_mfma_f32_32x32x16_bf16 v[48:63], a[64:67], v[8:11], v[48:63]
    ds_read_b128 v[28:31], v4 offset:39424
    s_waitcnt lgkmcnt(4)
    v_mfma_f32_32x32x16_bf16 v[48:63], a[68:71], v[12:15], v[48:63]
    ds_read_b128 v[8:11], v4 offset:39936
    s_add_u32 m0, s44, 118784
    s_add_u32 s21, s43, 376832
    buffer_load_dwordx4 v1, s[8:11], s21 offen lds
    s_waitcnt lgkmcnt(4)
    v_mfma_f32_32x32x16_bf16 v[48:63], a[72:75], v[16:19], v[48:63]
    ds_read_b128 v[12:15], v4 offset:40448
    s_waitcnt lgkmcnt(4)
    v_mfma_f32_32x32x16_bf16 v[48:63], a[76:79], v[20:23], v[48:63]
    ds_read_b128 v[16:19], v4 offset:40960
    s_waitcnt lgkmcnt(4)
    v_mfma_f32_32x32x16_bf16 v[48:63], a[80:83], v[24:27], v[48:63]
    ds_read_b128 v[20:23], v4 offset:41472
    s_waitcnt lgkmcnt(4)
    v_mfma_f32_32x32x16_bf16 v[48:63], a[84:87], v[28:31], v[48:63]
    ds_read_b128 v[24:27], v4 offset:41984
    s_add_u32 m0, s44, 119808
    s_add_u32 s21, s43, 377856
    buffer_load_dwordx4 v1, s[8:11], s21 offen lds
    s_waitcnt lgkmcnt(4)
    v_mfma_f32_32x32x16_bf16 v[48:63], a[88:91], v[8:11], v[48:63]
    ds_read_b128 v[28:31], v4 offset:42496
    s_waitcnt lgkmcnt(4)
    v_mfma_f32_32x32x16_bf16 v[48:63], a[92:95], v[12:15], v[48:63]
    s_waitcnt vmcnt(17)
    s_barrier
    ds_read_b128 v[8:11], v5 offset:0
    s_waitcnt lgkmcnt(4)
    v_mfma_f32_32x32x16_bf16 v[48:63], a[96:99], v[16:19], v[48:63]
    ds_read_b128 v[12:15], v5 offset:512
    s_waitcnt lgkmcnt(4)
    v_mfma_f32_32x32x16_bf16 v[48:63], a[100:103], v[20:23], v[48:63]
    ds_read_b128 v[16:19], v5 offset:1024
    s_add_u32 m0, s44, 120832
    s_add_u32 s21, s43, 378880
    buffer_load_dwordx4 v1, s[8:11], s21 offen lds
    s_waitcnt lgkmcnt(4)
    v_mfma_f32_32x32x16_bf16 v[48:63], a[104:107], v[24:27], v[48:63]
    ds_read_b128 v[20:23], v5 offset:1536
    s_waitcnt lgkmcnt(4)
    v_mfma_f32_32x32x16_bf16 v[48:63], a[108:111], v[28:31], v[48:63]
    ds_read_b128 v[24:27], v5 offset:2048
    s_waitcnt lgkmcnt(4)
    v_mfma_f32_32x32x16_bf16 v[32:47], a[0:3], v[8:11], 0
    ds_read_b128 v[28:31], v5 offset:2560
    s_waitcnt lgkmcnt(4)
    v_mfma_f32_32x32x16_bf16 v[32:47], a[4:7], v[12:15], v[32:47]
    ds_read_b128 v[8:11], v5 offset:3072
    s_add_u32 m0, s44, 0
    s_add_u32 s21, s43, 372736
    buffer_load_dwordx4 v1, s[8:11], s21 offen lds
    s_waitcnt lgkmcnt(4)
    v_mfma_f32_32x32x16_bf16 v[32:47], a[8:11], v[16:19], v[32:47]
    ds_read_b128 v[12:15], v5 offset:3584
    s_waitcnt lgkmcnt(4)
    v_mfma_f32_32x32x16_bf16 v[32:47], a[12:15], v[20:23], v[32:47]
    ds_read_b128 v[16:19], v5 offset:4096
    s_waitcnt lgkmcnt(4)
    v_mfma_f32_32x32x16_bf16 v[32:47], a[16:19], v[24:27], v[32:47]
    ds_read_b128 v[20:23], v5 offset:4608
    s_waitcnt lgkmcnt(4)
    v_mfma_f32_32x32x16_bf16 v[32:47], a[20:23], v[28:31], v[32:47]
    ds_read_b128 v[24:27], v5 offset:5120
    s_add_u32 m0, s44, 1024
    s_add_u32 s21, s43, 373760
    buffer_load_dwordx4 v1, s[8:11], s21 offen lds
    s_waitcnt lgkmcnt(4)
    v_mfma_f32_32x32x16_bf16 v[32:47], a[24:27], v[8:11], v[32:47]
    ds_read_b128 v[28:31], v5 offset:5632
    v_cvt_pk_bf16_f32 v80, v48, v49
    v_cvt_pk_bf16_f32 v81, v52, v53
    s_waitcnt lgkmcnt(4)
    v_mfma_f32_32x32x16_bf16 v[32:47], a[28:31], v[12:15], v[32:47]
    ds_read_b128 v[8:11], v5 offset:6144
    v_cvt_pk_bf16_f32 v82, v50, v51
    v_cvt_pk_bf16_f32 v83, v54, v55
    s_waitcnt lgkmcnt(4)
    v_mfma_f32_32x32x16_bf16 v[32:47], a[32:35], v[16:19], v[32:47]
    ds_read_b128 v[12:15], v5 offset:6656
    v_cvt_pk_bf16_f32 v88, v56, v57
    v_cvt_pk_bf16_f32 v89, v60, v61
    s_waitcnt lgkmcnt(4)
    v_mfma_f32_32x32x16_bf16 v[32:47], a[36:39], v[20:23], v[32:47]
    ds_read_b128 v[16:19], v5 offset:7168
    s_add_u32 m0, s44, 2048
    s_add_u32 s21, s43, 374784
    buffer_load_dwordx4 v1, s[8:11], s21 offen lds
    v_cvt_pk_bf16_f32 v90, v58, v59
    v_cvt_pk_bf16_f32 v91, v62, v63
    s_waitcnt lgkmcnt(4)
    v_mfma_f32_32x32x16_bf16 v[32:47], a[40:43], v[24:27], v[32:47]
    ds_read_b128 v[20:23], v5 offset:7680
    s_add_u32 s23, s49, 22528
    buffer_store_dwordx4 v[80:83], v3, s[8:11], s23 offen sc1
    s_waitcnt lgkmcnt(4)
    v_mfma_f32_32x32x16_bf16 v[32:47], a[44:47], v[28:31], v[32:47]
    ds_read_b128 v[24:27], v5 offset:8192
    s_add_u32 s23, s49, 23040
    buffer_store_dwordx4 v[88:91], v3, s[8:11], s23 offen sc1
    s_waitcnt lgkmcnt(4)
    v_mfma_f32_32x32x16_bf16 v[32:47], a[48:51], v[8:11], v[32:47]
    ds_read_b128 v[28:31], v5 offset:8704
    s_waitcnt lgkmcnt(4)
    v_mfma_f32_32x32x16_bf16 v[32:47], a[52:55], v[12:15], v[32:47]
    ds_read_b128 v[8:11], v5 offset:9216
    s_add_u32 m0, s44, 3072
    s_add_u32 s21, s43, 375808
    buffer_load_dwordx4 v1, s[8:11], s21 offen lds
    s_waitcnt lgkmcnt(4)
    v_mfma_f32_32x32x16_bf16 v[32:47], a[56:59], v[16:19], v[32:47]
    ds_read_b128 v[12:15], v5 offset:9728
    s_waitcnt lgkmcnt(4)
    v_mfma_f32_32x32x16_bf16 v[32:47], a[60:63], v[20:23], v[32:47]
    ds_read_b128 v[16:19], v5 offset:10240
    s_waitcnt lgkmcnt(4)
    v_mfma_f32_32x32x16_bf16 v[32:47], a[64:67], v[24:27], v[32:47]
    ds_read_b128 v[20:23], v5 offset:10752
    s_waitcnt lgkmcnt(4)
    v_mfma_f32_32x32x16_bf16 v[32:47], a[68:71], v[28:31], v[32:47]
    ds_read_b128 v[24:27], v5 offset:11264
    s_add_u32 m0, s44, 4096
    s_add_u32 s21, s43, 376832
    buffer_load_dwordx4 v1, s[8:11], s21 offen lds
    s_waitcnt lgkmcnt(4)
    v_mfma_f32_32x32x16_bf16 v[32:47], a[72:75], v[8:11], v[32:47]
    ds_read_b128 v[28:31], v5 offset:11776
    s_waitcnt lgkmcnt(4)
    v_mfma_f32_32x32x16_bf16 v[32:47], a[76:79], v[12:15], v[32:47]
    ds_read_b128 v[8:11], v5 offset:12288
    s_waitcnt lgkmcnt(4)
    v_mfma_f32_32x32x16_bf16 v[32:47], a[80:83], v[16:19], v[32:47]
    ds_read_b128 v[12:15], v5 offset:12800
    s_waitcnt lgkmcnt(4)
    v_mfma_f32_32x32x16_bf16 v[32:47], a[84:87], v[20:23], v[32:47]
    ds_read_b128 v[16:19], v5 offset:13312
    s_add_u32 m0, s44, 5120
    s_add_u32 s21, s43, 377856
    buffer_load_dwordx4 v1, s[8:11], s21 offen lds
    s_waitcnt lgkmcnt(4)
    v_mfma_f32_32x32x16_bf16 v[32:47], a[88:91], v[24:27], v[32:47]
    ds_read_b128 v[20:23], v5 offset:13824
    s_waitcnt lgkmcnt(4)
    v_mfma_f32_32x32x16_bf16 v[32:47], a[92:95], v[28:31], v[32:47]
    s_waitcnt vmcnt(17)
    s_barrier
    ds_read_b128 v[24:27], v5 offset:28672
    s_waitcnt lgkmcnt(4)
    v_mfma_f32_32x32x16_bf16 v[32:47], a[96:99], v[8:11], v[32:47]
    ds_read_b128 v[28:31], v5 offset:29184
    s_waitcnt lgkmcnt(4)
    v_mfma_f32_32x32x16_bf16 v[32:47], a[100:103], v[12:15], v[32:47]
    ds_read_b128 v[8:11], v5 offset:29696
    s_add_u32 m0, s44, 6144
    s_add_u32 s21, s43, 378880
    buffer_load_dwordx4 v1, s[8:11], s21 offen lds
    s_waitcnt lgkmcnt(4)
    v_mfma_f32_32x32x16_bf16 v[32:47], a[104:107], v[16:19], v[32:47]
    ds_read_b128 v[12:15], v5 offset:30208
    s_waitcnt lgkmcnt(4)
    v_mfma_f32_32x32x16_bf16 v[32:47], a[108:111], v[20:23], v[32:47]
    ds_read_b128 v[16:19], v5 offset:30720
    s_waitcnt lgkmcnt(4)
    v_mfma_f32_32x32x16_bf16 v[48:63], a[0:3], v[24:27], 0
    ds_read_b128 v[20:23], v5 offset:31232
    s_waitcnt lgkmcnt(4)
    v_mfma_f32_32x32x16_bf16 v[48:63], a[4:7], v[28:31], v[48:63]
    ds_read_b128 v[24:27], v5 offset:31744
    s_add_u32 m0, s44, 28672
    s_add_u32 s21, s43, 372736
    buffer_load_dwordx4 v1, s[8:11], s21 offen lds
    s_waitcnt lgkmcnt(4)
    v_mfma_f32_32x32x16_bf16 v[48:63], a[8:11], v[8:11], v[48:63]
    ds_read_b128 v[28:31], v5 offset:32256
    s_waitcnt lgkmcnt(4)
    v_mfma_f32_32x32x16_bf16 v[48:63], a[12:15], v[12:15], v[48:63]
    ds_read_b128 v[8:11], v5 offset:32768
    s_waitcnt lgkmcnt(4)
    v_mfma_f32_32x32x16_bf16 v[48:63], a[16:19], v[16:19], v[48:63]
    ds_read_b128 v[12:15], v5 offset:33280
    s_waitcnt lgkmcnt(4)
    v_mfma_f32_32x32x16_bf16 v[48:63], a[20:23], v[20:23], v[48:63]
    ds_read_b128 v[16:19], v5 offset:33792
    s_add_u32 m0, s44, 29696
    s_add_u32 s21, s43, 373760
    buffer_load_dwordx4 v1, s[8:11], s21 offen lds
    s_waitcnt lgkmcnt(4)
    v_mfma_f32_32x32x16_bf16 v[48:63], a[24:27], v[24:27], v[48:63]
    ds_read_b128 v[20:23], v5 offset:34304
    v_cvt_pk_bf16_f32 v80, v32, v33
    v_cvt_pk_bf16_f32 v81, v36, v37
    s_waitcnt lgkmcnt(4)
    v_mfma_f32_32x32x16_bf16 v[48:63], a[28:31], v[28:31], v[48:63]
    ds_read_b128 v[24:27], v5 offset:34816
    v_cvt_pk_bf16_f32 v82, v34, v35
    v_cvt_pk_bf16_f32 v83, v38, v39
    s_waitcnt lgkmcnt(4)
    v_mfma_f32_32x32x16_bf16 v[48:63], a[32:35], v[8:11], v[48:63]
    ds_read_b128 v[28:31], v5 offset:35328
    v_cvt_pk_bf16_f32 v88, v40, v41
    v_cvt_pk_bf16_f32 v89, v44, v45
    s_waitcnt lgkmcnt(4)
    v_mfma_f32_32x32x16_bf16 v[48:63], a[36:39], v[12:15], v[48:63]
    ds_read_b128 v[8:11], v5 offset:35840
    s_add_u32 m0, s44, 30720
    s_add_u32 s21, s43, 374784
    buffer_load_dwordx4 v1, s[8:11], s21 offen lds
    v_cvt_pk_bf16_f32 v90, v42, v43
    v_cvt_pk_bf16_f32 v91, v46, v47
    s_waitcnt lgkmcnt(4)
    v_mfma_f32_32x32x16_bf16 v[48:63], a[40:43], v[16:19], v[48:63]
    ds_read_b128 v[12:15], v5 offset:36352
    s_add_u32 s23, s49, 24576
    buffer_store_dwordx4 v[80:83], v3, s[8:11], s23 offen sc1
    s_waitcnt lgkmcnt(4)
    v_mfma_f32_32x32x16_bf16 v[48:63], a[44:47], v[20:23], v[48:63]
    ds_read_b128 v[16:19], v5 offset:36864
    s_add_u32 s23, s49, 25088
    buffer_store_dwordx4 v[88:91], v3, s[8:11], s23 offen sc1
    s_waitcnt lgkmcnt(4)
    v_mfma_f32_32x32x16_bf16 v[48:63], a[48:51], v[24:27], v[48:63]
    ds_read_b128 v[20:23], v5 offset:37376
    s_waitcnt lgkmcnt(4)
    v_mfma_f32_32x32x16_bf16 v[48:63], a[52:55], v[28:31], v[48:63]
    ds_read_b128 v[24:27], v5 offset:37888
    s_add_u32 m0, s44, 31744
    s_add_u32 s21, s43, 375808
    buffer_load_dwordx4 v1, s[8:11], s21 offen lds
    s_waitcnt lgkmcnt(4)
    v_mfma_f32_32x32x16_bf16 v[48:63], a[56:59], v[8:11], v[48:63]
    ds_read_b128 v[28:31], v5 offset:38400
    s_waitcnt lgkmcnt(4)
    v_mfma_f32_32x32x16_bf16 v[48:63], a[60:63], v[12:15], v[48:63]
    ds_read_b128 v[8:11], v5 offset:38912
    s_waitcnt lgkmcnt(4)
    v_mfma_f32_32x32x16_bf16 v[48:63], a[64:67], v[16:19], v[48:63]
    ds_read_b128 v[12:15], v5 offset:39424
    s_waitcnt lgkmcnt(4)
    v_mfma_f32_32x32x16_bf16 v[48:63], a[68:71], v[20:23], v[48:63]
    ds_read_b128 v[16:19], v5 offset:39936
    s_add_u32 m0, s44, 32768
    s_add_u32 s21, s43, 376832
    buffer_load_dwordx4 v1, s[8:11], s21 offen lds
    s_waitcnt lgkmcnt(4)
    v_mfma_f32_32x32x16_bf16 v[48:63], a[72:75], v[24:27], v[48:63]
    ds_read_b128 v[20:23], v5 offset:40448
    s_waitcnt lgkmcnt(4)
    v_mfma_f32_32x32x16_bf16 v[48:63], a[76:79], v[28:31], v[48:63]
    ds_read_b128 v[24:27], v5 offset:40960
    s_waitcnt lgkmcnt(4)
    v_mfma_f32_32x32x16_bf16 v[48:63], a[80:83], v[8:11], v[48:63]
    ds_read_b128 v[28:31], v5 offset:41472
    s_waitcnt lgkmcnt(4)
    v_mfma_f32_32x32x16_bf16 v[48:63], a[84:87], v[12:15], v[48:63]
    ds_read_b128 v[8:11], v5 offset:41984
    s_add_u32 m0, s44, 33792
    s_add_u32 s21, s43, 377856
    buffer_load_dwordx4 v1, s[8:11], s21 offen lds
    s_waitcnt lgkmcnt(4)
    v_mfma_f32_32x32x16_bf16 v[48:63], a[88:91], v[16:19], v[48:63]
    ds_read_b128 v[12:15], v5 offset:42496
    s_waitcnt lgkmcnt(4)
    v_mfma_f32_32x32x16_bf16 v[48:63], a[92:95], v[20:23], v[48:63]
    s_nop 0
    s_waitcnt lgkmcnt(4)
    v_mfma_f32_32x32x16_bf16 v[48:63], a[96:99], v[24:27], v[48:63]
    s_nop 0
    s_waitcnt lgkmcnt(4)
    v_mfma_f32_32x32x16_bf16 v[48:63], a[100:103], v[28:31], v[48:63]
    s_nop 0
    s_add_u32 m0, s44, 34816
    s_add_u32 s21, s43, 378880
    buffer_load_dwordx4 v1, s[8:11], s21 offen lds
    s_waitcnt lgkmcnt(4)
    v_mfma_f32_32x32x16_bf16 v[48:63], a[104:107], v[8:11], v[48:63]
    s_nop 0
    s_waitcnt lgkmcnt(4)
    v_mfma_f32_32x32x16_bf16 v[48:63], a[108:111], v[12:15], v[48:63]
    s_nop 0
    s_nop 10
    v_cvt_pk_bf16_f32 v80, v48, v49
    v_cvt_pk_bf16_f32 v81, v52, v53
    v_cvt_pk_bf16_f32 v82, v50, v51
    v_cvt_pk_bf16_f32 v83, v54, v55
    v_cvt_pk_bf16_f32 v88, v56, v57
    v_cvt_pk_bf16_f32 v89, v60, v61
    v_cvt_pk_bf16_f32 v90, v58, v59
    v_cvt_pk_bf16_f32 v91, v62, v63
    s_add_u32 s23, s49, 26624
    buffer_store_dwordx4 v[80:83], v3, s[8:11], s23 offen sc1
    s_add_u32 s23, s49, 27136
    buffer_store_dwordx4 v[88:91], v3, s[8:11], s23 offen sc1
    s_waitcnt vmcnt(0)
    s_barrier
    s_cmp_lg_u32 s14, 0
    s_cbranch_scc1 wkvq_sg
    s_lshl_b32 s24, s40, 7
    s_add_u32 s24, s24, 20447232
    s_mov_b64 exec, 1
    v_mov_b32 v251, 1
    buffer_atomic_add v251, off, s[8:11], s24
    s_mov_b64 exec, -1
wkvq_sg:
    s_branch wkv_next
wkv_done:
    s_mov_b32 s30, 20460032
    s_cmp_lg_u32 s14, 0
    s_cbranch_scc1 trc_cw
    s_mov_b64 exec, 1
    v_mov_b32 v251, 1
    buffer_atomic_add v251, off, s[8:11], s30 sc0
    v_mov_b32 v250, 143360
    s_waitcnt vmcnt(0)
    ds_write_b32 v250, v251
    s_waitcnt lgkmcnt(0)
    s_mov_b64 exec, -1
trc_cw:
    s_barrier
    v_mov_b32 v250, 143360
    ds_read_b32 v251, v250
    s_waitcnt lgkmcnt(0)
    v_readfirstlane_b32 s32, v251
    s_barrier
    s_nop 3
    s_lshl_b32 s33, s32, 2
    s_add_u32 s33, s33, s14
    s_load_dwordx2 s[24:25], s[0:1], 64
    s_waitcnt lgkmcnt(0)
    s_mov_b32 s56, s24
    s_and_b32 s57, s25, 0xffff
    s_mov_b32 s58, 1605632
    s_mov_b32 s59, 0x20000
    s_lshl_b32 s34, s33, 1
    v_lshrrev_b32 v2, 2, v0
    v_mul_u32_u24 v2, 3584, v2
    v_and_b32 v3, 3, v0
    v_lshl_add_u32 v2, v3, 4, v2
    v_bfe_u32 v4, v0, 2, 2
    v_and_b32 v5, 1, v4
    v_lshrrev_b32 v4, 1, v4
    v_lshl_add_u32 v5, v4, 3, v5
    v_bfe_u32 v6, v0, 4, 1
    v_lshl_add_u32 v5, v6, 2, v5
    v_lshlrev_b32 v5, 6, v5
    v_lshrrev_b32 v7, 5, v0
    v_lshl_add_u32 v5, v7, 5, v5
    v_lshl_add_u32 v5, v3, 3, v5
    s_lshl_b32 s44, s14, 10
    v_add_u32 v5, s44, v5
    v_mul_u32_u24 v8, 14336, v7
    v_lshl_add_u32 v8, v6, 8, v8
    v_and_b32 v9, 15, v0
    v_lshl_add_u32 v8, v9, 4, v8
    s_mov_b32 s46, s34
    s_add_u32 s47, s46, 2
    s_min_u32 s47, s47, 1568
chw_t1_u:
    s_cmp_ge_u32 s46, s47
    s_cbranch_scc1 chw_t1_ud
    s_mul_hi_u32 s48, s46, 153391690
    s_mul_i32 s49, s48, 28
    s_sub_u32 s49, s46, s49
    s_mul_i32 s20, s49, 57344
    s_lshl_b32 s21, s48, 6
    s_add_u32 s20, s20, s21
    s_mov_b32 m0, s44
    s_nop 0
    buffer_load_dwordx4 v2, s[56:59], s20 offen lds
    s_mul_i32 s21, s48, 28672
    s_lshl_b32 s22, s49, 9
    s_add_u32 s21, s21, s22
    s_add_u32 s21, s21, 106954752
    s_waitcnt vmcnt(0)
    ds_read_b64_tr_b16 v[12:13], v5
    ds_read_b64_tr_b16 v[14:15], v5 offset:128
    s_waitcnt lgkmcnt(0)
    buffer_store_dwordx4 v[12:15], v8, s[8:11], s21 offen sc1
    s_add_u32 s46, s46, 1
    s_branch chw_t1_u
chw_t1_ud:
    s_load_dwordx2 s[24:25], s[0:1], 88
    s_waitcnt lgkmcnt(0)
    s_mov_b32 s56, s24
    s_and_b32 s57, s25, 0xffff
    s_mov_b32 s58, 802816
    s_mov_b32 s59, 0x20000
    v_lshrrev_b32 v2, 2, v0
    v_mul_u32_u24 v2, 896, v2
    v_and_b32 v3, 3, v0
    v_lshl_add_u32 v2, v3, 4, v2
    v_bfe_u32 v4, v0, 2, 2
    v_and_b32 v5, 1, v4
    v_lshrrev_b32 v4, 1, v4
    v_lshl_add_u32 v5, v4, 3, v5
    v_bfe_u32 v6, v0, 4, 1
    v_lshl_add_u32 v5, v6, 2, v5
    v_lshlrev_b32 v5, 6, v5
    v_lshrrev_b32 v7, 5, v0
    v_lshl_add_u32 v5, v7, 5, v5
    v_lshl_add_u32 v5, v3, 3, v5
    s_lshl_b32 s44, s14, 10
    v_add_u32 v5, s44, v5
    v_mul_u32_u24 v8, 28672, v7
    v_lshl_add_u32 v8, v6, 8, v8
    v_and_b32 v9, 15, v0
    v_lshl_add_u32 v8, v9, 4, v8
    s_mov_b32 s46, s33
    s_add_u32 s47, s46, 1
    s_min_u32 s47, s47, 784
chw_t2_u:
    s_cmp_ge_u32 s46, s47
    s_cbranch_scc1 chw_t2_ud
    s_mul_hi_u32 s48, s46, 76695845
    s_mul_i32 s49, s48, 56
    s_sub_u32 s49, s46, s49
    s_mul_i32 s20, s49, 14336
    s_lshl_b32 s21, s48, 6
    s_add_u32 s20, s20, s21
    s_mov_b32 m0, s44
    s_nop 0
    buffer_load_dwordx4 v2, s[56:59], s20 offen lds
    s_mul_i32 s21, s48, 57344
    s_lshl_b32 s22, s49, 9
    s_add_u32 s21, s21, s22
    s_add_u32 s21, s21, 109051904
    s_waitcnt vmcnt(0)
    ds_read_b64_tr_b16 v[12:13], v5
    ds_read_b64_tr_b16 v[14:15], v5 offset:128
    s_waitcnt lgkmcnt(0)
    buffer_store_dwordx4 v[12:15], v8, s[8:11], s21 offen sc1
    s_add_u32 s46, s46, 1
    s_branch chw_t2_u
chw_t2_ud:
    s_cmp_ge_u32 s32, 14
    s_cbranch_scc1 chw_ncs
    s_barrier
    s_load_dwordx2 s[24:25], s[0:1], 64
    s_waitcnt lgkmcnt(0)
    s_mov_b32 s56, s24
    s_and_b32 s57, s25, 0xffff
    s_mov_b32 s58, 1605632
    s_mov_b32 s59, 0x20000
    s_mov_b32 s40, s32
    v_lshlrev_b32 v2, 2, v0
    s_lshl_b32 s20, s40, 8
    s_mul_i32 s21, s14, 401408
    s_add_u32 s20, s20, s21
    v_mov_b32 v8, 0
    v_mov_b32 v9, 0
    buffer_load_dword v16, v2, s[56:59], s20 offen
    s_add_u32 s20, s20, 3584
    buffer_load_dword v17, v2, s[56:59], s20 offen
    s_add_u32 s20, s20, 3584
    buffer_load_dword v18, v2, s[56:59], s20 offen
    s_add_u32 s20, s20, 3584
    buffer_load_dword v19, v2, s[56:59], s20 offen
    s_add_u32 s20, s20, 3584
    buffer_load_dword v20, v2, s[56:59], s20 offen
    s_add_u32 s20, s20, 3584
    buffer_load_dword v21, v2, s[56:59], s20 offen
    s_add_u32 s20, s20, 3584
    buffer_load_dword v22, v2, s[56:59], s20 offen
    s_add_u32 s20, s20, 3584
    buffer_load_dword v23, v2, s[56:59], s20 offen
    s_add_u32 s20, s20, 3584
    buffer_load_dword v24, v2, s[56:59], s20 offen
    s_add_u32 s20, s20, 3584
    buffer_load_dword v25, v2, s[56:59], s20 offen
    s_add_u32 s20, s20, 3584
    buffer_load_dword v26, v2, s[56:59], s20 offen
    s_add_u32 s20, s20, 3584
    buffer_load_dword v27, v2, s[56:59], s20 offen
    s_add_u32 s20, s20, 3584
    buffer_load_dword v28, v2, s[56:59], s20 offen
    s_add_u32 s20, s20, 3584
    buffer_load_dword v29, v2, s[56:59], s20 offen
    s_add_u32 s20, s20, 3584
    buffer_load_dword v30, v2, s[56:59], s20 offen
    s_add_u32 s20, s20, 3584
    buffer_load_dword v31, v2, s[56:59], s20 offen
    s_add_u32 s20, s20, 3584
    buffer_load_dword v32, v2, s[56:59], s20 offen
    s_add_u32 s20, s20, 3584
    buffer_load_dword v33, v2, s[56:59], s20 offen
    s_add_u32 s20, s20, 3584
    buffer_load_dword v34, v2, s[56:59], s20 offen
    s_add_u32 s20, s20, 3584
    buffer_load_dword v35, v2, s[56:59], s20 offen
    s_add_u32 s20, s20, 3584
    buffer_load_dword v36, v2, s[56:59], s20 offen
    s_add_u32 s20, s20, 3584
    buffer_load_dword v37, v2, s[56:59], s20 offen
    s_add_u32 s20, s20, 3584
    buffer_load_dword v38, v2, s[56:59], s20 offen
    s_add_u32 s20, s20, 3584
    buffer_load_dword v39, v2, s[56:59], s20 offen
    s_add_u32 s20, s20, 3584
    buffer_load_dword v40, v2, s[56:59], s20 offen
    s_add_u32 s20, s20, 3584
    buffer_load_dword v41, v2, s[56:59], s20 offen
    s_add_u32 s20, s20, 3584
    buffer_load_dword v42, v2, s[56:59], s20 offen
    s_add_u32 s20, s20, 3584
    buffer_load_dword v43, v2, s[56:59], s20 offen
    s_add_u32 s20, s20, 3584
    buffer_load_dword v44, v2, s[56:59], s20 offen
    s_add_u32 s20, s20, 3584
    buffer_load_dword v45, v2, s[56:59], s20 offen
    s_add_u32 s20, s20, 3584
    buffer_load_dword v46, v2, s[56:59], s20 offen
    s_add_u32 s20, s20, 3584
    buffer_load_dword v47, v2, s[56:59], s20 offen
    s_add_u32 s20, s20, 3584
    buffer_load_dword v48, v2, s[56:59], s20 offen
    s_add_u32 s20, s20, 3584
    buffer_load_dword v49, v2, s[56:59], s20 offen
    s_add_u32 s20, s20, 3584
    buffer_load_dword v50, v2, s[56:59], s20 offen
    s_add_u32 s20, s20, 3584
    buffer_load_dword v51, v2, s[56:59], s20 offen
    s_add_u32 s20, s20, 3584
    buffer_load_dword v52, v2, s[56:59], s20 offen
    s_add_u32 s20, s20, 3584
    buffer_load_dword v53, v2, s[56:59], s20 offen
    s_add_u32 s20, s20, 3584
    buffer_load_dword v54, v2, s[56:59], s20 offen
    s_add_u32 s20, s20, 3584
    buffer_load_dword v55, v2, s[56:59], s20 offen
    s_add_u32 s20, s20, 3584
    buffer_load_dword v56, v2, s[56:59], s20 offen
    s_add_u32 s20, s20, 3584
    buffer_load_dword v57, v2, s[56:59], s20 offen
    s_add_u32 s20, s20, 3584
    buffer_load_dword v58, v2, s[56:59], s20 offen
    s_add_u32 s20, s20, 3584
    buffer_load_dword v59, v2, s[56:59], s20 offen
    s_add_u32 s20, s20, 3584
    buffer_load_dword v60, v2, s[56:59], s20 offen
    s_add_u32 s20, s20, 3584
    buffer_load_dword v61, v2, s[56:59], s20 offen
    s_add_u32 s20, s20, 3584
    buffer_load_dword v62, v2, s[56:59], s20 offen
    s_add_u32 s20, s20, 3584
    buffer_load_dword v63, v2, s[56:59], s20 offen
    s_add_u32 s20, s20, 3584
    buffer_load_dword v64, v2, s[56:59], s20 offen
    s_add_u32 s20, s20, 3584
    buffer_load_dword v65, v2, s[56:59], s20 offen
    s_add_u32 s20, s20, 3584
    buffer_load_dword v66, v2, s[56:59], s20 offen
    s_add_u32 s20, s20, 3584
    buffer_load_dword v67, v2, s[56:59], s20 offen
    s_add_u32 s20, s20, 3584
    buffer_load_dword v68, v2, s[56:59], s20 offen
    s_add_u32 s20, s20, 3584
    buffer_load_dword v69, v2, s[56:59], s20 offen
    s_add_u32 s20, s20, 3584
    buffer_load_dword v70, v2, s[56:59], s20 offen
    s_add_u32 s20, s20, 3584
    buffer_load_dword v71, v2, s[56:59], s20 offen
    s_add_u32 s20, s20, 3584
    s_waitcnt vmcnt(0)
    v_lshlrev_b32 v10, 16, v16
    v_and_b32 v11, 0xffff0000, v16
    v_add_f32 v8, v8, v10
    v_add_f32 v9, v9, v11
    v_lshlrev_b32 v10, 16, v17
    v_and_b32 v11, 0xffff0000, v17
    v_add_f32 v8, v8, v10
    v_add_f32 v9, v9, v11
    v_lshlrev_b32 v10, 16, v18
    v_and_b32 v11, 0xffff0000, v18
    v_add_f32 v8, v8, v10
    v_add_f32 v9, v9, v11
    v_lshlrev_b32 v10, 16, v19
    v_and_b32 v11, 0xffff0000, v19
    v_add_f32 v8, v8, v10
    v_add_f32 v9, v9, v11
    v_lshlrev_b32 v10, 16, v20
    v_and_b32 v11, 0xffff0000, v20
    v_add_f32 v8, v8, v10
    v_add_f32 v9, v9, v11
    v_lshlrev_b32 v10, 16, v21
    v_and_b32 v11, 0xffff0000, v21
    v_add_f32 v8, v8, v10
    v_add_f32 v9, v9, v11
    v_lshlrev_b32 v10, 16, v22
    v_and_b32 v11, 0xffff0000, v22
    v_add_f32 v8, v8, v10
    v_add_f32 v9, v9, v11
    v_lshlrev_b32 v10, 16, v23
    v_and_b32 v11, 0xffff0000, v23
    v_add_f32 v8, v8, v10
    v_add_f32 v9, v9, v11
    v_lshlrev_b32 v10, 16, v24
    v_and_b32 v11, 0xffff0000, v24
    v_add_f32 v8, v8, v10
    v_add_f32 v9, v9, v11
    v_lshlrev_b32 v10, 16, v25
    v_and_b32 v11, 0xffff0000, v25
    v_add_f32 v8, v8, v10
    v_add_f32 v9, v9, v11
    v_lshlrev_b32 v10, 16, v26
    v_and_b32 v11, 0xffff0000, v26
    v_add_f32 v8, v8, v10
    v_add_f32 v9, v9, v11
    v_lshlrev_b32 v10, 16, v27
    v_and_b32 v11, 0xffff0000, v27
    v_add_f32 v8, v8, v10
    v_add_f32 v9, v9, v11
    v_lshlrev_b32 v10, 16, v28
    v_and_b32 v11, 0xffff0000, v28
    v_add_f32 v8, v8, v10
    v_add_f32 v9, v9, v11
    v_lshlrev_b32 v10, 16, v29
    v_and_b32 v11, 0xffff0000, v29
    v_add_f32 v8, v8, v10
    v_add_f32 v9, v9, v11
    v_lshlrev_b32 v10, 16, v30
    v_and_b32 v11, 0xffff0000, v30
    v_add_f32 v8, v8, v10
    v_add_f32 v9, v9, v11
    v_lshlrev_b32 v10, 16, v31
    v_and_b32 v11, 0xffff0000, v31
    v_add_f32 v8, v8, v10
    v_add_f32 v9, v9, v11
    v_lshlrev_b32 v10, 16, v32
    v_and_b32 v11, 0xffff0000, v32
    v_add_f32 v8, v8, v10
    v_add_f32 v9, v9, v11
    v_lshlrev_b32 v10, 16, v33
    v_and_b32 v11, 0xffff0000, v33
    v_add_f32 v8, v8, v10
    v_add_f32 v9, v9, v11
    v_lshlrev_b32 v10, 16, v34
    v_and_b32 v11, 0xffff0000, v34
    v_add_f32 v8, v8, v10
    v_add_f32 v9, v9, v11
    v_lshlrev_b32 v10, 16, v35
    v_and_b32 v11, 0xffff0000, v35
    v_add_f32 v8, v8, v10
    v_add_f32 v9, v9, v11
    v_lshlrev_b32 v10, 16, v36
    v_and_b32 v11, 0xffff0000, v36
    v_add_f32 v8, v8, v10
    v_add_f32 v9, v9, v11
    v_lshlrev_b32 v10, 16, v37
    v_and_b32 v11, 0xffff0000, v37
    v_add_f32 v8, v8, v10
    v_add_f32 v9, v9, v11
    v_lshlrev_b32 v10, 16, v38
    v_and_b32 v11, 0xffff0000, v38
    v_add_f32 v8, v8, v10
    v_add_f32 v9, v9, v11
    v_lshlrev_b32 v10, 16, v39
    v_and_b32 v11, 0xffff0000, v39
    v_add_f32 v8, v8, v10
    v_add_f32 v9, v9, v11
    v_lshlrev_b32 v10, 16, v40
    v_and_b32 v11, 0xffff0000, v40
    v_add_f32 v8, v8, v10
    v_add_f32 v9, v9, v11
    v_lshlrev_b32 v10, 16, v41
    v_and_b32 v11, 0xffff0000, v41
    v_add_f32 v8, v8, v10
    v_add_f32 v9, v9, v11
    v_lshlrev_b32 v10, 16, v42
    v_and_b32 v11, 0xffff0000, v42
    v_add_f32 v8, v8, v10
    v_add_f32 v9, v9, v11
    v_lshlrev_b32 v10, 16, v43
    v_and_b32 v11, 0xffff0000, v43
    v_add_f32 v8, v8, v10
    v_add_f32 v9, v9, v11
    v_lshlrev_b32 v10, 16, v44
    v_and_b32 v11, 0xffff0000, v44
    v_add_f32 v8, v8, v10
    v_add_f32 v9, v9, v11
    v_lshlrev_b32 v10, 16, v45
    v_and_b32 v11, 0xffff0000, v45
    v_add_f32 v8, v8, v10
    v_add_f32 v9, v9, v11
    v_lshlrev_b32 v10, 16, v46
    v_and_b32 v11, 0xffff0000, v46
    v_add_f32 v8, v8, v10
    v_add_f32 v9, v9, v11
    v_lshlrev_b32 v10, 16, v47
    v_and_b32 v11, 0xffff0000, v47
    v_add_f32 v8, v8, v10
    v_add_f32 v9, v9, v11
    v_lshlrev_b32 v10, 16, v48
    v_and_b32 v11, 0xffff0000, v48
    v_add_f32 v8, v8, v10
    v_add_f32 v9, v9, v11
    v_lshlrev_b32 v10, 16, v49
    v_and_b32 v11, 0xffff0000, v49
    v_add_f32 v8, v8, v10
    v_add_f32 v9, v9, v11
    v_lshlrev_b32 v10, 16, v50
    v_and_b32 v11, 0xffff0000, v50
    v_add_f32 v8, v8, v10
    v_add_f32 v9, v9, v11
    v_lshlrev_b32 v10, 16, v51
    v_and_b32 v11, 0xffff0000, v51
    v_add_f32 v8, v8, v10
    v_add_f32 v9, v9, v11
    v_lshlrev_b32 v10, 16, v52
    v_and_b32 v11, 0xffff0000, v52
    v_add_f32 v8, v8, v10
    v_add_f32 v9, v9, v11
    v_lshlrev_b32 v10, 16, v53
    v_and_b32 v11, 0xffff0000, v53
    v_add_f32 v8, v8, v10
    v_add_f32 v9, v9, v11
    v_lshlrev_b32 v10, 16, v54
    v_and_b32 v11, 0xffff0000, v54
    v_add_f32 v8, v8, v10
    v_add_f32 v9, v9, v11
    v_lshlrev_b32 v10, 16, v55
    v_and_b32 v11, 0xffff0000, v55
    v_add_f32 v8, v8, v10
    v_add_f32 v9, v9, v11
    v_lshlrev_b32 v10, 16, v56
    v_and_b32 v11, 0xffff0000, v56
    v_add_f32 v8, v8, v10
    v_add_f32 v9, v9, v11
    v_lshlrev_b32 v10, 16, v57
    v_and_b32 v11, 0xffff0000, v57
    v_add_f32 v8, v8, v10
    v_add_f32 v9, v9, v11
    v_lshlrev_b32 v10, 16, v58
    v_and_b32 v11, 0xffff0000, v58
    v_add_f32 v8, v8, v10
    v_add_f32 v9, v9, v11
    v_lshlrev_b32 v10, 16, v59
    v_and_b32 v11, 0xffff0000, v59
    v_add_f32 v8, v8, v10
    v_add_f32 v9, v9, v11
    v_lshlrev_b32 v10, 16, v60
    v_and_b32 v11, 0xffff0000, v60
    v_add_f32 v8, v8, v10
    v_add_f32 v9, v9, v11
    v_lshlrev_b32 v10, 16, v61
    v_and_b32 v11, 0xffff0000, v61
    v_add_f32 v8, v8, v10
    v_add_f32 v9, v9, v11
    v_lshlrev_b32 v10, 16, v62
    v_and_b32 v11, 0xffff0000, v62
    v_add_f32 v8, v8, v10
    v_add_f32 v9, v9, v11
    v_lshlrev_b32 v10, 16, v63
    v_and_b32 v11, 0xffff0000, v63
    v_add_f32 v8, v8, v10
    v_add_f32 v9, v9, v11
    v_lshlrev_b32 v10, 16, v64
    v_and_b32 v11, 0xffff0000, v64
    v_add_f32 v8, v8, v10
    v_add_f32 v9, v9, v11
    v_lshlrev_b32 v10, 16, v65
    v_and_b32 v11, 0xffff0000, v65
    v_add_f32 v8, v8, v10
    v_add_f32 v9, v9, v11
    v_lshlrev_b32 v10, 16, v66
    v_and_b32 v11, 0xffff0000, v66
    v_add_f32 v8, v8, v10
    v_add_f32 v9, v9, v11
    v_lshlrev_b32 v10, 16, v67
    v_and_b32 v11, 0xffff0000, v67
    v_add_f32 v8, v8, v10
    v_add_f32 v9, v9, v11
    v_lshlrev_b32 v10, 16, v68
    v_and_b32 v11, 0xffff0000, v68
    v_add_f32 v8, v8, v10
    v_add_f32 v9, v9, v11
    v_lshlrev_b32 v10, 16, v69
    v_and_b32 v11, 0xffff0000, v69
    v_add_f32 v8, v8, v10
    v_add_f32 v9, v9, v11
    v_lshlrev_b32 v10, 16, v70
    v_and_b32 v11, 0xffff0000, v70
    v_add_f32 v8, v8, v10
    v_add_f32 v9, v9, v11
    v_lshlrev_b32 v10, 16, v71
    v_and_b32 v11, 0xffff0000, v71
    v_add_f32 v8, v8, v10
    v_add_f32 v9, v9, v11
    buffer_load_dword v16, v2, s[56:59], s20 offen
    s_add_u32 s20, s20, 3584
    buffer_load_dword v17, v2, s[56:59], s20 offen
    s_add_u32 s20, s20, 3584
    buffer_load_dword v18, v2, s[56:59], s20 offen
    s_add_u32 s20, s20, 3584
    buffer_load_dword v19, v2, s[56:59], s20 offen
    s_add_u32 s20, s20, 3584
    buffer_load_dword v20, v2, s[56:59], s20 offen
    s_add_u32 s20, s20, 3584
    buffer_load_dword v21, v2, s[56:59], s20 offen
    s_add_u32 s20, s20, 3584
    buffer_load_dword v22, v2, s[56:59], s20 offen
    s_add_u32 s20, s20, 3584
    buffer_load_dword v23, v2, s[56:59], s20 offen
    s_add_u32 s20, s20, 3584
    buffer_load_dword v24, v2, s[56:59], s20 offen
    s_add_u32 s20, s20, 3584
    buffer_load_dword v25, v2, s[56:59], s20 offen
    s_add_u32 s20, s20, 3584
    buffer_load_dword v26, v2, s[56:59], s20 offen
    s_add_u32 s20, s20, 3584
    buffer_load_dword v27, v2, s[56:59], s20 offen
    s_add_u32 s20, s20, 3584
    buffer_load_dword v28, v2, s[56:59], s20 offen
    s_add_u32 s20, s20, 3584
    buffer_load_dword v29, v2, s[56:59], s20 offen
    s_add_u32 s20, s20, 3584
    buffer_load_dword v30, v2, s[56:59], s20 offen
    s_add_u32 s20, s20, 3584
    buffer_load_dword v31, v2, s[56:59], s20 offen
    s_add_u32 s20, s20, 3584
    buffer_load_dword v32, v2, s[56:59], s20 offen
    s_add_u32 s20, s20, 3584
    buffer_load_dword v33, v2, s[56:59], s20 offen
    s_add_u32 s20, s20, 3584
    buffer_load_dword v34, v2, s[56:59], s20 offen
    s_add_u32 s20, s20, 3584
    buffer_load_dword v35, v2, s[56:59], s20 offen
    s_add_u32 s20, s20, 3584
    buffer_load_dword v36, v2, s[56:59], s20 offen
    s_add_u32 s20, s20, 3584
    buffer_load_dword v37, v2, s[56:59], s20 offen
    s_add_u32 s20, s20, 3584
    buffer_load_dword v38, v2, s[56:59], s20 offen
    s_add_u32 s20, s20, 3584
    buffer_load_dword v39, v2, s[56:59], s20 offen
    s_add_u32 s20, s20, 3584
    buffer_load_dword v40, v2, s[56:59], s20 offen
    s_add_u32 s20, s20, 3584
    buffer_load_dword v41, v2, s[56:59], s20 offen
    s_add_u32 s20, s20, 3584
    buffer_load_dword v42, v2, s[56:59], s20 offen
    s_add_u32 s20, s20, 3584
    buffer_load_dword v43, v2, s[56:59], s20 offen
    s_add_u32 s20, s20, 3584
    buffer_load_dword v44, v2, s[56:59], s20 offen
    s_add_u32 s20, s20, 3584
    buffer_load_dword v45, v2, s[56:59], s20 offen
    s_add_u32 s20, s20, 3584
    buffer_load_dword v46, v2, s[56:59], s20 offen
    s_add_u32 s20, s20, 3584
    buffer_load_dword v47, v2, s[56:59], s20 offen
    s_add_u32 s20, s20, 3584
    buffer_load_dword v48, v2, s[56:59], s20 offen
    s_add_u32 s20, s20, 3584
    buffer_load_dword v49, v2, s[56:59], s20 offen
    s_add_u32 s20, s20, 3584
    buffer_load_dword v50, v2, s[56:59], s20 offen
    s_add_u32 s20, s20, 3584
    buffer_load_dword v51, v2, s[56:59], s20 offen
    s_add_u32 s20, s20, 3584
    buffer_load_dword v52, v2, s[56:59], s20 offen
    s_add_u32 s20, s20, 3584
    buffer_load_dword v53, v2, s[56:59], s20 offen
    s_add_u32 s20, s20, 3584
    buffer_load_dword v54, v2, s[56:59], s20 offen
    s_add_u32 s20, s20, 3584
    buffer_load_dword v55, v2, s[56:59], s20 offen
    s_add_u32 s20, s20, 3584
    buffer_load_dword v56, v2, s[56:59], s20 offen
    s_add_u32 s20, s20, 3584
    buffer_load_dword v57, v2, s[56:59], s20 offen
    s_add_u32 s20, s20, 3584
    buffer_load_dword v58, v2, s[56:59], s20 offen
    s_add_u32 s20, s20, 3584
    buffer_load_dword v59, v2, s[56:59], s20 offen
    s_add_u32 s20, s20, 3584
    buffer_load_dword v60, v2, s[56:59], s20 offen
    s_add_u32 s20, s20, 3584
    buffer_load_dword v61, v2, s[56:59], s20 offen
    s_add_u32 s20, s20, 3584
    buffer_load_dword v62, v2, s[56:59], s20 offen
    s_add_u32 s20, s20, 3584
    buffer_load_dword v63, v2, s[56:59], s20 offen
    s_add_u32 s20, s20, 3584
    buffer_load_dword v64, v2, s[56:59], s20 offen
    s_add_u32 s20, s20, 3584
    buffer_load_dword v65, v2, s[56:59], s20 offen
    s_add_u32 s20, s20, 3584
    buffer_load_dword v66, v2, s[56:59], s20 offen
    s_add_u32 s20, s20, 3584
    buffer_load_dword v67, v2, s[56:59], s20 offen
    s_add_u32 s20, s20, 3584
    buffer_load_dword v68, v2, s[56:59], s20 offen
    s_add_u32 s20, s20, 3584
    buffer_load_dword v69, v2, s[56:59], s20 offen
    s_add_u32 s20, s20, 3584
    buffer_load_dword v70, v2, s[56:59], s20 offen
    s_add_u32 s20, s20, 3584
    buffer_load_dword v71, v2, s[56:59], s20 offen
    s_add_u32 s20, s20, 3584
    s_waitcnt vmcnt(0)
    v_lshlrev_b32 v10, 16, v16
    v_and_b32 v11, 0xffff0000, v16
    v_add_f32 v8, v8, v10
    v_add_f32 v9, v9, v11
    v_lshlrev_b32 v10, 16, v17
    v_and_b32 v11, 0xffff0000, v17
    v_add_f32 v8, v8, v10
    v_add_f32 v9, v9, v11
    v_lshlrev_b32 v10, 16, v18
    v_and_b32 v11, 0xffff0000, v18
    v_add_f32 v8, v8, v10
    v_add_f32 v9, v9, v11
    v_lshlrev_b32 v10, 16, v19
    v_and_b32 v11, 0xffff0000, v19
    v_add_f32 v8, v8, v10
    v_add_f32 v9, v9, v11
    v_lshlrev_b32 v10, 16, v20
    v_and_b32 v11, 0xffff0000, v20
    v_add_f32 v8, v8, v10
    v_add_f32 v9, v9, v11
    v_lshlrev_b32 v10, 16, v21
    v_and_b32 v11, 0xffff0000, v21
    v_add_f32 v8, v8, v10
    v_add_f32 v9, v9, v11
    v_lshlrev_b32 v10, 16, v22
    v_and_b32 v11, 0xffff0000, v22
    v_add_f32 v8, v8, v10
    v_add_f32 v9, v9, v11
    v_lshlrev_b32 v10, 16, v23
    v_and_b32 v11, 0xffff0000, v23
    v_add_f32 v8, v8, v10
    v_add_f32 v9, v9, v11
    v_lshlrev_b32 v10, 16, v24
    v_and_b32 v11, 0xffff0000, v24
    v_add_f32 v8, v8, v10
    v_add_f32 v9, v9, v11
    v_lshlrev_b32 v10, 16, v25
    v_and_b32 v11, 0xffff0000, v25
    v_add_f32 v8, v8, v10
    v_add_f32 v9, v9, v11
    v_lshlrev_b32 v10, 16, v26
    v_and_b32 v11, 0xffff0000, v26
    v_add_f32 v8, v8, v10
    v_add_f32 v9, v9, v11
    v_lshlrev_b32 v10, 16, v27
    v_and_b32 v11, 0xffff0000, v27
    v_add_f32 v8, v8, v10
    v_add_f32 v9, v9, v11
    v_lshlrev_b32 v10, 16, v28
    v_and_b32 v11, 0xffff0000, v28
    v_add_f32 v8, v8, v10
    v_add_f32 v9, v9, v11
    v_lshlrev_b32 v10, 16, v29
    v_and_b32 v11, 0xffff0000, v29
    v_add_f32 v8, v8, v10
    v_add_f32 v9, v9, v11
    v_lshlrev_b32 v10, 16, v30
    v_and_b32 v11, 0xffff0000, v30
    v_add_f32 v8, v8, v10
    v_add_f32 v9, v9, v11
    v_lshlrev_b32 v10, 16, v31
    v_and_b32 v11, 0xffff0000, v31
    v_add_f32 v8, v8, v10
    v_add_f32 v9, v9, v11
    v_lshlrev_b32 v10, 16, v32
    v_and_b32 v11, 0xffff0000, v32
    v_add_f32 v8, v8, v10
    v_add_f32 v9, v9, v11
    v_lshlrev_b32 v10, 16, v33
    v_and_b32 v11, 0xffff0000, v33
    v_add_f32 v8, v8, v10
    v_add_f32 v9, v9, v11
    v_lshlrev_b32 v10, 16, v34
    v_and_b32 v11, 0xffff0000, v34
    v_add_f32 v8, v8, v10
    v_add_f32 v9, v9, v11
    v_lshlrev_b32 v10, 16, v35
    v_and_b32 v11, 0xffff0000, v35
    v_add_f32 v8, v8, v10
    v_add_f32 v9, v9, v11
    v_lshlrev_b32 v10, 16, v36
    v_and_b32 v11, 0xffff0000, v36
    v_add_f32 v8, v8, v10
    v_add_f32 v9, v9, v11
    v_lshlrev_b32 v10, 16, v37
    v_and_b32 v11, 0xffff0000, v37
    v_add_f32 v8, v8, v10
    v_add_f32 v9, v9, v11
    v_lshlrev_b32 v10, 16, v38
    v_and_b32 v11, 0xffff0000, v38
    v_add_f32 v8, v8, v10
    v_add_f32 v9, v9, v11
    v_lshlrev_b32 v10, 16, v39
    v_and_b32 v11, 0xffff0000, v39
    v_add_f32 v8, v8, v10
    v_add_f32 v9, v9, v11
    v_lshlrev_b32 v10, 16, v40
    v_and_b32 v11, 0xffff0000, v40
    v_add_f32 v8, v8, v10
    v_add_f32 v9, v9, v11
    v_lshlrev_b32 v10, 16, v41
    v_and_b32 v11, 0xffff0000, v41
    v_add_f32 v8, v8, v10
    v_add_f32 v9, v9, v11
    v_lshlrev_b32 v10, 16, v42
    v_and_b32 v11, 0xffff0000, v42
    v_add_f32 v8, v8, v10
    v_add_f32 v9, v9, v11
    v_lshlrev_b32 v10, 16, v43
    v_and_b32 v11, 0xffff0000, v43
    v_add_f32 v8, v8, v10
    v_add_f32 v9, v9, v11
    v_lshlrev_b32 v10, 16, v44
    v_and_b32 v11, 0xffff0000, v44
    v_add_f32 v8, v8, v10
    v_add_f32 v9, v9, v11
    v_lshlrev_b32 v10, 16, v45
    v_and_b32 v11, 0xffff0000, v45
    v_add_f32 v8, v8, v10
    v_add_f32 v9, v9, v11
    v_lshlrev_b32 v10, 16, v46
    v_and_b32 v11, 0xffff0000, v46
    v_add_f32 v8, v8, v10
    v_add_f32 v9, v9, v11
    v_lshlrev_b32 v10, 16, v47
    v_and_b32 v11, 0xffff0000, v47
    v_add_f32 v8, v8, v10
    v_add_f32 v9, v9, v11
    v_lshlrev_b32 v10, 16, v48
    v_and_b32 v11, 0xffff0000, v48
    v_add_f32 v8, v8, v10
    v_add_f32 v9, v9, v11
    v_lshlrev_b32 v10, 16, v49
    v_and_b32 v11, 0xffff0000, v49
    v_add_f32 v8, v8, v10
    v_add_f32 v9, v9, v11
    v_lshlrev_b32 v10, 16, v50
    v_and_b32 v11, 0xffff0000, v50
    v_add_f32 v8, v8, v10
    v_add_f32 v9, v9, v11
    v_lshlrev_b32 v10, 16, v51
    v_and_b32 v11, 0xffff0000, v51
    v_add_f32 v8, v8, v10
    v_add_f32 v9, v9, v11
    v_lshlrev_b32 v10, 16, v52
    v_and_b32 v11, 0xffff0000, v52
    v_add_f32 v8, v8, v10
    v_add_f32 v9, v9, v11
    v_lshlrev_b32 v10, 16, v53
    v_and_b32 v11, 0xffff0000, v53
    v_add_f32 v8, v8, v10
    v_add_f32 v9, v9, v11
    v_lshlrev_b32 v10, 16, v54
    v_and_b32 v11, 0xffff0000, v54
    v_add_f32 v8, v8, v10
    v_add_f32 v9, v9, v11
    v_lshlrev_b32 v10, 16, v55
    v_and_b32 v11, 0xffff0000, v55
    v_add_f32 v8, v8, v10
    v_add_f32 v9, v9, v11
    v_lshlrev_b32 v10, 16, v56
    v_and_b32 v11, 0xffff0000, v56
    v_add_f32 v8, v8, v10
    v_add_f32 v9, v9, v11
    v_lshlrev_b32 v10, 16, v57
    v_and_b32 v11, 0xffff0000, v57
    v_add_f32 v8, v8, v10
    v_add_f32 v9, v9, v11
    v_lshlrev_b32 v10, 16, v58
    v_and_b32 v11, 0xffff0000, v58
    v_add_f32 v8, v8, v10
    v_add_f32 v9, v9, v11
    v_lshlrev_b32 v10, 16, v59
    v_and_b32 v11, 0xffff0000, v59
    v_add_f32 v8, v8, v10
    v_add_f32 v9, v9, v11
    v_lshlrev_b32 v10, 16, v60
    v_and_b32 v11, 0xffff0000, v60
    v_add_f32 v8, v8, v10
    v_add_f32 v9, v9, v11
    v_lshlrev_b32 v10, 16, v61
    v_and_b32 v11, 0xffff0000, v61
    v_add_f32 v8, v8, v10
    v_add_f32 v9, v9, v11
    v_lshlrev_b32 v10, 16, v62
    v_and_b32 v11, 0xffff0000, v62
    v_add_f32 v8, v8, v10
    v_add_f32 v9, v9, v11
    v_lshlrev_b32 v10, 16, v63
    v_and_b32 v11, 0xffff0000, v63
    v_add_f32 v8, v8, v10
    v_add_f32 v9, v9, v11
    v_lshlrev_b32 v10, 16, v64
    v_and_b32 v11, 0xffff0000, v64
    v_add_f32 v8, v8, v10
    v_add_f32 v9, v9, v11
    v_lshlrev_b32 v10, 16, v65
    v_and_b32 v11, 0xffff0000, v65
    v_add_f32 v8, v8, v10
    v_add_f32 v9, v9, v11
    v_lshlrev_b32 v10, 16, v66
    v_and_b32 v11, 0xffff0000, v66
    v_add_f32 v8, v8, v10
    v_add_f32 v9, v9, v11
    v_lshlrev_b32 v10, 16, v67
    v_and_b32 v11, 0xffff0000, v67
    v_add_f32 v8, v8, v10
    v_add_f32 v9, v9, v11
    v_lshlrev_b32 v10, 16, v68
    v_and_b32 v11, 0xffff0000, v68
    v_add_f32 v8, v8, v10
    v_add_f32 v9, v9, v11
    v_lshlrev_b32 v10, 16, v69
    v_and_b32 v11, 0xffff0000, v69
    v_add_f32 v8, v8, v10
    v_add_f32 v9, v9, v11
    v_lshlrev_b32 v10, 16, v70
    v_and_b32 v11, 0xffff0000, v70
    v_add_f32 v8, v8, v10
    v_add_f32 v9, v9, v11
    v_lshlrev_b32 v10, 16, v71
    v_and_b32 v11, 0xffff0000, v71
    v_add_f32 v8, v8, v10
    v_add_f32 v9, v9, v11
    v_lshlrev_b32 v3, 3, v0
    s_lshl_b32 s21, s14, 9
    v_add_u32 v4, s21, v3
    ds_write_b64 v4, v[8:9]
    s_waitcnt lgkmcnt(0)
    s_barrier
    ds_read_b64 v[12:13], v3 offset:0
    ds_read_b64 v[14:15], v3 offset:512
    ds_read_b64 v[16:17], v3 offset:1024
    ds_read_b64 v[18:19], v3 offset:1536
    s_waitcnt lgkmcnt(0)
    v_pk_add_f32 v[12:13], v[12:13], v[14:15]
    v_pk_add_f32 v[12:13], v[12:13], v[16:17]
    v_pk_add_f32 v[12:13], v[12:13], v[18:19]
    s_lshl_b32 s20, s40, 9
    s_add_u32 s20, s20, 127926272
    s_cmp_lg_u32 s14, 0
    s_cbranch_scc1 chw_csx
    buffer_store_dwordx2 v[12:13], v3, s[8:11], s20 offen sc1
chw_csx:
    s_barrier
chw_ncs:
    s_waitcnt vmcnt(0)
    s_barrier
    s_cmp_lg_u32 s14, 0
    s_cbranch_scc1 chwtr_sg
    s_mov_b32 s24, 20459648
    s_mov_b64 exec, 1
    v_mov_b32 v251, 1
    buffer_atomic_add v251, off, s[8:11], s24
    s_mov_b64 exec, -1
chwtr_sg:
    s_add_u32 s37, s12, 6
    s_cmp_ge_u32 s37, 7
    s_cselect_b32 s20, 7, 0
    s_sub_u32 s37, s37, s20
    s_cmp_ge_u32 s37, 7
    s_cselect_b32 s20, 7, 0
    s_sub_u32 s37, s37, s20
    s_cmp_ge_u32 s37, 7
    s_cselect_b32 s20, 7, 0
    s_sub_u32 s37, s37, s20
    s_mov_b32 s36, 0
og_next:
    s_lshl_b32 s30, s37, 7
    s_add_u32 s30, s30, 20461568
    s_cmp_lg_u32 s14, 0
    s_cbranch_scc1 ogc_cw
    s_mov_b64 exec, 1
    v_mov_b32 v251, 1
    buffer_atomic_add v251, off, s[8:11], s30 sc0
    v_mov_b32 v250, 143360
    s_waitcnt vmcnt(0)
    ds_write_b32 v250, v251
    s_waitcnt lgkmcnt(0)
    s_mov_b64 exec, -1
ogc_cw:
    s_barrier
    v_mov_b32 v250, 143360
    ds_read_b32 v251, v250
    s_waitcnt lgkmcnt(0)
    v_readfirstlane_b32 s29, v251
    s_barrier
    s_nop 3
    s_cmp_lt_u32 s37, 4
    s_cselect_b32 s31, 35, 28
    s_cmp_lt_u32 s29, s31
    s_cbranch_scc1 og_ok
    s_add_u32 s37, s37, 1
    s_cmp_ge_u32 s37, 7
    s_cselect_b32 s20, 7, 0
    s_sub_u32 s37, s37, s20
    s_add_u32 s36, s36, 1
    s_cmp_lt_u32 s36, 7
    s_cbranch_scc1 og_next
og_ok:
    s_mul_hi_u32 s20, s29, 613566757
    s_mul_i32 s21, s20, 7
    s_sub_u32 s35, s29, s21
    s_mul_i32 s34, s20, 7
    s_add_u32 s34, s34, s37
    v_accvgpr_write_b32 a192, 0
    v_accvgpr_write_b32 a193, 0
    v_accvgpr_write_b32 a194, 0
    v_accvgpr_write_b32 a195, 0
    v_accvgpr_write_b32 a196, 0
    v_accvgpr_write_b32 a197, 0
    v_accvgpr_write_b32 a198, 0
    v_accvgpr_write_b32 a199, 0
    v_accvgpr_write_b32 a200, 0
    v_accvgpr_write_b32 a201, 0
    v_accvgpr_write_b32 a202, 0
    v_accvgpr_write_b32 a203, 0
    v_accvgpr_write_b32 a204, 0
    v_accvgpr_write_b32 a205, 0
    v_accvgpr_write_b32 a206, 0
    v_accvgpr_write_b32 a207, 0
    v_accvgpr_write_b32 a208, 0
    v_accvgpr_write_b32 a209, 0
    v_accvgpr_write_b32 a210, 0
    v_accvgpr_write_b32 a211, 0
    v_accvgpr_write_b32 a212, 0
    v_accvgpr_write_b32 a213, 0
    v_accvgpr_write_b32 a214, 0
    v_accvgpr_write_b32 a215, 0
    v_accvgpr_write_b32 a216, 0
    v_accvgpr_write_b32 a217, 0
    v_accvgpr_write_b32 a218, 0
    v_accvgpr_write_b32 a219, 0
    v_accvgpr_write_b32 a220, 0
    v_accvgpr_write_b32 a221, 0
    v_accvgpr_write_b32 a222, 0
    v_accvgpr_write_b32 a223, 0
    v_accvgpr_write_b32 a224, 0
    v_accvgpr_write_b32 a225, 0
    v_accvgpr_write_b32 a226, 0
    v_accvgpr_write_b32 a227, 0
    v_accvgpr_write_b32 a228, 0
    v_accvgpr_write_b32 a229, 0
    v_accvgpr_write_b32 a230, 0
    v_accvgpr_write_b32 a231, 0
    v_accvgpr_write_b32 a232, 0
    v_accvgpr_write_b32 a233, 0
    v_accvgpr_write_b32 a234, 0
    v_accvgpr_write_b32 a235, 0
    v_accvgpr_write_b32 a236, 0
    v_accvgpr_write_b32 a237, 0
    v_accvgpr_write_b32 a238, 0
    v_accvgpr_write_b32 a239, 0
    v_accvgpr_write_b32 a240, 0
    v_accvgpr_write_b32 a241, 0
    v_accvgpr_write_b32 a242, 0
    v_accvgpr_write_b32 a243, 0
    v_accvgpr_write_b32 a244, 0
    v_accvgpr_write_b32 a245, 0
    v_accvgpr_write_b32 a246, 0
    v_accvgpr_write_b32 a247, 0
    v_accvgpr_write_b32 a248, 0
    v_accvgpr_write_b32 a249, 0
    v_accvgpr_write_b32 a250, 0
    v_accvgpr_write_b32 a251, 0
    v_accvgpr_write_b32 a252, 0
    v_accvgpr_write_b32 a253, 0
    v_accvgpr_write_b32 a254, 0
    v_accvgpr_write_b32 a255, 0
    s_add_u32 s37, s12, 6
    s_cmp_ge_u32 s37, 7
    s_cselect_b32 s20, 7, 0
    s_sub_u32 s37, s37, s20
    s_cmp_ge_u32 s37, 7
    s_cselect_b32 s20, 7, 0
    s_sub_u32 s37, s37, s20
    s_cmp_ge_u32 s37, 7
    s_cselect_b32 s20, 7, 0
    s_sub_u32 s37, s37, s20
    s_lshl_b32 s30, s37, 7
    s_add_u32 s30, s30, 20453376
    s_cmp_lg_u32 s14, 0
    s_cbranch_scc1 rl1_cw
    s_mov_b64 exec, 1
    v_mov_b32 v251, 1
    buffer_atomic_add v251, off, s[8:11], s30 sc0
    v_mov_b32 v250, 143360
    s_waitcnt vmcnt(0)
    ds_write_b32 v250, v251
    s_waitcnt lgkmcnt(0)
    s_mov_b64 exec, -1
rl1_cw:
    s_barrier
    v_mov_b32 v250, 143360
    ds_read_b32 v251, v250
    s_waitcnt lgkmcnt(0)
    v_readfirstlane_b32 s29, v251
    s_barrier
    s_nop 3
    s_cmp_lt_u32 s29, 16
    s_cbranch_scc1 rl_sp
    s_mov_b32 s30, 20459776
    s_cmp_lg_u32 s14, 0
    s_cbranch_scc1 rl2_cw
    s_mov_b64 exec, 1
    v_mov_b32 v251, 1
    buffer_atomic_add v251, off, s[8:11], s30 sc0
    v_mov_b32 v250, 143360
    s_waitcnt vmcnt(0)
    ds_write_b32 v250, v251
    s_waitcnt lgkmcnt(0)
    s_mov_b64 exec, -1
rl2_cw:
    s_barrier
    v_mov_b32 v250, 143360
    ds_read_b32 v251, v250
    s_waitcnt lgkmcnt(0)
    v_readfirstlane_b32 s33, v251
    s_barrier
    s_nop 3
    s_cmp_lt_u32 s33, 112
    s_cbranch_scc1 rl_tok
    s_mov_b32 s37, 0
rl_steal:
    s_lshl_b32 s30, s37, 7
    s_add_u32 s30, s30, 20453376
    s_cmp_lg_u32 s14, 0
    s_cbranch_scc1 rl3_cw
    s_mov_b64 exec, 1
    v_mov_b32 v251, 1
    buffer_atomic_add v251, off, s[8:11], s30 sc0
    v_mov_b32 v250, 143360
    s_waitcnt vmcnt(0)
    ds_write_b32 v250, v251
    s_waitcnt lgkmcnt(0)
    s_mov_b64 exec, -1
rl3_cw:
    s_barrier
    v_mov_b32 v250, 143360
    ds_read_b32 v251, v250
    s_waitcnt lgkmcnt(0)
    v_readfirstlane_b32 s29, v251
    s_barrier
    s_nop 3
    s_cmp_lt_u32 s29, 16
    s_cbranch_scc1 rl_sp
    s_add_u32 s37, s37, 1
    s_cmp_lt_u32 s37, 7
    s_cbranch_scc1 rl_steal
    s_branch ch_exit
rl_sp:
    s_mov_b32 s38, s29
    s_mov_b32 s39, s37
    s_add_u32 s90, s12, 6
    s_cmp_ge_u32 s90, 7
    s_cselect_b32 s20, 7, 0
    s_sub_u32 s90, s90, s20
    s_cmp_ge_u32 s90, 7
    s_cselect_b32 s20, 7, 0
    s_sub_u32 s90, s90, s20
    s_cmp_ge_u32 s90, 7
    s_cselect_b32 s20, 7, 0
    s_sub_u32 s90, s90, s20
    s_mov_b32 s91, 0
wkq_next:
    s_lshl_b32 s92, s90, 7
    s_add_u32 s92, s92, 20452352
    s_cmp_lg_u32 s14, 0
    s_cbranch_scc1 wkq_cw
    s_mov_b64 exec, 1
    v_mov_b32 v251, 1
    buffer_atomic_add v251, off, s[8:11], s92 sc0
    v_mov_b32 v250, 143360
    s_waitcnt vmcnt(0)
    ds_write_b32 v250, v251
    s_waitcnt lgkmcnt(0)
    s_mov_b64 exec, -1
wkq_cw:
    s_barrier
    v_mov_b32 v250, 143360
    ds_read_b32 v251, v250
    s_waitcnt lgkmcnt(0)
    v_readfirstlane_b32 s93, v251
    s_barrier
    s_nop 3
    s_cmp_lt_u32 s90, 2
    s_cselect_b32 s94, 48, 32
    s_cmp_lt_u32 s93, s94
    s_cbranch_scc1 wkq_run
    s_add_u32 s91, s91, 1
    s_cmp_ge_u32 s91, 7
    s_cbranch_scc1 wkq_done
    s_add_u32 s90, s90, 1
    s_cmp_ge_u32 s90, 7
    s_cselect_b32 s20, 7, 0
    s_sub_u32 s90, s90, s20
    s_branch wkq_next
wkq_run:
    s_lshr_b32 s40, s93, 1
    s_and_b32 s41, s93, 1
    s_cmp_lt_u32 s90, 2
    s_cbranch_scc0 wkq_two
    s_mul_hi_u32 s40, s93, 1431655766
    s_mul_i32 s20, s40, 3
    s_sub_u32 s41, s93, s20
wkq_two:
    s_mul_i32 s41, s41, 7
    s_add_u32 s41, s41, s90
    v_lshlrev_b32 v1, 4, v0
    v_bfe_u32 v2, v0, 4, 1
    v_mul_u32_u24 v2, 14336, v2
    v_lshrrev_b32 v250, 5, v0
    v_lshl_add_u32 v2, v250, 8, v2
    v_and_b32 v250, 15, v0
    v_lshl_add_u32 v2, v250, 4, v2
    v_bfe_u32 v3, v0, 4, 1
    v_mul_u32_u24 v3, 1024, v3
    v_lshrrev_b32 v250, 5, v0
    v_lshl_add_u32 v3, v250, 8, v3
    v_and_b32 v250, 15, v0
    v_lshl_add_u32 v3, v250, 4, v3
    v_mov_b32 v4, v2
    v_add_u32 v5, 57344, v2
    v_add_u32 v6, 114688, v2
    s_mul_i32 s42, s41, 401408
    s_mul_i32 s20, s14, 7168
    s_add_u32 s42, s42, s20
    s_add_u32 s43, s42, 9437184
    s_add_u32 s42, s42, 2097152
    s_mov_b32 s44, s20
    s_lshl_b32 s45, s40, 3
    s_lshl_b32 s20, s14, 1
    s_add_u32 s45, s45, s20
    s_mul_i32 s46, s45, 14336
    s_lshl_b32 s47, s41, 7
    s_add_u32 s47, s47, s45
    s_mul_i32 s47, s47, 14336
    s_add_u32 s47, s47, 67108864
    s_lshl_b32 s48, s40, 2
    s_add_u32 s48, s48, s14
    s_lshl_b32 s48, s48, 4
    s_add_u32 s48, s48, s41
    s_mul_i32 s49, s48, 28672
    s_add_u32 s49, s49, 37748736
    s_lshl_b32 s50, s48, 12
    s_add_u32 s50, s50, 96468992
    s_add_u32 s22, s46, 0
    buffer_load_dwordx4 a[0:3], v2, s[8:11], s22 offen offset:0
    buffer_load_dwordx4 a[4:7], v2, s[8:11], s22 offen offset:512
    buffer_load_dwordx4 a[8:11], v2, s[8:11], s22 offen offset:1024
    buffer_load_dwordx4 a[12:15], v2, s[8:11], s22 offen offset:1536
    buffer_load_dwordx4 a[16:19], v2, s[8:11], s22 offen offset:2048
    buffer_load_dwordx4 a[20:23], v2, s[8:11], s22 offen offset:2560
    buffer_load_dwordx4 a[24:27], v2, s[8:11], s22 offen offset:3072
    buffer_load_dwordx4 a[28:31], v2, s[8:11], s22 offen offset:3584
    s_add_u32 s22, s46, 4096
    buffer_load_dwordx4 a[32:35], v2, s[8:11], s22 offen offset:0
    buffer_load_dwordx4 a[36:39], v2, s[8:11], s22 offen offset:512
    buffer_load_dwordx4 a[40:43], v2, s[8:11], s22 offen offset:1024
    buffer_load_dwordx4 a[44:47], v2, s[8:11], s22 offen offset:1536
    buffer_load_dwordx4 a[48:51], v2, s[8:11], s22 offen offset:2048
    buffer_load_dwordx4 a[52:55], v2, s[8:11], s22 offen offset:2560
    buffer_load_dwordx4 a[56:59], v2, s[8:11], s22 offen offset:3072
    buffer_load_dwordx4 a[60:63], v2, s[8:11], s22 offen offset:3584
    s_add_u32 s22, s46, 8192
    buffer_load_dwordx4 a[64:67], v2, s[8:11], s22 offen offset:0
    buffer_load_dwordx4 a[68:71], v2, s[8:11], s22 offen offset:512
    buffer_load_dwordx4 a[72:75], v2, s[8:11], s22 offen offset:1024
    buffer_load_dwordx4 a[76:79], v2, s[8:11], s22 offen offset:1536
    buffer_load_dwordx4 a[80:83], v2, s[8:11], s22 offen offset:2048
    buffer_load_dwordx4 a[84:87], v2, s[8:11], s22 offen offset:2560
    buffer_load_dwordx4 a[88:91], v2, s[8:11], s22 offen offset:3072
    buffer_load_dwordx4 a[92:95], v2, s[8:11], s22 offen offset:3584
    s_add_u32 s22, s46, 12288
    buffer_load_dwordx4 a[96:99], v2, s[8:11], s22 offen offset:0
    buffer_load_dwordx4 a[100:103], v2, s[8:11], s22 offen offset:512
    buffer_load_dwordx4 a[104:107], v2, s[8:11], s22 offen offset:1024
    buffer_load_dwordx4 a[108:111], v2, s[8:11], s22 offen offset:1536
    s_add_u32 m0, s44, 0
    s_add_u32 s21, s42, 0
    buffer_load_dwordx4 v1, s[8:11], s21 offen offset:0 lds
    buffer_load_dwordx4 v1, s[8:11], s21 offen offset:1024 lds
    buffer_load_dwordx4 v1, s[8:11], s21 offen offset:2048 lds
    buffer_load_dwordx4 v1, s[8:11], s21 offen offset:3072 lds
    s_add_u32 m0, s44, 4096
    s_add_u32 s21, s42, 4096
    buffer_load_dwordx4 v1, s[8:11], s21 offen offset:0 lds
    buffer_load_dwordx4 v1, s[8:11], s21 offen offset:1024 lds
    buffer_load_dwordx4 v1, s[8:11], s21 offen offset:2048 lds
    s_add_u32 m0, s44, 28672
    s_add_u32 s21, s42, 28672
    buffer_load_dwordx4 v1, s[8:11], s21 offen offset:0 lds
    buffer_load_dwordx4 v1, s[8:11], s21 offen offset:1024 lds
    buffer_load_dwordx4 v1, s[8:11], s21 offen offset:2048 lds
    buffer_load_dwordx4 v1, s[8:11], s21 offen offset:3072 lds
    s_add_u32 m0, s44, 32768
    s_add_u32 s21, s42, 32768
    buffer_load_dwordx4 v1, s[8:11], s21 offen offset:0 lds
    buffer_load_dwordx4 v1, s[8:11], s21 offen offset:1024 lds
    buffer_load_dwordx4 v1, s[8:11], s21 offen offset:2048 lds
    s_add_u32 m0, s44, 57344
    s_add_u32 s21, s42, 57344
    buffer_load_dwordx4 v1, s[8:11], s21 offen offset:0 lds
    buffer_load_dwordx4 v1, s[8:11], s21 offen offset:1024 lds
    buffer_load_dwordx4 v1, s[8:11], s21 offen offset:2048 lds
    buffer_load_dwordx4 v1, s[8:11], s21 offen offset:3072 lds
    s_add_u32 m0, s44, 61440
    s_add_u32 s21, s42, 61440
    buffer_load_dwordx4 v1, s[8:11], s21 offen offset:0 lds
    buffer_load_dwordx4 v1, s[8:11], s21 offen offset:1024 lds
    buffer_load_dwordx4 v1, s[8:11], s21 offen offset:2048 lds
    s_waitcnt vmcnt(14)
    s_barrier
    ds_read_b128 v[8:11], v4 offset:0
    ds_read_b128 v[12:15], v4 offset:512
    ds_read_b128 v[16:19], v4 offset:1024
    ds_read_b128 v[20:23], v4 offset:1536
    ds_read_b128 v[24:27], v4 offset:2048
    s_waitcnt lgkmcnt(4)
    v_mfma_f32_32x32x16_bf16 v[32:47], v[8:11], a[0:3], 0
    ds_read_b128 v[28:31], v4 offset:2560
    s_waitcnt lgkmcnt(4)
    v_mfma_f32_32x32x16_bf16 v[32:47], v[12:15], a[4:7], v[32:47]
    ds_read_b128 v[8:11], v4 offset:3072
    s_add_u32 m0, s44, 86016
    s_add_u32 s21, s42, 86016
    buffer_load_dwordx4 v1, s[8:11], s21 offen lds
    s_waitcnt lgkmcnt(4)
    v_mfma_f32_32x32x16_bf16 v[32:47], v[16:19], a[8:11], v[32:47]
    ds_read_b128 v[12:15], v4 offset:3584
    s_waitcnt lgkmcnt(4)
    v_mfma_f32_32x32x16_bf16 v[32:47], v[20:23], a[12:15], v[32:47]
    ds_read_b128 v[16:19], v4 offset:4096
    s_waitcnt lgkmcnt(4)
    v_mfma_f32_32x32x16_bf16 v[32:47], v[24:27], a[16:19], v[32:47]
    ds_read_b128 v[20:23], v4 offset:4608
    s_waitcnt lgkmcnt(4)
    v_mfma_f32_32x32x16_bf16 v[32:47], v[28:31], a[20:23], v[32:47]
    ds_read_b128 v[24:27], v4 offset:5120
    s_add_u32 m0, s44, 87040
    s_add_u32 s21, s42, 87040
    buffer_load_dwordx4 v1, s[8:11], s21 offen lds
    s_waitcnt lgkmcnt(4)
    v_mfma_f32_32x32x16_bf16 v[32:47], v[8:11], a[24:27], v[32:47]
    ds_read_b128 v[28:31], v4 offset:5632
    s_waitcnt lgkmcnt(4)
    v_mfma_f32_32x32x16_bf16 v[32:47], v[12:15], a[28:31], v[32:47]
    ds_read_b128 v[8:11], v4 offset:6144
    s_waitcnt lgkmcnt(4)
    v_mfma_f32_32x32x16_bf16 v[32:47], v[16:19], a[32:35], v[32:47]
    ds_read_b128 v[12:15], v4 offset:6656
    s_waitcnt lgkmcnt(4)
    v_mfma_f32_32x32x16_bf16 v[32:47], v[20:23], a[36:39], v[32:47]
    ds_read_b128 v[16:19], v4 offset:7168
    s_add_u32 m0, s44, 88064
    s_add_u32 s21, s42, 88064
    buffer_load_dwordx4 v1, s[8:11], s21 offen lds
    s_waitcnt lgkmcnt(4)
    v_mfma_f32_32x32x16_bf16 v[32:47], v[24:27], a[40:43], v[32:47]
    ds_read_b128 v[20:23], v4 offset:7680
    s_waitcnt lgkmcnt(4)
    v_mfma_f32_32x32x16_bf16 v[32:47], v[28:31], a[44:47], v[32:47]
    ds_read_b128 v[24:27], v4 offset:8192
    s_waitcnt lgkmcnt(4)
    v_mfma_f32_32x32x16_bf16 v[32:47], v[8:11], a[48:51], v[32:47]
    ds_read_b128 v[28:31], v4 offset:8704
    s_waitcnt lgkmcnt(4)
    v_mfma_f32_32x32x16_bf16 v[32:47], v[12:15], a[52:55], v[32:47]
    ds_read_b128 v[8:11], v4 offset:9216
    s_add_u32 m0, s44, 89088
    s_add_u32 s21, s42, 89088
    buffer_load_dwordx4 v1, s[8:11], s21 offen lds
    s_waitcnt lgkmcnt(4)
    v_mfma_f32_32x32x16_bf16 v[32:47], v[16:19], a[56:59], v[32:47]
    ds_read_b128 v[12:15], v4 offset:9728
    s_waitcnt lgkmcnt(4)
    v_mfma_f32_32x32x16_bf16 v[32:47], v[20:23], a[60:63], v[32:47]
    ds_read_b128 v[16:19], v4 offset:10240
    s_waitcnt lgkmcnt(4)
    v_mfma_f32_32x32x16_bf16 v[32:47], v[24:27], a[64:67], v[32:47]
    ds_read_b128 v[20:23], v4 offset:10752
    s_waitcnt lgkmcnt(4)
    v_mfma_f32_32x32x16_bf16 v[32:47], v[28:31], a[68:71], v[32:47]
    ds_read_b128 v[24:27], v4 offset:11264
    s_add_u32 m0, s44, 90112
    s_add_u32 s21, s42, 90112
    buffer_load_dwordx4 v1, s[8:11], s21 offen lds
    s_waitcnt lgkmcnt(4)
    v_mfma_f32_32x32x16_bf16 v[32:47], v[8:11], a[72:75], v[32:47]
    ds_read_b128 v[28:31], v4 offset:11776
    s_waitcnt lgkmcnt(4)
    v_mfma_f32_32x32x16_bf16 v[32:47], v[12:15], a[76:79], v[32:47]
    ds_read_b128 v[8:11], v4 offset:12288
    s_waitcnt lgkmcnt(4)
    v_mfma_f32_32x32x16_bf16 v[32:47], v[16:19], a[80:83], v[32:47]
    ds_read_b128 v[12:15], v4 offset:12800
    s_waitcnt lgkmcnt(4)
    v_mfma_f32_32x32x16_bf16 v[32:47], v[20:23], a[84:87], v[32:47]
    ds_read_b128 v[16:19], v4 offset:13312
    s_add_u32 m0, s44, 91136
    s_add_u32 s21, s42, 91136
    buffer_load_dwordx4 v1, s[8:11], s21 offen lds
    s_waitcnt lgkmcnt(4)
    v_mfma_f32_32x32x16_bf16 v[32:47], v[24:27], a[88:91], v[32:47]
    ds_read_b128 v[20:23], v4 offset:13824
    s_waitcnt lgkmcnt(4)
    v_mfma_f32_32x32x16_bf16 v[32:47], v[28:31], a[92:95], v[32:47]
    s_waitcnt vmcnt(13)
    s_barrier
    ds_read_b128 v[24:27], v4 offset:28672
    s_waitcnt lgkmcnt(4)
    v_mfma_f32_32x32x16_bf16 v[32:47], v[8:11], a[96:99], v[32:47]
    ds_read_b128 v[28:31], v4 offset:29184
    s_waitcnt lgkmcnt(4)
    v_mfma_f32_32x32x16_bf16 v[32:47], v[12:15], a[100:103], v[32:47]
    ds_read_b128 v[8:11], v4 offset:29696
    s_add_u32 m0, s44, 92160
    s_add_u32 s21, s42, 92160
    buffer_load_dwordx4 v1, s[8:11], s21 offen lds
    s_waitcnt lgkmcnt(4)
    v_mfma_f32_32x32x16_bf16 v[32:47], v[16:19], a[104:107], v[32:47]
    ds_read_b128 v[12:15], v4 offset:30208
    s_waitcnt lgkmcnt(4)
    v_mfma_f32_32x32x16_bf16 v[32:47], v[20:23], a[108:111], v[32:47]
    ds_read_b128 v[16:19], v4 offset:30720
    s_waitcnt lgkmcnt(4)
    v_mfma_f32_32x32x16_bf16 v[48:63], v[24:27], a[0:3], 0
    ds_read_b128 v[20:23], v4 offset:31232
    s_waitcnt lgkmcnt(4)
    v_mfma_f32_32x32x16_bf16 v[48:63], v[28:31], a[4:7], v[48:63]
    ds_read_b128 v[24:27], v4 offset:31744
    s_add_u32 m0, s44, 114688
    s_add_u32 s21, s42, 114688
    buffer_load_dwordx4 v1, s[8:11], s21 offen lds
    s_waitcnt lgkmcnt(4)
    v_mfma_f32_32x32x16_bf16 v[48:63], v[8:11], a[8:11], v[48:63]
    ds_read_b128 v[28:31], v4 offset:32256
    s_waitcnt lgkmcnt(4)
    v_mfma_f32_32x32x16_bf16 v[48:63], v[12:15], a[12:15], v[48:63]
    ds_read_b128 v[8:11], v4 offset:32768
    s_waitcnt lgkmcnt(4)
    v_mfma_f32_32x32x16_bf16 v[48:63], v[16:19], a[16:19], v[48:63]
    ds_read_b128 v[12:15], v4 offset:33280
    s_waitcnt lgkmcnt(4)
    v_mfma_f32_32x32x16_bf16 v[48:63], v[20:23], a[20:23], v[48:63]
    ds_read_b128 v[16:19], v4 offset:33792
    s_add_u32 m0, s44, 115712
    s_add_u32 s21, s42, 115712
    buffer_load_dwordx4 v1, s[8:11], s21 offen lds
    s_waitcnt lgkmcnt(4)
    v_mfma_f32_32x32x16_bf16 v[48:63], v[24:27], a[24:27], v[48:63]
    ds_read_b128 v[20:23], v4 offset:34304
    v_cvt_pk_bf16_f32 v80, v32, v33
    v_cvt_pk_bf16_f32 v81, v36, v37
    s_waitcnt lgkmcnt(4)
    v_mfma_f32_32x32x16_bf16 v[48:63], v[28:31], a[28:31], v[48:63]
    ds_read_b128 v[24:27], v4 offset:34816
    v_cvt_pk_bf16_f32 v82, v34, v35
    v_cvt_pk_bf16_f32 v83, v38, v39
    s_waitcnt lgkmcnt(4)
    v_mfma_f32_32x32x16_bf16 v[48:63], v[8:11], a[32:35], v[48:63]
    ds_read_b128 v[28:31], v4 offset:35328
    v_cvt_pk_bf16_f32 v88, v40, v41
    v_cvt_pk_bf16_f32 v89, v44, v45
    s_waitcnt lgkmcnt(4)
    v_mfma_f32_32x32x16_bf16 v[48:63], v[12:15], a[36:39], v[48:63]
    ds_read_b128 v[8:11], v4 offset:35840
    s_add_u32 m0, s44, 116736
    s_add_u32 s21, s42, 116736
    buffer_load_dwordx4 v1, s[8:11], s21 offen lds
    v_cvt_pk_bf16_f32 v90, v42, v43
    v_cvt_pk_bf16_f32 v91, v46, v47
    s_waitcnt lgkmcnt(4)
    v_mfma_f32_32x32x16_bf16 v[48:63], v[16:19], a[40:43], v[48:63]
    ds_read_b128 v[12:15], v4 offset:36352
    s_add_u32 s23, s47, 0
    buffer_store_dwordx4 v[80:83], v2, s[8:11], s23 offen sc1
    s_waitcnt lgkmcnt(4)
    v_mfma_f32_32x32x16_bf16 v[48:63], v[20:23], a[44:47], v[48:63]
    ds_read_b128 v[16:19], v4 offset:36864
    v_mfma_f32_32x32x16_bf16 v[64:79], a[0:3], v[80:83], 0
    s_waitcnt lgkmcnt(4)
    v_mfma_f32_32x32x16_bf16 v[48:63], v[24:27], a[48:51], v[48:63]
    ds_read_b128 v[20:23], v4 offset:37376
    s_add_u32 s23, s47, 512
    buffer_store_dwordx4 v[88:91], v2, s[8:11], s23 offen sc1
    s_waitcnt lgkmcnt(4)
    v_mfma_f32_32x32x16_bf16 v[48:63], v[28:31], a[52:55], v[48:63]
    ds_read_b128 v[24:27], v4 offset:37888
    s_add_u32 m0, s44, 117760
    s_add_u32 s21, s42, 117760
    buffer_load_dwordx4 v1, s[8:11], s21 offen lds
    v_mfma_f32_32x32x16_bf16 v[64:79], a[4:7], v[88:91], v[64:79]
    s_waitcnt lgkmcnt(4)
    v_mfma_f32_32x32x16_bf16 v[48:63], v[8:11], a[56:59], v[48:63]
    ds_read_b128 v[28:31], v4 offset:38400
    s_waitcnt lgkmcnt(4)
    v_mfma_f32_32x32x16_bf16 v[48:63], v[12:15], a[60:63], v[48:63]
    ds_read_b128 v[8:11], v4 offset:38912
    s_waitcnt lgkmcnt(4)
    v_mfma_f32_32x32x16_bf16 v[48:63], v[16:19], a[64:67], v[48:63]
    ds_read_b128 v[12:15], v4 offset:39424
    s_waitcnt lgkmcnt(4)
    v_mfma_f32_32x32x16_bf16 v[48:63], v[20:23], a[68:71], v[48:63]
    ds_read_b128 v[16:19], v4 offset:39936
    s_add_u32 m0, s44, 118784
    s_add_u32 s21, s42, 118784
    buffer_load_dwordx4 v1, s[8:11], s21 offen lds
    s_waitcnt lgkmcnt(4)
    v_mfma_f32_32x32x16_bf16 v[48:63], v[24:27], a[72:75], v[48:63]
    ds_read_b128 v[20:23], v4 offset:40448
    s_waitcnt lgkmcnt(4)
    v_mfma_f32_32x32x16_bf16 v[48:63], v[28:31], a[76:79], v[48:63]
    ds_read_b128 v[24:27], v4 offset:40960
    s_waitcnt lgkmcnt(4)
    v_mfma_f32_32x32x16_bf16 v[48:63], v[8:11], a[80:83], v[48:63]
    ds_read_b128 v[28:31], v4 offset:41472
    s_waitcnt lgkmcnt(4)
    v_mfma_f32_32x32x16_bf16 v[48:63], v[12:15], a[84:87], v[48:63]
    ds_read_b128 v[8:11], v4 offset:41984
    s_add_u32 m0, s44, 119808
    s_add_u32 s21, s42, 119808
    buffer_load_dwordx4 v1, s[8:11], s21 offen lds
    s_waitcnt lgkmcnt(4)
    v_mfma_f32_32x32x16_bf16 v[48:63], v[16:19], a[88:91], v[48:63]
    ds_read_b128 v[12:15], v4 offset:42496
    s_waitcnt lgkmcnt(4)
    v_mfma_f32_32x32x16_bf16 v[48:63], v[20:23], a[92:95], v[48:63]
    s_waitcnt vmcnt(15)
    s_barrier
    ds_read_b128 v[16:19], v5 offset:0
    s_waitcnt lgkmcnt(4)
    v_mfma_f32_32x32x16_bf16 v[48:63], v[24:27], a[96:99], v[48:63]
    ds_read_b128 v[20:23], v5 offset:512
    s_waitcnt lgkmcnt(4)
    v_mfma_f32_32x32x16_bf16 v[48:63], v[28:31], a[100:103], v[48:63]
    ds_read_b128 v[24:27], v5 offset:1024
    s_add_u32 m0, s44, 120832
    s_add_u32 s21, s42, 120832
    buffer_load_dwordx4 v1, s[8:11], s21 offen lds
    s_waitcnt lgkmcnt(4)
    v_mfma_f32_32x32x16_bf16 v[48:63], v[8:11], a[104:107], v[48:63]
    ds_read_b128 v[28:31], v5 offset:1536
    s_waitcnt lgkmcnt(4)
    v_mfma_f32_32x32x16_bf16 v[48:63], v[12:15], a[108:111], v[48:63]
    ds_read_b128 v[8:11], v5 offset:2048
    s_waitcnt lgkmcnt(4)
    v_mfma_f32_32x32x16_bf16 v[32:47], v[16:19], a[0:3], 0
    ds_read_b128 v[12:15], v5 offset:2560
    s_waitcnt lgkmcnt(4)
    v_mfma_f32_32x32x16_bf16 v[32:47], v[20:23], a[4:7], v[32:47]
    ds_read_b128 v[16:19], v5 offset:3072
    s_add_u32 m0, s44, 0
    s_add_u32 s21, s42, 143360
    buffer_load_dwordx4 v1, s[8:11], s21 offen lds
    s_waitcnt lgkmcnt(4)
    v_mfma_f32_32x32x16_bf16 v[32:47], v[24:27], a[8:11], v[32:47]
    ds_read_b128 v[20:23], v5 offset:3584
    s_waitcnt lgkmcnt(4)
    v_mfma_f32_32x32x16_bf16 v[32:47], v[28:31], a[12:15], v[32:47]
    ds_read_b128 v[24:27], v5 offset:4096
    s_waitcnt lgkmcnt(4)
    v_mfma_f32_32x32x16_bf16 v[32:47], v[8:11], a[16:19], v[32:47]
    ds_read_b128 v[28:31], v5 offset:4608
    s_waitcnt lgkmcnt(4)
    v_mfma_f32_32x32x16_bf16 v[32:47], v[12:15], a[20:23], v[32:47]
    ds_read_b128 v[8:11], v5 offset:5120
    s_add_u32 m0, s44, 1024
    s_add_u32 s21, s42, 144384
    buffer_load_dwordx4 v1, s[8:11], s21 offen lds
    s_waitcnt lgkmcnt(4)
    v_mfma_f32_32x32x16_bf16 v[32:47], v[16:19], a[24:27], v[32:47]
    ds_read_b128 v[12:15], v5 offset:5632
    v_cvt_pk_bf16_f32 v80, v48, v49
    v_cvt_pk_bf16_f32 v81, v52, v53
    s_waitcnt lgkmcnt(4)
    v_mfma_f32_32x32x16_bf16 v[32:47], v[20:23], a[28:31], v[32:47]
    ds_read_b128 v[16:19], v5 offset:6144
    v_cvt_pk_bf16_f32 v82, v50, v51
    v_cvt_pk_bf16_f32 v83, v54, v55
    s_waitcnt lgkmcnt(4)
    v_mfma_f32_32x32x16_bf16 v[32:47], v[24:27], a[32:35], v[32:47]
    ds_read_b128 v[20:23], v5 offset:6656
    v_cvt_pk_bf16_f32 v88, v56, v57
    v_cvt_pk_bf16_f32 v89, v60, v61
    s_waitcnt lgkmcnt(4)
    v_mfma_f32_32x32x16_bf16 v[32:47], v[28:31], a[36:39], v[32:47]
    ds_read_b128 v[24:27], v5 offset:7168
    s_add_u32 m0, s44, 2048
    s_add_u32 s21, s42, 145408
    buffer_load_dwordx4 v1, s[8:11], s21 offen lds
    v_cvt_pk_bf16_f32 v90, v58, v59
    v_cvt_pk_bf16_f32 v91, v62, v63
    s_waitcnt lgkmcnt(4)
    v_mfma_f32_32x32x16_bf16 v[32:47], v[8:11], a[40:43], v[32:47]
    ds_read_b128 v[28:31], v5 offset:7680
    s_add_u32 s23, s47, 1024
    buffer_store_dwordx4 v[80:83], v2, s[8:11], s23 offen sc1
    s_waitcnt lgkmcnt(4)
    v_mfma_f32_32x32x16_bf16 v[32:47], v[12:15], a[44:47], v[32:47]
    ds_read_b128 v[8:11], v5 offset:8192
    v_mfma_f32_32x32x16_bf16 v[64:79], a[8:11], v[80:83], v[64:79]
    s_waitcnt lgkmcnt(4)
    v_mfma_f32_32x32x16_bf16 v[32:47], v[16:19], a[48:51], v[32:47]
    ds_read_b128 v[12:15], v5 offset:8704
    s_add_u32 s23, s47, 1536
    buffer_store_dwordx4 v[88:91], v2, s[8:11], s23 offen sc1
    s_waitcnt lgkmcnt(4)
    v_mfma_f32_32x32x16_bf16 v[32:47], v[20:23], a[52:55], v[32:47]
    ds_read_b128 v[16:19], v5 offset:9216
    s_add_u32 m0, s44, 3072
    s_add_u32 s21, s42, 146432
    buffer_load_dwordx4 v1, s[8:11], s21 offen lds
    v_mfma_f32_32x32x16_bf16 v[64:79], a[12:15], v[88:91], v[64:79]
    s_waitcnt lgkmcnt(4)
    v_mfma_f32_32x32x16_bf16 v[32:47], v[24:27], a[56:59], v[32:47]
    ds_read_b128 v[20:23], v5 offset:9728
    s_waitcnt lgkmcnt(4)
    v_mfma_f32_32x32x16_bf16 v[32:47], v[28:31], a[60:63], v[32:47]
    ds_read_b128 v[24:27], v5 offset:10240
    s_waitcnt lgkmcnt(4)
    v_mfma_f32_32x32x16_bf16 v[32:47], v[8:11], a[64:67], v[32:47]
    ds_read_b128 v[28:31], v5 offset:10752
    s_waitcnt lgkmcnt(4)
    v_mfma_f32_32x32x16_bf16 v[32:47], v[12:15], a[68:71], v[32:47]
    ds_read_b128 v[8:11], v5 offset:11264
    s_add_u32 m0, s44, 4096
    s_add_u32 s21, s42, 147456
    buffer_load_dwordx4 v1, s[8:11], s21 offen lds
    s_waitcnt lgkmcnt(4)
    v_mfma_f32_32x32x16_bf16 v[32:47], v[16:19], a[72:75], v[32:47]
    ds_read_b128 v[12:15], v5 offset:11776
    s_waitcnt lgkmcnt(4)
    v_mfma_f32_32x32x16_bf16 v[32:47], v[20:23], a[76:79], v[32:47]
    ds_read_b128 v[16:19], v5 offset:12288
    s_waitcnt lgkmcnt(4)
    v_mfma_f32_32x32x16_bf16 v[32:47], v[24:27], a[80:83], v[32:47]
    ds_read_b128 v[20:23], v5 offset:12800
    s_waitcnt lgkmcnt(4)
    v_mfma_f32_32x32x16_bf16 v[32:47], v[28:31], a[84:87], v[32:47]
    ds_read_b128 v[24:27], v5 offset:13312
    s_add_u32 m0, s44, 5120
    s_add_u32 s21, s42, 148480
    buffer_load_dwordx4 v1, s[8:11], s21 offen lds
    s_waitcnt lgkmcnt(4)
    v_mfma_f32_32x32x16_bf16 v[32:47], v[8:11], a[88:91], v[32:47]
    ds_read_b128 v[28:31], v5 offset:13824
    s_waitcnt lgkmcnt(4)
    v_mfma_f32_32x32x16_bf16 v[32:47], v[12:15], a[92:95], v[32:47]
    s_waitcnt vmcnt(17)
    s_barrier
    ds_read_b128 v[8:11], v5 offset:28672
    s_waitcnt lgkmcnt(4)
    v_mfma_f32_32x32x16_bf16 v[32:47], v[16:19], a[96:99], v[32:47]
    ds_read_b128 v[12:15], v5 offset:29184
    s_waitcnt lgkmcnt(4)
    v_mfma_f32_32x32x16_bf16 v[32:47], v[20:23], a[100:103], v[32:47]
    ds_read_b128 v[16:19], v5 offset:29696
    s_add_u32 m0, s44, 6144
    s_add_u32 s21, s42, 149504
    buffer_load_dwordx4 v1, s[8:11], s21 offen lds
    s_waitcnt lgkmcnt(4)
    v_mfma_f32_32x32x16_bf16 v[32:47], v[24:27], a[104:107], v[32:47]
    ds_read_b128 v[20:23], v5 offset:30208
    s_waitcnt lgkmcnt(4)
    v_mfma_f32_32x32x16_bf16 v[32:47], v[28:31], a[108:111], v[32:47]
    ds_read_b128 v[24:27], v5 offset:30720
    s_waitcnt lgkmcnt(4)
    v_mfma_f32_32x32x16_bf16 v[48:63], v[8:11], a[0:3], 0
    ds_read_b128 v[28:31], v5 offset:31232
    s_waitcnt lgkmcnt(4)
    v_mfma_f32_32x32x16_bf16 v[48:63], v[12:15], a[4:7], v[48:63]
    ds_read_b128 v[8:11], v5 offset:31744
    s_add_u32 m0, s44, 28672
    s_add_u32 s21, s42, 172032
    buffer_load_dwordx4 v1, s[8:11], s21 offen lds
    s_waitcnt lgkmcnt(4)
    v_mfma_f32_32x32x16_bf16 v[48:63], v[16:19], a[8:11], v[48:63]
    ds_read_b128 v[12:15], v5 offset:32256
    s_waitcnt lgkmcnt(4)
    v_mfma_f32_32x32x16_bf16 v[48:63], v[20:23], a[12:15], v[48:63]
    ds_read_b128 v[16:19], v5 offset:32768
    s_waitcnt lgkmcnt(4)
    v_mfma_f32_32x32x16_bf16 v[48:63], v[24:27], a[16:19], v[48:63]
    ds_read_b128 v[20:23], v5 offset:33280
    s_waitcnt lgkmcnt(4)
    v_mfma_f32_32x32x16_bf16 v[48:63], v[28:31], a[20:23], v[48:63]
    ds_read_b128 v[24:27], v5 offset:33792
    s_add_u32 m0, s44, 29696
    s_add_u32 s21, s42, 173056
    buffer_load_dwordx4 v1, s[8:11], s21 offen lds
    s_waitcnt lgkmcnt(4)
    v_mfma_f32_32x32x16_bf16 v[48:63], v[8:11], a[24:27], v[48:63]
    ds_read_b128 v[28:31], v5 offset:34304
    v_cvt_pk_bf16_f32 v80, v32, v33
    v_cvt_pk_bf16_f32 v81, v36, v37
    s_waitcnt lgkmcnt(4)
    v_mfma_f32_32x32x16_bf16 v[48:63], v[12:15], a[28:31], v[48:63]
    ds_read_b128 v[8:11], v5 offset:34816
    v_cvt_pk_bf16_f32 v82, v34, v35
    v_cvt_pk_bf16_f32 v83, v38, v39
    s_waitcnt lgkmcnt(4)
    v_mfma_f32_32x32x16_bf16 v[48:63], v[16:19], a[32:35], v[48:63]
    ds_read_b128 v[12:15], v5 offset:35328
    v_cvt_pk_bf16_f32 v88, v40, v41
    v_cvt_pk_bf16_f32 v89, v44, v45
    s_waitcnt lgkmcnt(4)
    v_mfma_f32_32x32x16_bf16 v[48:63], v[20:23], a[36:39], v[48:63]
    ds_read_b128 v[16:19], v5 offset:35840
    s_add_u32 m0, s44, 30720
    s_add_u32 s21, s42, 174080
    buffer_load_dwordx4 v1, s[8:11], s21 offen lds
    v_cvt_pk_bf16_f32 v90, v42, v43
    v_cvt_pk_bf16_f32 v91, v46, v47
    s_waitcnt lgkmcnt(4)
    v_mfma_f32_32x32x16_bf16 v[48:63], v[24:27], a[40:43], v[48:63]
    ds_read_b128 v[20:23], v5 offset:36352
    s_add_u32 s23, s47, 2048
    buffer_store_dwordx4 v[80:83], v2, s[8:11], s23 offen sc1
    s_waitcnt lgkmcnt(4)
    v_mfma_f32_32x32x16_bf16 v[48:63], v[28:31], a[44:47], v[48:63]
    ds_read_b128 v[24:27], v5 offset:36864
    v_mfma_f32_32x32x16_bf16 v[64:79], a[16:19], v[80:83], v[64:79]
    s_waitcnt lgkmcnt(4)
    v_mfma_f32_32x32x16_bf16 v[48:63], v[8:11], a[48:51], v[48:63]
    ds_read_b128 v[28:31], v5 offset:37376
    s_add_u32 s23, s47, 2560
    buffer_store_dwordx4 v[88:91], v2, s[8:11], s23 offen sc1
    s_waitcnt lgkmcnt(4)
    v_mfma_f32_32x32x16_bf16 v[48:63], v[12:15], a[52:55], v[48:63]
    ds_read_b128 v[8:11], v5 offset:37888
    s_add_u32 m0, s44, 31744
    s_add_u32 s21, s42, 175104
    buffer_load_dwordx4 v1, s[8:11], s21 offen lds
    v_mfma_f32_32x32x16_bf16 v[64:79], a[20:23], v[88:91], v[64:79]
    s_waitcnt lgkmcnt(4)
    v_mfma_f32_32x32x16_bf16 v[48:63], v[16:19], a[56:59], v[48:63]
    ds_read_b128 v[12:15], v5 offset:38400
    s_waitcnt lgkmcnt(4)
    v_mfma_f32_32x32x16_bf16 v[48:63], v[20:23], a[60:63], v[48:63]
    ds_read_b128 v[16:19], v5 offset:38912
    s_waitcnt lgkmcnt(4)
    v_mfma_f32_32x32x16_bf16 v[48:63], v[24:27], a[64:67], v[48:63]
    ds_read_b128 v[20:23], v5 offset:39424
    s_waitcnt lgkmcnt(4)
    v_mfma_f32_32x32x16_bf16 v[48:63], v[28:31], a[68:71], v[48:63]
    ds_read_b128 v[24:27], v5 offset:39936
    s_add_u32 m0, s44, 32768
    s_add_u32 s21, s42, 176128
    buffer_load_dwordx4 v1, s[8:11], s21 offen lds
    s_waitcnt lgkmcnt(4)
    v_mfma_f32_32x32x16_bf16 v[48:63], v[8:11], a[72:75], v[48:63]
    ds_read_b128 v[28:31], v5 offset:40448
    s_waitcnt lgkmcnt(4)
    v_mfma_f32_32x32x16_bf16 v[48:63], v[12:15], a[76:79], v[48:63]
    ds_read_b128 v[8:11], v5 offset:40960
    s_waitcnt lgkmcnt(4)
    v_mfma_f32_32x32x16_bf16 v[48:63], v[16:19], a[80:83], v[48:63]
    ds_read_b128 v[12:15], v5 offset:41472
    s_waitcnt lgkmcnt(4)
    v_mfma_f32_32x32x16_bf16 v[48:63], v[20:23], a[84:87], v[48:63]
    ds_read_b128 v[16:19], v5 offset:41984
    s_add_u32 m0, s44, 33792
    s_add_u32 s21, s42, 177152
    buffer_load_dwordx4 v1, s[8:11], s21 offen lds
    s_waitcnt lgkmcnt(4)
    v_mfma_f32_32x32x16_bf16 v[48:63], v[24:27], a[88:91], v[48:63]
    ds_read_b128 v[20:23], v5 offset:42496
    s_waitcnt lgkmcnt(4)
    v_mfma_f32_32x32x16_bf16 v[48:63], v[28:31], a[92:95], v[48:63]
    s_waitcnt vmcnt(17)
    s_barrier
    ds_read_b128 v[24:27], v6 offset:0
    s_waitcnt lgkmcnt(4)
    v_mfma_f32_32x32x16_bf16 v[48:63], v[8:11], a[96:99], v[48:63]
    ds_read_b128 v[28:31], v6 offset:512
    s_waitcnt lgkmcnt(4)
    v_mfma_f32_32x32x16_bf16 v[48:63], v[12:15], a[100:103], v[48:63]
    ds_read_b128 v[8:11], v6 offset:1024
    s_add_u32 m0, s44, 34816
    s_add_u32 s21, s42, 178176
    buffer_load_dwordx4 v1, s[8:11], s21 offen lds
    s_waitcnt lgkmcnt(4)
    v_mfma_f32_32x32x16_bf16 v[48:63], v[16:19], a[104:107], v[48:63]
    ds_read_b128 v[12:15], v6 offset:1536
    s_waitcnt lgkmcnt(4)
    v_mfma_f32_32x32x16_bf16 v[48:63], v[20:23], a[108:111], v[48:63]
    ds_read_b128 v[16:19], v6 offset:2048
    s_waitcnt lgkmcnt(4)
    v_mfma_f32_32x32x16_bf16 v[32:47], v[24:27], a[0:3], 0
    ds_read_b128 v[20:23], v6 offset:2560
    s_waitcnt lgkmcnt(4)
    v_mfma_f32_32x32x16_bf16 v[32:47], v[28:31], a[4:7], v[32:47]
    ds_read_b128 v[24:27], v6 offset:3072
    s_add_u32 m0, s44, 57344
    s_add_u32 s21, s42, 200704
    buffer_load_dwordx4 v1, s[8:11], s21 offen lds
    s_waitcnt lgkmcnt(4)
    v_mfma_f32_32x32x16_bf16 v[32:47], v[8:11], a[8:11], v[32:47]
    ds_read_b128 v[28:31], v6 offset:3584
    s_waitcnt lgkmcnt(4)
    v_mfma_f32_32x32x16_bf16 v[32:47], v[12:15], a[12:15], v[32:47]
    ds_read_b128 v[8:11], v6 offset:4096
    s_waitcnt lgkmcnt(4)
    v_mfma_f32_32x32x16_bf16 v[32:47], v[16:19], a[16:19], v[32:47]
    ds_read_b128 v[12:15], v6 offset:4608
    s_waitcnt lgkmcnt(4)
    v_mfma_f32_32x32x16_bf16 v[32:47], v[20:23], a[20:23], v[32:47]
    ds_read_b128 v[16:19], v6 offset:5120
    s_add_u32 m0, s44, 58368
    s_add_u32 s21, s42, 201728
    buffer_load_dwordx4 v1, s[8:11], s21 offen lds
    s_waitcnt lgkmcnt(4)
    v_mfma_f32_32x32x16_bf16 v[32:47], v[24:27], a[24:27], v[32:47]
    ds_read_b128 v[20:23], v6 offset:5632
    v_cvt_pk_bf16_f32 v80, v48, v49
    v_cvt_pk_bf16_f32 v81, v52, v53
    s_waitcnt lgkmcnt(4)
    v_mfma_f32_32x32x16_bf16 v[32:47], v[28:31], a[28:31], v[32:47]
    ds_read_b128 v[24:27], v6 offset:6144
    v_cvt_pk_bf16_f32 v82, v50, v51
    v_cvt_pk_bf16_f32 v83, v54, v55
    s_waitcnt lgkmcnt(4)
    v_mfma_f32_32x32x16_bf16 v[32:47], v[8:11], a[32:35], v[32:47]
    ds_read_b128 v[28:31], v6 offset:6656
    v_cvt_pk_bf16_f32 v88, v56, v57
    v_cvt_pk_bf16_f32 v89, v60, v61
    s_waitcnt lgkmcnt(4)
    v_mfma_f32_32x32x16_bf16 v[32:47], v[12:15], a[36:39], v[32:47]
    ds_read_b128 v[8:11], v6 offset:7168
    s_add_u32 m0, s44, 59392
    s_add_u32 s21, s42, 202752
    buffer_load_dwordx4 v1, s[8:11], s21 offen lds
    v_cvt_pk_bf16_f32 v90, v58, v59
    v_cvt_pk_bf16_f32 v91, v62, v63
    s_waitcnt lgkmcnt(4)
    v_mfma_f32_32x32x16_bf16 v[32:47], v[16:19], a[40:43], v[32:47]
    ds_read_b128 v[12:15], v6 offset:7680
    s_add_u32 s23, s47, 3072
    buffer_store_dwordx4 v[80:83], v2, s[8:11], s23 offen sc1
    s_waitcnt lgkmcnt(4)
    v_mfma_f32_32x32x16_bf16 v[32:47], v[20:23], a[44:47], v[32:47]
    ds_read_b128 v[16:19], v6 offset:8192
    v_mfma_f32_32x32x16_bf16 v[64:79], a[24:27], v[80:83], v[64:79]
    s_waitcnt lgkmcnt(4)
    v_mfma_f32_32x32x16_bf16 v[32:47], v[24:27], a[48:51], v[32:47]
    ds_read_b128 v[20:23], v6 offset:8704
    s_add_u32 s23, s47, 3584
    buffer_store_dwordx4 v[88:91], v2, s[8:11], s23 offen sc1
    s_waitcnt lgkmcnt(4)
    v_mfma_f32_32x32x16_bf16 v[32:47], v[28:31], a[52:55], v[32:47]
    ds_read_b128 v[24:27], v6 offset:9216
    s_add_u32 m0, s44, 60416
    s_add_u32 s21, s42, 203776
    buffer_load_dwordx4 v1, s[8:11], s21 offen lds
    v_mfma_f32_32x32x16_bf16 v[64:79], a[28:31], v[88:91], v[64:79]
    s_waitcnt lgkmcnt(4)
    v_mfma_f32_32x32x16_bf16 v[32:47], v[8:11], a[56:59], v[32:47]
    ds_read_b128 v[28:31], v6 offset:9728
    s_waitcnt lgkmcnt(4)
    v_mfma_f32_32x32x16_bf16 v[32:47], v[12:15], a[60:63], v[32:47]
    ds_read_b128 v[8:11], v6 offset:10240
    s_waitcnt lgkmcnt(4)
    v_mfma_f32_32x32x16_bf16 v[32:47], v[16:19], a[64:67], v[32:47]
    ds_read_b128 v[12:15], v6 offset:10752
    s_waitcnt lgkmcnt(4)
    v_mfma_f32_32x32x16_bf16 v[32:47], v[20:23], a[68:71], v[32:47]
    ds_read_b128 v[16:19], v6 offset:11264
    s_add_u32 m0, s44, 61440
    s_add_u32 s21, s42, 204800
    buffer_load_dwordx4 v1, s[8:11], s21 offen lds
    s_waitcnt lgkmcnt(4)
    v_mfma_f32_32x32x16_bf16 v[32:47], v[24:27], a[72:75], v[32:47]
    ds_read_b128 v[20:23], v6 offset:11776
    s_waitcnt lgkmcnt(4)
    v_mfma_f32_32x32x16_bf16 v[32:47], v[28:31], a[76:79], v[32:47]
    ds_read_b128 v[24:27], v6 offset:12288
    s_waitcnt lgkmcnt(4)
    v_mfma_f32_32x32x16_bf16 v[32:47], v[8:11], a[80:83], v[32:47]
    ds_read_b128 v[28:31], v6 offset:12800
    s_waitcnt lgkmcnt(4)
    v_mfma_f32_32x32x16_bf16 v[32:47], v[12:15], a[84:87], v[32:47]
    ds_read_b128 v[8:11], v6 offset:13312
    s_add_u32 m0, s44, 62464
    s_add_u32 s21, s42, 205824
    buffer_load_dwordx4 v1, s[8:11], s21 offen lds
    s_waitcnt lgkmcnt(4)
    v_mfma_f32_32x32x16_bf16 v[32:47], v[16:19], a[88:91], v[32:47]
    ds_read_b128 v[12:15], v6 offset:13824
    s_waitcnt lgkmcnt(4)
    v_mfma_f32_32x32x16_bf16 v[32:47], v[20:23], a[92:95], v[32:47]
    s_waitcnt vmcnt(17)
    s_barrier
    ds_read_b128 v[16:19], v4 offset:0
    s_waitcnt lgkmcnt(4)
    v_mfma_f32_32x32x16_bf16 v[32:47], v[24:27], a[96:99], v[32:47]
    ds_read_b128 v[20:23], v4 offset:512
    s_waitcnt lgkmcnt(4)
    v_mfma_f32_32x32x16_bf16 v[32:47], v[28:31], a[100:103], v[32:47]
    ds_read_b128 v[24:27], v4 offset:1024
    s_add_u32 m0, s44, 63488
    s_add_u32 s21, s42, 206848
    buffer_load_dwordx4 v1, s[8:11], s21 offen lds
    s_waitcnt lgkmcnt(4)
    v_mfma_f32_32x32x16_bf16 v[32:47], v[8:11], a[104:107], v[32:47]
    ds_read_b128 v[28:31], v4 offset:1536
    s_waitcnt lgkmcnt(4)
    v_mfma_f32_32x32x16_bf16 v[32:47], v[12:15], a[108:111], v[32:47]
    ds_read_b128 v[8:11], v4 offset:2048
    s_waitcnt lgkmcnt(4)
    v_mfma_f32_32x32x16_bf16 v[48:63], v[16:19], a[0:3], 0
    ds_read_b128 v[12:15], v4 offset:2560
    s_waitcnt lgkmcnt(4)
    v_mfma_f32_32x32x16_bf16 v[48:63], v[20:23], a[4:7], v[48:63]
    ds_read_b128 v[16:19], v4 offset:3072
    s_add_u32 m0, s44, 86016
    s_add_u32 s21, s42, 229376
    buffer_load_dwordx4 v1, s[8:11], s21 offen lds
    s_waitcnt lgkmcnt(4)
    v_mfma_f32_32x32x16_bf16 v[48:63], v[24:27], a[8:11], v[48:63]
    ds_read_b128 v[20:23], v4 offset:3584
    s_waitcnt lgkmcnt(4)
    v_mfma_f32_32x32x16_bf16 v[48:63], v[28:31], a[12:15], v[48:63]
    ds_read_b128 v[24:27], v4 offset:4096
    s_waitcnt lgkmcnt(4)
    v_mfma_f32_32x32x16_bf16 v[48:63], v[8:11], a[16:19], v[48:63]
    ds_read_b128 v[28:31], v4 offset:4608
    s_waitcnt lgkmcnt(4)
    v_mfma_f32_32x32x16_bf16 v[48:63], v[12:15], a[20:23], v[48:63]
    ds_read_b128 v[8:11], v4 offset:5120
    s_add_u32 m0, s44, 87040
    s_add_u32 s21, s42, 230400
    buffer_load_dwordx4 v1, s[8:11], s21 offen lds
    s_waitcnt lgkmcnt(4)
    v_mfma_f32_32x32x16_bf16 v[48:63], v[16:19], a[24:27], v[48:63]
    ds_read_b128 v[12:15], v4 offset:5632
    v_cvt_pk_bf16_f32 v80, v32, v33
    v_cvt_pk_bf16_f32 v81, v36, v37
    s_waitcnt lgkmcnt(4)
    v_mfma_f32_32x32x16_bf16 v[48:63], v[20:23], a[28:31], v[48:63]
    ds_read_b128 v[16:19], v4 offset:6144
    v_cvt_pk_bf16_f32 v82, v34, v35
    v_cvt_pk_bf16_f32 v83, v38, v39
    s_waitcnt lgkmcnt(4)
    v_mfma_f32_32x32x16_bf16 v[48:63], v[24:27], a[32:35], v[48:63]
    ds_read_b128 v[20:23], v4 offset:6656
    v_cvt_pk_bf16_f32 v88, v40, v41
    v_cvt_pk_bf16_f32 v89, v44, v45
    s_waitcnt lgkmcnt(4)
    v_mfma_f32_32x32x16_bf16 v[48:63], v[28:31], a[36:39], v[48:63]
    ds_read_b128 v[24:27], v4 offset:7168
    s_add_u32 m0, s44, 88064
    s_add_u32 s21, s42, 231424
    buffer_load_dwordx4 v1, s[8:11], s21 offen lds
    v_cvt_pk_bf16_f32 v90, v42, v43
    v_cvt_pk_bf16_f32 v91, v46, v47
    s_waitcnt lgkmcnt(4)
    v_mfma_f32_32x32x16_bf16 v[48:63], v[8:11], a[40:43], v[48:63]
    ds_read_b128 v[28:31], v4 offset:7680
    s_add_u32 s23, s47, 4096
    buffer_store_dwordx4 v[80:83], v2, s[8:11], s23 offen sc1
    s_waitcnt lgkmcnt(4)
    v_mfma_f32_32x32x16_bf16 v[48:63], v[12:15], a[44:47], v[48:63]
    ds_read_b128 v[8:11], v4 offset:8192
    v_mfma_f32_32x32x16_bf16 v[64:79], a[32:35], v[80:83], v[64:79]
    s_waitcnt lgkmcnt(4)
    v_mfma_f32_32x32x16_bf16 v[48:63], v[16:19], a[48:51], v[48:63]
    ds_read_b128 v[12:15], v4 offset:8704
    s_add_u32 s23, s47, 4608
    buffer_store_dwordx4 v[88:91], v2, s[8:11], s23 offen sc1
    s_waitcnt lgkmcnt(4)
    v_mfma_f32_32x32x16_bf16 v[48:63], v[20:23], a[52:55], v[48:63]
    ds_read_b128 v[16:19], v4 offset:9216
    s_add_u32 m0, s44, 89088
    s_add_u32 s21, s42, 232448
    buffer_load_dwordx4 v1, s[8:11], s21 offen lds
    v_mfma_f32_32x32x16_bf16 v[64:79], a[36:39], v[88:91], v[64:79]
    s_waitcnt lgkmcnt(4)
    v_mfma_f32_32x32x16_bf16 v[48:63], v[24:27], a[56:59], v[48:63]
    ds_read_b128 v[20:23], v4 offset:9728
    s_waitcnt lgkmcnt(4)
    v_mfma_f32_32x32x16_bf16 v[48:63], v[28:31], a[60:63], v[48:63]
    ds_read_b128 v[24:27], v4 offset:10240
    s_waitcnt lgkmcnt(4)
    v_mfma_f32_32x32x16_bf16 v[48:63], v[8:11], a[64:67], v[48:63]
    ds_read_b128 v[28:31], v4 offset:10752
    s_waitcnt lgkmcnt(4)
    v_mfma_f32_32x32x16_bf16 v[48:63], v[12:15], a[68:71], v[48:63]
    ds_read_b128 v[8:11], v4 offset:11264
    s_add_u32 m0, s44, 90112
    s_add_u32 s21, s42, 233472
    buffer_load_dwordx4 v1, s[8:11], s21 offen lds
    s_waitcnt lgkmcnt(4)
    v_mfma_f32_32x32x16_bf16 v[48:63], v[16:19], a[72:75], v[48:63]
    ds_read_b128 v[12:15], v4 offset:11776
    s_waitcnt lgkmcnt(4)
    v_mfma_f32_32x32x16_bf16 v[48:63], v[20:23], a[76:79], v[48:63]
    ds_read_b128 v[16:19], v4 offset:12288
    s_waitcnt lgkmcnt(4)
    v_mfma_f32_32x32x16_bf16 v[48:63], v[24:27], a[80:83], v[48:63]
    ds_read_b128 v[20:23], v4 offset:12800
    s_waitcnt lgkmcnt(4)
    v_mfma_f32_32x32x16_bf16 v[48:63], v[28:31], a[84:87], v[48:63]
    ds_read_b128 v[24:27], v4 offset:13312
    s_add_u32 m0, s44, 91136
    s_add_u32 s21, s42, 234496
    buffer_load_dwordx4 v1, s[8:11], s21 offen lds
    s_waitcnt lgkmcnt(4)
    v_mfma_f32_32x32x16_bf16 v[48:63], v[8:11], a[88:91], v[48:63]
    ds_read_b128 v[28:31], v4 offset:13824
    s_waitcnt lgkmcnt(4)
    v_mfma_f32_32x32x16_bf16 v[48:63], v[12:15], a[92:95], v[48:63]
    s_waitcnt vmcnt(17)
    s_barrier
    ds_read_b128 v[8:11], v4 offset:28672
    s_waitcnt lgkmcnt(4)
    v_mfma_f32_32x32x16_bf16 v[48:63], v[16:19], a[96:99], v[48:63]
    ds_read_b128 v[12:15], v4 offset:29184
    s_waitcnt lgkmcnt(4)
    v_mfma_f32_32x32x16_bf16 v[48:63], v[20:23], a[100:103], v[48:63]
    ds_read_b128 v[16:19], v4 offset:29696
    s_add_u32 m0, s44, 92160
    s_add_u32 s21, s42, 235520
    buffer_load_dwordx4 v1, s[8:11], s21 offen lds
    s_waitcnt lgkmcnt(4)
    v_mfma_f32_32x32x16_bf16 v[48:63], v[24:27], a[104:107], v[48:63]
    ds_read_b128 v[20:23], v4 offset:30208
    s_waitcnt lgkmcnt(4)
    v_mfma_f32_32x32x16_bf16 v[48:63], v[28:31], a[108:111], v[48:63]
    ds_read_b128 v[24:27], v4 offset:30720
    s_waitcnt lgkmcnt(4)
    v_mfma_f32_32x32x16_bf16 v[32:47], v[8:11], a[0:3], 0
    ds_read_b128 v[28:31], v4 offset:31232
    s_waitcnt lgkmcnt(4)
    v_mfma_f32_32x32x16_bf16 v[32:47], v[12:15], a[4:7], v[32:47]
    ds_read_b128 v[8:11], v4 offset:31744
    s_add_u32 m0, s44, 114688
    s_add_u32 s21, s42, 258048
    buffer_load_dwordx4 v1, s[8:11], s21 offen lds
    s_waitcnt lgkmcnt(4)
    v_mfma_f32_32x32x16_bf16 v[32:47], v[16:19], a[8:11], v[32:47]
    ds_read_b128 v[12:15], v4 offset:32256
    s_waitcnt lgkmcnt(4)
    v_mfma_f32_32x32x16_bf16 v[32:47], v[20:23], a[12:15], v[32:47]
    ds_read_b128 v[16:19], v4 offset:32768
    s_waitcnt lgkmcnt(4)
    v_mfma_f32_32x32x16_bf16 v[32:47], v[24:27], a[16:19], v[32:47]
    ds_read_b128 v[20:23], v4 offset:33280
    s_waitcnt lgkmcnt(4)
    v_mfma_f32_32x32x16_bf16 v[32:47], v[28:31], a[20:23], v[32:47]
    ds_read_b128 v[24:27], v4 offset:33792
    s_add_u32 m0, s44, 115712
    s_add_u32 s21, s42, 259072
    buffer_load_dwordx4 v1, s[8:11], s21 offen lds
    s_waitcnt lgkmcnt(4)
    v_mfma_f32_32x32x16_bf16 v[32:47], v[8:11], a[24:27], v[32:47]
    ds_read_b128 v[28:31], v4 offset:34304
    v_cvt_pk_bf16_f32 v80, v48, v49
    v_cvt_pk_bf16_f32 v81, v52, v53
    s_waitcnt lgkmcnt(4)
    v_mfma_f32_32x32x16_bf16 v[32:47], v[12:15], a[28:31], v[32:47]
    ds_read_b128 v[8:11], v4 offset:34816
    v_cvt_pk_bf16_f32 v82, v50, v51
    v_cvt_pk_bf16_f32 v83, v54, v55
    s_waitcnt lgkmcnt(4)
    v_mfma_f32_32x32x16_bf16 v[32:47], v[16:19], a[32:35], v[32:47]
    ds_read_b128 v[12:15], v4 offset:35328
    v_cvt_pk_bf16_f32 v88, v56, v57
    v_cvt_pk_bf16_f32 v89, v60, v61
    s_waitcnt lgkmcnt(4)
    v_mfma_f32_32x32x16_bf16 v[32:47], v[20:23], a[36:39], v[32:47]
    ds_read_b128 v[16:19], v4 offset:35840
    s_add_u32 m0, s44, 116736
    s_add_u32 s21, s42, 260096
    buffer_load_dwordx4 v1, s[8:11], s21 offen lds
    v_cvt_pk_bf16_f32 v90, v58, v59
    v_cvt_pk_bf16_f32 v91, v62, v63
    s_waitcnt lgkmcnt(4)
    v_mfma_f32_32x32x16_bf16 v[32:47], v[24:27], a[40:43], v[32:47]
    ds_read_b128 v[20:23], v4 offset:36352
    s_add_u32 s23, s47, 5120
    buffer_store_dwordx4 v[80:83], v2, s[8:11], s23 offen sc1
    s_waitcnt lgkmcnt(4)
    v_mfma_f32_32x32x16_bf16 v[32:47], v[28:31], a[44:47], v[32:47]
    ds_read_b128 v[24:27], v4 offset:36864
    v_mfma_f32_32x32x16_bf16 v[64:79], a[40:43], v[80:83], v[64:79]
    s_waitcnt lgkmcnt(4)
    v_mfma_f32_32x32x16_bf16 v[32:47], v[8:11], a[48:51], v[32:47]
    ds_read_b128 v[28:31], v4 offset:37376
    s_add_u32 s23, s47, 5632
    buffer_store_dwordx4 v[88:91], v2, s[8:11], s23 offen sc1
    s_waitcnt lgkmcnt(4)
    v_mfma_f32_32x32x16_bf16 v[32:47], v[12:15], a[52:55], v[32:47]
    ds_read_b128 v[8:11], v4 offset:37888
    s_add_u32 m0, s44, 117760
    s_add_u32 s21, s42, 261120
    buffer_load_dwordx4 v1, s[8:11], s21 offen lds
    v_mfma_f32_32x32x16_bf16 v[64:79], a[44:47], v[88:91], v[64:79]
    s_waitcnt lgkmcnt(4)
    v_mfma_f32_32x32x16_bf16 v[32:47], v[16:19], a[56:59], v[32:47]
    ds_read_b128 v[12:15], v4 offset:38400
    s_waitcnt lgkmcnt(4)
    v_mfma_f32_32x32x16_bf16 v[32:47], v[20:23], a[60:63], v[32:47]
    ds_read_b128 v[16:19], v4 offset:38912
    s_waitcnt lgkmcnt(4)
    v_mfma_f32_32x32x16_bf16 v[32:47], v[24:27], a[64:67], v[32:47]
    ds_read_b128 v[20:23], v4 offset:39424
    s_waitcnt lgkmcnt(4)
    v_mfma_f32_32x32x16_bf16 v[32:47], v[28:31], a[68:71], v[32:47]
    ds_read_b128 v[24:27], v4 offset:39936
    s_add_u32 m0, s44, 118784
    s_add_u32 s21, s42, 262144
    buffer_load_dwordx4 v1, s[8:11], s21 offen lds
    s_waitcnt lgkmcnt(4)
    v_mfma_f32_32x32x16_bf16 v[32:47], v[8:11], a[72:75], v[32:47]
    ds_read_b128 v[28:31], v4 offset:40448
    s_waitcnt lgkmcnt(4)
    v_mfma_f32_32x32x16_bf16 v[32:47], v[12:15], a[76:79], v[32:47]
    ds_read_b128 v[8:11], v4 offset:40960
    s_waitcnt lgkmcnt(4)
    v_mfma_f32_32x32x16_bf16 v[32:47], v[16:19], a[80:83], v[32:47]
    ds_read_b128 v[12:15], v4 offset:41472
    s_waitcnt lgkmcnt(4)
    v_mfma_f32_32x32x16_bf16 v[32:47], v[20:23], a[84:87], v[32:47]
    ds_read_b128 v[16:19], v4 offset:41984
    s_add_u32 m0, s44, 119808
    s_add_u32 s21, s42, 263168
    buffer_load_dwordx4 v1, s[8:11], s21 offen lds
    s_waitcnt lgkmcnt(4)
    v_mfma_f32_32x32x16_bf16 v[32:47], v[24:27], a[88:91], v[32:47]
    ds_read_b128 v[20:23], v4 offset:42496
    s_waitcnt lgkmcnt(4)
    v_mfma_f32_32x32x16_bf16 v[32:47], v[28:31], a[92:95], v[32:47]
    s_waitcnt vmcnt(17)
    s_barrier
    ds_read_b128 v[24:27], v5 offset:0
    s_waitcnt lgkmcnt(4)
    v_mfma_f32_32x32x16_bf16 v[32:47], v[8:11], a[96:99], v[32:47]
    ds_read_b128 v[28:31], v5 offset:512
    s_waitcnt lgkmcnt(4)
    v_mfma_f32_32x32x16_bf16 v[32:47], v[12:15], a[100:103], v[32:47]
    ds_read_b128 v[8:11], v5 offset:1024
    s_add_u32 m0, s44, 120832
    s_add_u32 s21, s42, 264192
    buffer_load_dwordx4 v1, s[8:11], s21 offen lds
    s_waitcnt lgkmcnt(4)
    v_mfma_f32_32x32x16_bf16 v[32:47], v[16:19], a[104:107], v[32:47]
    ds_read_b128 v[12:15], v5 offset:1536
    s_waitcnt lgkmcnt(4)
    v_mfma_f32_32x32x16_bf16 v[32:47], v[20:23], a[108:111], v[32:47]
    ds_read_b128 v[16:19], v5 offset:2048
    s_waitcnt lgkmcnt(4)
    v_mfma_f32_32x32x16_bf16 v[48:63], v[24:27], a[0:3], 0
    ds_read_b128 v[20:23], v5 offset:2560
    s_waitcnt lgkmcnt(4)
    v_mfma_f32_32x32x16_bf16 v[48:63], v[28:31], a[4:7], v[48:63]
    ds_read_b128 v[24:27], v5 offset:3072
    s_add_u32 m0, s44, 0
    s_add_u32 s21, s42, 286720
    buffer_load_dwordx4 v1, s[8:11], s21 offen lds
    s_waitcnt lgkmcnt(4)
    v_mfma_f32_32x32x16_bf16 v[48:63], v[8:11], a[8:11], v[48:63]
    ds_read_b128 v[28:31], v5 offset:3584
    s_waitcnt lgkmcnt(4)
    v_mfma_f32_32x32x16_bf16 v[48:63], v[12:15], a[12:15], v[48:63]
    ds_read_b128 v[8:11], v5 offset:4096
    s_waitcnt lgkmcnt(4)
    v_mfma_f32_32x32x16_bf16 v[48:63], v[16:19], a[16:19], v[48:63]
    ds_read_b128 v[12:15], v5 offset:4608
    s_waitcnt lgkmcnt(4)
    v_mfma_f32_32x32x16_bf16 v[48:63], v[20:23], a[20:23], v[48:63]
    ds_read_b128 v[16:19], v5 offset:5120
    s_add_u32 m0, s44, 1024
    s_add_u32 s21, s42, 287744
    buffer_load_dwordx4 v1, s[8:11], s21 offen lds
    s_waitcnt lgkmcnt(4)
    v_mfma_f32_32x32x16_bf16 v[48:63], v[24:27], a[24:27], v[48:63]
    ds_read_b128 v[20:23], v5 offset:5632
    v_cvt_pk_bf16_f32 v80, v32, v33
    v_cvt_pk_bf16_f32 v81, v36, v37
    s_waitcnt lgkmcnt(4)
    v_mfma_f32_32x32x16_bf16 v[48:63], v[28:31], a[28:31], v[48:63]
    ds_read_b128 v[24:27], v5 offset:6144
    v_cvt_pk_bf16_f32 v82, v34, v35
    v_cvt_pk_bf16_f32 v83, v38, v39
    s_waitcnt lgkmcnt(4)
    v_mfma_f32_32x32x16_bf16 v[48:63], v[8:11], a[32:35], v[48:63]
    ds_read_b128 v[28:31], v5 offset:6656
    v_cvt_pk_bf16_f32 v88, v40, v41
    v_cvt_pk_bf16_f32 v89, v44, v45
    s_waitcnt lgkmcnt(4)
    v_mfma_f32_32x32x16_bf16 v[48:63], v[12:15], a[36:39], v[48:63]
    ds_read_b128 v[8:11], v5 offset:7168
    s_add_u32 m0, s44, 2048
    s_add_u32 s21, s42, 288768
    buffer_load_dwordx4 v1, s[8:11], s21 offen lds
    v_cvt_pk_bf16_f32 v90, v42, v43
    v_cvt_pk_bf16_f32 v91, v46, v47
    s_waitcnt lgkmcnt(4)
    v_mfma_f32_32x32x16_bf16 v[48:63], v[16:19], a[40:43], v[48:63]
    ds_read_b128 v[12:15], v5 offset:7680
    s_add_u32 s23, s47, 6144
    buffer_store_dwordx4 v[80:83], v2, s[8:11], s23 offen sc1
    s_waitcnt lgkmcnt(4)
    v_mfma_f32_32x32x16_bf16 v[48:63], v[20:23], a[44:47], v[48:63]
    ds_read_b128 v[16:19], v5 offset:8192
    v_mfma_f32_32x32x16_bf16 v[64:79], a[48:51], v[80:83], v[64:79]
    s_waitcnt lgkmcnt(4)
    v_mfma_f32_32x32x16_bf16 v[48:63], v[24:27], a[48:51], v[48:63]
    ds_read_b128 v[20:23], v5 offset:8704
    s_add_u32 s23, s47, 6656
    buffer_store_dwordx4 v[88:91], v2, s[8:11], s23 offen sc1
    s_waitcnt lgkmcnt(4)
    v_mfma_f32_32x32x16_bf16 v[48:63], v[28:31], a[52:55], v[48:63]
    ds_read_b128 v[24:27], v5 offset:9216
    s_add_u32 m0, s44, 3072
    s_add_u32 s21, s42, 289792
    buffer_load_dwordx4 v1, s[8:11], s21 offen lds
    v_mfma_f32_32x32x16_bf16 v[64:79], a[52:55], v[88:91], v[64:79]
    s_waitcnt lgkmcnt(4)
    v_mfma_f32_32x32x16_bf16 v[48:63], v[8:11], a[56:59], v[48:63]
    ds_read_b128 v[28:31], v5 offset:9728
    s_waitcnt lgkmcnt(4)
    v_mfma_f32_32x32x16_bf16 v[48:63], v[12:15], a[60:63], v[48:63]
    ds_read_b128 v[8:11], v5 offset:10240
    s_waitcnt lgkmcnt(4)
    v_mfma_f32_32x32x16_bf16 v[48:63], v[16:19], a[64:67], v[48:63]
    ds_read_b128 v[12:15], v5 offset:10752
    s_waitcnt lgkmcnt(4)
    v_mfma_f32_32x32x16_bf16 v[48:63], v[20:23], a[68:71], v[48:63]
    ds_read_b128 v[16:19], v5 offset:11264
    s_add_u32 m0, s44, 4096
    s_add_u32 s21, s42, 290816
    buffer_load_dwordx4 v1, s[8:11], s21 offen lds
    s_waitcnt lgkmcnt(4)
    v_mfma_f32_32x32x16_bf16 v[48:63], v[24:27], a[72:75], v[48:63]
    ds_read_b128 v[20:23], v5 offset:11776
    s_waitcnt lgkmcnt(4)
    v_mfma_f32_32x32x16_bf16 v[48:63], v[28:31], a[76:79], v[48:63]
    ds_read_b128 v[24:27], v5 offset:12288
    s_waitcnt lgkmcnt(4)
    v_mfma_f32_32x32x16_bf16 v[48:63], v[8:11], a[80:83], v[48:63]
    ds_read_b128 v[28:31], v5 offset:12800
    s_waitcnt lgkmcnt(4)
    v_mfma_f32_32x32x16_bf16 v[48:63], v[12:15], a[84:87], v[48:63]
    ds_read_b128 v[8:11], v5 offset:13312
    s_add_u32 m0, s44, 5120
    s_add_u32 s21, s42, 291840
    buffer_load_dwordx4 v1, s[8:11], s21 offen lds
    s_waitcnt lgkmcnt(4)
    v_mfma_f32_32x32x16_bf16 v[48:63], v[16:19], a[88:91], v[48:63]
    ds_read_b128 v[12:15], v5 offset:13824
    s_waitcnt lgkmcnt(4)
    v_mfma_f32_32x32x16_bf16 v[48:63], v[20:23], a[92:95], v[48:63]
    s_waitcnt vmcnt(17)
    s_barrier
    ds_read_b128 v[16:19], v5 offset:28672
    s_waitcnt lgkmcnt(4)
    v_mfma_f32_32x32x16_bf16 v[48:63], v[24:27], a[96:99], v[48:63]
    ds_read_b128 v[20:23], v5 offset:29184
    s_waitcnt lgkmcnt(4)
    v_mfma_f32_32x32x16_bf16 v[48:63], v[28:31], a[100:103], v[48:63]
    ds_read_b128 v[24:27], v5 offset:29696
    s_add_u32 m0, s44, 6144
    s_add_u32 s21, s42, 292864
    buffer_load_dwordx4 v1, s[8:11], s21 offen lds
    s_waitcnt lgkmcnt(4)
    v_mfma_f32_32x32x16_bf16 v[48:63], v[8:11], a[104:107], v[48:63]
    ds_read_b128 v[28:31], v5 offset:30208
    s_waitcnt lgkmcnt(4)
    v_mfma_f32_32x32x16_bf16 v[48:63], v[12:15], a[108:111], v[48:63]
    ds_read_b128 v[8:11], v5 offset:30720
    s_waitcnt lgkmcnt(4)
    v_mfma_f32_32x32x16_bf16 v[32:47], v[16:19], a[0:3], 0
    ds_read_b128 v[12:15], v5 offset:31232
    s_waitcnt lgkmcnt(4)
    v_mfma_f32_32x32x16_bf16 v[32:47], v[20:23], a[4:7], v[32:47]
    ds_read_b128 v[16:19], v5 offset:31744
    s_add_u32 m0, s44, 28672
    s_add_u32 s21, s42, 315392
    buffer_load_dwordx4 v1, s[8:11], s21 offen lds
    s_waitcnt lgkmcnt(4)
    v_mfma_f32_32x32x16_bf16 v[32:47], v[24:27], a[8:11], v[32:47]
    ds_read_b128 v[20:23], v5 offset:32256
    s_waitcnt lgkmcnt(4)
    v_mfma_f32_32x32x16_bf16 v[32:47], v[28:31], a[12:15], v[32:47]
    ds_read_b128 v[24:27], v5 offset:32768
    s_waitcnt lgkmcnt(4)
    v_mfma_f32_32x32x16_bf16 v[32:47], v[8:11], a[16:19], v[32:47]
    ds_read_b128 v[28:31], v5 offset:33280
    s_waitcnt lgkmcnt(4)
    v_mfma_f32_32x32x16_bf16 v[32:47], v[12:15], a[20:23], v[32:47]
    ds_read_b128 v[8:11], v5 offset:33792
    s_add_u32 m0, s44, 29696
    s_add_u32 s21, s42, 316416
    buffer_load_dwordx4 v1, s[8:11], s21 offen lds
    s_waitcnt lgkmcnt(4)
    v_mfma_f32_32x32x16_bf16 v[32:47], v[16:19], a[24:27], v[32:47]
    ds_read_b128 v[12:15], v5 offset:34304
    v_cvt_pk_bf16_f32 v80, v48, v49
    v_cvt_pk_bf16_f32 v81, v52, v53
    s_waitcnt lgkmcnt(4)
    v_mfma_f32_32x32x16_bf16 v[32:47], v[20:23], a[28:31], v[32:47]
    ds_read_b128 v[16:19], v5 offset:34816
    v_cvt_pk_bf16_f32 v82, v50, v51
    v_cvt_pk_bf16_f32 v83, v54, v55
    s_waitcnt lgkmcnt(4)
    v_mfma_f32_32x32x16_bf16 v[32:47], v[24:27], a[32:35], v[32:47]
    ds_read_b128 v[20:23], v5 offset:35328
    v_cvt_pk_bf16_f32 v88, v56, v57
    v_cvt_pk_bf16_f32 v89, v60, v61
    s_waitcnt lgkmcnt(4)
    v_mfma_f32_32x32x16_bf16 v[32:47], v[28:31], a[36:39], v[32:47]
    ds_read_b128 v[24:27], v5 offset:35840
    s_add_u32 m0, s44, 30720
    s_add_u32 s21, s42, 317440
    buffer_load_dwordx4 v1, s[8:11], s21 offen lds
    v_cvt_pk_bf16_f32 v90, v58, v59
    v_cvt_pk_bf16_f32 v91, v62, v63
    s_waitcnt lgkmcnt(4)
    v_mfma_f32_32x32x16_bf16 v[32:47], v[8:11], a[40:43], v[32:47]
    ds_read_b128 v[28:31], v5 offset:36352
    s_add_u32 s23, s47, 7168
    buffer_store_dwordx4 v[80:83], v2, s[8:11], s23 offen sc1
    s_waitcnt lgkmcnt(4)
    v_mfma_f32_32x32x16_bf16 v[32:47], v[12:15], a[44:47], v[32:47]
    ds_read_b128 v[8:11], v5 offset:36864
    v_mfma_f32_32x32x16_bf16 v[64:79], a[56:59], v[80:83], v[64:79]
    s_waitcnt lgkmcnt(4)
    v_mfma_f32_32x32x16_bf16 v[32:47], v[16:19], a[48:51], v[32:47]
    ds_read_b128 v[12:15], v5 offset:37376
    s_add_u32 s23, s47, 7680
    buffer_store_dwordx4 v[88:91], v2, s[8:11], s23 offen sc1
    s_waitcnt lgkmcnt(4)
    v_mfma_f32_32x32x16_bf16 v[32:47], v[20:23], a[52:55], v[32:47]
    ds_read_b128 v[16:19], v5 offset:37888
    s_add_u32 m0, s44, 31744
    s_add_u32 s21, s42, 318464
    buffer_load_dwordx4 v1, s[8:11], s21 offen lds
    v_mfma_f32_32x32x16_bf16 v[64:79], a[60:63], v[88:91], v[64:79]
    s_waitcnt lgkmcnt(4)
    v_mfma_f32_32x32x16_bf16 v[32:47], v[24:27], a[56:59], v[32:47]
    ds_read_b128 v[20:23], v5 offset:38400
    s_waitcnt lgkmcnt(4)
    v_mfma_f32_32x32x16_bf16 v[32:47], v[28:31], a[60:63], v[32:47]
    ds_read_b128 v[24:27], v5 offset:38912
    s_waitcnt lgkmcnt(4)
    v_mfma_f32_32x32x16_bf16 v[32:47], v[8:11], a[64:67], v[32:47]
    ds_read_b128 v[28:31], v5 offset:39424
    s_waitcnt lgkmcnt(4)
    v_mfma_f32_32x32x16_bf16 v[32:47], v[12:15], a[68:71], v[32:47]
    ds_read_b128 v[8:11], v5 offset:39936
    s_add_u32 m0, s44, 32768
    s_add_u32 s21, s42, 319488
    buffer_load_dwordx4 v1, s[8:11], s21 offen lds
    s_waitcnt lgkmcnt(4)
    v_mfma_f32_32x32x16_bf16 v[32:47], v[16:19], a[72:75], v[32:47]
    ds_read_b128 v[12:15], v5 offset:40448
    s_waitcnt lgkmcnt(4)
    v_mfma_f32_32x32x16_bf16 v[32:47], v[20:23], a[76:79], v[32:47]
    ds_read_b128 v[16:19], v5 offset:40960
    s_waitcnt lgkmcnt(4)
    v_mfma_f32_32x32x16_bf16 v[32:47], v[24:27], a[80:83], v[32:47]
    ds_read_b128 v[20:23], v5 offset:41472
    s_waitcnt lgkmcnt(4)
    v_mfma_f32_32x32x16_bf16 v[32:47], v[28:31], a[84:87], v[32:47]
    ds_read_b128 v[24:27], v5 offset:41984
    s_add_u32 m0, s44, 33792
    s_add_u32 s21, s42, 320512
    buffer_load_dwordx4 v1, s[8:11], s21 offen lds
    s_waitcnt lgkmcnt(4)
    v_mfma_f32_32x32x16_bf16 v[32:47], v[8:11], a[88:91], v[32:47]
    ds_read_b128 v[28:31], v5 offset:42496
    s_waitcnt lgkmcnt(4)
    v_mfma_f32_32x32x16_bf16 v[32:47], v[12:15], a[92:95], v[32:47]
    s_waitcnt vmcnt(17)
    s_barrier
    ds_read_b128 v[8:11], v6 offset:0
    s_waitcnt lgkmcnt(4)
    v_mfma_f32_32x32x16_bf16 v[32:47], v[16:19], a[96:99], v[32:47]
    ds_read_b128 v[12:15], v6 offset:512
    s_waitcnt lgkmcnt(4)
    v_mfma_f32_32x32x16_bf16 v[32:47], v[20:23], a[100:103], v[32:47]
    ds_read_b128 v[16:19], v6 offset:1024
    s_add_u32 m0, s44, 34816
    s_add_u32 s21, s42, 321536
    buffer_load_dwordx4 v1, s[8:11], s21 offen lds
    s_waitcnt lgkmcnt(4)
    v_mfma_f32_32x32x16_bf16 v[32:47], v[24:27], a[104:107], v[32:47]
    ds_read_b128 v[20:23], v6 offset:1536
    s_waitcnt lgkmcnt(4)
    v_mfma_f32_32x32x16_bf16 v[32:47], v[28:31], a[108:111], v[32:47]
    ds_read_b128 v[24:27], v6 offset:2048
    s_waitcnt lgkmcnt(4)
    v_mfma_f32_32x32x16_bf16 v[48:63], v[8:11], a[0:3], 0
    ds_read_b128 v[28:31], v6 offset:2560
    s_waitcnt lgkmcnt(4)
    v_mfma_f32_32x32x16_bf16 v[48:63], v[12:15], a[4:7], v[48:63]
    ds_read_b128 v[8:11], v6 offset:3072
    s_add_u32 m0, s44, 57344
    s_add_u32 s21, s42, 344064
    buffer_load_dwordx4 v1, s[8:11], s21 offen lds
    s_waitcnt lgkmcnt(4)
    v_mfma_f32_32x32x16_bf16 v[48:63], v[16:19], a[8:11], v[48:63]
    ds_read_b128 v[12:15], v6 offset:3584
    s_waitcnt lgkmcnt(4)
    v_mfma_f32_32x32x16_bf16 v[48:63], v[20:23], a[12:15], v[48:63]
    ds_read_b128 v[16:19], v6 offset:4096
    s_waitcnt lgkmcnt(4)
    v_mfma_f32_32x32x16_bf16 v[48:63], v[24:27], a[16:19], v[48:63]
    ds_read_b128 v[20:23], v6 offset:4608
    s_waitcnt lgkmcnt(4)
    v_mfma_f32_32x32x16_bf16 v[48:63], v[28:31], a[20:23], v[48:63]
    ds_read_b128 v[24:27], v6 offset:5120
    s_add_u32 m0, s44, 58368
    s_add_u32 s21, s42, 345088
    buffer_load_dwordx4 v1, s[8:11], s21 offen lds
    s_waitcnt lgkmcnt(4)
    v_mfma_f32_32x32x16_bf16 v[48:63], v[8:11], a[24:27], v[48:63]
    ds_read_b128 v[28:31], v6 offset:5632
    v_cvt_pk_bf16_f32 v80, v32, v33
    v_cvt_pk_bf16_f32 v81, v36, v37
    s_waitcnt lgkmcnt(4)
    v_mfma_f32_32x32x16_bf16 v[48:63], v[12:15], a[28:31], v[48:63]
    ds_read_b128 v[8:11], v6 offset:6144
    v_cvt_pk_bf16_f32 v82, v34, v35
    v_cvt_pk_bf16_f32 v83, v38, v39
    s_waitcnt lgkmcnt(4)
    v_mfma_f32_32x32x16_bf16 v[48:63], v[16:19], a[32:35], v[48:63]
    ds_read_b128 v[12:15], v6 offset:6656
    v_cvt_pk_bf16_f32 v88, v40, v41
    v_cvt_pk_bf16_f32 v89, v44, v45
    s_waitcnt lgkmcnt(4)
    v_mfma_f32_32x32x16_bf16 v[48:63], v[20:23], a[36:39], v[48:63]
    ds_read_b128 v[16:19], v6 offset:7168
    s_add_u32 m0, s44, 59392
    s_add_u32 s21, s42, 346112
    buffer_load_dwordx4 v1, s[8:11], s21 offen lds
    v_cvt_pk_bf16_f32 v90, v42, v43
    v_cvt_pk_bf16_f32 v91, v46, v47
    s_waitcnt lgkmcnt(4)
    v_mfma_f32_32x32x16_bf16 v[48:63], v[24:27], a[40:43], v[48:63]
    ds_read_b128 v[20:23], v6 offset:7680
    s_add_u32 s23, s47, 8192
    buffer_store_dwordx4 v[80:83], v2, s[8:11], s23 offen sc1
    s_waitcnt lgkmcnt(4)
    v_mfma_f32_32x32x16_bf16 v[48:63], v[28:31], a[44:47], v[48:63]
    ds_read_b128 v[24:27], v6 offset:8192
    v_mfma_f32_32x32x16_bf16 v[64:79], a[64:67], v[80:83], v[64:79]
    s_waitcnt lgkmcnt(4)
    v_mfma_f32_32x32x16_bf16 v[48:63], v[8:11], a[48:51], v[48:63]
    ds_read_b128 v[28:31], v6 offset:8704
    s_add_u32 s23, s47, 8704
    buffer_store_dwordx4 v[88:91], v2, s[8:11], s23 offen sc1
    s_waitcnt lgkmcnt(4)
    v_mfma_f32_32x32x16_bf16 v[48:63], v[12:15], a[52:55], v[48:63]
    ds_read_b128 v[8:11], v6 offset:9216
    s_add_u32 m0, s44, 60416
    s_add_u32 s21, s42, 347136
    buffer_load_dwordx4 v1, s[8:11], s21 offen lds
    v_mfma_f32_32x32x16_bf16 v[64:79], a[68:71], v[88:91], v[64:79]
    s_waitcnt lgkmcnt(4)
    v_mfma_f32_32x32x16_bf16 v[48:63], v[16:19], a[56:59], v[48:63]
    ds_read_b128 v[12:15], v6 offset:9728
    s_waitcnt lgkmcnt(4)
    v_mfma_f32_32x32x16_bf16 v[48:63], v[20:23], a[60:63], v[48:63]
    ds_read_b128 v[16:19], v6 offset:10240
    s_waitcnt lgkmcnt(4)
    v_mfma_f32_32x32x16_bf16 v[48:63], v[24:27], a[64:67], v[48:63]
    ds_read_b128 v[20:23], v6 offset:10752
    s_waitcnt lgkmcnt(4)
    v_mfma_f32_32x32x16_bf16 v[48:63], v[28:31], a[68:71], v[48:63]
    ds_read_b128 v[24:27], v6 offset:11264
    s_add_u32 m0, s44, 61440
    s_add_u32 s21, s42, 348160
    buffer_load_dwordx4 v1, s[8:11], s21 offen lds
    s_waitcnt lgkmcnt(4)
    v_mfma_f32_32x32x16_bf16 v[48:63], v[8:11], a[72:75], v[48:63]
    ds_read_b128 v[28:31], v6 offset:11776
    s_waitcnt lgkmcnt(4)
    v_mfma_f32_32x32x16_bf16 v[48:63], v[12:15], a[76:79], v[48:63]
    ds_read_b128 v[8:11], v6 offset:12288
    s_waitcnt lgkmcnt(4)
    v_mfma_f32_32x32x16_bf16 v[48:63], v[16:19], a[80:83], v[48:63]
    ds_read_b128 v[12:15], v6 offset:12800
    s_waitcnt lgkmcnt(4)
    v_mfma_f32_32x32x16_bf16 v[48:63], v[20:23], a[84:87], v[48:63]
    ds_read_b128 v[16:19], v6 offset:13312
    s_add_u32 m0, s44, 62464
    s_add_u32 s21, s42, 349184
    buffer_load_dwordx4 v1, s[8:11], s21 offen lds
    s_waitcnt lgkmcnt(4)
    v_mfma_f32_32x32x16_bf16 v[48:63], v[24:27], a[88:91], v[48:63]
    ds_read_b128 v[20:23], v6 offset:13824
    s_waitcnt lgkmcnt(4)
    v_mfma_f32_32x32x16_bf16 v[48:63], v[28:31], a[92:95], v[48:63]
    s_waitcnt vmcnt(17)
    s_barrier
    ds_read_b128 v[24:27], v4 offset:0
    s_waitcnt lgkmcnt(4)
    v_mfma_f32_32x32x16_bf16 v[48:63], v[8:11], a[96:99], v[48:63]
    ds_read_b128 v[28:31], v4 offset:512
    s_waitcnt lgkmcnt(4)
    v_mfma_f32_32x32x16_bf16 v[48:63], v[12:15], a[100:103], v[48:63]
    ds_read_b128 v[8:11], v4 offset:1024
    s_add_u32 m0, s44, 63488
    s_add_u32 s21, s42, 350208
    buffer_load_dwordx4 v1, s[8:11], s21 offen lds
    s_waitcnt lgkmcnt(4)
    v_mfma_f32_32x32x16_bf16 v[48:63], v[16:19], a[104:107], v[48:63]
    ds_read_b128 v[12:15], v4 offset:1536
    s_waitcnt lgkmcnt(4)
    v_mfma_f32_32x32x16_bf16 v[48:63], v[20:23], a[108:111], v[48:63]
    ds_read_b128 v[16:19], v4 offset:2048
    s_waitcnt lgkmcnt(4)
    v_mfma_f32_32x32x16_bf16 v[32:47], v[24:27], a[0:3], 0
    ds_read_b128 v[20:23], v4 offset:2560
    s_waitcnt lgkmcnt(4)
    v_mfma_f32_32x32x16_bf16 v[32:47], v[28:31], a[4:7], v[32:47]
    ds_read_b128 v[24:27], v4 offset:3072
    s_add_u32 m0, s44, 86016
    s_add_u32 s21, s42, 372736
    buffer_load_dwordx4 v1, s[8:11], s21 offen lds
    s_waitcnt lgkmcnt(4)
    v_mfma_f32_32x32x16_bf16 v[32:47], v[8:11], a[8:11], v[32:47]
    ds_read_b128 v[28:31], v4 offset:3584
    s_waitcnt lgkmcnt(4)
    v_mfma_f32_32x32x16_bf16 v[32:47], v[12:15], a[12:15], v[32:47]
    ds_read_b128 v[8:11], v4 offset:4096
    s_waitcnt lgkmcnt(4)
    v_mfma_f32_32x32x16_bf16 v[32:47], v[16:19], a[16:19], v[32:47]
    ds_read_b128 v[12:15], v4 offset:4608
    s_waitcnt lgkmcnt(4)
    v_mfma_f32_32x32x16_bf16 v[32:47], v[20:23], a[20:23], v[32:47]
    ds_read_b128 v[16:19], v4 offset:5120
    s_add_u32 m0, s44, 87040
    s_add_u32 s21, s42, 373760
    buffer_load_dwordx4 v1, s[8:11], s21 offen lds
    s_waitcnt lgkmcnt(4)
    v_mfma_f32_32x32x16_bf16 v[32:47], v[24:27], a[24:27], v[32:47]
    ds_read_b128 v[20:23], v4 offset:5632
    v_cvt_pk_bf16_f32 v80, v48, v49
    v_cvt_pk_bf16_f32 v81, v52, v53
    s_waitcnt lgkmcnt(4)
    v_mfma_f32_32x32x16_bf16 v[32:47], v[28:31], a[28:31], v[32:47]
    ds_read_b128 v[24:27], v4 offset:6144
    v_cvt_pk_bf16_f32 v82, v50, v51
    v_cvt_pk_bf16_f32 v83, v54, v55
    s_waitcnt lgkmcnt(4)
    v_mfma_f32_32x32x16_bf16 v[32:47], v[8:11], a[32:35], v[32:47]
    ds_read_b128 v[28:31], v4 offset:6656
    v_cvt_pk_bf16_f32 v88, v56, v57
    v_cvt_pk_bf16_f32 v89, v60, v61
    s_waitcnt lgkmcnt(4)
    v_mfma_f32_32x32x16_bf16 v[32:47], v[12:15], a[36:39], v[32:47]
    ds_read_b128 v[8:11], v4 offset:7168
    s_add_u32 m0, s44, 88064
    s_add_u32 s21, s42, 374784
    buffer_load_dwordx4 v1, s[8:11], s21 offen lds
    v_cvt_pk_bf16_f32 v90, v58, v59
    v_cvt_pk_bf16_f32 v91, v62, v63
    s_waitcnt lgkmcnt(4)
    v_mfma_f32_32x32x16_bf16 v[32:47], v[16:19], a[40:43], v[32:47]
    ds_read_b128 v[12:15], v4 offset:7680
    s_add_u32 s23, s47, 9216
    buffer_store_dwordx4 v[80:83], v2, s[8:11], s23 offen sc1
    s_waitcnt lgkmcnt(4)
    v_mfma_f32_32x32x16_bf16 v[32:47], v[20:23], a[44:47], v[32:47]
    ds_read_b128 v[16:19], v4 offset:8192
    v_mfma_f32_32x32x16_bf16 v[64:79], a[72:75], v[80:83], v[64:79]
    s_waitcnt lgkmcnt(4)
    v_mfma_f32_32x32x16_bf16 v[32:47], v[24:27], a[48:51], v[32:47]
    ds_read_b128 v[20:23], v4 offset:8704
    s_add_u32 s23, s47, 9728
    buffer_store_dwordx4 v[88:91], v2, s[8:11], s23 offen sc1
    s_waitcnt lgkmcnt(4)
    v_mfma_f32_32x32x16_bf16 v[32:47], v[28:31], a[52:55], v[32:47]
    ds_read_b128 v[24:27], v4 offset:9216
    s_add_u32 m0, s44, 89088
    s_add_u32 s21, s42, 375808
    buffer_load_dwordx4 v1, s[8:11], s21 offen lds
    v_mfma_f32_32x32x16_bf16 v[64:79], a[76:79], v[88:91], v[64:79]
    s_waitcnt lgkmcnt(4)
    v_mfma_f32_32x32x16_bf16 v[32:47], v[8:11], a[56:59], v[32:47]
    ds_read_b128 v[28:31], v4 offset:9728
    s_waitcnt lgkmcnt(4)
    v_mfma_f32_32x32x16_bf16 v[32:47], v[12:15], a[60:63], v[32:47]
    ds_read_b128 v[8:11], v4 offset:10240
    s_waitcnt lgkmcnt(4)
    v_mfma_f32_32x32x16_bf16 v[32:47], v[16:19], a[64:67], v[32:47]
    ds_read_b128 v[12:15], v4 offset:10752
    s_waitcnt lgkmcnt(4)
    v_mfma_f32_32x32x16_bf16 v[32:47], v[20:23], a[68:71], v[32:47]
    ds_read_b128 v[16:19], v4 offset:11264
    s_add_u32 m0, s44, 90112
    s_add_u32 s21, s42, 376832
    buffer_load_dwordx4 v1, s[8:11], s21 offen lds
    s_waitcnt lgkmcnt(4)
    v_mfma_f32_32x32x16_bf16 v[32:47], v[24:27], a[72:75], v[32:47]
    ds_read_b128 v[20:23], v4 offset:11776
    s_waitcnt lgkmcnt(4)
    v_mfma_f32_32x32x16_bf16 v[32:47], v[28:31], a[76:79], v[32:47]
    ds_read_b128 v[24:27], v4 offset:12288
    s_waitcnt lgkmcnt(4)
    v_mfma_f32_32x32x16_bf16 v[32:47], v[8:11], a[80:83], v[32:47]
    ds_read_b128 v[28:31], v4 offset:12800
    s_waitcnt lgkmcnt(4)
    v_mfma_f32_32x32x16_bf16 v[32:47], v[12:15], a[84:87], v[32:47]
    ds_read_b128 v[8:11], v4 offset:13312
    s_add_u32 m0, s44, 91136
    s_add_u32 s21, s42, 377856
    buffer_load_dwordx4 v1, s[8:11], s21 offen lds
    s_waitcnt lgkmcnt(4)
    v_mfma_f32_32x32x16_bf16 v[32:47], v[16:19], a[88:91], v[32:47]
    ds_read_b128 v[12:15], v4 offset:13824
    s_waitcnt lgkmcnt(4)
    v_mfma_f32_32x32x16_bf16 v[32:47], v[20:23], a[92:95], v[32:47]
    s_waitcnt vmcnt(17)
    s_barrier
    ds_read_b128 v[16:19], v4 offset:28672
    s_waitcnt lgkmcnt(4)
    v_mfma_f32_32x32x16_bf16 v[32:47], v[24:27], a[96:99], v[32:47]
    ds_read_b128 v[20:23], v4 offset:29184
    s_waitcnt lgkmcnt(4)
    v_mfma_f32_32x32x16_bf16 v[32:47], v[28:31], a[100:103], v[32:47]
    ds_read_b128 v[24:27], v4 offset:29696
    s_add_u32 m0, s44, 92160
    s_add_u32 s21, s42, 378880
    buffer_load_dwordx4 v1, s[8:11], s21 offen lds
    s_waitcnt lgkmcnt(4)
    v_mfma_f32_32x32x16_bf16 v[32:47], v[8:11], a[104:107], v[32:47]
    ds_read_b128 v[28:31], v4 offset:30208
    s_waitcnt lgkmcnt(4)
    v_mfma_f32_32x32x16_bf16 v[32:47], v[12:15], a[108:111], v[32:47]
    ds_read_b128 v[8:11], v4 offset:30720
    s_waitcnt lgkmcnt(4)
    v_mfma_f32_32x32x16_bf16 v[48:63], v[16:19], a[0:3], 0
    ds_read_b128 v[12:15], v4 offset:31232
    s_waitcnt lgkmcnt(4)
    v_mfma_f32_32x32x16_bf16 v[48:63], v[20:23], a[4:7], v[48:63]
    ds_read_b128 v[16:19], v4 offset:31744
    s_add_u32 m0, s44, 114688
    s_add_u32 s21, s42, 372736
    buffer_load_dwordx4 v1, s[8:11], s21 offen lds
    s_waitcnt lgkmcnt(4)
    v_mfma_f32_32x32x16_bf16 v[48:63], v[24:27], a[8:11], v[48:63]
    ds_read_b128 v[20:23], v4 offset:32256
    s_waitcnt lgkmcnt(4)
    v_mfma_f32_32x32x16_bf16 v[48:63], v[28:31], a[12:15], v[48:63]
    ds_read_b128 v[24:27], v4 offset:32768
    s_waitcnt lgkmcnt(4)
    v_mfma_f32_32x32x16_bf16 v[48:63], v[8:11], a[16:19], v[48:63]
    ds_read_b128 v[28:31], v4 offset:33280
    s_waitcnt lgkmcnt(4)
    v_mfma_f32_32x32x16_bf16 v[48:63], v[12:15], a[20:23], v[48:63]
    ds_read_b128 v[8:11], v4 offset:33792
    s_add_u32 m0, s44, 115712
    s_add_u32 s21, s42, 373760
    buffer_load_dwordx4 v1, s[8:11], s21 offen lds
    s_waitcnt lgkmcnt(4)
    v_mfma_f32_32x32x16_bf16 v[48:63], v[16:19], a[24:27], v[48:63]
    ds_read_b128 v[12:15], v4 offset:34304
    v_cvt_pk_bf16_f32 v80, v32, v33
    v_cvt_pk_bf16_f32 v81, v36, v37
    s_waitcnt lgkmcnt(4)
    v_mfma_f32_32x32x16_bf16 v[48:63], v[20:23], a[28:31], v[48:63]
    ds_read_b128 v[16:19], v4 offset:34816
    v_cvt_pk_bf16_f32 v82, v34, v35
    v_cvt_pk_bf16_f32 v83, v38, v39
    s_waitcnt lgkmcnt(4)
    v_mfma_f32_32x32x16_bf16 v[48:63], v[24:27], a[32:35], v[48:63]
    ds_read_b128 v[20:23], v4 offset:35328
    v_cvt_pk_bf16_f32 v88, v40, v41
    v_cvt_pk_bf16_f32 v89, v44, v45
    s_waitcnt lgkmcnt(4)
    v_mfma_f32_32x32x16_bf16 v[48:63], v[28:31], a[36:39], v[48:63]
    ds_read_b128 v[24:27], v4 offset:35840
    s_add_u32 m0, s44, 116736
    s_add_u32 s21, s42, 374784
    buffer_load_dwordx4 v1, s[8:11], s21 offen lds
    v_cvt_pk_bf16_f32 v90, v42, v43
    v_cvt_pk_bf16_f32 v91, v46, v47
    s_waitcnt lgkmcnt(4)
    v_mfma_f32_32x32x16_bf16 v[48:63], v[8:11], a[40:43], v[48:63]
    ds_read_b128 v[28:31], v4 offset:36352
    s_add_u32 s23, s47, 10240
    buffer_store_dwordx4 v[80:83], v2, s[8:11], s23 offen sc1
    s_waitcnt lgkmcnt(4)
    v_mfma_f32_32x32x16_bf16 v[48:63], v[12:15], a[44:47], v[48:63]
    ds_read_b128 v[8:11], v4 offset:36864
    v_mfma_f32_32x32x16_bf16 v[64:79], a[80:83], v[80:83], v[64:79]
    s_waitcnt lgkmcnt(4)
    v_mfma_f32_32x32x16_bf16 v[48:63], v[16:19], a[48:51], v[48:63]
    ds_read_b128 v[12:15], v4 offset:37376
    s_add_u32 s23, s47, 10752
    buffer_store_dwordx4 v[88:91], v2, s[8:11], s23 offen sc1
    s_waitcnt lgkmcnt(4)
    v_mfma_f32_32x32x16_bf16 v[48:63], v[20:23], a[52:55], v[48:63]
    ds_read_b128 v[16:19], v4 offset:37888
    s_add_u32 m0, s44, 117760
    s_add_u32 s21, s42, 375808
    buffer_load_dwordx4 v1, s[8:11], s21 offen lds
    v_mfma_f32_32x32x16_bf16 v[64:79], a[84:87], v[88:91], v[64:79]
    s_waitcnt lgkmcnt(4)
    v_mfma_f32_32x32x16_bf16 v[48:63], v[24:27], a[56:59], v[48:63]
    ds_read_b128 v[20:23], v4 offset:38400
    s_waitcnt lgkmcnt(4)
    v_mfma_f32_32x32x16_bf16 v[48:63], v[28:31], a[60:63], v[48:63]
    ds_read_b128 v[24:27], v4 offset:38912
    s_waitcnt lgkmcnt(4)
    v_mfma_f32_32x32x16_bf16 v[48:63], v[8:11], a[64:67], v[48:63]
    ds_read_b128 v[28:31], v4 offset:39424
    s_waitcnt lgkmcnt(4)
    v_mfma_f32_32x32x16_bf16 v[48:63], v[12:15], a[68:71], v[48:63]
    ds_read_b128 v[8:11], v4 offset:39936
    s_add_u32 m0, s44, 118784
    s_add_u32 s21, s42, 376832
    buffer_load_dwordx4 v1, s[8:11], s21 offen lds
    s_waitcnt lgkmcnt(4)
    v_mfma_f32_32x32x16_bf16 v[48:63], v[16:19], a[72:75], v[48:63]
    ds_read_b128 v[12:15], v4 offset:40448
    s_waitcnt lgkmcnt(4)
    v_mfma_f32_32x32x16_bf16 v[48:63], v[20:23], a[76:79], v[48:63]
    ds_read_b128 v[16:19], v4 offset:40960
    s_waitcnt lgkmcnt(4)
    v_mfma_f32_32x32x16_bf16 v[48:63], v[24:27], a[80:83], v[48:63]
    ds_read_b128 v[20:23], v4 offset:41472
    s_waitcnt lgkmcnt(4)
    v_mfma_f32_32x32x16_bf16 v[48:63], v[28:31], a[84:87], v[48:63]
    ds_read_b128 v[24:27], v4 offset:41984
    s_add_u32 m0, s44, 119808
    s_add_u32 s21, s42, 377856
    buffer_load_dwordx4 v1, s[8:11], s21 offen lds
    s_waitcnt lgkmcnt(4)
    v_mfma_f32_32x32x16_bf16 v[48:63], v[8:11], a[88:91], v[48:63]
    ds_read_b128 v[28:31], v4 offset:42496
    s_waitcnt lgkmcnt(4)
    v_mfma_f32_32x32x16_bf16 v[48:63], v[12:15], a[92:95], v[48:63]
    s_waitcnt vmcnt(17)
    s_barrier
    ds_read_b128 v[8:11], v5 offset:0
    s_waitcnt lgkmcnt(4)
    v_mfma_f32_32x32x16_bf16 v[48:63], v[16:19], a[96:99], v[48:63]
    ds_read_b128 v[12:15], v5 offset:512
    s_waitcnt lgkmcnt(4)
    v_mfma_f32_32x32x16_bf16 v[48:63], v[20:23], a[100:103], v[48:63]
    ds_read_b128 v[16:19], v5 offset:1024
    s_add_u32 m0, s44, 120832
    s_add_u32 s21, s42, 378880
    buffer_load_dwordx4 v1, s[8:11], s21 offen lds
    s_waitcnt lgkmcnt(4)
    v_mfma_f32_32x32x16_bf16 v[48:63], v[24:27], a[104:107], v[48:63]
    ds_read_b128 v[20:23], v5 offset:1536
    s_waitcnt lgkmcnt(4)
    v_mfma_f32_32x32x16_bf16 v[48:63], v[28:31], a[108:111], v[48:63]
    ds_read_b128 v[24:27], v5 offset:2048
    s_waitcnt lgkmcnt(4)
    v_mfma_f32_32x32x16_bf16 v[32:47], v[8:11], a[0:3], 0
    ds_read_b128 v[28:31], v5 offset:2560
    s_waitcnt lgkmcnt(4)
    v_mfma_f32_32x32x16_bf16 v[32:47], v[12:15], a[4:7], v[32:47]
    ds_read_b128 v[8:11], v5 offset:3072
    s_add_u32 m0, s44, 0
    s_add_u32 s21, s42, 372736
    buffer_load_dwordx4 v1, s[8:11], s21 offen lds
    s_waitcnt lgkmcnt(4)
    v_mfma_f32_32x32x16_bf16 v[32:47], v[16:19], a[8:11], v[32:47]
    ds_read_b128 v[12:15], v5 offset:3584
    s_waitcnt lgkmcnt(4)
    v_mfma_f32_32x32x16_bf16 v[32:47], v[20:23], a[12:15], v[32:47]
    ds_read_b128 v[16:19], v5 offset:4096
    s_waitcnt lgkmcnt(4)
    v_mfma_f32_32x32x16_bf16 v[32:47], v[24:27], a[16:19], v[32:47]
    ds_read_b128 v[20:23], v5 offset:4608
    s_waitcnt lgkmcnt(4)
    v_mfma_f32_32x32x16_bf16 v[32:47], v[28:31], a[20:23], v[32:47]
    ds_read_b128 v[24:27], v5 offset:5120
    s_add_u32 m0, s44, 1024
    s_add_u32 s21, s42, 373760
    buffer_load_dwordx4 v1, s[8:11], s21 offen lds
    s_waitcnt lgkmcnt(4)
    v_mfma_f32_32x32x16_bf16 v[32:47], v[8:11], a[24:27], v[32:47]
    ds_read_b128 v[28:31], v5 offset:5632
    v_cvt_pk_bf16_f32 v80, v48, v49
    v_cvt_pk_bf16_f32 v81, v52, v53
    s_waitcnt lgkmcnt(4)
    v_mfma_f32_32x32x16_bf16 v[32:47], v[12:15], a[28:31], v[32:47]
    ds_read_b128 v[8:11], v5 offset:6144
    v_cvt_pk_bf16_f32 v82, v50, v51
    v_cvt_pk_bf16_f32 v83, v54, v55
    s_waitcnt lgkmcnt(4)
    v_mfma_f32_32x32x16_bf16 v[32:47], v[16:19], a[32:35], v[32:47]
    ds_read_b128 v[12:15], v5 offset:6656
    v_cvt_pk_bf16_f32 v88, v56, v57
    v_cvt_pk_bf16_f32 v89, v60, v61
    s_waitcnt lgkmcnt(4)
    v_mfma_f32_32x32x16_bf16 v[32:47], v[20:23], a[36:39], v[32:47]
    ds_read_b128 v[16:19], v5 offset:7168
    s_add_u32 m0, s44, 2048
    s_add_u32 s21, s42, 374784
    buffer_load_dwordx4 v1, s[8:11], s21 offen lds
    v_cvt_pk_bf16_f32 v90, v58, v59
    v_cvt_pk_bf16_f32 v91, v62, v63
    s_waitcnt lgkmcnt(4)
    v_mfma_f32_32x32x16_bf16 v[32:47], v[24:27], a[40:43], v[32:47]
    ds_read_b128 v[20:23], v5 offset:7680
    s_add_u32 s23, s47, 11264
    buffer_store_dwordx4 v[80:83], v2, s[8:11], s23 offen sc1
    s_waitcnt lgkmcnt(4)
    v_mfma_f32_32x32x16_bf16 v[32:47], v[28:31], a[44:47], v[32:47]
    ds_read_b128 v[24:27], v5 offset:8192
    v_mfma_f32_32x32x16_bf16 v[64:79], a[88:91], v[80:83], v[64:79]
    s_waitcnt lgkmcnt(4)
    v_mfma_f32_32x32x16_bf16 v[32:47], v[8:11], a[48:51], v[32:47]
    ds_read_b128 v[28:31], v5 offset:8704
    s_add_u32 s23, s47, 11776
    buffer_store_dwordx4 v[88:91], v2, s[8:11], s23 offen sc1
    s_waitcnt lgkmcnt(4)
    v_mfma_f32_32x32x16_bf16 v[32:47], v[12:15], a[52:55], v[32:47]
    ds_read_b128 v[8:11], v5 offset:9216
    s_add_u32 m0, s44, 3072
    s_add_u32 s21, s42, 375808
    buffer_load_dwordx4 v1, s[8:11], s21 offen lds
    v_mfma_f32_32x32x16_bf16 v[64:79], a[92:95], v[88:91], v[64:79]
    s_waitcnt lgkmcnt(4)
    v_mfma_f32_32x32x16_bf16 v[32:47], v[16:19], a[56:59], v[32:47]
    ds_read_b128 v[12:15], v5 offset:9728
    s_waitcnt lgkmcnt(4)
    v_mfma_f32_32x32x16_bf16 v[32:47], v[20:23], a[60:63], v[32:47]
    ds_read_b128 v[16:19], v5 offset:10240
    s_waitcnt lgkmcnt(4)
    v_mfma_f32_32x32x16_bf16 v[32:47], v[24:27], a[64:67], v[32:47]
    ds_read_b128 v[20:23], v5 offset:10752
    s_waitcnt lgkmcnt(4)
    v_mfma_f32_32x32x16_bf16 v[32:47], v[28:31], a[68:71], v[32:47]
    ds_read_b128 v[24:27], v5 offset:11264
    s_add_u32 m0, s44, 4096
    s_add_u32 s21, s42, 376832
    buffer_load_dwordx4 v1, s[8:11], s21 offen lds
    s_waitcnt lgkmcnt(4)
    v_mfma_f32_32x32x16_bf16 v[32:47], v[8:11], a[72:75], v[32:47]
    ds_read_b128 v[28:31], v5 offset:11776
    s_waitcnt lgkmcnt(4)
    v_mfma_f32_32x32x16_bf16 v[32:47], v[12:15], a[76:79], v[32:47]
    ds_read_b128 v[8:11], v5 offset:12288
    s_waitcnt lgkmcnt(4)
    v_mfma_f32_32x32x16_bf16 v[32:47], v[16:19], a[80:83], v[32:47]
    ds_read_b128 v[12:15], v5 offset:12800
    s_waitcnt lgkmcnt(4)
    v_mfma_f32_32x32x16_bf16 v[32:47], v[20:23], a[84:87], v[32:47]
    ds_read_b128 v[16:19], v5 offset:13312
    s_add_u32 m0, s44, 5120
    s_add_u32 s21, s42, 377856
    buffer_load_dwordx4 v1, s[8:11], s21 offen lds
    s_waitcnt lgkmcnt(4)
    v_mfma_f32_32x32x16_bf16 v[32:47], v[24:27], a[88:91], v[32:47]
    ds_read_b128 v[20:23], v5 offset:13824
    s_waitcnt lgkmcnt(4)
    v_mfma_f32_32x32x16_bf16 v[32:47], v[28:31], a[92:95], v[32:47]
    s_waitcnt vmcnt(17)
    s_barrier
    ds_read_b128 v[24:27], v5 offset:28672
    s_waitcnt lgkmcnt(4)
    v_mfma_f32_32x32x16_bf16 v[32:47], v[8:11], a[96:99], v[32:47]
    ds_read_b128 v[28:31], v5 offset:29184
    s_waitcnt lgkmcnt(4)
    v_mfma_f32_32x32x16_bf16 v[32:47], v[12:15], a[100:103], v[32:47]
    ds_read_b128 v[8:11], v5 offset:29696
    s_add_u32 m0, s44, 6144
    s_add_u32 s21, s42, 378880
    buffer_load_dwordx4 v1, s[8:11], s21 offen lds
    s_waitcnt lgkmcnt(4)
    v_mfma_f32_32x32x16_bf16 v[32:47], v[16:19], a[104:107], v[32:47]
    ds_read_b128 v[12:15], v5 offset:30208
    s_waitcnt lgkmcnt(4)
    v_mfma_f32_32x32x16_bf16 v[32:47], v[20:23], a[108:111], v[32:47]
    ds_read_b128 v[16:19], v5 offset:30720
    s_waitcnt lgkmcnt(4)
    v_mfma_f32_32x32x16_bf16 v[48:63], v[24:27], a[0:3], 0
    ds_read_b128 v[20:23], v5 offset:31232
    s_waitcnt lgkmcnt(4)
    v_mfma_f32_32x32x16_bf16 v[48:63], v[28:31], a[4:7], v[48:63]
    ds_read_b128 v[24:27], v5 offset:31744
    s_add_u32 m0, s44, 28672
    s_add_u32 s21, s42, 372736
    buffer_load_dwordx4 v1, s[8:11], s21 offen lds
    s_waitcnt lgkmcnt(4)
    v_mfma_f32_32x32x16_bf16 v[48:63], v[8:11], a[8:11], v[48:63]
    ds_read_b128 v[28:31], v5 offset:32256
    s_waitcnt lgkmcnt(4)
    v_mfma_f32_32x32x16_bf16 v[48:63], v[12:15], a[12:15], v[48:63]
    ds_read_b128 v[8:11], v5 offset:32768
    s_waitcnt lgkmcnt(4)
    v_mfma_f32_32x32x16_bf16 v[48:63], v[16:19], a[16:19], v[48:63]
    ds_read_b128 v[12:15], v5 offset:33280
    s_waitcnt lgkmcnt(4)
    v_mfma_f32_32x32x16_bf16 v[48:63], v[20:23], a[20:23], v[48:63]
    ds_read_b128 v[16:19], v5 offset:33792
    s_add_u32 m0, s44, 29696
    s_add_u32 s21, s42, 373760
    buffer_load_dwordx4 v1, s[8:11], s21 offen lds
    s_waitcnt lgkmcnt(4)
    v_mfma_f32_32x32x16_bf16 v[48:63], v[24:27], a[24:27], v[48:63]
    ds_read_b128 v[20:23], v5 offset:34304
    v_cvt_pk_bf16_f32 v80, v32, v33
    v_cvt_pk_bf16_f32 v81, v36, v37
    s_waitcnt lgkmcnt(4)
    v_mfma_f32_32x32x16_bf16 v[48:63], v[28:31], a[28:31], v[48:63]
    ds_read_b128 v[24:27], v5 offset:34816
    v_cvt_pk_bf16_f32 v82, v34, v35
    v_cvt_pk_bf16_f32 v83, v38, v39
    s_waitcnt lgkmcnt(4)
    v_mfma_f32_32x32x16_bf16 v[48:63], v[8:11], a[32:35], v[48:63]
    ds_read_b128 v[28:31], v5 offset:35328
    v_cvt_pk_bf16_f32 v88, v40, v41
    v_cvt_pk_bf16_f32 v89, v44, v45
    s_waitcnt lgkmcnt(4)
    v_mfma_f32_32x32x16_bf16 v[48:63], v[12:15], a[36:39], v[48:63]
    ds_read_b128 v[8:11], v5 offset:35840
    s_add_u32 m0, s44, 30720
    s_add_u32 s21, s42, 374784
    buffer_load_dwordx4 v1, s[8:11], s21 offen lds
    v_cvt_pk_bf16_f32 v90, v42, v43
    v_cvt_pk_bf16_f32 v91, v46, v47
    s_waitcnt lgkmcnt(4)
    v_mfma_f32_32x32x16_bf16 v[48:63], v[16:19], a[40:43], v[48:63]
    ds_read_b128 v[12:15], v5 offset:36352
    s_add_u32 s23, s47, 12288
    buffer_store_dwordx4 v[80:83], v2, s[8:11], s23 offen sc1
    s_waitcnt lgkmcnt(4)
    v_mfma_f32_32x32x16_bf16 v[48:63], v[20:23], a[44:47], v[48:63]
    ds_read_b128 v[16:19], v5 offset:36864
    v_mfma_f32_32x32x16_bf16 v[64:79], a[96:99], v[80:83], v[64:79]
    s_waitcnt lgkmcnt(4)
    v_mfma_f32_32x32x16_bf16 v[48:63], v[24:27], a[48:51], v[48:63]
    ds_read_b128 v[20:23], v5 offset:37376
    s_add_u32 s23, s47, 12800
    buffer_store_dwordx4 v[88:91], v2, s[8:11], s23 offen sc1
    s_waitcnt lgkmcnt(4)
    v_mfma_f32_32x32x16_bf16 v[48:63], v[28:31], a[52:55], v[48:63]
    ds_read_b128 v[24:27], v5 offset:37888
    s_add_u32 m0, s44, 31744
    s_add_u32 s21, s42, 375808
    buffer_load_dwordx4 v1, s[8:11], s21 offen lds
    v_mfma_f32_32x32x16_bf16 v[64:79], a[100:103], v[88:91], v[64:79]
    s_waitcnt lgkmcnt(4)
    v_mfma_f32_32x32x16_bf16 v[48:63], v[8:11], a[56:59], v[48:63]
    ds_read_b128 v[28:31], v5 offset:38400
    s_waitcnt lgkmcnt(4)
    v_mfma_f32_32x32x16_bf16 v[48:63], v[12:15], a[60:63], v[48:63]
    ds_read_b128 v[8:11], v5 offset:38912
    s_waitcnt lgkmcnt(4)
    v_mfma_f32_32x32x16_bf16 v[48:63], v[16:19], a[64:67], v[48:63]
    ds_read_b128 v[12:15], v5 offset:39424
    s_waitcnt lgkmcnt(4)
    v_mfma_f32_32x32x16_bf16 v[48:63], v[20:23], a[68:71], v[48:63]
    ds_read_b128 v[16:19], v5 offset:39936
    s_add_u32 m0, s44, 32768
    s_add_u32 s21, s42, 376832
    buffer_load_dwordx4 v1, s[8:11], s21 offen lds
    s_waitcnt lgkmcnt(4)
    v_mfma_f32_32x32x16_bf16 v[48:63], v[24:27], a[72:75], v[48:63]
    ds_read_b128 v[20:23], v5 offset:40448
    s_waitcnt lgkmcnt(4)
    v_mfma_f32_32x32x16_bf16 v[48:63], v[28:31], a[76:79], v[48:63]
    ds_read_b128 v[24:27], v5 offset:40960
    s_waitcnt lgkmcnt(4)
    v_mfma_f32_32x32x16_bf16 v[48:63], v[8:11], a[80:83], v[48:63]
    ds_read_b128 v[28:31], v5 offset:41472
    s_waitcnt lgkmcnt(4)
    v_mfma_f32_32x32x16_bf16 v[48:63], v[12:15], a[84:87], v[48:63]
    ds_read_b128 v[8:11], v5 offset:41984
    s_add_u32 m0, s44, 33792
    s_add_u32 s21, s42, 377856
    buffer_load_dwordx4 v1, s[8:11], s21 offen lds
    s_waitcnt lgkmcnt(4)
    v_mfma_f32_32x32x16_bf16 v[48:63], v[16:19], a[88:91], v[48:63]
    ds_read_b128 v[12:15], v5 offset:42496
    s_waitcnt lgkmcnt(4)
    v_mfma_f32_32x32x16_bf16 v[48:63], v[20:23], a[92:95], v[48:63]
    s_nop 0
    s_waitcnt lgkmcnt(4)
    v_mfma_f32_32x32x16_bf16 v[48:63], v[24:27], a[96:99], v[48:63]
    s_nop 0
    s_waitcnt lgkmcnt(4)
    v_mfma_f32_32x32x16_bf16 v[48:63], v[28:31], a[100:103], v[48:63]
    s_nop 0
    s_add_u32 m0, s44, 34816
    s_add_u32 s21, s42, 378880
    buffer_load_dwordx4 v1, s[8:11], s21 offen lds
    s_waitcnt lgkmcnt(4)
    v_mfma_f32_32x32x16_bf16 v[48:63], v[8:11], a[104:107], v[48:63]
    s_nop 0
    s_waitcnt lgkmcnt(4)
    v_mfma_f32_32x32x16_bf16 v[48:63], v[12:15], a[108:111], v[48:63]
    s_nop 0
    s_nop 10
    v_cvt_pk_bf16_f32 v80, v48, v49
    v_cvt_pk_bf16_f32 v81, v52, v53
    v_cvt_pk_bf16_f32 v82, v50, v51
    v_cvt_pk_bf16_f32 v83, v54, v55
    v_cvt_pk_bf16_f32 v88, v56, v57
    v_cvt_pk_bf16_f32 v89, v60, v61
    v_cvt_pk_bf16_f32 v90, v58, v59
    v_cvt_pk_bf16_f32 v91, v62, v63
    s_add_u32 s23, s47, 13312
    buffer_store_dwordx4 v[80:83], v2, s[8:11], s23 offen sc1
    v_mfma_f32_32x32x16_bf16 v[64:79], a[104:107], v[80:83], v[64:79]
    s_add_u32 s23, s47, 13824
    buffer_store_dwordx4 v[88:91], v2, s[8:11], s23 offen sc1
    v_mfma_f32_32x32x16_bf16 v[64:79], a[108:111], v[88:91], v[64:79]
    s_nop 7
    s_nop 7
    buffer_store_dwordx4 v[64:67], v1, s[8:11], s50 offen offset:0 sc1
    buffer_store_dwordx4 v[68:71], v1, s[8:11], s50 offen offset:1024 sc1
    buffer_store_dwordx4 v[72:75], v1, s[8:11], s50 offen offset:2048 sc1
    buffer_store_dwordx4 v[76:79], v1, s[8:11], s50 offen offset:3072 sc1
    s_waitcnt vmcnt(0)
    s_barrier
    s_cmp_lg_u32 s14, 0
    s_cbranch_scc1 wkqq_sg
    s_lshl_b32 s24, s40, 7
    s_add_u32 s24, s24, 20449280
    s_mov_b64 exec, 1
    v_mov_b32 v251, 1
    buffer_atomic_add v251, off, s[8:11], s24
    s_mov_b64 exec, -1
wkqq_sg:
    s_branch wkq_next
wkq_done:
    v_accvgpr_write_b32 a192, 0
    v_accvgpr_write_b32 a193, 0
    v_accvgpr_write_b32 a194, 0
    v_accvgpr_write_b32 a195, 0
    v_accvgpr_write_b32 a196, 0
    v_accvgpr_write_b32 a197, 0
    v_accvgpr_write_b32 a198, 0
    v_accvgpr_write_b32 a199, 0
    v_accvgpr_write_b32 a200, 0
    v_accvgpr_write_b32 a201, 0
    v_accvgpr_write_b32 a202, 0
    v_accvgpr_write_b32 a203, 0
    v_accvgpr_write_b32 a204, 0
    v_accvgpr_write_b32 a205, 0
    v_accvgpr_write_b32 a206, 0
    v_accvgpr_write_b32 a207, 0
    v_accvgpr_write_b32 a208, 0
    v_accvgpr_write_b32 a209, 0
    v_accvgpr_write_b32 a210, 0
    v_accvgpr_write_b32 a211, 0
    v_accvgpr_write_b32 a212, 0
    v_accvgpr_write_b32 a213, 0
    v_accvgpr_write_b32 a214, 0
    v_accvgpr_write_b32 a215, 0
    v_accvgpr_write_b32 a216, 0
    v_accvgpr_write_b32 a217, 0
    v_accvgpr_write_b32 a218, 0
    v_accvgpr_write_b32 a219, 0
    v_accvgpr_write_b32 a220, 0
    v_accvgpr_write_b32 a221, 0
    v_accvgpr_write_b32 a222, 0
    v_accvgpr_write_b32 a223, 0
    v_accvgpr_write_b32 a224, 0
    v_accvgpr_write_b32 a225, 0
    v_accvgpr_write_b32 a226, 0
    v_accvgpr_write_b32 a227, 0
    v_accvgpr_write_b32 a228, 0
    v_accvgpr_write_b32 a229, 0
    v_accvgpr_write_b32 a230, 0
    v_accvgpr_write_b32 a231, 0
    v_accvgpr_write_b32 a232, 0
    v_accvgpr_write_b32 a233, 0
    v_accvgpr_write_b32 a234, 0
    v_accvgpr_write_b32 a235, 0
    v_accvgpr_write_b32 a236, 0
    v_accvgpr_write_b32 a237, 0
    v_accvgpr_write_b32 a238, 0
    v_accvgpr_write_b32 a239, 0
    v_accvgpr_write_b32 a240, 0
    v_accvgpr_write_b32 a241, 0
    v_accvgpr_write_b32 a242, 0
    v_accvgpr_write_b32 a243, 0
    v_accvgpr_write_b32 a244, 0
    v_accvgpr_write_b32 a245, 0
    v_accvgpr_write_b32 a246, 0
    v_accvgpr_write_b32 a247, 0
    v_accvgpr_write_b32 a248, 0
    v_accvgpr_write_b32 a249, 0
    v_accvgpr_write_b32 a250, 0
    v_accvgpr_write_b32 a251, 0
    v_accvgpr_write_b32 a252, 0
    v_accvgpr_write_b32 a253, 0
    v_accvgpr_write_b32 a254, 0
    v_accvgpr_write_b32 a255, 0
    s_mov_b32 s29, s38
    s_mov_b32 s37, s39
    s_mov_b32 s40, s29
    s_mov_b32 s41, s37
    s_mul_i32 s28, s41, 16
    s_add_u32 s28, s28, s40
    s_add_u32 s28, s28, 960
    s_load_dwordx2 s[24:25], s[0:1], 72
    s_waitcnt lgkmcnt(0)
    s_mov_b32 s56, s24
    s_and_b32 s57, s25, 0xffff
    s_mov_b32 s58, 8388608
    s_mov_b32 s59, 0x20000
    v_lshlrev_b32 v1, 4, v0
    v_bfe_u32 v2, v0, 4, 1
    v_mul_u32_u24 v2, 65536, v2
    v_lshrrev_b32 v250, 5, v0
    v_lshl_add_u32 v2, v250, 8, v2
    v_and_b32 v250, 15, v0
    v_lshl_add_u32 v2, v250, 4, v2
    v_bfe_u32 v3, v0, 4, 1
    v_mul_u32_u24 v3, 28672, v3
    v_lshrrev_b32 v250, 5, v0
    v_lshl_add_u32 v3, v250, 8, v3
    v_and_b32 v250, 15, v0
    v_lshl_add_u32 v3, v250, 4, v3
    v_lshrrev_b32 v16, 4, v0
    v_and_b32 v17, 15, v0
    v_add_u32 v18, 0, v16
    v_xor_b32 v18, v18, v17
    v_and_b32 v18, 15, v18
    v_lshlrev_b32 v18, 4, v18
    v_lshl_add_u32 v4, v16, 12, v18
    v_add_u32 v18, 4, v16
    v_xor_b32 v18, v18, v17
    v_and_b32 v18, 15, v18
    v_lshlrev_b32 v18, 4, v18
    v_lshl_add_u32 v5, v16, 12, v18
    v_add_u32 v18, 8, v16
    v_xor_b32 v18, v18, v17
    v_and_b32 v18, 15, v18
    v_lshlrev_b32 v18, 4, v18
    v_lshl_add_u32 v6, v16, 12, v18
    v_add_u32 v18, 12, v16
    v_xor_b32 v18, v18, v17
    v_and_b32 v18, 15, v18
    v_lshlrev_b32 v18, 4, v18
    v_lshl_add_u32 v7, v16, 12, v18
    v_and_b32 v16, 31, v0
    v_lshrrev_b32 v17, 5, v0
    v_add_u32 v18, 0, v17
    v_xor_b32 v18, v18, v16
    v_and_b32 v18, 15, v18
    v_lshlrev_b32 v18, 4, v18
    v_lshl_add_u32 v8, v16, 8, v18
    v_add_u32 v18, 2, v17
    v_xor_b32 v18, v18, v16
    v_and_b32 v18, 15, v18
    v_lshlrev_b32 v18, 4, v18
    v_lshl_add_u32 v9, v16, 8, v18
    v_add_u32 v18, 4, v17
    v_xor_b32 v18, v18, v16
    v_and_b32 v18, 15, v18
    v_lshlrev_b32 v18, 4, v18
    v_lshl_add_u32 v10, v16, 8, v18
    v_add_u32 v18, 6, v17
    v_xor_b32 v18, v18, v16
    v_and_b32 v18, 15, v18
    v_lshlrev_b32 v18, 4, v18
    v_lshl_add_u32 v11, v16, 8, v18
    v_add_u32 v18, 8, v17
    v_xor_b32 v18, v18, v16
    v_and_b32 v18, 15, v18
    v_lshlrev_b32 v18, 4, v18
    v_lshl_add_u32 v12, v16, 8, v18
    v_add_u32 v18, 10, v17
    v_xor_b32 v18, v18, v16
    v_and_b32 v18, 15, v18
    v_lshlrev_b32 v18, 4, v18
    v_lshl_add_u32 v13, v16, 8, v18
    v_add_u32 v18, 12, v17
    v_xor_b32 v18, v18, v16
    v_and_b32 v18, 15, v18
    v_lshlrev_b32 v18, 4, v18
    v_lshl_add_u32 v14, v16, 8, v18
    v_add_u32 v18, 14, v17
    v_xor_b32 v18, v18, v16
    v_and_b32 v18, 15, v18
    v_lshlrev_b32 v18, 4, v18
    v_lshl_add_u32 v15, v16, 8, v18
    s_lshl_b32 s42, s40, 19
    s_lshl_b32 s20, s14, 17
    s_add_u32 s42, s42, s20
    s_lshl_b32 s43, s14, 13
    s_lshl_b32 s44, s41, 3
    s_lshl_b32 s20, s14, 1
    s_add_u32 s44, s44, s20
    s_lshl_b32 s44, s44, 16
    s_add_u32 s44, s44, 115343360
    s_mov_b32 s48, 0
    s_mov_b32 s47, 0
    s_lshl_b32 s49, s48, 8
    s_add_u32 s49, s49, s42
    s_add_u32 s50, s47, s43
    s_add_u32 m0, s50, 0
    s_add_u32 s21, s49, 0
    buffer_load_dwordx4 v4, s[56:59], s21 offen lds
    s_add_u32 m0, s50, 1024
    s_add_u32 s21, s49, 16384
    buffer_load_dwordx4 v5, s[56:59], s21 offen lds
    s_add_u32 m0, s50, 2048
    s_add_u32 s21, s49, 32768
    buffer_load_dwordx4 v6, s[56:59], s21 offen lds
    s_add_u32 m0, s50, 3072
    s_add_u32 s21, s49, 49152
    buffer_load_dwordx4 v7, s[56:59], s21 offen lds
    s_add_u32 m0, s50, 4096
    s_add_u32 s21, s49, 65536
    buffer_load_dwordx4 v4, s[56:59], s21 offen lds
    s_add_u32 m0, s50, 5120
    s_add_u32 s21, s49, 81920
    buffer_load_dwordx4 v5, s[56:59], s21 offen lds
    s_add_u32 m0, s50, 6144
    s_add_u32 s21, s49, 98304
    buffer_load_dwordx4 v6, s[56:59], s21 offen lds
    s_add_u32 m0, s50, 7168
    s_add_u32 s21, s49, 114688
    buffer_load_dwordx4 v7, s[56:59], s21 offen lds
    s_mov_b32 s48, 1
    s_mov_b32 s47, 32768
    s_lshl_b32 s49, s48, 8
    s_add_u32 s49, s49, s42
    s_add_u32 s50, s47, s43
    s_add_u32 m0, s50, 0
    s_add_u32 s21, s49, 0
    buffer_load_dwordx4 v4, s[56:59], s21 offen lds
    s_add_u32 m0, s50, 1024
    s_add_u32 s21, s49, 16384
    buffer_load_dwordx4 v5, s[56:59], s21 offen lds
    s_add_u32 m0, s50, 2048
    s_add_u32 s21, s49, 32768
    buffer_load_dwordx4 v6, s[56:59], s21 offen lds
    s_add_u32 m0, s50, 3072
    s_add_u32 s21, s49, 49152
    buffer_load_dwordx4 v7, s[56:59], s21 offen lds
    s_add_u32 m0, s50, 4096
    s_add_u32 s21, s49, 65536
    buffer_load_dwordx4 v4, s[56:59], s21 offen lds
    s_add_u32 m0, s50, 5120
    s_add_u32 s21, s49, 81920
    buffer_load_dwordx4 v5, s[56:59], s21 offen lds
    s_add_u32 m0, s50, 6144
    s_add_u32 s21, s49, 98304
    buffer_load_dwordx4 v6, s[56:59], s21 offen lds
    s_add_u32 m0, s50, 7168
    s_add_u32 s21, s49, 114688
    buffer_load_dwordx4 v7, s[56:59], s21 offen lds
    s_mov_b32 s45, 0
    s_mov_b32 s46, 0
spo_chunk:
    s_cmp_lg_u32 s45, 14
    s_cbranch_scc1 spo_now
    s_getpc_b64 s[20:21]
ctch2:
    s_sub_u32 s20, s20, ctch2-main_kernel
    s_subb_u32 s21, s21, 0
    v_lshlrev_b32 v248, 7, v0
    s_lshl_b32 s22, s14, 13
    v_add_u32 v248, s22, v248
    v_min_u32 v246, main_code_end-main_kernel-4, v248
    global_load_dword v247, v246, s[20:21]
    v_add_u32 v248, 0x8000, v248
    v_min_u32 v246, main_code_end-main_kernel-4, v248
    global_load_dword v247, v246, s[20:21]
    v_add_u32 v248, 0x8000, v248
    v_min_u32 v246, main_code_end-main_kernel-4, v248
    global_load_dword v247, v246, s[20:21]
    v_add_u32 v248, 0x8000, v248
    s_mov_b32 s27, 20459648
    s_waitcnt vmcnt(0)
    s_cmp_lg_u32 s14, 0
    s_cbranch_scc1 spo_wtr_ok
spo_wtr:
    buffer_load_dword v251, off, s[8:11], s27 sc1
    s_waitcnt vmcnt(0)
    v_readfirstlane_b32 s26, v251
    s_nop 2
    s_cmp_ge_u32 s26, 224
    s_cbranch_scc1 spo_wtr_ok
    s_sleep 3
    s_sub_u32 s17, s17, 1
    s_cmp_gt_i32 s17, 0
    s_cbranch_scc1 spo_wtr
spo_wtr_ok:
    s_barrier
    s_and_b32 s62, s14, 1
    s_lshr_b32 s63, s14, 1
    s_lshl_b32 s51, s35, 1
    s_add_u32 s51, s51, s63
    s_mul_i32 s52, s51, 57344
    s_add_u32 s52, s52, 109051904
    v_bfe_u32 v249, v0, 4, 1
    v_mul_u32_u24 v249, 28672, v249
    v_lshrrev_b32 v250, 5, v0
    v_lshl_add_u32 v249, v250, 8, v249
    v_and_b32 v250, 15, v0
    v_lshl_add_u32 v249, v250, 4, v249
    s_add_u32 s53, s52, 0
    buffer_load_dwordx4 a[0:3], v249, s[8:11], s53 offen offset:0
    buffer_load_dwordx4 a[4:7], v249, s[8:11], s53 offen offset:512
    buffer_load_dwordx4 a[8:11], v249, s[8:11], s53 offen offset:1024
    buffer_load_dwordx4 a[12:15], v249, s[8:11], s53 offen offset:1536
    buffer_load_dwordx4 a[16:19], v249, s[8:11], s53 offen offset:2048
    buffer_load_dwordx4 a[20:23], v249, s[8:11], s53 offen offset:2560
    buffer_load_dwordx4 a[24:27], v249, s[8:11], s53 offen offset:3072
    buffer_load_dwordx4 a[28:31], v249, s[8:11], s53 offen offset:3584
    s_add_u32 s53, s52, 4096
    buffer_load_dwordx4 a[32:35], v249, s[8:11], s53 offen offset:0
    buffer_load_dwordx4 a[36:39], v249, s[8:11], s53 offen offset:512
    buffer_load_dwordx4 a[40:43], v249, s[8:11], s53 offen offset:1024
    buffer_load_dwordx4 a[44:47], v249, s[8:11], s53 offen offset:1536
    buffer_load_dwordx4 a[48:51], v249, s[8:11], s53 offen offset:2048
    buffer_load_dwordx4 a[52:55], v249, s[8:11], s53 offen offset:2560
    buffer_load_dwordx4 a[56:59], v249, s[8:11], s53 offen offset:3072
    buffer_load_dwordx4 a[60:63], v249, s[8:11], s53 offen offset:3584
    s_add_u32 s53, s52, 8192
    buffer_load_dwordx4 a[64:67], v249, s[8:11], s53 offen offset:0
    buffer_load_dwordx4 a[68:71], v249, s[8:11], s53 offen offset:512
    buffer_load_dwordx4 a[72:75], v249, s[8:11], s53 offen offset:1024
    buffer_load_dwordx4 a[76:79], v249, s[8:11], s53 offen offset:1536
    buffer_load_dwordx4 a[80:83], v249, s[8:11], s53 offen offset:2048
    buffer_load_dwordx4 a[84:87], v249, s[8:11], s53 offen offset:2560
    buffer_load_dwordx4 a[88:91], v249, s[8:11], s53 offen offset:3072
    buffer_load_dwordx4 a[92:95], v249, s[8:11], s53 offen offset:3584
    s_add_u32 s53, s52, 12288
    buffer_load_dwordx4 a[96:99], v249, s[8:11], s53 offen offset:0
    buffer_load_dwordx4 a[100:103], v249, s[8:11], s53 offen offset:512
    buffer_load_dwordx4 a[104:107], v249, s[8:11], s53 offen offset:1024
    buffer_load_dwordx4 a[108:111], v249, s[8:11], s53 offen offset:1536
    buffer_load_dwordx4 a[112:115], v249, s[8:11], s53 offen offset:2048
    buffer_load_dwordx4 a[116:119], v249, s[8:11], s53 offen offset:2560
    buffer_load_dwordx4 a[120:123], v249, s[8:11], s53 offen offset:3072
    buffer_load_dwordx4 a[124:127], v249, s[8:11], s53 offen offset:3584
    s_add_u32 s53, s52, 16384
    buffer_load_dwordx4 a[128:131], v249, s[8:11], s53 offen offset:0
    buffer_load_dwordx4 a[132:135], v249, s[8:11], s53 offen offset:512
    buffer_load_dwordx4 a[136:139], v249, s[8:11], s53 offen offset:1024
    buffer_load_dwordx4 a[140:143], v249, s[8:11], s53 offen offset:1536
    buffer_load_dwordx4 a[144:147], v249, s[8:11], s53 offen offset:2048
    buffer_load_dwordx4 a[148:151], v249, s[8:11], s53 offen offset:2560
    buffer_load_dwordx4 a[152:155], v249, s[8:11], s53 offen offset:3072
    buffer_load_dwordx4 a[156:159], v249, s[8:11], s53 offen offset:3584
    s_add_u32 s53, s52, 20480
    buffer_load_dwordx4 a[160:163], v249, s[8:11], s53 offen offset:0
    buffer_load_dwordx4 a[164:167], v249, s[8:11], s53 offen offset:512
    buffer_load_dwordx4 a[168:171], v249, s[8:11], s53 offen offset:1024
    buffer_load_dwordx4 a[172:175], v249, s[8:11], s53 offen offset:1536
    buffer_load_dwordx4 a[176:179], v249, s[8:11], s53 offen offset:2048
    buffer_load_dwordx4 a[180:183], v249, s[8:11], s53 offen offset:2560
    buffer_load_dwordx4 a[184:187], v249, s[8:11], s53 offen offset:3072
    buffer_load_dwordx4 a[188:191], v249, s[8:11], s53 offen offset:3584
spo_now:
    s_cmp_lg_u32 s45, 15
    s_cbranch_scc1 spo_noz1
    s_lshl_b32 s27, s40, 7
    s_add_u32 s27, s27, 20473856
    s_waitcnt vmcnt(0)
    s_cmp_lg_u32 s14, 0
    s_cbranch_scc1 spo_w1_ok
spo_w1:
    buffer_load_dword v251, off, s[8:11], s27 sc1
    s_waitcnt vmcnt(0)
    v_readfirstlane_b32 s26, v251
    s_nop 2
    s_cmp_ge_u32 s26, 14
    s_cbranch_scc1 spo_w1_ok
    s_sleep 3
    s_sub_u32 s17, s17, 1
    s_cmp_gt_i32 s17, 0
    s_cbranch_scc1 spo_w1
spo_w1_ok:
    s_barrier
    s_load_dwordx2 s[24:25], s[0:1], 80
    s_waitcnt lgkmcnt(0)
    s_mov_b32 s60, s24
    s_and_b32 s61, s25, 0xffff
    s_mov_b32 s62, 4096
    s_mov_b32 s63, 0x20000
    v_and_b32 v164, 31, v0
    v_lshlrev_b32 v164, 1, v164
    s_lshl_b32 s51, s40, 8
    buffer_load_ushort v160, v164, s[60:63], s51 offen offset:0
    buffer_load_ushort v161, v164, s[60:63], s51 offen offset:64
    buffer_load_ushort v162, v164, s[60:63], s51 offen offset:128
    buffer_load_ushort v163, v164, s[60:63], s51 offen offset:192
    s_lshl_b32 s54, s40, 3
    s_mul_i32 s54, s54, 28672
    s_lshl_b32 s52, s41, 3
    s_lshl_b32 s20, s14, 1
    s_add_u32 s52, s52, s20
    s_lshl_b32 s52, s52, 9
    s_add_u32 s54, s54, s52
    s_add_u32 s53, s54, 111149056
    buffer_load_dwordx4 v[128:131], v3, s[8:11], s53 offen offset:0 sc1
    buffer_load_dwordx4 v[132:135], v3, s[8:11], s53 offen offset:512 sc1
    s_add_u32 s53, s54, 111206400
    buffer_load_dwordx4 v[136:139], v3, s[8:11], s53 offen offset:0 sc1
    buffer_load_dwordx4 v[140:143], v3, s[8:11], s53 offen offset:512 sc1
    s_add_u32 s53, s54, 111263744
    buffer_load_dwordx4 v[144:147], v3, s[8:11], s53 offen offset:0 sc1
    buffer_load_dwordx4 v[148:151], v3, s[8:11], s53 offen offset:512 sc1
    s_add_u32 s53, s54, 111321088
    buffer_load_dwordx4 v[152:155], v3, s[8:11], s53 offen offset:0 sc1
    buffer_load_dwordx4 v[156:159], v3, s[8:11], s53 offen offset:512 sc1
spo_noz1:
    s_add_u32 s48, s45, 2
    s_min_u32 s48, s48, 15
    s_add_u32 s47, s46, 65536
    s_and_b32 s47, s47, 131071
    s_lshl_b32 s49, s48, 8
    s_add_u32 s49, s49, s42
    s_add_u32 s50, s47, s43
    s_add_u32 m0, s50, 0
    s_add_u32 s21, s49, 0
    buffer_load_dwordx4 v4, s[56:59], s21 offen lds
    s_add_u32 m0, s50, 1024
    s_add_u32 s21, s49, 16384
    buffer_load_dwordx4 v5, s[56:59], s21 offen lds
    s_add_u32 m0, s50, 2048
    s_add_u32 s21, s49, 32768
    buffer_load_dwordx4 v6, s[56:59], s21 offen lds
    s_add_u32 m0, s50, 3072
    s_add_u32 s21, s49, 49152
    buffer_load_dwordx4 v7, s[56:59], s21 offen lds
    s_add_u32 m0, s50, 4096
    s_add_u32 s21, s49, 65536
    buffer_load_dwordx4 v4, s[56:59], s21 offen lds
    s_add_u32 m0, s50, 5120
    s_add_u32 s21, s49, 81920
    buffer_load_dwordx4 v5, s[56:59], s21 offen lds
    s_add_u32 m0, s50, 6144
    s_add_u32 s21, s49, 98304
    buffer_load_dwordx4 v6, s[56:59], s21 offen lds
    s_add_u32 m0, s50, 7168
    s_add_u32 s21, s49, 114688
    buffer_load_dwordx4 v7, s[56:59], s21 offen lds
    s_lshl_b32 s27, s45, 3
    s_and_b32 s20, s12, 7
    s_add_u32 s27, s27, s20
    s_lshl_b32 s27, s27, 7
    s_add_u32 s27, s27, 20480000
    s_waitcnt vmcnt(0)
    s_cmp_lg_u32 s14, 0
    s_cbranch_scc1 spo_wz_ok
spo_wz:
    buffer_load_dword v251, off, s[8:11], s27 sc1
    s_waitcnt vmcnt(0)
    v_readfirstlane_b32 s26, v251
    s_nop 2
    s_cmp_ge_u32 s26, 14
    s_cbranch_scc1 spo_wz_ok
    s_sleep 1
    s_sub_u32 s17, s17, 1
    s_cmp_gt_i32 s17, 0
    s_cbranch_scc1 spo_wz
spo_wz_ok:
    s_barrier
    s_lshl_b32 s22, s45, 12
    s_add_u32 s22, s22, s44
    buffer_load_dwordx4 v[16:19], v2, s[8:11], s22 offen offset:0
    buffer_load_dwordx4 v[20:23], v2, s[8:11], s22 offen offset:512
    buffer_load_dwordx4 v[24:27], v2, s[8:11], s22 offen offset:1024
    buffer_load_dwordx4 v[28:31], v2, s[8:11], s22 offen offset:1536
    buffer_load_dwordx4 v[32:35], v2, s[8:11], s22 offen offset:2048
    buffer_load_dwordx4 v[36:39], v2, s[8:11], s22 offen offset:2560
    buffer_load_dwordx4 v[40:43], v2, s[8:11], s22 offen offset:3072
    buffer_load_dwordx4 v[44:47], v2, s[8:11], s22 offen offset:3584
    s_waitcnt vmcnt(16)
    s_barrier
    v_add_u32 v80, s46, v8
    v_add_u32 v81, s46, v9
    v_add_u32 v82, s46, v10
    v_add_u32 v83, s46, v11
    v_add_u32 v84, s46, v12
    v_add_u32 v85, s46, v13
    v_add_u32 v86, s46, v14
    v_add_u32 v87, s46, v15
    ds_read_b128 v[48:51], v80 offset:0
    ds_read_b128 v[52:55], v80 offset:8192
    ds_read_b128 v[56:59], v80 offset:16384
    ds_read_b128 v[60:63], v80 offset:24576
    ds_read_b128 v[64:67], v81 offset:0
    ds_read_b128 v[68:71], v81 offset:8192
    s_waitcnt vmcnt(7)
    s_waitcnt lgkmcnt(5)
    v_mfma_f32_32x32x16_bf16 a[192:207], v[16:19], v[48:51], a[192:207]
    ds_read_b128 v[72:75], v81 offset:16384
    s_waitcnt lgkmcnt(5)
    v_mfma_f32_32x32x16_bf16 a[208:223], v[16:19], v[52:55], a[208:223]
    ds_read_b128 v[76:79], v81 offset:24576
    s_waitcnt lgkmcnt(5)
    v_mfma_f32_32x32x16_bf16 a[224:239], v[16:19], v[56:59], a[224:239]
    ds_read_b128 v[48:51], v82 offset:0
    s_waitcnt lgkmcnt(5)
    v_mfma_f32_32x32x16_bf16 a[240:255], v[16:19], v[60:63], a[240:255]
    ds_read_b128 v[52:55], v82 offset:8192
    s_waitcnt vmcnt(6)
    s_waitcnt lgkmcnt(5)
    v_mfma_f32_32x32x16_bf16 a[192:207], v[20:23], v[64:67], a[192:207]
    ds_read_b128 v[56:59], v82 offset:16384
    s_waitcnt lgkmcnt(5)
    v_mfma_f32_32x32x16_bf16 a[208:223], v[20:23], v[68:71], a[208:223]
    ds_read_b128 v[60:63], v82 offset:24576
    s_waitcnt lgkmcnt(5)
    v_mfma_f32_32x32x16_bf16 a[224:239], v[20:23], v[72:75], a[224:239]
    ds_read_b128 v[64:67], v83 offset:0
    s_waitcnt lgkmcnt(5)
    v_mfma_f32_32x32x16_bf16 a[240:255], v[20:23], v[76:79], a[240:255]
    ds_read_b128 v[68:71], v83 offset:8192
    s_waitcnt vmcnt(5)
    s_waitcnt lgkmcnt(5)
    v_mfma_f32_32x32x16_bf16 a[192:207], v[24:27], v[48:51], a[192:207]
    ds_read_b128 v[72:75], v83 offset:16384
    s_waitcnt lgkmcnt(5)
    v_mfma_f32_32x32x16_bf16 a[208:223], v[24:27], v[52:55], a[208:223]
    ds_read_b128 v[76:79], v83 offset:24576
    s_waitcnt lgkmcnt(5)
    v_mfma_f32_32x32x16_bf16 a[224:239], v[24:27], v[56:59], a[224:239]
    ds_read_b128 v[48:51], v84 offset:0
    s_waitcnt lgkmcnt(5)
    v_mfma_f32_32x32x16_bf16 a[240:255], v[24:27], v[60:63], a[240:255]
    ds_read_b128 v[52:55], v84 offset:8192
    s_waitcnt vmcnt(4)
    s_waitcnt lgkmcnt(5)
    v_mfma_f32_32x32x16_bf16 a[192:207], v[28:31], v[64:67], a[192:207]
    ds_read_b128 v[56:59], v84 offset:16384
    s_waitcnt lgkmcnt(5)
    v_mfma_f32_32x32x16_bf16 a[208:223], v[28:31], v[68:71], a[208:223]
    ds_read_b128 v[60:63], v84 offset:24576
    s_waitcnt lgkmcnt(5)
    v_mfma_f32_32x32x16_bf16 a[224:239], v[28:31], v[72:75], a[224:239]
    ds_read_b128 v[64:67], v85 offset:0
    s_waitcnt lgkmcnt(5)
    v_mfma_f32_32x32x16_bf16 a[240:255], v[28:31], v[76:79], a[240:255]
    ds_read_b128 v[68:71], v85 offset:8192
    s_waitcnt vmcnt(3)
    s_waitcnt lgkmcnt(5)
    v_mfma_f32_32x32x16_bf16 a[192:207], v[32:35], v[48:51], a[192:207]
    ds_read_b128 v[72:75], v85 offset:16384
    s_waitcnt lgkmcnt(5)
    v_mfma_f32_32x32x16_bf16 a[208:223], v[32:35], v[52:55], a[208:223]
    ds_read_b128 v[76:79], v85 offset:24576
    s_waitcnt lgkmcnt(5)
    v_mfma_f32_32x32x16_bf16 a[224:239], v[32:35], v[56:59], a[224:239]
    ds_read_b128 v[48:51], v86 offset:0
    s_waitcnt lgkmcnt(5)
    v_mfma_f32_32x32x16_bf16 a[240:255], v[32:35], v[60:63], a[240:255]
    ds_read_b128 v[52:55], v86 offset:8192
    s_waitcnt vmcnt(2)
    s_waitcnt lgkmcnt(5)
    v_mfma_f32_32x32x16_bf16 a[192:207], v[36:39], v[64:67], a[192:207]
    ds_read_b128 v[56:59], v86 offset:16384
    s_waitcnt lgkmcnt(5)
    v_mfma_f32_32x32x16_bf16 a[208:223], v[36:39], v[68:71], a[208:223]
    ds_read_b128 v[60:63], v86 offset:24576
    s_waitcnt lgkmcnt(5)
    v_mfma_f32_32x32x16_bf16 a[224:239], v[36:39], v[72:75], a[224:239]
    ds_read_b128 v[64:67], v87 offset:0
    s_waitcnt lgkmcnt(5)
    v_mfma_f32_32x32x16_bf16 a[240:255], v[36:39], v[76:79], a[240:255]
    ds_read_b128 v[68:71], v87 offset:8192
    s_waitcnt vmcnt(1)
    s_waitcnt lgkmcnt(5)
    v_mfma_f32_32x32x16_bf16 a[192:207], v[40:43], v[48:51], a[192:207]
    ds_read_b128 v[72:75], v87 offset:16384
    s_waitcnt lgkmcnt(5)
    v_mfma_f32_32x32x16_bf16 a[208:223], v[40:43], v[52:55], a[208:223]
    ds_read_b128 v[76:79], v87 offset:24576
    s_waitcnt lgkmcnt(5)
    v_mfma_f32_32x32x16_bf16 a[224:239], v[40:43], v[56:59], a[224:239]
    s_waitcnt lgkmcnt(4)
    v_mfma_f32_32x32x16_bf16 a[240:255], v[40:43], v[60:63], a[240:255]
    s_waitcnt vmcnt(0)
    s_waitcnt lgkmcnt(3)
    v_mfma_f32_32x32x16_bf16 a[192:207], v[44:47], v[64:67], a[192:207]
    s_waitcnt lgkmcnt(2)
    v_mfma_f32_32x32x16_bf16 a[208:223], v[44:47], v[68:71], a[208:223]
    s_waitcnt lgkmcnt(1)
    v_mfma_f32_32x32x16_bf16 a[224:239], v[44:47], v[72:75], a[224:239]
    s_waitcnt lgkmcnt(0)
    v_mfma_f32_32x32x16_bf16 a[240:255], v[44:47], v[76:79], a[240:255]
    s_barrier
    s_add_u32 s46, s46, 32768
    s_and_b32 s46, s46, 131071
    s_add_u32 s45, s45, 1
    s_cmp_lt_u32 s45, 16
    s_nop 6
    s_cbranch_scc1 spo_chunk
    s_waitcnt vmcnt(0)
    s_mov_b32 s47, s54
    v_lshlrev_b32 v160, 16, v160
    v_accvgpr_read_b32 v96, a192
    v_accvgpr_read_b32 v97, a193
    v_accvgpr_read_b32 v98, a194
    v_accvgpr_read_b32 v99, a195
    v_accvgpr_read_b32 v100, a196
    v_accvgpr_read_b32 v101, a197
    v_accvgpr_read_b32 v102, a198
    v_accvgpr_read_b32 v103, a199
    v_accvgpr_read_b32 v104, a200
    v_accvgpr_read_b32 v105, a201
    v_accvgpr_read_b32 v106, a202
    v_accvgpr_read_b32 v107, a203
    v_accvgpr_read_b32 v108, a204
    v_accvgpr_read_b32 v109, a205
    v_accvgpr_read_b32 v110, a206
    v_accvgpr_read_b32 v111, a207
    v_add_f32 v96, v96, v160
    v_add_f32 v97, v97, v160
    v_add_f32 v98, v98, v160
    v_add_f32 v99, v99, v160
    v_add_f32 v100, v100, v160
    v_add_f32 v101, v101, v160
    v_add_f32 v102, v102, v160
    v_add_f32 v103, v103, v160
    v_add_f32 v104, v104, v160
    v_add_f32 v105, v105, v160
    v_add_f32 v106, v106, v160
    v_add_f32 v107, v107, v160
    v_add_f32 v108, v108, v160
    v_add_f32 v109, v109, v160
    v_add_f32 v110, v110, v160
    v_add_f32 v111, v111, v160
    v_lshlrev_b32 v60, 16, v128
    v_and_b32 v61, 0xffff0000, v128
    v_mul_f32 v60, v60, v96
    v_mul_f32 v61, v61, v97
    v_cvt_pk_bf16_f32 v112, v60, v61
    v_lshlrev_b32 v60, 16, v129
    v_and_b32 v61, 0xffff0000, v129
    v_mul_f32 v60, v60, v100
    v_mul_f32 v61, v61, v101
    v_cvt_pk_bf16_f32 v113, v60, v61
    v_lshlrev_b32 v60, 16, v130
    v_and_b32 v61, 0xffff0000, v130
    v_mul_f32 v60, v60, v98
    v_mul_f32 v61, v61, v99
    v_cvt_pk_bf16_f32 v114, v60, v61
    v_lshlrev_b32 v60, 16, v131
    v_and_b32 v61, 0xffff0000, v131
    v_mul_f32 v60, v60, v102
    v_mul_f32 v61, v61, v103
    v_cvt_pk_bf16_f32 v115, v60, v61
    s_add_u32 s49, s47, 119537664
    buffer_store_dwordx4 v[112:115], v3, s[8:11], s49 offen offset:0 sc1
    v_lshlrev_b32 v60, 16, v132
    v_and_b32 v61, 0xffff0000, v132
    v_mul_f32 v60, v60, v104
    v_mul_f32 v61, v61, v105
    v_cvt_pk_bf16_f32 v116, v60, v61
    v_lshlrev_b32 v60, 16, v133
    v_and_b32 v61, 0xffff0000, v133
    v_mul_f32 v60, v60, v108
    v_mul_f32 v61, v61, v109
    v_cvt_pk_bf16_f32 v117, v60, v61
    v_lshlrev_b32 v60, 16, v134
    v_and_b32 v61, 0xffff0000, v134
    v_mul_f32 v60, v60, v106
    v_mul_f32 v61, v61, v107
    v_cvt_pk_bf16_f32 v118, v60, v61
    v_lshlrev_b32 v60, 16, v135
    v_and_b32 v61, 0xffff0000, v135
    v_mul_f32 v60, v60, v110
    v_mul_f32 v61, v61, v111
    v_cvt_pk_bf16_f32 v119, v60, v61
    s_add_u32 s49, s47, 119537664
    buffer_store_dwordx4 v[116:119], v3, s[8:11], s49 offen offset:512 sc1
    v_lshlrev_b32 v161, 16, v161
    v_accvgpr_read_b32 v96, a208
    v_accvgpr_read_b32 v97, a209
    v_accvgpr_read_b32 v98, a210
    v_accvgpr_read_b32 v99, a211
    v_accvgpr_read_b32 v100, a212
    v_accvgpr_read_b32 v101, a213
    v_accvgpr_read_b32 v102, a214
    v_accvgpr_read_b32 v103, a215
    v_accvgpr_read_b32 v104, a216
    v_accvgpr_read_b32 v105, a217
    v_accvgpr_read_b32 v106, a218
    v_accvgpr_read_b32 v107, a219
    v_accvgpr_read_b32 v108, a220
    v_accvgpr_read_b32 v109, a221
    v_accvgpr_read_b32 v110, a222
    v_accvgpr_read_b32 v111, a223
    v_add_f32 v96, v96, v161
    v_add_f32 v97, v97, v161
    v_add_f32 v98, v98, v161
    v_add_f32 v99, v99, v161
    v_add_f32 v100, v100, v161
    v_add_f32 v101, v101, v161
    v_add_f32 v102, v102, v161
    v_add_f32 v103, v103, v161
    v_add_f32 v104, v104, v161
    v_add_f32 v105, v105, v161
    v_add_f32 v106, v106, v161
    v_add_f32 v107, v107, v161
    v_add_f32 v108, v108, v161
    v_add_f32 v109, v109, v161
    v_add_f32 v110, v110, v161
    v_add_f32 v111, v111, v161
    v_lshlrev_b32 v60, 16, v136
    v_and_b32 v61, 0xffff0000, v136
    v_mul_f32 v60, v60, v96
    v_mul_f32 v61, v61, v97
    v_cvt_pk_bf16_f32 v120, v60, v61
    v_lshlrev_b32 v60, 16, v137
    v_and_b32 v61, 0xffff0000, v137
    v_mul_f32 v60, v60, v100
    v_mul_f32 v61, v61, v101
    v_cvt_pk_bf16_f32 v121, v60, v61
    v_lshlrev_b32 v60, 16, v138
    v_and_b32 v61, 0xffff0000, v138
    v_mul_f32 v60, v60, v98
    v_mul_f32 v61, v61, v99
    v_cvt_pk_bf16_f32 v122, v60, v61
    v_lshlrev_b32 v60, 16, v139
    v_and_b32 v61, 0xffff0000, v139
    v_mul_f32 v60, v60, v102
    v_mul_f32 v61, v61, v103
    v_cvt_pk_bf16_f32 v123, v60, v61
    s_add_u32 s49, s47, 119595008
    buffer_store_dwordx4 v[120:123], v3, s[8:11], s49 offen offset:0 sc1
    v_lshlrev_b32 v60, 16, v140
    v_and_b32 v61, 0xffff0000, v140
    v_mul_f32 v60, v60, v104
    v_mul_f32 v61, v61, v105
    v_cvt_pk_bf16_f32 v124, v60, v61
    v_lshlrev_b32 v60, 16, v141
    v_and_b32 v61, 0xffff0000, v141
    v_mul_f32 v60, v60, v108
    v_mul_f32 v61, v61, v109
    v_cvt_pk_bf16_f32 v125, v60, v61
    v_lshlrev_b32 v60, 16, v142
    v_and_b32 v61, 0xffff0000, v142
    v_mul_f32 v60, v60, v106
    v_mul_f32 v61, v61, v107
    v_cvt_pk_bf16_f32 v126, v60, v61
    v_lshlrev_b32 v60, 16, v143
    v_and_b32 v61, 0xffff0000, v143
    v_mul_f32 v60, v60, v110
    v_mul_f32 v61, v61, v111
    v_cvt_pk_bf16_f32 v127, v60, v61
    s_add_u32 s49, s47, 119595008
    buffer_store_dwordx4 v[124:127], v3, s[8:11], s49 offen offset:512 sc1
    v_lshlrev_b32 v162, 16, v162
    v_accvgpr_read_b32 v96, a224
    v_accvgpr_read_b32 v97, a225
    v_accvgpr_read_b32 v98, a226
    v_accvgpr_read_b32 v99, a227
    v_accvgpr_read_b32 v100, a228
    v_accvgpr_read_b32 v101, a229
    v_accvgpr_read_b32 v102, a230
    v_accvgpr_read_b32 v103, a231
    v_accvgpr_read_b32 v104, a232
    v_accvgpr_read_b32 v105, a233
    v_accvgpr_read_b32 v106, a234
    v_accvgpr_read_b32 v107, a235
    v_accvgpr_read_b32 v108, a236
    v_accvgpr_read_b32 v109, a237
    v_accvgpr_read_b32 v110, a238
    v_accvgpr_read_b32 v111, a239
    v_add_f32 v96, v96, v162
    v_add_f32 v97, v97, v162
    v_add_f32 v98, v98, v162
    v_add_f32 v99, v99, v162
    v_add_f32 v100, v100, v162
    v_add_f32 v101, v101, v162
    v_add_f32 v102, v102, v162
    v_add_f32 v103, v103, v162
    v_add_f32 v104, v104, v162
    v_add_f32 v105, v105, v162
    v_add_f32 v106, v106, v162
    v_add_f32 v107, v107, v162
    v_add_f32 v108, v108, v162
    v_add_f32 v109, v109, v162
    v_add_f32 v110, v110, v162
    v_add_f32 v111, v111, v162
    v_lshlrev_b32 v60, 16, v144
    v_and_b32 v61, 0xffff0000, v144
    v_mul_f32 v60, v60, v96
    v_mul_f32 v61, v61, v97
    v_cvt_pk_bf16_f32 v112, v60, v61
    v_lshlrev_b32 v60, 16, v145
    v_and_b32 v61, 0xffff0000, v145
    v_mul_f32 v60, v60, v100
    v_mul_f32 v61, v61, v101
    v_cvt_pk_bf16_f32 v113, v60, v61
    v_lshlrev_b32 v60, 16, v146
    v_and_b32 v61, 0xffff0000, v146
    v_mul_f32 v60, v60, v98
    v_mul_f32 v61, v61, v99
    v_cvt_pk_bf16_f32 v114, v60, v61
    v_lshlrev_b32 v60, 16, v147
    v_and_b32 v61, 0xffff0000, v147
    v_mul_f32 v60, v60, v102
    v_mul_f32 v61, v61, v103
    v_cvt_pk_bf16_f32 v115, v60, v61
    s_add_u32 s49, s47, 119652352
    buffer_store_dwordx4 v[112:115], v3, s[8:11], s49 offen offset:0 sc1
    v_lshlrev_b32 v60, 16, v148
    v_and_b32 v61, 0xffff0000, v148
    v_mul_f32 v60, v60, v104
    v_mul_f32 v61, v61, v105
    v_cvt_pk_bf16_f32 v116, v60, v61
    v_lshlrev_b32 v60, 16, v149
    v_and_b32 v61, 0xffff0000, v149
    v_mul_f32 v60, v60, v108
    v_mul_f32 v61, v61, v109
    v_cvt_pk_bf16_f32 v117, v60, v61
    v_lshlrev_b32 v60, 16, v150
    v_and_b32 v61, 0xffff0000, v150
    v_mul_f32 v60, v60, v106
    v_mul_f32 v61, v61, v107
    v_cvt_pk_bf16_f32 v118, v60, v61
    v_lshlrev_b32 v60, 16, v151
    v_and_b32 v61, 0xffff0000, v151
    v_mul_f32 v60, v60, v110
    v_mul_f32 v61, v61, v111
    v_cvt_pk_bf16_f32 v119, v60, v61
    s_add_u32 s49, s47, 119652352
    buffer_store_dwordx4 v[116:119], v3, s[8:11], s49 offen offset:512 sc1
    v_lshlrev_b32 v163, 16, v163
    v_accvgpr_read_b32 v96, a240
    v_accvgpr_read_b32 v97, a241
    v_accvgpr_read_b32 v98, a242
    v_accvgpr_read_b32 v99, a243
    v_accvgpr_read_b32 v100, a244
    v_accvgpr_read_b32 v101, a245
    v_accvgpr_read_b32 v102, a246
    v_accvgpr_read_b32 v103, a247
    v_accvgpr_read_b32 v104, a248
    v_accvgpr_read_b32 v105, a249
    v_accvgpr_read_b32 v106, a250
    v_accvgpr_read_b32 v107, a251
    v_accvgpr_read_b32 v108, a252
    v_accvgpr_read_b32 v109, a253
    v_accvgpr_read_b32 v110, a254
    v_accvgpr_read_b32 v111, a255
    v_add_f32 v96, v96, v163
    v_add_f32 v97, v97, v163
    v_add_f32 v98, v98, v163
    v_add_f32 v99, v99, v163
    v_add_f32 v100, v100, v163
    v_add_f32 v101, v101, v163
    v_add_f32 v102, v102, v163
    v_add_f32 v103, v103, v163
    v_add_f32 v104, v104, v163
    v_add_f32 v105, v105, v163
    v_add_f32 v106, v106, v163
    v_add_f32 v107, v107, v163
    v_add_f32 v108, v108, v163
    v_add_f32 v109, v109, v163
    v_add_f32 v110, v110, v163
    v_add_f32 v111, v111, v163
    v_lshlrev_b32 v60, 16, v152
    v_and_b32 v61, 0xffff0000, v152
    v_mul_f32 v60, v60, v96
    v_mul_f32 v61, v61, v97
    v_cvt_pk_bf16_f32 v120, v60, v61
    v_lshlrev_b32 v60, 16, v153
    v_and_b32 v61, 0xffff0000, v153
    v_mul_f32 v60, v60, v100
    v_mul_f32 v61, v61, v101
    v_cvt_pk_bf16_f32 v121, v60, v61
    v_lshlrev_b32 v60, 16, v154
    v_and_b32 v61, 0xffff0000, v154
    v_mul_f32 v60, v60, v98
    v_mul_f32 v61, v61, v99
    v_cvt_pk_bf16_f32 v122, v60, v61
    v_lshlrev_b32 v60, 16, v155
    v_and_b32 v61, 0xffff0000, v155
    v_mul_f32 v60, v60, v102
    v_mul_f32 v61, v61, v103
    v_cvt_pk_bf16_f32 v123, v60, v61
    s_add_u32 s49, s47, 119709696
    buffer_store_dwordx4 v[120:123], v3, s[8:11], s49 offen offset:0 sc1
    v_lshlrev_b32 v60, 16, v156
    v_and_b32 v61, 0xffff0000, v156
    v_mul_f32 v60, v60, v104
    v_mul_f32 v61, v61, v105
    v_cvt_pk_bf16_f32 v124, v60, v61
    v_lshlrev_b32 v60, 16, v157
    v_and_b32 v61, 0xffff0000, v157
    v_mul_f32 v60, v60, v108
    v_mul_f32 v61, v61, v109
    v_cvt_pk_bf16_f32 v125, v60, v61
    v_lshlrev_b32 v60, 16, v158
    v_and_b32 v61, 0xffff0000, v158
    v_mul_f32 v60, v60, v106
    v_mul_f32 v61, v61, v107
    v_cvt_pk_bf16_f32 v126, v60, v61
    v_lshlrev_b32 v60, 16, v159
    v_and_b32 v61, 0xffff0000, v159
    v_mul_f32 v60, v60, v110
    v_mul_f32 v61, v61, v111
    v_cvt_pk_bf16_f32 v127, v60, v61
    s_add_u32 s49, s47, 119709696
    buffer_store_dwordx4 v[124:127], v3, s[8:11], s49 offen offset:512 sc1
    s_waitcnt vmcnt(0)
    s_barrier
    s_cmp_lg_u32 s14, 0
    s_cbranch_scc1 spou_sg
    s_lshl_b32 s24, s40, 7
    s_add_u32 s24, s24, 20477952
    s_mov_b64 exec, 1
    v_mov_b32 v251, 1
    buffer_atomic_add v251, off, s[8:11], s24
    s_mov_b64 exec, -1
spou_sg:
    s_branch rl_out
rl_tok:
    s_cmp_ge_u32 s33, 48
    s_cbranch_scc1 tok_poolb
    s_cmp_ge_u32 s33, 16
    s_cselect_b32 s39, 32, 16
    s_cselect_b32 s20, 16, 0
    s_sub_u32 s38, s33, s20
tok_nexta:
    s_cmp_ge_u32 s38, 256
    s_cbranch_scc1 tok_done
    s_lshr_b32 s40, s38, 2
    s_lshr_b32 s29, s40, 2
    s_and_b32 s41, s38, 3
    s_mul_i32 s28, s29, 60
    s_and_b32 s20, s40, 3
    s_lshl_b32 s20, s20, 2
    s_add_u32 s28, s28, s20
    s_add_u32 s28, s28, s41
    s_cmp_ge_u32 s33, 16
    s_cselect_b32 s20, 16, 0
    s_add_u32 s28, s28, s20
    s_cmp_ge_u32 s33, 16
    s_cbranch_scc1 tok_pv
    s_lshl_b32 s27, s29, 7
    s_add_u32 s27, s27, 20449280
    s_waitcnt vmcnt(0)
    s_cmp_lg_u32 s14, 0
    s_cbranch_scc1 tok_wq_ok
tok_wq:
    buffer_load_dword v251, off, s[8:11], s27 sc1
    s_waitcnt vmcnt(0)
    v_readfirstlane_b32 s26, v251
    s_nop 2
    s_cmp_ge_u32 s26, 16
    s_cbranch_scc1 tok_wq_ok
    s_sleep 3
    s_sub_u32 s17, s17, 1
    s_cmp_gt_i32 s17, 0
    s_cbranch_scc1 tok_wq
tok_wq_ok:
    s_barrier
    v_lshlrev_b32 v1, 4, v0
    v_bfe_u32 v2, v0, 4, 1
    v_mul_u32_u24 v2, 14336, v2
    v_lshrrev_b32 v250, 5, v0
    v_lshl_add_u32 v2, v250, 8, v2
    v_and_b32 v250, 15, v0
    v_lshl_add_u32 v2, v250, 4, v2
    s_lshl_b32 s42, s41, 2
    s_add_u32 s42, s42, s14
    s_lshl_b32 s43, s42, 7
    s_lshl_b32 s20, s40, 1
    s_add_u32 s43, s43, s20
    s_mul_i32 s43, s43, 14336
    s_add_u32 s43, s43, 67108864
    s_add_u32 s22, s43, 0
    buffer_load_dwordx4 a[0:3], v2, s[8:11], s22 offen offset:0 sc1
    buffer_load_dwordx4 a[4:7], v2, s[8:11], s22 offen offset:512 sc1
    buffer_load_dwordx4 a[8:11], v2, s[8:11], s22 offen offset:1024 sc1
    buffer_load_dwordx4 a[12:15], v2, s[8:11], s22 offen offset:1536 sc1
    buffer_load_dwordx4 a[16:19], v2, s[8:11], s22 offen offset:2048 sc1
    buffer_load_dwordx4 a[20:23], v2, s[8:11], s22 offen offset:2560 sc1
    buffer_load_dwordx4 a[24:27], v2, s[8:11], s22 offen offset:3072 sc1
    buffer_load_dwordx4 a[28:31], v2, s[8:11], s22 offen offset:3584 sc1
    s_add_u32 s22, s43, 4096
    buffer_load_dwordx4 a[32:35], v2, s[8:11], s22 offen offset:0 sc1
    buffer_load_dwordx4 a[36:39], v2, s[8:11], s22 offen offset:512 sc1
    buffer_load_dwordx4 a[40:43], v2, s[8:11], s22 offen offset:1024 sc1
    buffer_load_dwordx4 a[44:47], v2, s[8:11], s22 offen offset:1536 sc1
    buffer_load_dwordx4 a[48:51], v2, s[8:11], s22 offen offset:2048 sc1
    buffer_load_dwordx4 a[52:55], v2, s[8:11], s22 offen offset:2560 sc1
    buffer_load_dwordx4 a[56:59], v2, s[8:11], s22 offen offset:3072 sc1
    buffer_load_dwordx4 a[60:63], v2, s[8:11], s22 offen offset:3584 sc1
    s_add_u32 s22, s43, 8192
    buffer_load_dwordx4 a[64:67], v2, s[8:11], s22 offen offset:0 sc1
    buffer_load_dwordx4 a[68:71], v2, s[8:11], s22 offen offset:512 sc1
    buffer_load_dwordx4 a[72:75], v2, s[8:11], s22 offen offset:1024 sc1
    buffer_load_dwordx4 a[76:79], v2, s[8:11], s22 offen offset:1536 sc1
    buffer_load_dwordx4 a[80:83], v2, s[8:11], s22 offen offset:2048 sc1
    buffer_load_dwordx4 a[84:87], v2, s[8:11], s22 offen offset:2560 sc1
    buffer_load_dwordx4 a[88:91], v2, s[8:11], s22 offen offset:3072 sc1
    buffer_load_dwordx4 a[92:95], v2, s[8:11], s22 offen offset:3584 sc1
    s_add_u32 s22, s43, 12288
    buffer_load_dwordx4 a[96:99], v2, s[8:11], s22 offen offset:0 sc1
    buffer_load_dwordx4 a[100:103], v2, s[8:11], s22 offen offset:512 sc1
    buffer_load_dwordx4 a[104:107], v2, s[8:11], s22 offen offset:1024 sc1
    buffer_load_dwordx4 a[108:111], v2, s[8:11], s22 offen offset:1536 sc1
    s_lshl_b32 s44, s40, 4
    s_add_u32 s44, s44, s42
    s_lshl_b32 s45, s44, 12
    s_add_u32 s45, s45, 96468992
    buffer_load_dwordx4 v[144:147], v1, s[8:11], s45 offen offset:0 sc1
    buffer_load_dwordx4 v[148:151], v1, s[8:11], s45 offen offset:1024 sc1
    buffer_load_dwordx4 v[152:155], v1, s[8:11], s45 offen offset:2048 sc1
    buffer_load_dwordx4 v[156:159], v1, s[8:11], s45 offen offset:3072 sc1
    v_and_b32 v5, 31, v0
    v_lshrrev_b32 v6, 5, v0
    v_lshlrev_b32 v7, 2, v6
    v_sub_u32 v7, v5, v7
    v_cmp_le_i32 s[64:65], 0, v7
    v_cmp_le_i32 s[66:67], 1, v7
    v_cmp_le_i32 s[68:69], 2, v7
    v_cmp_le_i32 s[70:71], 3, v7
    v_cmp_le_i32 s[72:73], 8, v7
    v_cmp_le_i32 s[74:75], 9, v7
    v_cmp_le_i32 s[76:77], 10, v7
    v_cmp_le_i32 s[78:79], 11, v7
    v_cmp_le_i32 s[80:81], 16, v7
    v_cmp_le_i32 s[82:83], 17, v7
    v_cmp_le_i32 s[84:85], 18, v7
    v_cmp_le_i32 s[86:87], 19, v7
    v_cmp_le_i32 s[88:89], 24, v7
    v_cmp_le_i32 s[90:91], 25, v7
    v_cmp_le_i32 s[92:93], 26, v7
    v_cmp_le_i32 s[94:95], 27, v7
    s_mov_b32 s27, 20459520
    s_waitcnt vmcnt(0)
    s_cmp_lg_u32 s14, 0
    s_cbranch_scc1 tok_wm_ok
tok_wm:
    buffer_load_dword v251, off, s[8:11], s27 sc1
    s_waitcnt vmcnt(0)
    v_readfirstlane_b32 s26, v251
    s_nop 2
    s_cmp_ge_u32 s26, s40
    s_cbranch_scc1 tok_wm_ok
    s_sleep 3
    s_sub_u32 s17, s17, 1
    s_cmp_gt_i32 s17, 0
    s_cbranch_scc1 tok_wm
tok_wm_ok:
    s_barrier
    s_mul_i32 s46, s40, 7168
    s_add_u32 s46, s46, 17301504
    s_lshl_b32 s20, s14, 11
    s_add_u32 s46, s46, s20
    buffer_load_dwordx4 v[8:11], v1, s[8:11], s46 offen sc1
    buffer_load_dwordx4 v[12:15], v1, s[8:11], s46 offen offset:1024 sc1
    v_add_u32 v3, s20, v1
    s_waitcnt vmcnt(0)
    ds_write_b128 v3, v[8:11]
    ds_write_b128 v3, v[12:15] offset:1024
    s_waitcnt lgkmcnt(0)
    s_barrier
    v_and_b32 v8, 7, v0
    v_lshlrev_b32 v8, 4, v8
    v_lshl_add_u32 v8, v6, 3, v8
    ds_read2_b32 v[16:17], v8 offset0:0 offset1:32
    ds_read2_b32 v[18:19], v8 offset0:1 offset1:33
    ds_read2_b32 v[20:21], v8 offset0:64 offset1:96
    ds_read2_b32 v[22:23], v8 offset0:65 offset1:97
    v_add_u32 v8, 512, v8
    ds_read2_b32 v[24:25], v8 offset0:0 offset1:32
    ds_read2_b32 v[26:27], v8 offset0:1 offset1:33
    ds_read2_b32 v[28:29], v8 offset0:64 offset1:96
    ds_read2_b32 v[30:31], v8 offset0:65 offset1:97
    s_waitcnt lgkmcnt(0)
    v_add_u32 v8, 512, v8
    ds_read2_b32 v[32:33], v8 offset0:0 offset1:32
    ds_read2_b32 v[34:35], v8 offset0:1 offset1:33
    ds_read2_b32 v[36:37], v8 offset0:64 offset1:96
    ds_read2_b32 v[38:39], v8 offset0:65 offset1:97
    v_add_u32 v8, 512, v8
    ds_read2_b32 v[40:41], v8 offset0:0 offset1:32
    ds_read2_b32 v[42:43], v8 offset0:1 offset1:33
    ds_read2_b32 v[44:45], v8 offset0:64 offset1:96
    ds_read2_b32 v[46:47], v8 offset0:65 offset1:97
    s_waitcnt lgkmcnt(0)
    v_add_u32 v8, 512, v8
    ds_read2_b32 v[48:49], v8 offset0:0 offset1:32
    ds_read2_b32 v[50:51], v8 offset0:1 offset1:33
    ds_read2_b32 v[52:53], v8 offset0:64 offset1:96
    ds_read2_b32 v[54:55], v8 offset0:65 offset1:97
    v_add_u32 v8, 512, v8
    ds_read2_b32 v[56:57], v8 offset0:0 offset1:32
    ds_read2_b32 v[58:59], v8 offset0:1 offset1:33
    ds_read2_b32 v[60:61], v8 offset0:64 offset1:96
    ds_read2_b32 v[62:63], v8 offset0:65 offset1:97
    s_waitcnt lgkmcnt(0)
    v_add_u32 v8, 512, v8
    ds_read2_b32 v[64:65], v8 offset0:0 offset1:32
    ds_read2_b32 v[66:67], v8 offset0:1 offset1:33
    ds_read2_b32 v[68:69], v8 offset0:64 offset1:96
    ds_read2_b32 v[70:71], v8 offset0:65 offset1:97
    v_add_u32 v8, 512, v8
    ds_read2_b32 v[72:73], v8 offset0:0 offset1:32
    ds_read2_b32 v[74:75], v8 offset0:1 offset1:33
    ds_read2_b32 v[76:77], v8 offset0:64 offset1:96
    ds_read2_b32 v[78:79], v8 offset0:65 offset1:97
    s_waitcnt lgkmcnt(0)
    v_add_u32 v8, 512, v8
    ds_read2_b32 v[80:81], v8 offset0:0 offset1:32
    ds_read2_b32 v[82:83], v8 offset0:1 offset1:33
    ds_read2_b32 v[84:85], v8 offset0:64 offset1:96
    ds_read2_b32 v[86:87], v8 offset0:65 offset1:97
    v_add_u32 v8, 512, v8
    ds_read2_b32 v[88:89], v8 offset0:0 offset1:32
    ds_read2_b32 v[90:91], v8 offset0:1 offset1:33
    ds_read2_b32 v[92:93], v8 offset0:64 offset1:96
    ds_read2_b32 v[94:95], v8 offset0:65 offset1:97
    s_waitcnt lgkmcnt(0)
    v_add_u32 v8, 512, v8
    ds_read2_b32 v[96:97], v8 offset0:0 offset1:32
    ds_read2_b32 v[98:99], v8 offset0:1 offset1:33
    ds_read2_b32 v[100:101], v8 offset0:64 offset1:96
    ds_read2_b32 v[102:103], v8 offset0:65 offset1:97
    v_add_u32 v8, 512, v8
    ds_read2_b32 v[104:105], v8 offset0:0 offset1:32
    ds_read2_b32 v[106:107], v8 offset0:1 offset1:33
    ds_read2_b32 v[108:109], v8 offset0:64 offset1:96
    ds_read2_b32 v[110:111], v8 offset0:65 offset1:97
    s_waitcnt lgkmcnt(0)
    v_add_u32 v8, 512, v8
    ds_read2_b32 v[112:113], v8 offset0:0 offset1:32
    ds_read2_b32 v[114:115], v8 offset0:1 offset1:33
    ds_read2_b32 v[116:117], v8 offset0:64 offset1:96
    ds_read2_b32 v[118:119], v8 offset0:65 offset1:97
    v_add_u32 v8, 512, v8
    ds_read2_b32 v[120:121], v8 offset0:0 offset1:32
    ds_read2_b32 v[122:123], v8 offset0:1 offset1:33
    ds_read2_b32 v[124:125], v8 offset0:64 offset1:96
    ds_read2_b32 v[126:127], v8 offset0:65 offset1:97
    s_waitcnt lgkmcnt(0)
    v_mfma_f32_32x32x16_bf16 v[128:143], v[16:19], a[0:3], 0
    v_mfma_f32_32x32x16_bf16 v[128:143], v[20:23], a[4:7], v[128:143]
    v_mfma_f32_32x32x16_bf16 v[128:143], v[24:27], a[8:11], v[128:143]
    v_mfma_f32_32x32x16_bf16 v[128:143], v[28:31], a[12:15], v[128:143]
    v_mfma_f32_32x32x16_bf16 v[128:143], v[32:35], a[16:19], v[128:143]
    v_mfma_f32_32x32x16_bf16 v[128:143], v[36:39], a[20:23], v[128:143]
    v_mfma_f32_32x32x16_bf16 v[128:143], v[40:43], a[24:27], v[128:143]
    v_mfma_f32_32x32x16_bf16 v[128:143], v[44:47], a[28:31], v[128:143]
    v_mfma_f32_32x32x16_bf16 v[128:143], v[48:51], a[32:35], v[128:143]
    v_mfma_f32_32x32x16_bf16 v[128:143], v[52:55], a[36:39], v[128:143]
    v_mfma_f32_32x32x16_bf16 v[128:143], v[56:59], a[40:43], v[128:143]
    v_mfma_f32_32x32x16_bf16 v[128:143], v[60:63], a[44:47], v[128:143]
    v_mfma_f32_32x32x16_bf16 v[128:143], v[64:67], a[48:51], v[128:143]
    v_mfma_f32_32x32x16_bf16 v[128:143], v[68:71], a[52:55], v[128:143]
    v_mfma_f32_32x32x16_bf16 v[128:143], v[72:75], a[56:59], v[128:143]
    v_mfma_f32_32x32x16_bf16 v[128:143], v[76:79], a[60:63], v[128:143]
    v_mfma_f32_32x32x16_bf16 v[128:143], v[80:83], a[64:67], v[128:143]
    v_mfma_f32_32x32x16_bf16 v[128:143], v[84:87], a[68:71], v[128:143]
    v_mfma_f32_32x32x16_bf16 v[128:143], v[88:91], a[72:75], v[128:143]
    v_mfma_f32_32x32x16_bf16 v[128:143], v[92:95], a[76:79], v[128:143]
    v_mfma_f32_32x32x16_bf16 v[128:143], v[96:99], a[80:83], v[128:143]
    v_mfma_f32_32x32x16_bf16 v[128:143], v[100:103], a[84:87], v[128:143]
    v_mfma_f32_32x32x16_bf16 v[128:143], v[104:107], a[88:91], v[128:143]
    v_mfma_f32_32x32x16_bf16 v[128:143], v[108:111], a[92:95], v[128:143]
    v_mfma_f32_32x32x16_bf16 v[128:143], v[112:115], a[96:99], v[128:143]
    v_mfma_f32_32x32x16_bf16 v[128:143], v[116:119], a[100:103], v[128:143]
    v_mfma_f32_32x32x16_bf16 v[128:143], v[120:123], a[104:107], v[128:143]
    v_mfma_f32_32x32x16_bf16 v[128:143], v[124:127], a[108:111], v[128:143]
    v_mov_b32 v11, 4048155338
    v_cndmask_b32 v144, v11, v144, s[64:65]
    v_cndmask_b32 v145, v11, v145, s[66:67]
    v_cndmask_b32 v146, v11, v146, s[68:69]
    v_cndmask_b32 v147, v11, v147, s[70:71]
    v_cndmask_b32 v148, v11, v148, s[72:73]
    v_cndmask_b32 v149, v11, v149, s[74:75]
    v_cndmask_b32 v150, v11, v150, s[76:77]
    v_cndmask_b32 v151, v11, v151, s[78:79]
    v_cndmask_b32 v152, v11, v152, s[80:81]
    v_cndmask_b32 v153, v11, v153, s[82:83]
    v_cndmask_b32 v154, v11, v154, s[84:85]
    v_cndmask_b32 v155, v11, v155, s[86:87]
    v_cndmask_b32 v156, v11, v156, s[88:89]
    v_cndmask_b32 v157, v11, v157, s[90:91]
    v_cndmask_b32 v158, v11, v158, s[92:93]
    v_cndmask_b32 v159, v11, v159, s[94:95]
    v_max3_f32 v12, v144, v145, v146
    v_max3_f32 v12, v12, v147, v148
    v_max3_f32 v12, v12, v149, v150
    v_max3_f32 v12, v12, v151, v152
    v_max3_f32 v12, v12, v153, v154
    v_max3_f32 v12, v12, v155, v156
    v_max3_f32 v12, v12, v157, v158
    v_max3_f32 v12, v12, v159, v128
    v_max3_f32 v12, v12, v129, v130
    v_max_f32 v12, v12, v131
    v_mov_b32 v13, v12
    s_nop 1
    v_permlane32_swap_b32 v13, v12
    v_max_f32 v12, v12, v13
    v_sub_f32 v144, v144, v12
    v_sub_f32 v145, v145, v12
    v_sub_f32 v146, v146, v12
    v_sub_f32 v147, v147, v12
    v_sub_f32 v148, v148, v12
    v_sub_f32 v149, v149, v12
    v_sub_f32 v150, v150, v12
    v_sub_f32 v151, v151, v12
    v_sub_f32 v152, v152, v12
    v_sub_f32 v153, v153, v12
    v_sub_f32 v154, v154, v12
    v_sub_f32 v155, v155, v12
    v_sub_f32 v156, v156, v12
    v_sub_f32 v157, v157, v12
    v_sub_f32 v158, v158, v12
    v_sub_f32 v159, v159, v12
    v_sub_f32 v128, v128, v12
    v_sub_f32 v129, v129, v12
    v_sub_f32 v130, v130, v12
    v_sub_f32 v131, v131, v12
    v_exp_f32 v144, v144
    v_exp_f32 v145, v145
    v_exp_f32 v146, v146
    v_exp_f32 v147, v147
    v_exp_f32 v148, v148
    v_exp_f32 v149, v149
    v_exp_f32 v150, v150
    v_exp_f32 v151, v151
    v_exp_f32 v152, v152
    v_exp_f32 v153, v153
    v_exp_f32 v154, v154
    v_exp_f32 v155, v155
    v_exp_f32 v156, v156
    v_exp_f32 v157, v157
    v_exp_f32 v158, v158
    v_exp_f32 v159, v159
    v_exp_f32 v128, v128
    v_exp_f32 v129, v129
    v_exp_f32 v130, v130
    v_exp_f32 v131, v131
    v_add_f32 v14, v144, v145
    v_add_f32 v14, v14, v146
    v_add_f32 v14, v14, v147
    v_add_f32 v14, v14, v148
    v_add_f32 v14, v14, v149
    v_add_f32 v14, v14, v150
    v_add_f32 v14, v14, v151
    v_add_f32 v14, v14, v152
    v_add_f32 v14, v14, v153
    v_add_f32 v14, v14, v154
    v_add_f32 v14, v14, v155
    v_add_f32 v14, v14, v156
    v_add_f32 v14, v14, v157
    v_add_f32 v14, v14, v158
    v_add_f32 v14, v14, v159
    v_add_f32 v14, v14, v128
    v_add_f32 v14, v14, v129
    v_add_f32 v14, v14, v130
    v_add_f32 v14, v14, v131
    v_mov_b32 v13, v14
    s_nop 1
    v_permlane32_swap_b32 v13, v14
    v_add_f32 v14, v14, v13
    v_rcp_f32 v14, v14
    s_nop 0
    v_mul_f32 v144, v144, v14
    v_mul_f32 v145, v145, v14
    v_mul_f32 v146, v146, v14
    v_mul_f32 v147, v147, v14
    v_mul_f32 v148, v148, v14
    v_mul_f32 v149, v149, v14
    v_mul_f32 v150, v150, v14
    v_mul_f32 v151, v151, v14
    v_mul_f32 v152, v152, v14
    v_mul_f32 v153, v153, v14
    v_mul_f32 v154, v154, v14
    v_mul_f32 v155, v155, v14
    v_mul_f32 v156, v156, v14
    v_mul_f32 v157, v157, v14
    v_mul_f32 v158, v158, v14
    v_mul_f32 v159, v159, v14
    v_mul_f32 v128, v128, v14
    v_mul_f32 v129, v129, v14
    v_mul_f32 v130, v130, v14
    v_mul_f32 v131, v131, v14
    s_lshl_b32 s47, s44, 11
    s_add_u32 s47, s47, 123731968
    v_cvt_pk_bf16_f32 v160, v144, v145
    v_cvt_pk_bf16_f32 v161, v148, v149
    v_cvt_pk_bf16_f32 v162, v146, v147
    v_cvt_pk_bf16_f32 v163, v150, v151
    buffer_store_dwordx4 v[160:163], v1, s[8:11], s47 offen offset:0 sc1
    v_cvt_pk_bf16_f32 v164, v152, v153
    v_cvt_pk_bf16_f32 v165, v156, v157
    v_cvt_pk_bf16_f32 v166, v154, v155
    v_cvt_pk_bf16_f32 v167, v158, v159
    buffer_store_dwordx4 v[164:167], v1, s[8:11], s47 offen offset:1024 sc1
    v_cvt_pk_bf16_f32 v168, v128, v129
    v_cvt_pk_bf16_f32 v169, v130, v131
    s_lshr_b32 s48, s44, 1
    s_lshl_b32 s48, s48, 10
    s_and_b32 s20, s42, 1
    s_lshl_b32 s20, s20, 2
    s_add_u32 s48, s48, s20
    s_add_u32 s48, s48, 125829120
    buffer_store_dword v168, v1, s[8:11], s48 offen sc1
    buffer_store_dword v169, v1, s[8:11], s48 offen offset:8 sc1
    s_waitcnt vmcnt(0)
    s_barrier
    s_cmp_lg_u32 s14, 0
    s_cbranch_scc1 toksp_sg
    s_lshl_b32 s24, s40, 7
    s_add_u32 s24, s24, 20463616
    s_mov_b64 exec, 1
    v_mov_b32 v251, 1
    buffer_atomic_add v251, off, s[8:11], s24
    s_mov_b64 exec, -1
toksp_sg:
    s_branch tok_adva
tok_pv:
    s_lshl_b32 s27, s29, 7
    s_add_u32 s20, s27, 20460544
    s_add_u32 s27, s27, 20447232
    s_cmp_lt_u32 s29, 2
    s_cselect_b32 s27, s20, s27
    s_cselect_b32 s31, 224, 16
    s_waitcnt vmcnt(0)
    s_cmp_lg_u32 s14, 0
    s_cbranch_scc1 tok_wv_ok
tok_wv:
    buffer_load_dword v251, off, s[8:11], s27 sc1
    s_waitcnt vmcnt(0)
    v_readfirstlane_b32 s26, v251
    s_nop 2
    s_cmp_ge_u32 s26, s31
    s_cbranch_scc1 tok_wv_ok
    s_sleep 3
    s_sub_u32 s17, s17, 1
    s_cmp_gt_i32 s17, 0
    s_cbranch_scc1 tok_wv
tok_wv_ok:
    s_barrier
    v_lshlrev_b32 v1, 4, v0
    v_bfe_u32 v2, v0, 4, 1
    v_mul_u32_u24 v2, 14336, v2
    v_lshrrev_b32 v250, 5, v0
    v_lshl_add_u32 v2, v250, 8, v2
    v_and_b32 v250, 15, v0
    v_lshl_add_u32 v2, v250, 4, v2
    v_bfe_u32 v3, v0, 4, 1
    v_mul_u32_u24 v3, 1024, v3
    v_lshrrev_b32 v250, 5, v0
    v_lshl_add_u32 v3, v250, 8, v3
    v_and_b32 v250, 15, v0
    v_lshl_add_u32 v3, v250, 4, v3
    v_bfe_u32 v4, v0, 4, 1
    v_mul_u32_u24 v4, 2048, v4
    v_lshrrev_b32 v250, 5, v0
    v_lshl_add_u32 v4, v250, 8, v4
    v_and_b32 v250, 15, v0
    v_lshl_add_u32 v4, v250, 4, v4
    s_lshl_b32 s42, s41, 2
    s_add_u32 s42, s42, s14
    s_mul_i32 s43, s40, 458752
    s_lshl_b32 s20, s42, 11
    s_add_u32 s43, s43, s20
    s_add_u32 s43, s43, 37748736
    s_add_u32 s22, s43, 0
    buffer_load_dwordx4 a[0:3], v3, s[8:11], s22 offen offset:0 sc1
    buffer_load_dwordx4 a[4:7], v3, s[8:11], s22 offen offset:512 sc1
    s_add_u32 s22, s43, 28672
    buffer_load_dwordx4 a[8:11], v3, s[8:11], s22 offen offset:0 sc1
    buffer_load_dwordx4 a[12:15], v3, s[8:11], s22 offen offset:512 sc1
    s_add_u32 s22, s43, 57344
    buffer_load_dwordx4 a[16:19], v3, s[8:11], s22 offen offset:0 sc1
    buffer_load_dwordx4 a[20:23], v3, s[8:11], s22 offen offset:512 sc1
    s_add_u32 s22, s43, 86016
    buffer_load_dwordx4 a[24:27], v3, s[8:11], s22 offen offset:0 sc1
    buffer_load_dwordx4 a[28:31], v3, s[8:11], s22 offen offset:512 sc1
    s_add_u32 s22, s43, 114688
    buffer_load_dwordx4 a[32:35], v3, s[8:11], s22 offen offset:0 sc1
    buffer_load_dwordx4 a[36:39], v3, s[8:11], s22 offen offset:512 sc1
    s_add_u32 s22, s43, 143360
    buffer_load_dwordx4 a[40:43], v3, s[8:11], s22 offen offset:0 sc1
    buffer_load_dwordx4 a[44:47], v3, s[8:11], s22 offen offset:512 sc1
    s_add_u32 s22, s43, 172032
    buffer_load_dwordx4 a[48:51], v3, s[8:11], s22 offen offset:0 sc1
    buffer_load_dwordx4 a[52:55], v3, s[8:11], s22 offen offset:512 sc1
    s_add_u32 s22, s43, 200704
    buffer_load_dwordx4 a[56:59], v3, s[8:11], s22 offen offset:0 sc1
    buffer_load_dwordx4 a[60:63], v3, s[8:11], s22 offen offset:512 sc1
    s_add_u32 s22, s43, 229376
    buffer_load_dwordx4 a[64:67], v3, s[8:11], s22 offen offset:0 sc1
    buffer_load_dwordx4 a[68:71], v3, s[8:11], s22 offen offset:512 sc1
    s_add_u32 s22, s43, 258048
    buffer_load_dwordx4 a[72:75], v3, s[8:11], s22 offen offset:0 sc1
    buffer_load_dwordx4 a[76:79], v3, s[8:11], s22 offen offset:512 sc1
    s_add_u32 s22, s43, 286720
    buffer_load_dwordx4 a[80:83], v3, s[8:11], s22 offen offset:0 sc1
    buffer_load_dwordx4 a[84:87], v3, s[8:11], s22 offen offset:512 sc1
    s_add_u32 s22, s43, 315392
    buffer_load_dwordx4 a[88:91], v3, s[8:11], s22 offen offset:0 sc1
    buffer_load_dwordx4 a[92:95], v3, s[8:11], s22 offen offset:512 sc1
    s_add_u32 s22, s43, 344064
    buffer_load_dwordx4 a[96:99], v3, s[8:11], s22 offen offset:0 sc1
    buffer_load_dwordx4 a[100:103], v3, s[8:11], s22 offen offset:512 sc1
    s_add_u32 s22, s43, 372736
    buffer_load_dwordx4 a[104:107], v3, s[8:11], s22 offen offset:0 sc1
    buffer_load_dwordx4 a[108:111], v3, s[8:11], s22 offen offset:512 sc1
    s_add_u32 s22, s43, 401408
    buffer_load_dwordx4 a[112:115], v3, s[8:11], s22 offen offset:0 sc1
    buffer_load_dwordx4 a[116:119], v3, s[8:11], s22 offen offset:512 sc1
    s_add_u32 s22, s43, 430080
    buffer_load_dwordx4 a[120:123], v3, s[8:11], s22 offen offset:0 sc1
    buffer_load_dwordx4 a[124:127], v3, s[8:11], s22 offen offset:512 sc1
    s_lshl_b32 s44, s40, 1
    s_mul_i32 s44, s44, 14336
    s_lshl_b32 s20, s42, 10
    s_add_u32 s44, s44, s20
    s_add_u32 s22, s44, 100663296
    buffer_load_dwordx4 v[192:195], v2, s[8:11], s22 offen offset:0
    buffer_load_dwordx4 v[196:199], v2, s[8:11], s22 offen offset:512
    s_add_u32 s31, s40, 1
    s_mov_b32 s27, 20459520
    s_waitcnt vmcnt(0)
    s_cmp_lg_u32 s14, 0
    s_cbranch_scc1 tok_wb_ok
tok_wb:
    buffer_load_dword v251, off, s[8:11], s27 sc1
    s_waitcnt vmcnt(0)
    v_readfirstlane_b32 s26, v251
    s_nop 2
    s_cmp_ge_u32 s26, s31
    s_cbranch_scc1 tok_wb_ok
    s_sleep 3
    s_sub_u32 s17, s17, 1
    s_cmp_gt_i32 s17, 0
    s_cbranch_scc1 tok_wb
tok_wb_ok:
    s_barrier
    s_lshl_b32 s27, s40, 7
    s_add_u32 s27, s27, 20463616
    s_waitcnt vmcnt(0)
    s_cmp_lg_u32 s14, 0
    s_cbranch_scc1 tok_wp_ok
tok_wp:
    buffer_load_dword v251, off, s[8:11], s27 sc1
    s_waitcnt vmcnt(0)
    v_readfirstlane_b32 s26, v251
    s_nop 2
    s_cmp_ge_u32 s26, 4
    s_cbranch_scc1 tok_wp_ok
    s_sleep 3
    s_sub_u32 s17, s17, 1
    s_cmp_gt_i32 s17, 0
    s_cbranch_scc1 tok_wp
tok_wp_ok:
    s_barrier
    s_mul_i32 s45, s40, 229376
    s_lshl_b32 s20, s42, 14
    s_add_u32 s45, s45, s20
    s_add_u32 s45, s45, 20971520
    s_add_u32 s22, s45, 0
    buffer_load_dwordx4 a[128:131], v4, s[8:11], s22 offen offset:0 sc1
    buffer_load_dwordx4 a[132:135], v4, s[8:11], s22 offen offset:512 sc1
    s_add_u32 s22, s45, 1024
    buffer_load_dwordx4 a[136:139], v4, s[8:11], s22 offen offset:0 sc1
    buffer_load_dwordx4 a[140:143], v4, s[8:11], s22 offen offset:512 sc1
    s_add_u32 s22, s45, 4096
    buffer_load_dwordx4 a[144:147], v4, s[8:11], s22 offen offset:0 sc1
    buffer_load_dwordx4 a[148:151], v4, s[8:11], s22 offen offset:512 sc1
    s_add_u32 s22, s45, 5120
    buffer_load_dwordx4 a[152:155], v4, s[8:11], s22 offen offset:0 sc1
    buffer_load_dwordx4 a[156:159], v4, s[8:11], s22 offen offset:512 sc1
    s_add_u32 s22, s45, 8192
    buffer_load_dwordx4 a[160:163], v4, s[8:11], s22 offen offset:0 sc1
    buffer_load_dwordx4 a[164:167], v4, s[8:11], s22 offen offset:512 sc1
    s_add_u32 s22, s45, 9216
    buffer_load_dwordx4 a[168:171], v4, s[8:11], s22 offen offset:0 sc1
    buffer_load_dwordx4 a[172:175], v4, s[8:11], s22 offen offset:512 sc1
    s_add_u32 s22, s45, 12288
    buffer_load_dwordx4 a[176:179], v4, s[8:11], s22 offen offset:0 sc1
    buffer_load_dwordx4 a[180:183], v4, s[8:11], s22 offen offset:512 sc1
    s_add_u32 s22, s45, 13312
    buffer_load_dwordx4 a[184:187], v4, s[8:11], s22 offen offset:0 sc1
    buffer_load_dwordx4 a[188:191], v4, s[8:11], s22 offen offset:512 sc1
    s_lshl_b32 s46, s40, 15
    s_add_u32 s46, s46, 123731968
    s_lshl_b32 s47, s40, 13
    s_add_u32 s47, s47, 125829120
    s_lshl_b32 s20, s14, 13
    s_add_u32 s46, s46, s20
    s_lshl_b32 s21, s14, 11
    s_add_u32 s47, s47, s21
    s_add_u32 s22, s46, 0
    buffer_load_dwordx4 v[16:19], v1, s[8:11], s22 offen offset:0 sc1
    buffer_load_dwordx4 v[20:23], v1, s[8:11], s22 offen offset:1024 sc1
    buffer_load_dwordx4 v[24:27], v1, s[8:11], s22 offen offset:2048 sc1
    buffer_load_dwordx4 v[28:31], v1, s[8:11], s22 offen offset:3072 sc1
    s_add_u32 s22, s46, 4096
    buffer_load_dwordx4 v[32:35], v1, s[8:11], s22 offen offset:0 sc1
    buffer_load_dwordx4 v[36:39], v1, s[8:11], s22 offen offset:1024 sc1
    buffer_load_dwordx4 v[40:43], v1, s[8:11], s22 offen offset:2048 sc1
    buffer_load_dwordx4 v[44:47], v1, s[8:11], s22 offen offset:3072 sc1
    buffer_load_dwordx4 v[48:51], v1, s[8:11], s47 offen offset:0 sc1
    buffer_load_dwordx4 v[52:55], v1, s[8:11], s47 offen offset:1024 sc1
    v_add_u32 v5, s20, v1
    v_add_u32 v6, s21, v1
    s_waitcnt vmcnt(0)
    ds_write_b128 v5, v[16:19] offset:0
    ds_write_b128 v5, v[20:23] offset:1024
    ds_write_b128 v5, v[24:27] offset:2048
    ds_write_b128 v5, v[28:31] offset:3072
    ds_write_b128 v5, v[32:35] offset:4096
    ds_write_b128 v5, v[36:39] offset:5120
    ds_write_b128 v5, v[40:43] offset:6144
    ds_write_b128 v5, v[44:47] offset:7168
    ds_write_b128 v6, v[48:51] offset:32768
    ds_write_b128 v6, v[52:55] offset:33792
    s_waitcnt lgkmcnt(0)
    s_barrier
    ds_read_b128 v[16:19], v1 offset:0
    ds_read_b128 v[20:23], v1 offset:1024
    ds_read_b128 v[24:27], v1 offset:2048
    ds_read_b128 v[28:31], v1 offset:3072
    ds_read_b128 v[32:35], v1 offset:4096
    ds_read_b128 v[36:39], v1 offset:5120
    ds_read_b128 v[40:43], v1 offset:6144
    ds_read_b128 v[44:47], v1 offset:7168
    s_waitcnt lgkmcnt(0)
    ds_read_b128 v[48:51], v1 offset:8192
    ds_read_b128 v[52:55], v1 offset:9216
    ds_read_b128 v[56:59], v1 offset:10240
    ds_read_b128 v[60:63], v1 offset:11264
    ds_read_b128 v[64:67], v1 offset:12288
    ds_read_b128 v[68:71], v1 offset:13312
    ds_read_b128 v[72:75], v1 offset:14336
    ds_read_b128 v[76:79], v1 offset:15360
    s_waitcnt lgkmcnt(0)
    ds_read_b128 v[80:83], v1 offset:16384
    ds_read_b128 v[84:87], v1 offset:17408
    ds_read_b128 v[88:91], v1 offset:18432
    ds_read_b128 v[92:95], v1 offset:19456
    ds_read_b128 v[96:99], v1 offset:20480
    ds_read_b128 v[100:103], v1 offset:21504
    ds_read_b128 v[104:107], v1 offset:22528
    ds_read_b128 v[108:111], v1 offset:23552
    s_waitcnt lgkmcnt(0)
    ds_read_b128 v[112:115], v1 offset:24576
    ds_read_b128 v[116:119], v1 offset:25600
    ds_read_b128 v[120:123], v1 offset:26624
    ds_read_b128 v[124:127], v1 offset:27648
    ds_read_b128 v[128:131], v1 offset:28672
    ds_read_b128 v[132:135], v1 offset:29696
    ds_read_b128 v[136:139], v1 offset:30720
    ds_read_b128 v[140:143], v1 offset:31744
    s_waitcnt lgkmcnt(0)
    ds_read_b128 v[144:147], v1 offset:32768
    ds_read_b128 v[148:151], v1 offset:33792
    ds_read_b128 v[152:155], v1 offset:34816
    ds_read_b128 v[156:159], v1 offset:35840
    ds_read_b128 v[160:163], v1 offset:36864
    ds_read_b128 v[164:167], v1 offset:37888
    ds_read_b128 v[168:171], v1 offset:38912
    ds_read_b128 v[172:175], v1 offset:39936
    s_waitcnt lgkmcnt(0)
    v_mfma_f32_32x32x16_bf16 v[176:191], a[0:3], v[16:19], 0
    v_mfma_f32_32x32x16_bf16 v[176:191], a[4:7], v[20:23], v[176:191]
    v_mfma_f32_32x32x16_bf16 v[176:191], a[8:11], v[24:27], v[176:191]
    v_mfma_f32_32x32x16_bf16 v[176:191], a[12:15], v[28:31], v[176:191]
    v_mfma_f32_32x32x16_bf16 v[176:191], a[16:19], v[32:35], v[176:191]
    v_mfma_f32_32x32x16_bf16 v[176:191], a[20:23], v[36:39], v[176:191]
    v_mfma_f32_32x32x16_bf16 v[176:191], a[24:27], v[40:43], v[176:191]
    v_mfma_f32_32x32x16_bf16 v[176:191], a[28:31], v[44:47], v[176:191]
    v_mfma_f32_32x32x16_bf16 v[176:191], a[32:35], v[48:51], v[176:191]
    v_mfma_f32_32x32x16_bf16 v[176:191], a[36:39], v[52:55], v[176:191]
    v_mfma_f32_32x32x16_bf16 v[176:191], a[40:43], v[56:59], v[176:191]
    v_mfma_f32_32x32x16_bf16 v[176:191], a[44:47], v[60:63], v[176:191]
    v_mfma_f32_32x32x16_bf16 v[176:191], a[48:51], v[64:67], v[176:191]
    v_mfma_f32_32x32x16_bf16 v[176:191], a[52:55], v[68:71], v[176:191]
    v_mfma_f32_32x32x16_bf16 v[176:191], a[56:59], v[72:75], v[176:191]
    v_mfma_f32_32x32x16_bf16 v[176:191], a[60:63], v[76:79], v[176:191]
    v_mfma_f32_32x32x16_bf16 v[176:191], a[64:67], v[80:83], v[176:191]
    v_mfma_f32_32x32x16_bf16 v[176:191], a[68:71], v[84:87], v[176:191]
    v_mfma_f32_32x32x16_bf16 v[176:191], a[72:75], v[88:91], v[176:191]
    v_mfma_f32_32x32x16_bf16 v[176:191], a[76:79], v[92:95], v[176:191]
    v_mfma_f32_32x32x16_bf16 v[176:191], a[80:83], v[96:99], v[176:191]
    v_mfma_f32_32x32x16_bf16 v[176:191], a[84:87], v[100:103], v[176:191]
    v_mfma_f32_32x32x16_bf16 v[176:191], a[88:91], v[104:107], v[176:191]
    v_mfma_f32_32x32x16_bf16 v[176:191], a[92:95], v[108:111], v[176:191]
    v_mfma_f32_32x32x16_bf16 v[176:191], a[96:99], v[112:115], v[176:191]
    v_mfma_f32_32x32x16_bf16 v[176:191], a[100:103], v[116:119], v[176:191]
    v_mfma_f32_32x32x16_bf16 v[176:191], a[104:107], v[120:123], v[176:191]
    v_mfma_f32_32x32x16_bf16 v[176:191], a[108:111], v[124:127], v[176:191]
    v_mfma_f32_32x32x16_bf16 v[176:191], a[112:115], v[128:131], v[176:191]
    v_mfma_f32_32x32x16_bf16 v[176:191], a[116:119], v[132:135], v[176:191]
    v_mfma_f32_32x32x16_bf16 v[176:191], a[120:123], v[136:139], v[176:191]
    v_mfma_f32_32x32x16_bf16 v[176:191], a[124:127], v[140:143], v[176:191]
    v_mfma_f32_32x32x16_bf16 v[176:191], a[128:131], v[144:147], v[176:191]
    v_mfma_f32_32x32x16_bf16 v[176:191], a[132:135], v[144:147], v[176:191]
    v_mfma_f32_32x32x16_bf16 v[176:191], a[136:139], v[148:151], v[176:191]
    v_mfma_f32_32x32x16_bf16 v[176:191], a[140:143], v[148:151], v[176:191]
    v_mfma_f32_32x32x16_bf16 v[176:191], a[144:147], v[152:155], v[176:191]
    v_mfma_f32_32x32x16_bf16 v[176:191], a[148:151], v[152:155], v[176:191]
    v_mfma_f32_32x32x16_bf16 v[176:191], a[152:155], v[156:159], v[176:191]
    v_mfma_f32_32x32x16_bf16 v[176:191], a[156:159], v[156:159], v[176:191]
    v_mfma_f32_32x32x16_bf16 v[176:191], a[160:163], v[160:163], v[176:191]
    v_mfma_f32_32x32x16_bf16 v[176:191], a[164:167], v[160:163], v[176:191]
    v_mfma_f32_32x32x16_bf16 v[176:191], a[168:171], v[164:167], v[176:191]
    v_mfma_f32_32x32x16_bf16 v[176:191], a[172:175], v[164:167], v[176:191]
    v_mfma_f32_32x32x16_bf16 v[176:191], a[176:179], v[168:171], v[176:191]
    v_mfma_f32_32x32x16_bf16 v[176:191], a[180:183], v[168:171], v[176:191]
    v_mfma_f32_32x32x16_bf16 v[176:191], a[184:187], v[172:175], v[176:191]
    v_mfma_f32_32x32x16_bf16 v[176:191], a[188:191], v[172:175], v[176:191]
    s_cmp_ge_u32 s42, 14
    s_nop 10
    s_cbranch_scc1 tokv_absent
    v_cvt_pk_bf16_f32 v15, v176, v177
    v_lshlrev_b32 v208, 16, v15
    v_and_b32 v209, 0xffff0000, v15
    v_lshlrev_b32 v13, 16, v192
    v_and_b32 v12, 0xffff0000, v192
    v_add_f32 v208, v208, v13
    v_add_f32 v209, v209, v12
    v_cvt_pk_bf16_f32 v200, v208, v209
    v_lshlrev_b32 v208, 16, v200
    v_and_b32 v209, 0xffff0000, v200
    v_cvt_pk_bf16_f32 v15, v180, v181
    v_lshlrev_b32 v212, 16, v15
    v_and_b32 v213, 0xffff0000, v15
    v_lshlrev_b32 v13, 16, v193
    v_and_b32 v12, 0xffff0000, v193
    v_add_f32 v212, v212, v13
    v_add_f32 v213, v213, v12
    v_cvt_pk_bf16_f32 v201, v212, v213
    v_lshlrev_b32 v212, 16, v201
    v_and_b32 v213, 0xffff0000, v201
    v_cvt_pk_bf16_f32 v15, v178, v179
    v_lshlrev_b32 v210, 16, v15
    v_and_b32 v211, 0xffff0000, v15
    v_lshlrev_b32 v13, 16, v194
    v_and_b32 v12, 0xffff0000, v194
    v_add_f32 v210, v210, v13
    v_add_f32 v211, v211, v12
    v_cvt_pk_bf16_f32 v202, v210, v211
    v_lshlrev_b32 v210, 16, v202
    v_and_b32 v211, 0xffff0000, v202
    v_cvt_pk_bf16_f32 v15, v182, v183
    v_lshlrev_b32 v214, 16, v15
    v_and_b32 v215, 0xffff0000, v15
    v_lshlrev_b32 v13, 16, v195
    v_and_b32 v12, 0xffff0000, v195
    v_add_f32 v214, v214, v13
    v_add_f32 v215, v215, v12
    v_cvt_pk_bf16_f32 v203, v214, v215
    v_lshlrev_b32 v214, 16, v203
    v_and_b32 v215, 0xffff0000, v203
    s_add_u32 s22, s44, 102760448
    buffer_store_dwordx4 v[200:203], v2, s[8:11], s22 offen offset:0 sc1
    v_cvt_pk_bf16_f32 v15, v184, v185
    v_lshlrev_b32 v216, 16, v15
    v_and_b32 v217, 0xffff0000, v15
    v_lshlrev_b32 v13, 16, v196
    v_and_b32 v12, 0xffff0000, v196
    v_add_f32 v216, v216, v13
    v_add_f32 v217, v217, v12
    v_cvt_pk_bf16_f32 v204, v216, v217
    v_lshlrev_b32 v216, 16, v204
    v_and_b32 v217, 0xffff0000, v204
    v_cvt_pk_bf16_f32 v15, v188, v189
    v_lshlrev_b32 v220, 16, v15
    v_and_b32 v221, 0xffff0000, v15
    v_lshlrev_b32 v13, 16, v197
    v_and_b32 v12, 0xffff0000, v197
    v_add_f32 v220, v220, v13
    v_add_f32 v221, v221, v12
    v_cvt_pk_bf16_f32 v205, v220, v221
    v_lshlrev_b32 v220, 16, v205
    v_and_b32 v221, 0xffff0000, v205
    v_cvt_pk_bf16_f32 v15, v186, v187
    v_lshlrev_b32 v218, 16, v15
    v_and_b32 v219, 0xffff0000, v15
    v_lshlrev_b32 v13, 16, v198
    v_and_b32 v12, 0xffff0000, v198
    v_add_f32 v218, v218, v13
    v_add_f32 v219, v219, v12
    v_cvt_pk_bf16_f32 v206, v218, v219
    v_lshlrev_b32 v218, 16, v206
    v_and_b32 v219, 0xffff0000, v206
    v_cvt_pk_bf16_f32 v15, v190, v191
    v_lshlrev_b32 v222, 16, v15
    v_and_b32 v223, 0xffff0000, v15
    v_lshlrev_b32 v13, 16, v199
    v_and_b32 v12, 0xffff0000, v199
    v_add_f32 v222, v222, v13
    v_add_f32 v223, v223, v12
    v_cvt_pk_bf16_f32 v207, v222, v223
    v_lshlrev_b32 v222, 16, v207
    v_and_b32 v223, 0xffff0000, v207
    s_add_u32 s22, s44, 102760448
    buffer_store_dwordx4 v[204:207], v2, s[8:11], s22 offen offset:512 sc1
    v_add_f32 v8, v208, v209
    v_mul_f32 v9, v208, v208
    v_fmac_f32 v9, v209, v209
    v_add_f32 v8, v8, v210
    v_fmac_f32 v9, v210, v210
    v_add_f32 v8, v8, v211
    v_fmac_f32 v9, v211, v211
    v_add_f32 v8, v8, v212
    v_fmac_f32 v9, v212, v212
    v_add_f32 v8, v8, v213
    v_fmac_f32 v9, v213, v213
    v_add_f32 v8, v8, v214
    v_fmac_f32 v9, v214, v214
    v_add_f32 v8, v8, v215
    v_fmac_f32 v9, v215, v215
    v_add_f32 v8, v8, v216
    v_fmac_f32 v9, v216, v216
    v_add_f32 v8, v8, v217
    v_fmac_f32 v9, v217, v217
    v_add_f32 v8, v8, v218
    v_fmac_f32 v9, v218, v218
    v_add_f32 v8, v8, v219
    v_fmac_f32 v9, v219, v219
    v_add_f32 v8, v8, v220
    v_fmac_f32 v9, v220, v220
    v_add_f32 v8, v8, v221
    v_fmac_f32 v9, v221, v221
    v_add_f32 v8, v8, v222
    v_fmac_f32 v9, v222, v222
    v_add_f32 v8, v8, v223
    v_fmac_f32 v9, v223, v223
    v_mov_b32 v13, v8
    s_nop 1
    v_permlane32_swap_b32 v13, v8
    v_add_f32 v8, v8, v13
    v_mov_b32 v13, v9
    s_nop 1
    v_permlane32_swap_b32 v13, v9
    v_add_f32 v9, v9, v13
    s_lshl_b32 s22, s40, 4
    s_add_u32 s22, s22, s42
    s_lshl_b32 s22, s22, 8
    s_add_u32 s22, s22, 126877696
    v_lshlrev_b32 v10, 3, v0
    s_mov_b32 exec_hi, 0
    buffer_store_dwordx2 v[8:9], v10, s[8:11], s22 offen sc1
    s_mov_b64 exec, -1
tokv_absent:
    s_waitcnt vmcnt(0)
    s_barrier
    s_cmp_lg_u32 s14, 0
    s_cbranch_scc1 toksv_sg
    s_lshl_b32 s24, s40, 7
    s_add_u32 s24, s24, 20500480
    s_mov_b64 exec, 1
    v_mov_b32 v251, 1
    buffer_atomic_add v251, off, s[8:11], s24
    s_mov_b64 exec, -1
toksv_sg:
tok_adva:
    s_barrier
    s_add_u32 s38, s38, s39
    s_branch tok_nexta
tok_poolb:
    s_sub_u32 s38, s33, 48
tok_next:
    s_cmp_ge_u32 s38, 448
    s_cbranch_scc1 tok_done
    s_mul_hi_u32 s29, s38, 153391690
    s_mul_i32 s20, s29, 28
    s_sub_u32 s41, s38, s20
    s_mul_i32 s28, s29, 60
    s_add_u32 s28, s28, s41
    s_add_u32 s28, s28, 32
    s_mov_b32 s40, s29
    s_add_u32 s20, s41, 14
    s_sub_u32 s21, s41, 14
    s_cmp_lt_u32 s41, 14
    s_cselect_b32 s41, s20, s21
    s_mov_b32 s27, 20459648
    s_waitcnt vmcnt(0)
    s_cmp_lg_u32 s14, 0
    s_cbranch_scc1 tok_wt_ok
tok_wt:
    buffer_load_dword v251, off, s[8:11], s27 sc1
    s_waitcnt vmcnt(0)
    v_readfirstlane_b32 s26, v251
    s_nop 2
    s_cmp_ge_u32 s26, 224
    s_cbranch_scc1 tok_wt_ok
    s_sleep 3
    s_sub_u32 s17, s17, 1
    s_cmp_gt_i32 s17, 0
    s_cbranch_scc1 tok_wt
tok_wt_ok:
    s_barrier
    s_cmp_ge_u32 s41, 14
    s_cbranch_scc1 tok_z2
    v_lshlrev_b32 v1, 4, v0
    v_bfe_u32 v2, v0, 4, 1
    v_mul_u32_u24 v2, 14336, v2
    v_lshrrev_b32 v250, 5, v0
    v_lshl_add_u32 v2, v250, 8, v2
    v_and_b32 v250, 15, v0
    v_lshl_add_u32 v2, v250, 4, v2
    v_bfe_u32 v3, v0, 4, 1
    v_mul_u32_u24 v3, 28672, v3
    v_lshrrev_b32 v250, 5, v0
    v_lshl_add_u32 v3, v250, 8, v3
    v_and_b32 v250, 15, v0
    v_lshl_add_u32 v3, v250, 4, v3
    v_mov_b32 v4, v2
    v_add_u32 v5, 57344, v2
    v_add_u32 v6, 114688, v2
    s_mov_b32 s61, 3184710632
    v_mov_b32 v194, 3222493025
    s_lshl_b32 s48, s40, 2
    s_add_u32 s48, s48, s14
    s_lshl_b32 s45, s48, 1
    s_mul_i32 s46, s45, 14336
    s_add_u32 s46, s46, 102760448
    s_mul_i32 s42, s41, 57344
    s_mul_i32 s20, s14, 7168
    s_add_u32 s42, s42, s20
    s_add_u32 s42, s42, 106954752
    s_mov_b32 s44, s20
    s_add_u32 m0, s44, 0
    s_add_u32 s21, s42, 0
    buffer_load_dwordx4 v1, s[8:11], s21 offen offset:0 lds
    buffer_load_dwordx4 v1, s[8:11], s21 offen offset:1024 lds
    buffer_load_dwordx4 v1, s[8:11], s21 offen offset:2048 lds
    buffer_load_dwordx4 v1, s[8:11], s21 offen offset:3072 lds
    s_add_u32 m0, s44, 4096
    s_add_u32 s21, s42, 4096
    buffer_load_dwordx4 v1, s[8:11], s21 offen offset:0 lds
    buffer_load_dwordx4 v1, s[8:11], s21 offen offset:1024 lds
    buffer_load_dwordx4 v1, s[8:11], s21 offen offset:2048 lds
    s_add_u32 m0, s44, 28672
    s_add_u32 s21, s42, 28672
    buffer_load_dwordx4 v1, s[8:11], s21 offen offset:0 lds
    buffer_load_dwordx4 v1, s[8:11], s21 offen offset:1024 lds
    buffer_load_dwordx4 v1, s[8:11], s21 offen offset:2048 lds
    buffer_load_dwordx4 v1, s[8:11], s21 offen offset:3072 lds
    s_add_u32 m0, s44, 32768
    s_add_u32 s21, s42, 32768
    buffer_load_dwordx4 v1, s[8:11], s21 offen offset:0 lds
    buffer_load_dwordx4 v1, s[8:11], s21 offen offset:1024 lds
    buffer_load_dwordx4 v1, s[8:11], s21 offen offset:2048 lds
    v_lshrrev_b32 v7, 5, v0
    v_lshlrev_b32 v7, 4, v7
    s_mul_i32 s47, s41, 256
    s_add_u32 s47, s47, 127926272
    s_waitcnt vmcnt(0)
    s_barrier
    s_lshl_b32 s27, s40, 2
    s_add_u32 s27, s27, s14
    s_lshl_b32 s27, s27, 7
    s_add_u32 s27, s27, 20500480
tok_wh1:
    buffer_load_dword v251, off, s[8:11], s27 sc1
    s_waitcnt vmcnt(0)
    v_readfirstlane_b32 s26, v251
    s_nop 2
    s_cmp_ge_u32 s26, 4
    s_cbranch_scc1 tok_wh1_ok
    s_sleep 2
    s_sub_u32 s17, s17, 1
    s_cmp_gt_i32 s17, 0
    s_cbranch_scc1 tok_wh1
tok_wh1_ok:
    s_add_u32 s22, s46, 0
    buffer_load_dwordx4 a[0:3], v2, s[8:11], s22 offen offset:0
    buffer_load_dwordx4 a[4:7], v2, s[8:11], s22 offen offset:512
    buffer_load_dwordx4 a[8:11], v2, s[8:11], s22 offen offset:1024
    buffer_load_dwordx4 a[12:15], v2, s[8:11], s22 offen offset:1536
    buffer_load_dwordx4 a[16:19], v2, s[8:11], s22 offen offset:2048
    buffer_load_dwordx4 a[20:23], v2, s[8:11], s22 offen offset:2560
    buffer_load_dwordx4 a[24:27], v2, s[8:11], s22 offen offset:3072
    buffer_load_dwordx4 a[28:31], v2, s[8:11], s22 offen offset:3584
    s_add_u32 s22, s46, 4096
    buffer_load_dwordx4 a[32:35], v2, s[8:11], s22 offen offset:0
    buffer_load_dwordx4 a[36:39], v2, s[8:11], s22 offen offset:512
    buffer_load_dwordx4 a[40:43], v2, s[8:11], s22 offen offset:1024
    buffer_load_dwordx4 a[44:47], v2, s[8:11], s22 offen offset:1536
    buffer_load_dwordx4 a[48:51], v2, s[8:11], s22 offen offset:2048
    buffer_load_dwordx4 a[52:55], v2, s[8:11], s22 offen offset:2560
    buffer_load_dwordx4 a[56:59], v2, s[8:11], s22 offen offset:3072
    buffer_load_dwordx4 a[60:63], v2, s[8:11], s22 offen offset:3584
    s_add_u32 s22, s46, 8192
    buffer_load_dwordx4 a[64:67], v2, s[8:11], s22 offen offset:0
    buffer_load_dwordx4 a[68:71], v2, s[8:11], s22 offen offset:512
    buffer_load_dwordx4 a[72:75], v2, s[8:11], s22 offen offset:1024
    buffer_load_dwordx4 a[76:79], v2, s[8:11], s22 offen offset:1536
    buffer_load_dwordx4 a[80:83], v2, s[8:11], s22 offen offset:2048
    buffer_load_dwordx4 a[84:87], v2, s[8:11], s22 offen offset:2560
    buffer_load_dwordx4 a[88:91], v2, s[8:11], s22 offen offset:3072
    buffer_load_dwordx4 a[92:95], v2, s[8:11], s22 offen offset:3584
    s_add_u32 s22, s46, 12288
    buffer_load_dwordx4 a[96:99], v2, s[8:11], s22 offen offset:0
    buffer_load_dwordx4 a[100:103], v2, s[8:11], s22 offen offset:512
    buffer_load_dwordx4 a[104:107], v2, s[8:11], s22 offen offset:1024
    buffer_load_dwordx4 a[108:111], v2, s[8:11], s22 offen offset:1536
    v_and_b32 v200, 31, v0
    v_lshlrev_b32 v200, 3, v200
    s_lshl_b32 s22, s48, 12
    s_add_u32 s22, s22, 126877696
    buffer_load_dwordx2 v[32:33], v200, s[8:11], s22 offen offset:0
    buffer_load_dwordx2 v[34:35], v200, s[8:11], s22 offen offset:256
    buffer_load_dwordx2 v[36:37], v200, s[8:11], s22 offen offset:512
    buffer_load_dwordx2 v[38:39], v200, s[8:11], s22 offen offset:768
    buffer_load_dwordx2 v[40:41], v200, s[8:11], s22 offen offset:1024
    buffer_load_dwordx2 v[42:43], v200, s[8:11], s22 offen offset:1280
    buffer_load_dwordx2 v[44:45], v200, s[8:11], s22 offen offset:1536
    buffer_load_dwordx2 v[46:47], v200, s[8:11], s22 offen offset:1792
    buffer_load_dwordx2 v[48:49], v200, s[8:11], s22 offen offset:2048
    buffer_load_dwordx2 v[50:51], v200, s[8:11], s22 offen offset:2304
    buffer_load_dwordx2 v[52:53], v200, s[8:11], s22 offen offset:2560
    buffer_load_dwordx2 v[54:55], v200, s[8:11], s22 offen offset:2816
    buffer_load_dwordx2 v[56:57], v200, s[8:11], s22 offen offset:3072
    buffer_load_dwordx2 v[58:59], v200, s[8:11], s22 offen offset:3328
    s_waitcnt vmcnt(0)
    v_pk_add_f32 v[32:33], v[32:33], v[34:35]
    v_pk_add_f32 v[32:33], v[32:33], v[36:37]
    v_pk_add_f32 v[32:33], v[32:33], v[38:39]
    v_pk_add_f32 v[32:33], v[32:33], v[40:41]
    v_pk_add_f32 v[32:33], v[32:33], v[42:43]
    v_pk_add_f32 v[32:33], v[32:33], v[44:45]
    v_pk_add_f32 v[32:33], v[32:33], v[46:47]
    v_pk_add_f32 v[32:33], v[32:33], v[48:49]
    v_pk_add_f32 v[32:33], v[32:33], v[50:51]
    v_pk_add_f32 v[32:33], v[32:33], v[52:53]
    v_pk_add_f32 v[32:33], v[32:33], v[54:55]
    v_pk_add_f32 v[32:33], v[32:33], v[56:57]
    v_pk_add_f32 v[32:33], v[32:33], v[58:59]
    v_mul_f32 v192, 991054117, v32
    v_mul_f32 v193, 991054117, v33
    v_fma_f32 v193, -v192, v192, v193
    v_max_f32 v193, 0, v193
    v_add_f32 v193, 925353388, v193
    v_rsq_f32 v193, v193
    ds_read_b128 v[8:11], v4 offset:0
    ds_read_b128 v[12:15], v4 offset:512
    ds_read_b128 v[16:19], v4 offset:1024
    ds_read_b128 v[20:23], v4 offset:1536
    ds_read_b128 v[24:27], v4 offset:2048
    buffer_load_dwordx4 v[144:147], v7, s[8:11], s47 offen offset:0 sc1
    buffer_load_dwordx4 v[148:151], v7, s[8:11], s47 offen offset:32 sc1
    buffer_load_dwordx4 v[152:155], v7, s[8:11], s47 offen offset:64 sc1
    buffer_load_dwordx4 v[156:159], v7, s[8:11], s47 offen offset:96 sc1
    s_waitcnt lgkmcnt(4)
    v_mfma_f32_32x32x16_bf16 v[32:47], v[8:11], a[0:3], 0
    ds_read_b128 v[28:31], v4 offset:2560
    s_waitcnt lgkmcnt(4)
    v_mfma_f32_32x32x16_bf16 v[32:47], v[12:15], a[4:7], v[32:47]
    ds_read_b128 v[8:11], v4 offset:3072
    s_waitcnt lgkmcnt(4)
    v_mfma_f32_32x32x16_bf16 v[32:47], v[16:19], a[8:11], v[32:47]
    ds_read_b128 v[12:15], v4 offset:3584
    buffer_load_dwordx4 v[160:163], v7, s[8:11], s47 offen offset:128 sc1
    s_waitcnt lgkmcnt(4)
    v_mfma_f32_32x32x16_bf16 v[32:47], v[20:23], a[12:15], v[32:47]
    ds_read_b128 v[16:19], v4 offset:4096
    s_waitcnt lgkmcnt(4)
    v_mfma_f32_32x32x16_bf16 v[32:47], v[24:27], a[16:19], v[32:47]
    ds_read_b128 v[20:23], v4 offset:4608
    s_waitcnt lgkmcnt(4)
    v_mfma_f32_32x32x16_bf16 v[32:47], v[28:31], a[20:23], v[32:47]
    ds_read_b128 v[24:27], v4 offset:5120
    s_waitcnt lgkmcnt(4)
    v_mfma_f32_32x32x16_bf16 v[32:47], v[8:11], a[24:27], v[32:47]
    ds_read_b128 v[28:31], v4 offset:5632
    buffer_load_dwordx4 v[164:167], v7, s[8:11], s47 offen offset:160 sc1
    s_waitcnt lgkmcnt(4)
    v_mfma_f32_32x32x16_bf16 v[32:47], v[12:15], a[28:31], v[32:47]
    ds_read_b128 v[8:11], v4 offset:6144
    s_waitcnt lgkmcnt(4)
    v_mfma_f32_32x32x16_bf16 v[32:47], v[16:19], a[32:35], v[32:47]
    ds_read_b128 v[12:15], v4 offset:6656
    s_waitcnt lgkmcnt(4)
    v_mfma_f32_32x32x16_bf16 v[32:47], v[20:23], a[36:39], v[32:47]
    ds_read_b128 v[16:19], v4 offset:7168
    s_waitcnt lgkmcnt(4)
    v_mfma_f32_32x32x16_bf16 v[32:47], v[24:27], a[40:43], v[32:47]
    ds_read_b128 v[20:23], v4 offset:7680
    buffer_load_dwordx4 v[168:171], v7, s[8:11], s47 offen offset:192 sc1
    s_waitcnt lgkmcnt(4)
    v_mfma_f32_32x32x16_bf16 v[32:47], v[28:31], a[44:47], v[32:47]
    ds_read_b128 v[24:27], v4 offset:8192
    s_waitcnt lgkmcnt(4)
    v_mfma_f32_32x32x16_bf16 v[32:47], v[8:11], a[48:51], v[32:47]
    ds_read_b128 v[28:31], v4 offset:8704
    s_waitcnt lgkmcnt(4)
    v_mfma_f32_32x32x16_bf16 v[32:47], v[12:15], a[52:55], v[32:47]
    ds_read_b128 v[8:11], v4 offset:9216
    s_waitcnt lgkmcnt(4)
    v_mfma_f32_32x32x16_bf16 v[32:47], v[16:19], a[56:59], v[32:47]
    ds_read_b128 v[12:15], v4 offset:9728
    buffer_load_dwordx4 v[172:175], v7, s[8:11], s47 offen offset:224 sc1
    s_waitcnt lgkmcnt(4)
    v_mfma_f32_32x32x16_bf16 v[32:47], v[20:23], a[60:63], v[32:47]
    ds_read_b128 v[16:19], v4 offset:10240
    s_waitcnt lgkmcnt(4)
    v_mfma_f32_32x32x16_bf16 v[32:47], v[24:27], a[64:67], v[32:47]
    ds_read_b128 v[20:23], v4 offset:10752
    s_waitcnt lgkmcnt(4)
    v_mfma_f32_32x32x16_bf16 v[32:47], v[28:31], a[68:71], v[32:47]
    ds_read_b128 v[24:27], v4 offset:11264
    s_waitcnt lgkmcnt(4)
    v_mfma_f32_32x32x16_bf16 v[32:47], v[8:11], a[72:75], v[32:47]
    ds_read_b128 v[28:31], v4 offset:11776
    s_waitcnt lgkmcnt(4)
    v_mfma_f32_32x32x16_bf16 v[32:47], v[12:15], a[76:79], v[32:47]
    ds_read_b128 v[8:11], v4 offset:12288
    s_waitcnt lgkmcnt(4)
    v_mfma_f32_32x32x16_bf16 v[32:47], v[16:19], a[80:83], v[32:47]
    ds_read_b128 v[12:15], v4 offset:12800
    s_waitcnt lgkmcnt(4)
    v_mfma_f32_32x32x16_bf16 v[32:47], v[20:23], a[84:87], v[32:47]
    ds_read_b128 v[16:19], v4 offset:13312
    s_waitcnt lgkmcnt(4)
    v_mfma_f32_32x32x16_bf16 v[32:47], v[24:27], a[88:91], v[32:47]
    ds_read_b128 v[20:23], v4 offset:13824
    s_waitcnt lgkmcnt(4)
    v_mfma_f32_32x32x16_bf16 v[32:47], v[28:31], a[92:95], v[32:47]
    ds_read_b128 v[24:27], v4 offset:28672
    s_waitcnt lgkmcnt(4)
    v_mfma_f32_32x32x16_bf16 v[32:47], v[8:11], a[96:99], v[32:47]
    ds_read_b128 v[28:31], v4 offset:29184
    s_waitcnt lgkmcnt(4)
    v_mfma_f32_32x32x16_bf16 v[32:47], v[12:15], a[100:103], v[32:47]
    ds_read_b128 v[8:11], v4 offset:29696
    s_waitcnt lgkmcnt(4)
    v_mfma_f32_32x32x16_bf16 v[32:47], v[16:19], a[104:107], v[32:47]
    ds_read_b128 v[12:15], v4 offset:30208
    s_waitcnt lgkmcnt(4)
    v_mfma_f32_32x32x16_bf16 v[32:47], v[20:23], a[108:111], v[32:47]
    ds_read_b128 v[16:19], v4 offset:30720
    s_waitcnt lgkmcnt(4)
    v_mfma_f32_32x32x16_bf16 v[48:63], v[24:27], a[0:3], 0
    ds_read_b128 v[20:23], v4 offset:31232
    s_waitcnt lgkmcnt(4)
    v_mfma_f32_32x32x16_bf16 v[48:63], v[28:31], a[4:7], v[48:63]
    ds_read_b128 v[24:27], v4 offset:31744
    s_waitcnt lgkmcnt(4)
    v_mfma_f32_32x32x16_bf16 v[48:63], v[8:11], a[8:11], v[48:63]
    ds_read_b128 v[28:31], v4 offset:32256
    s_waitcnt vmcnt(0)
    s_waitcnt lgkmcnt(4)
    v_mfma_f32_32x32x16_bf16 v[48:63], v[12:15], a[12:15], v[48:63]
    ds_read_b128 v[8:11], v4 offset:32768
    v_fma_f32 v32, -v192, v144, v32
    v_fma_f32 v33, -v192, v145, v33
    v_fma_f32 v34, -v192, v146, v34
    v_fma_f32 v35, -v192, v147, v35
    v_mul_f32 v32, v32, v193
    v_mul_f32 v33, v33, v193
    v_mul_f32 v34, v34, v193
    v_mul_f32 v35, v35, v193
    s_waitcnt lgkmcnt(4)
    v_mfma_f32_32x32x16_bf16 v[48:63], v[16:19], a[16:19], v[48:63]
    ds_read_b128 v[12:15], v4 offset:33280
    v_mul_f32 v196, v32, v32
    v_mul_f32 v197, v33, v33
    v_mul_f32 v198, v34, v34
    v_mul_f32 v199, v35, v35
    v_fma_f32 v196, v196, s61, v194
    v_fma_f32 v197, v197, s61, v194
    v_fma_f32 v198, v198, s61, v194
    v_fma_f32 v199, v199, s61, v194
    s_waitcnt lgkmcnt(4)
    v_mfma_f32_32x32x16_bf16 v[48:63], v[20:23], a[20:23], v[48:63]
    ds_read_b128 v[16:19], v4 offset:33792
    v_mul_f32 v196, v196, v32
    v_mul_f32 v197, v197, v33
    v_mul_f32 v198, v198, v34
    v_mul_f32 v199, v199, v35
    v_exp_f32 v196, v196
    v_exp_f32 v197, v197
    s_waitcnt lgkmcnt(4)
    v_mfma_f32_32x32x16_bf16 v[48:63], v[24:27], a[24:27], v[48:63]
    ds_read_b128 v[20:23], v4 offset:34304
    v_exp_f32 v198, v198
    v_exp_f32 v199, v199
    v_add_f32 v196, 1.0, v196
    v_add_f32 v197, 1.0, v197
    v_add_f32 v198, 1.0, v198
    v_add_f32 v199, 1.0, v199
    s_waitcnt lgkmcnt(4)
    v_mfma_f32_32x32x16_bf16 v[48:63], v[28:31], a[28:31], v[48:63]
    ds_read_b128 v[24:27], v4 offset:34816
    v_rcp_f32 v196, v196
    v_rcp_f32 v197, v197
    s_waitcnt lgkmcnt(4)
    v_mfma_f32_32x32x16_bf16 v[48:63], v[8:11], a[32:35], v[48:63]
    ds_read_b128 v[28:31], v4 offset:35328
    v_rcp_f32 v198, v198
    v_rcp_f32 v199, v199
    v_mul_f32 v32, v32, v196
    v_mul_f32 v33, v33, v197
    v_mul_f32 v34, v34, v198
    v_mul_f32 v35, v35, v199
    s_waitcnt lgkmcnt(4)
    v_mfma_f32_32x32x16_bf16 v[48:63], v[12:15], a[36:39], v[48:63]
    ds_read_b128 v[8:11], v4 offset:35840
    v_fma_f32 v36, -v192, v148, v36
    v_fma_f32 v37, -v192, v149, v37
    v_fma_f32 v38, -v192, v150, v38
    v_fma_f32 v39, -v192, v151, v39
    v_mul_f32 v36, v36, v193
    v_mul_f32 v37, v37, v193
    v_mul_f32 v38, v38, v193
    v_mul_f32 v39, v39, v193
    s_waitcnt lgkmcnt(4)
    v_mfma_f32_32x32x16_bf16 v[48:63], v[16:19], a[40:43], v[48:63]
    ds_read_b128 v[12:15], v4 offset:36352
    v_mul_f32 v196, v36, v36
    v_mul_f32 v197, v37, v37
    v_mul_f32 v198, v38, v38
    v_mul_f32 v199, v39, v39
    v_fma_f32 v196, v196, s61, v194
    v_fma_f32 v197, v197, s61, v194
    v_fma_f32 v198, v198, s61, v194
    v_fma_f32 v199, v199, s61, v194
    s_waitcnt lgkmcnt(4)
    v_mfma_f32_32x32x16_bf16 v[48:63], v[20:23], a[44:47], v[48:63]
    ds_read_b128 v[16:19], v4 offset:36864
    v_mul_f32 v196, v196, v36
    v_mul_f32 v197, v197, v37
    v_mul_f32 v198, v198, v38
    v_mul_f32 v199, v199, v39
    s_waitcnt lgkmcnt(4)
    v_mfma_f32_32x32x16_bf16 v[48:63], v[24:27], a[48:51], v[48:63]
    ds_read_b128 v[20:23], v4 offset:37376
    v_exp_f32 v196, v196
    v_exp_f32 v197, v197
    v_exp_f32 v198, v198
    v_exp_f32 v199, v199
    s_waitcnt lgkmcnt(4)
    v_mfma_f32_32x32x16_bf16 v[48:63], v[28:31], a[52:55], v[48:63]
    ds_read_b128 v[24:27], v4 offset:37888
    v_add_f32 v196, 1.0, v196
    v_add_f32 v197, 1.0, v197
    v_add_f32 v198, 1.0, v198
    v_add_f32 v199, 1.0, v199
    v_rcp_f32 v196, v196
    v_rcp_f32 v197, v197
    s_waitcnt lgkmcnt(4)
    v_mfma_f32_32x32x16_bf16 v[48:63], v[8:11], a[56:59], v[48:63]
    ds_read_b128 v[28:31], v4 offset:38400
    v_rcp_f32 v198, v198
    v_rcp_f32 v199, v199
    v_mul_f32 v36, v36, v196
    v_mul_f32 v37, v37, v197
    v_mul_f32 v38, v38, v198
    v_mul_f32 v39, v39, v199
    s_waitcnt lgkmcnt(4)
    v_mfma_f32_32x32x16_bf16 v[48:63], v[12:15], a[60:63], v[48:63]
    ds_read_b128 v[8:11], v4 offset:38912
    v_fma_f32 v40, -v192, v152, v40
    v_fma_f32 v41, -v192, v153, v41
    v_fma_f32 v42, -v192, v154, v42
    v_fma_f32 v43, -v192, v155, v43
    s_waitcnt lgkmcnt(4)
    v_mfma_f32_32x32x16_bf16 v[48:63], v[16:19], a[64:67], v[48:63]
    ds_read_b128 v[12:15], v4 offset:39424
    v_mul_f32 v40, v40, v193
    v_mul_f32 v41, v41, v193
    v_mul_f32 v42, v42, v193
    v_mul_f32 v43, v43, v193
    v_mul_f32 v196, v40, v40
    v_mul_f32 v197, v41, v41
    v_mul_f32 v198, v42, v42
    v_mul_f32 v199, v43, v43
    s_waitcnt lgkmcnt(4)
    v_mfma_f32_32x32x16_bf16 v[48:63], v[20:23], a[68:71], v[48:63]
    ds_read_b128 v[16:19], v4 offset:39936
    v_fma_f32 v196, v196, s61, v194
    v_fma_f32 v197, v197, s61, v194
    v_fma_f32 v198, v198, s61, v194
    v_fma_f32 v199, v199, s61, v194
    v_mul_f32 v196, v196, v40
    v_mul_f32 v197, v197, v41
    v_mul_f32 v198, v198, v42
    v_mul_f32 v199, v199, v43
    s_waitcnt lgkmcnt(4)
    v_mfma_f32_32x32x16_bf16 v[48:63], v[24:27], a[72:75], v[48:63]
    ds_read_b128 v[20:23], v4 offset:40448
    v_exp_f32 v196, v196
    v_exp_f32 v197, v197
    v_exp_f32 v198, v198
    v_exp_f32 v199, v199
    s_waitcnt lgkmcnt(4)
    v_mfma_f32_32x32x16_bf16 v[48:63], v[28:31], a[76:79], v[48:63]
    ds_read_b128 v[24:27], v4 offset:40960
    v_add_f32 v196, 1.0, v196
    v_add_f32 v197, 1.0, v197
    v_add_f32 v198, 1.0, v198
    v_add_f32 v199, 1.0, v199
    s_waitcnt lgkmcnt(4)
    v_mfma_f32_32x32x16_bf16 v[48:63], v[8:11], a[80:83], v[48:63]
    ds_read_b128 v[28:31], v4 offset:41472
    v_rcp_f32 v196, v196
    v_rcp_f32 v197, v197
    v_rcp_f32 v198, v198
    v_rcp_f32 v199, v199
    s_waitcnt lgkmcnt(4)
    v_mfma_f32_32x32x16_bf16 v[48:63], v[12:15], a[84:87], v[48:63]
    ds_read_b128 v[8:11], v4 offset:41984
    v_mul_f32 v40, v40, v196
    v_mul_f32 v41, v41, v197
    v_mul_f32 v42, v42, v198
    v_mul_f32 v43, v43, v199
    v_fma_f32 v44, -v192, v156, v44
    v_fma_f32 v45, -v192, v157, v45
    v_fma_f32 v46, -v192, v158, v46
    v_fma_f32 v47, -v192, v159, v47
    s_waitcnt lgkmcnt(4)
    v_mfma_f32_32x32x16_bf16 v[48:63], v[16:19], a[88:91], v[48:63]
    ds_read_b128 v[12:15], v4 offset:42496
    v_mul_f32 v44, v44, v193
    v_mul_f32 v45, v45, v193
    v_mul_f32 v46, v46, v193
    v_mul_f32 v47, v47, v193
    v_mul_f32 v196, v44, v44
    v_mul_f32 v197, v45, v45
    v_mul_f32 v198, v46, v46
    v_mul_f32 v199, v47, v47
    s_waitcnt lgkmcnt(4)
    v_mfma_f32_32x32x16_bf16 v[48:63], v[20:23], a[92:95], v[48:63]
    v_fma_f32 v196, v196, s61, v194
    v_fma_f32 v197, v197, s61, v194
    v_fma_f32 v198, v198, s61, v194
    v_fma_f32 v199, v199, s61, v194
    s_waitcnt lgkmcnt(4)
    v_mfma_f32_32x32x16_bf16 v[48:63], v[24:27], a[96:99], v[48:63]
    v_mul_f32 v196, v196, v44
    v_mul_f32 v197, v197, v45
    v_mul_f32 v198, v198, v46
    v_mul_f32 v199, v199, v47
    v_exp_f32 v196, v196
    v_exp_f32 v197, v197
    s_waitcnt lgkmcnt(4)
    v_mfma_f32_32x32x16_bf16 v[48:63], v[28:31], a[100:103], v[48:63]
    v_exp_f32 v198, v198
    v_exp_f32 v199, v199
    v_add_f32 v196, 1.0, v196
    v_add_f32 v197, 1.0, v197
    v_add_f32 v198, 1.0, v198
    v_add_f32 v199, 1.0, v199
    s_waitcnt lgkmcnt(4)
    v_mfma_f32_32x32x16_bf16 v[48:63], v[8:11], a[104:107], v[48:63]
    v_rcp_f32 v196, v196
    v_rcp_f32 v197, v197
    v_rcp_f32 v198, v198
    v_rcp_f32 v199, v199
    s_waitcnt lgkmcnt(4)
    v_mfma_f32_32x32x16_bf16 v[48:63], v[12:15], a[108:111], v[48:63]
    v_mul_f32 v44, v44, v196
    v_mul_f32 v45, v45, v197
    v_mul_f32 v46, v46, v198
    v_mul_f32 v47, v47, v199
    s_waitcnt vmcnt(0)
    s_nop 6
    v_fma_f32 v48, -v192, v160, v48
    v_fma_f32 v49, -v192, v161, v49
    v_fma_f32 v50, -v192, v162, v50
    v_fma_f32 v51, -v192, v163, v51
    v_mul_f32 v48, v48, v193
    v_mul_f32 v49, v49, v193
    v_mul_f32 v50, v50, v193
    v_mul_f32 v51, v51, v193
    v_mul_f32 v196, v48, v48
    v_mul_f32 v197, v49, v49
    v_mul_f32 v198, v50, v50
    v_mul_f32 v199, v51, v51
    v_fma_f32 v196, v196, s61, v194
    v_fma_f32 v197, v197, s61, v194
    v_fma_f32 v198, v198, s61, v194
    v_fma_f32 v199, v199, s61, v194
    v_mul_f32 v196, v196, v48
    v_mul_f32 v197, v197, v49
    v_mul_f32 v198, v198, v50
    v_mul_f32 v199, v199, v51
    v_exp_f32 v196, v196
    v_exp_f32 v197, v197
    v_exp_f32 v198, v198
    v_exp_f32 v199, v199
    v_add_f32 v196, 1.0, v196
    v_add_f32 v197, 1.0, v197
    v_add_f32 v198, 1.0, v198
    v_add_f32 v199, 1.0, v199
    v_rcp_f32 v196, v196
    v_rcp_f32 v197, v197
    v_rcp_f32 v198, v198
    v_rcp_f32 v199, v199
    v_mul_f32 v48, v48, v196
    v_mul_f32 v49, v49, v197
    v_mul_f32 v50, v50, v198
    v_mul_f32 v51, v51, v199
    v_fma_f32 v52, -v192, v164, v52
    v_fma_f32 v53, -v192, v165, v53
    v_fma_f32 v54, -v192, v166, v54
    v_fma_f32 v55, -v192, v167, v55
    v_mul_f32 v52, v52, v193
    v_mul_f32 v53, v53, v193
    v_mul_f32 v54, v54, v193
    v_mul_f32 v55, v55, v193
    v_mul_f32 v196, v52, v52
    v_mul_f32 v197, v53, v53
    v_mul_f32 v198, v54, v54
    v_mul_f32 v199, v55, v55
    v_fma_f32 v196, v196, s61, v194
    v_fma_f32 v197, v197, s61, v194
    v_fma_f32 v198, v198, s61, v194
    v_fma_f32 v199, v199, s61, v194
    v_mul_f32 v196, v196, v52
    v_mul_f32 v197, v197, v53
    v_mul_f32 v198, v198, v54
    v_mul_f32 v199, v199, v55
    v_exp_f32 v196, v196
    v_exp_f32 v197, v197
    v_exp_f32 v198, v198
    v_exp_f32 v199, v199
    v_add_f32 v196, 1.0, v196
    v_add_f32 v197, 1.0, v197
    v_add_f32 v198, 1.0, v198
    v_add_f32 v199, 1.0, v199
    v_rcp_f32 v196, v196
    v_rcp_f32 v197, v197
    v_rcp_f32 v198, v198
    v_rcp_f32 v199, v199
    v_mul_f32 v52, v52, v196
    v_mul_f32 v53, v53, v197
    v_mul_f32 v54, v54, v198
    v_mul_f32 v55, v55, v199
    v_fma_f32 v56, -v192, v168, v56
    v_fma_f32 v57, -v192, v169, v57
    v_fma_f32 v58, -v192, v170, v58
    v_fma_f32 v59, -v192, v171, v59
    v_mul_f32 v56, v56, v193
    v_mul_f32 v57, v57, v193
    v_mul_f32 v58, v58, v193
    v_mul_f32 v59, v59, v193
    v_mul_f32 v196, v56, v56
    v_mul_f32 v197, v57, v57
    v_mul_f32 v198, v58, v58
    v_mul_f32 v199, v59, v59
    v_fma_f32 v196, v196, s61, v194
    v_fma_f32 v197, v197, s61, v194
    v_fma_f32 v198, v198, s61, v194
    v_fma_f32 v199, v199, s61, v194
    v_mul_f32 v196, v196, v56
    v_mul_f32 v197, v197, v57
    v_mul_f32 v198, v198, v58
    v_mul_f32 v199, v199, v59
    v_exp_f32 v196, v196
    v_exp_f32 v197, v197
    v_exp_f32 v198, v198
    v_exp_f32 v199, v199
    v_add_f32 v196, 1.0, v196
    v_add_f32 v197, 1.0, v197
    v_add_f32 v198, 1.0, v198
    v_add_f32 v199, 1.0, v199
    v_rcp_f32 v196, v196
    v_rcp_f32 v197, v197
    v_rcp_f32 v198, v198
    v_rcp_f32 v199, v199
    v_mul_f32 v56, v56, v196
    v_mul_f32 v57, v57, v197
    v_mul_f32 v58, v58, v198
    v_mul_f32 v59, v59, v199
    v_fma_f32 v60, -v192, v172, v60
    v_fma_f32 v61, -v192, v173, v61
    v_fma_f32 v62, -v192, v174, v62
    v_fma_f32 v63, -v192, v175, v63
    v_mul_f32 v60, v60, v193
    v_mul_f32 v61, v61, v193
    v_mul_f32 v62, v62, v193
    v_mul_f32 v63, v63, v193
    v_mul_f32 v196, v60, v60
    v_mul_f32 v197, v61, v61
    v_mul_f32 v198, v62, v62
    v_mul_f32 v199, v63, v63
    v_fma_f32 v196, v196, s61, v194
    v_fma_f32 v197, v197, s61, v194
    v_fma_f32 v198, v198, s61, v194
    v_fma_f32 v199, v199, s61, v194
    v_mul_f32 v196, v196, v60
    v_mul_f32 v197, v197, v61
    v_mul_f32 v198, v198, v62
    v_mul_f32 v199, v199, v63
    v_exp_f32 v196, v196
    v_exp_f32 v197, v197
    v_exp_f32 v198, v198
    v_exp_f32 v199, v199
    v_add_f32 v196, 1.0, v196
    v_add_f32 v197, 1.0, v197
    v_add_f32 v198, 1.0, v198
    v_add_f32 v199, 1.0, v199
    v_rcp_f32 v196, v196
    v_rcp_f32 v197, v197
    v_rcp_f32 v198, v198
    v_rcp_f32 v199, v199
    v_mul_f32 v60, v60, v196
    v_mul_f32 v61, v61, v197
    v_mul_f32 v62, v62, v198
    v_mul_f32 v63, v63, v199
    s_mul_i32 s22, s45, 28672
    s_mul_i32 s20, s41, 2048
    s_add_u32 s22, s22, s20
    s_add_u32 s22, s22, 111149056
    s_add_u32 s23, s22, 0
    v_cvt_pk_bf16_f32 v216, v32, v33
    v_cvt_pk_bf16_f32 v217, v36, v37
    v_cvt_pk_bf16_f32 v218, v34, v35
    v_cvt_pk_bf16_f32 v219, v38, v39
    buffer_store_dwordx4 v[216:219], v3, s[8:11], s23 offen offset:0 sc1
    v_cvt_pk_bf16_f32 v220, v40, v41
    v_cvt_pk_bf16_f32 v221, v44, v45
    v_cvt_pk_bf16_f32 v222, v42, v43
    v_cvt_pk_bf16_f32 v223, v46, v47
    buffer_store_dwordx4 v[220:223], v3, s[8:11], s23 offen offset:512 sc1
    s_add_u32 s23, s22, 1024
    v_cvt_pk_bf16_f32 v224, v48, v49
    v_cvt_pk_bf16_f32 v225, v52, v53
    v_cvt_pk_bf16_f32 v226, v50, v51
    v_cvt_pk_bf16_f32 v227, v54, v55
    buffer_store_dwordx4 v[224:227], v3, s[8:11], s23 offen offset:0 sc1
    v_cvt_pk_bf16_f32 v228, v56, v57
    v_cvt_pk_bf16_f32 v229, v60, v61
    v_cvt_pk_bf16_f32 v230, v58, v59
    v_cvt_pk_bf16_f32 v231, v62, v63
    buffer_store_dwordx4 v[228:231], v3, s[8:11], s23 offen offset:512 sc1
    s_waitcnt vmcnt(0)
    s_barrier
    s_cmp_lg_u32 s14, 0
    s_cbranch_scc1 toks1_sg
    s_lshl_b32 s24, s40, 7
    s_add_u32 s24, s24, 20473856
    s_mov_b64 exec, 1
    v_mov_b32 v251, 1
    buffer_atomic_add v251, off, s[8:11], s24
    s_mov_b64 exec, -1
toks1_sg:
    s_branch tok_adv
tok_z2:
    v_lshlrev_b32 v1, 4, v0
    v_bfe_u32 v2, v0, 4, 1
    v_mul_u32_u24 v2, 14336, v2
    v_lshrrev_b32 v250, 5, v0
    v_lshl_add_u32 v2, v250, 8, v2
    v_and_b32 v250, 15, v0
    v_lshl_add_u32 v2, v250, 4, v2
    v_bfe_u32 v3, v0, 4, 1
    v_mul_u32_u24 v3, 28672, v3
    v_lshrrev_b32 v250, 5, v0
    v_lshl_add_u32 v3, v250, 8, v3
    v_and_b32 v250, 15, v0
    v_lshl_add_u32 v3, v250, 4, v3
    v_mov_b32 v4, v2
    v_add_u32 v5, 57344, v2
    v_add_u32 v6, 114688, v2
    s_mov_b32 s61, 3184710632
    v_mov_b32 v194, 3222493025
    s_lshl_b32 s48, s40, 2
    s_add_u32 s48, s48, s14
    s_lshl_b32 s45, s48, 1
    s_mul_i32 s46, s45, 14336
    s_add_u32 s46, s46, 102760448
    s_mul_i32 s42, s41, 57344
    s_mul_i32 s20, s14, 7168
    s_add_u32 s42, s42, s20
    s_add_u32 s42, s42, 106954752
    s_mov_b32 s44, s20
    s_add_u32 m0, s44, 0
    s_add_u32 s21, s42, 0
    buffer_load_dwordx4 v1, s[8:11], s21 offen offset:0 lds
    buffer_load_dwordx4 v1, s[8:11], s21 offen offset:1024 lds
    buffer_load_dwordx4 v1, s[8:11], s21 offen offset:2048 lds
    buffer_load_dwordx4 v1, s[8:11], s21 offen offset:3072 lds
    s_add_u32 m0, s44, 4096
    s_add_u32 s21, s42, 4096
    buffer_load_dwordx4 v1, s[8:11], s21 offen offset:0 lds
    buffer_load_dwordx4 v1, s[8:11], s21 offen offset:1024 lds
    buffer_load_dwordx4 v1, s[8:11], s21 offen offset:2048 lds
    s_add_u32 m0, s44, 28672
    s_add_u32 s21, s42, 28672
    buffer_load_dwordx4 v1, s[8:11], s21 offen offset:0 lds
    buffer_load_dwordx4 v1, s[8:11], s21 offen offset:1024 lds
    buffer_load_dwordx4 v1, s[8:11], s21 offen offset:2048 lds
    buffer_load_dwordx4 v1, s[8:11], s21 offen offset:3072 lds
    s_add_u32 m0, s44, 32768
    s_add_u32 s21, s42, 32768
    buffer_load_dwordx4 v1, s[8:11], s21 offen offset:0 lds
    buffer_load_dwordx4 v1, s[8:11], s21 offen offset:1024 lds
    buffer_load_dwordx4 v1, s[8:11], s21 offen offset:2048 lds
    v_lshrrev_b32 v7, 5, v0
    v_lshlrev_b32 v7, 4, v7
    s_mul_i32 s47, s41, 256
    s_add_u32 s47, s47, 127926272
    s_waitcnt vmcnt(0)
    s_barrier
    s_lshl_b32 s27, s40, 2
    s_add_u32 s27, s27, s14
    s_lshl_b32 s27, s27, 7
    s_add_u32 s27, s27, 20500480
tok_wh2:
    buffer_load_dword v251, off, s[8:11], s27 sc1
    s_waitcnt vmcnt(0)
    v_readfirstlane_b32 s26, v251
    s_nop 2
    s_cmp_ge_u32 s26, 4
    s_cbranch_scc1 tok_wh2_ok
    s_sleep 2
    s_sub_u32 s17, s17, 1
    s_cmp_gt_i32 s17, 0
    s_cbranch_scc1 tok_wh2
tok_wh2_ok:
    s_add_u32 s22, s46, 0
    buffer_load_dwordx4 a[0:3], v2, s[8:11], s22 offen offset:0
    buffer_load_dwordx4 a[4:7], v2, s[8:11], s22 offen offset:512
    buffer_load_dwordx4 a[8:11], v2, s[8:11], s22 offen offset:1024
    buffer_load_dwordx4 a[12:15], v2, s[8:11], s22 offen offset:1536
    buffer_load_dwordx4 a[16:19], v2, s[8:11], s22 offen offset:2048
    buffer_load_dwordx4 a[20:23], v2, s[8:11], s22 offen offset:2560
    buffer_load_dwordx4 a[24:27], v2, s[8:11], s22 offen offset:3072
    buffer_load_dwordx4 a[28:31], v2, s[8:11], s22 offen offset:3584
    s_add_u32 s22, s46, 4096
    buffer_load_dwordx4 a[32:35], v2, s[8:11], s22 offen offset:0
    buffer_load_dwordx4 a[36:39], v2, s[8:11], s22 offen offset:512
    buffer_load_dwordx4 a[40:43], v2, s[8:11], s22 offen offset:1024
    buffer_load_dwordx4 a[44:47], v2, s[8:11], s22 offen offset:1536
    buffer_load_dwordx4 a[48:51], v2, s[8:11], s22 offen offset:2048
    buffer_load_dwordx4 a[52:55], v2, s[8:11], s22 offen offset:2560
    buffer_load_dwordx4 a[56:59], v2, s[8:11], s22 offen offset:3072
    buffer_load_dwordx4 a[60:63], v2, s[8:11], s22 offen offset:3584
    s_add_u32 s22, s46, 8192
    buffer_load_dwordx4 a[64:67], v2, s[8:11], s22 offen offset:0
    buffer_load_dwordx4 a[68:71], v2, s[8:11], s22 offen offset:512
    buffer_load_dwordx4 a[72:75], v2, s[8:11], s22 offen offset:1024
    buffer_load_dwordx4 a[76:79], v2, s[8:11], s22 offen offset:1536
    buffer_load_dwordx4 a[80:83], v2, s[8:11], s22 offen offset:2048
    buffer_load_dwordx4 a[84:87], v2, s[8:11], s22 offen offset:2560
    buffer_load_dwordx4 a[88:91], v2, s[8:11], s22 offen offset:3072
    buffer_load_dwordx4 a[92:95], v2, s[8:11], s22 offen offset:3584
    s_add_u32 s22, s46, 12288
    buffer_load_dwordx4 a[96:99], v2, s[8:11], s22 offen offset:0
    buffer_load_dwordx4 a[100:103], v2, s[8:11], s22 offen offset:512
    buffer_load_dwordx4 a[104:107], v2, s[8:11], s22 offen offset:1024
    buffer_load_dwordx4 a[108:111], v2, s[8:11], s22 offen offset:1536
    v_and_b32 v200, 31, v0
    v_lshlrev_b32 v200, 3, v200
    s_lshl_b32 s22, s48, 12
    s_add_u32 s22, s22, 126877696
    buffer_load_dwordx2 v[32:33], v200, s[8:11], s22 offen offset:0
    buffer_load_dwordx2 v[34:35], v200, s[8:11], s22 offen offset:256
    buffer_load_dwordx2 v[36:37], v200, s[8:11], s22 offen offset:512
    buffer_load_dwordx2 v[38:39], v200, s[8:11], s22 offen offset:768
    buffer_load_dwordx2 v[40:41], v200, s[8:11], s22 offen offset:1024
    buffer_load_dwordx2 v[42:43], v200, s[8:11], s22 offen offset:1280
    buffer_load_dwordx2 v[44:45], v200, s[8:11], s22 offen offset:1536
    buffer_load_dwordx2 v[46:47], v200, s[8:11], s22 offen offset:1792
    buffer_load_dwordx2 v[48:49], v200, s[8:11], s22 offen offset:2048
    buffer_load_dwordx2 v[50:51], v200, s[8:11], s22 offen offset:2304
    buffer_load_dwordx2 v[52:53], v200, s[8:11], s22 offen offset:2560
    buffer_load_dwordx2 v[54:55], v200, s[8:11], s22 offen offset:2816
    buffer_load_dwordx2 v[56:57], v200, s[8:11], s22 offen offset:3072
    buffer_load_dwordx2 v[58:59], v200, s[8:11], s22 offen offset:3328
    s_waitcnt vmcnt(0)
    v_pk_add_f32 v[32:33], v[32:33], v[34:35]
    v_pk_add_f32 v[32:33], v[32:33], v[36:37]
    v_pk_add_f32 v[32:33], v[32:33], v[38:39]
    v_pk_add_f32 v[32:33], v[32:33], v[40:41]
    v_pk_add_f32 v[32:33], v[32:33], v[42:43]
    v_pk_add_f32 v[32:33], v[32:33], v[44:45]
    v_pk_add_f32 v[32:33], v[32:33], v[46:47]
    v_pk_add_f32 v[32:33], v[32:33], v[48:49]
    v_pk_add_f32 v[32:33], v[32:33], v[50:51]
    v_pk_add_f32 v[32:33], v[32:33], v[52:53]
    v_pk_add_f32 v[32:33], v[32:33], v[54:55]
    v_pk_add_f32 v[32:33], v[32:33], v[56:57]
    v_pk_add_f32 v[32:33], v[32:33], v[58:59]
    v_mul_f32 v192, 991054117, v32
    v_mul_f32 v193, 991054117, v33
    v_fma_f32 v193, -v192, v192, v193
    v_max_f32 v193, 0, v193
    v_add_f32 v193, 925353388, v193
    v_rsq_f32 v193, v193
    ds_read_b128 v[8:11], v4 offset:0
    ds_read_b128 v[12:15], v4 offset:512
    ds_read_b128 v[16:19], v4 offset:1024
    ds_read_b128 v[20:23], v4 offset:1536
    ds_read_b128 v[24:27], v4 offset:2048
    buffer_load_dwordx4 v[144:147], v7, s[8:11], s47 offen offset:0 sc1
    buffer_load_dwordx4 v[148:151], v7, s[8:11], s47 offen offset:32 sc1
    buffer_load_dwordx4 v[152:155], v7, s[8:11], s47 offen offset:64 sc1
    buffer_load_dwordx4 v[156:159], v7, s[8:11], s47 offen offset:96 sc1
    s_waitcnt lgkmcnt(4)
    v_mfma_f32_32x32x16_bf16 v[32:47], v[8:11], a[0:3], 0
    ds_read_b128 v[28:31], v4 offset:2560
    s_waitcnt lgkmcnt(4)
    v_mfma_f32_32x32x16_bf16 v[32:47], v[12:15], a[4:7], v[32:47]
    ds_read_b128 v[8:11], v4 offset:3072
    s_waitcnt lgkmcnt(4)
    v_mfma_f32_32x32x16_bf16 v[32:47], v[16:19], a[8:11], v[32:47]
    ds_read_b128 v[12:15], v4 offset:3584
    buffer_load_dwordx4 v[160:163], v7, s[8:11], s47 offen offset:128 sc1
    s_waitcnt lgkmcnt(4)
    v_mfma_f32_32x32x16_bf16 v[32:47], v[20:23], a[12:15], v[32:47]
    ds_read_b128 v[16:19], v4 offset:4096
    s_waitcnt lgkmcnt(4)
    v_mfma_f32_32x32x16_bf16 v[32:47], v[24:27], a[16:19], v[32:47]
    ds_read_b128 v[20:23], v4 offset:4608
    s_waitcnt lgkmcnt(4)
    v_mfma_f32_32x32x16_bf16 v[32:47], v[28:31], a[20:23], v[32:47]
    ds_read_b128 v[24:27], v4 offset:5120
    s_waitcnt lgkmcnt(4)
    v_mfma_f32_32x32x16_bf16 v[32:47], v[8:11], a[24:27], v[32:47]
    ds_read_b128 v[28:31], v4 offset:5632
    buffer_load_dwordx4 v[164:167], v7, s[8:11], s47 offen offset:160 sc1
    s_waitcnt lgkmcnt(4)
    v_mfma_f32_32x32x16_bf16 v[32:47], v[12:15], a[28:31], v[32:47]
    ds_read_b128 v[8:11], v4 offset:6144
    s_waitcnt lgkmcnt(4)
    v_mfma_f32_32x32x16_bf16 v[32:47], v[16:19], a[32:35], v[32:47]
    ds_read_b128 v[12:15], v4 offset:6656
    s_waitcnt lgkmcnt(4)
    v_mfma_f32_32x32x16_bf16 v[32:47], v[20:23], a[36:39], v[32:47]
    ds_read_b128 v[16:19], v4 offset:7168
    s_waitcnt lgkmcnt(4)
    v_mfma_f32_32x32x16_bf16 v[32:47], v[24:27], a[40:43], v[32:47]
    ds_read_b128 v[20:23], v4 offset:7680
    buffer_load_dwordx4 v[168:171], v7, s[8:11], s47 offen offset:192 sc1
    s_waitcnt lgkmcnt(4)
    v_mfma_f32_32x32x16_bf16 v[32:47], v[28:31], a[44:47], v[32:47]
    ds_read_b128 v[24:27], v4 offset:8192
    s_waitcnt lgkmcnt(4)
    v_mfma_f32_32x32x16_bf16 v[32:47], v[8:11], a[48:51], v[32:47]
    ds_read_b128 v[28:31], v4 offset:8704
    s_waitcnt lgkmcnt(4)
    v_mfma_f32_32x32x16_bf16 v[32:47], v[12:15], a[52:55], v[32:47]
    ds_read_b128 v[8:11], v4 offset:9216
    s_waitcnt lgkmcnt(4)
    v_mfma_f32_32x32x16_bf16 v[32:47], v[16:19], a[56:59], v[32:47]
    ds_read_b128 v[12:15], v4 offset:9728
    buffer_load_dwordx4 v[172:175], v7, s[8:11], s47 offen offset:224 sc1
    s_waitcnt lgkmcnt(4)
    v_mfma_f32_32x32x16_bf16 v[32:47], v[20:23], a[60:63], v[32:47]
    ds_read_b128 v[16:19], v4 offset:10240
    s_waitcnt lgkmcnt(4)
    v_mfma_f32_32x32x16_bf16 v[32:47], v[24:27], a[64:67], v[32:47]
    ds_read_b128 v[20:23], v4 offset:10752
    s_waitcnt lgkmcnt(4)
    v_mfma_f32_32x32x16_bf16 v[32:47], v[28:31], a[68:71], v[32:47]
    ds_read_b128 v[24:27], v4 offset:11264
    s_waitcnt lgkmcnt(4)
    v_mfma_f32_32x32x16_bf16 v[32:47], v[8:11], a[72:75], v[32:47]
    ds_read_b128 v[28:31], v4 offset:11776
    s_waitcnt lgkmcnt(4)
    v_mfma_f32_32x32x16_bf16 v[32:47], v[12:15], a[76:79], v[32:47]
    ds_read_b128 v[8:11], v4 offset:12288
    s_waitcnt lgkmcnt(4)
    v_mfma_f32_32x32x16_bf16 v[32:47], v[16:19], a[80:83], v[32:47]
    ds_read_b128 v[12:15], v4 offset:12800
    s_waitcnt lgkmcnt(4)
    v_mfma_f32_32x32x16_bf16 v[32:47], v[20:23], a[84:87], v[32:47]
    ds_read_b128 v[16:19], v4 offset:13312
    s_waitcnt lgkmcnt(4)
    v_mfma_f32_32x32x16_bf16 v[32:47], v[24:27], a[88:91], v[32:47]
    ds_read_b128 v[20:23], v4 offset:13824
    s_waitcnt lgkmcnt(4)
    v_mfma_f32_32x32x16_bf16 v[32:47], v[28:31], a[92:95], v[32:47]
    ds_read_b128 v[24:27], v4 offset:28672
    s_waitcnt lgkmcnt(4)
    v_mfma_f32_32x32x16_bf16 v[32:47], v[8:11], a[96:99], v[32:47]
    ds_read_b128 v[28:31], v4 offset:29184
    s_waitcnt lgkmcnt(4)
    v_mfma_f32_32x32x16_bf16 v[32:47], v[12:15], a[100:103], v[32:47]
    ds_read_b128 v[8:11], v4 offset:29696
    s_waitcnt lgkmcnt(4)
    v_mfma_f32_32x32x16_bf16 v[32:47], v[16:19], a[104:107], v[32:47]
    ds_read_b128 v[12:15], v4 offset:30208
    s_waitcnt lgkmcnt(4)
    v_mfma_f32_32x32x16_bf16 v[32:47], v[20:23], a[108:111], v[32:47]
    ds_read_b128 v[16:19], v4 offset:30720
    s_waitcnt lgkmcnt(4)
    v_mfma_f32_32x32x16_bf16 v[48:63], v[24:27], a[0:3], 0
    ds_read_b128 v[20:23], v4 offset:31232
    s_waitcnt lgkmcnt(4)
    v_mfma_f32_32x32x16_bf16 v[48:63], v[28:31], a[4:7], v[48:63]
    ds_read_b128 v[24:27], v4 offset:31744
    s_waitcnt lgkmcnt(4)
    v_mfma_f32_32x32x16_bf16 v[48:63], v[8:11], a[8:11], v[48:63]
    ds_read_b128 v[28:31], v4 offset:32256
    s_waitcnt vmcnt(0)
    s_waitcnt lgkmcnt(4)
    v_mfma_f32_32x32x16_bf16 v[48:63], v[12:15], a[12:15], v[48:63]
    ds_read_b128 v[8:11], v4 offset:32768
    v_fma_f32 v32, -v192, v144, v32
    v_fma_f32 v33, -v192, v145, v33
    v_fma_f32 v34, -v192, v146, v34
    v_fma_f32 v35, -v192, v147, v35
    v_mul_f32 v32, v32, v193
    v_mul_f32 v33, v33, v193
    v_mul_f32 v34, v34, v193
    v_mul_f32 v35, v35, v193
    s_waitcnt lgkmcnt(4)
    v_mfma_f32_32x32x16_bf16 v[48:63], v[16:19], a[16:19], v[48:63]
    ds_read_b128 v[12:15], v4 offset:33280
    v_mul_f32 v196, v32, v32
    v_mul_f32 v197, v33, v33
    v_mul_f32 v198, v34, v34
    v_mul_f32 v199, v35, v35
    v_fma_f32 v196, v196, s61, v194
    v_fma_f32 v197, v197, s61, v194
    v_fma_f32 v198, v198, s61, v194
    v_fma_f32 v199, v199, s61, v194
    s_waitcnt lgkmcnt(4)
    v_mfma_f32_32x32x16_bf16 v[48:63], v[20:23], a[20:23], v[48:63]
    ds_read_b128 v[16:19], v4 offset:33792
    v_mul_f32 v196, v196, v32
    v_mul_f32 v197, v197, v33
    v_mul_f32 v198, v198, v34
    v_mul_f32 v199, v199, v35
    v_exp_f32 v196, v196
    v_exp_f32 v197, v197
    s_waitcnt lgkmcnt(4)
    v_mfma_f32_32x32x16_bf16 v[48:63], v[24:27], a[24:27], v[48:63]
    ds_read_b128 v[20:23], v4 offset:34304
    v_exp_f32 v198, v198
    v_exp_f32 v199, v199
    v_add_f32 v196, 1.0, v196
    v_add_f32 v197, 1.0, v197
    v_add_f32 v198, 1.0, v198
    v_add_f32 v199, 1.0, v199
    s_waitcnt lgkmcnt(4)
    v_mfma_f32_32x32x16_bf16 v[48:63], v[28:31], a[28:31], v[48:63]
    ds_read_b128 v[24:27], v4 offset:34816
    v_rcp_f32 v196, v196
    v_rcp_f32 v197, v197
    s_waitcnt lgkmcnt(4)
    v_mfma_f32_32x32x16_bf16 v[48:63], v[8:11], a[32:35], v[48:63]
    ds_read_b128 v[28:31], v4 offset:35328
    v_rcp_f32 v198, v198
    v_rcp_f32 v199, v199
    v_mul_f32 v32, v32, v196
    v_mul_f32 v33, v33, v197
    v_mul_f32 v34, v34, v198
    v_mul_f32 v35, v35, v199
    s_waitcnt lgkmcnt(4)
    v_mfma_f32_32x32x16_bf16 v[48:63], v[12:15], a[36:39], v[48:63]
    ds_read_b128 v[8:11], v4 offset:35840
    v_fma_f32 v36, -v192, v148, v36
    v_fma_f32 v37, -v192, v149, v37
    v_fma_f32 v38, -v192, v150, v38
    v_fma_f32 v39, -v192, v151, v39
    v_mul_f32 v36, v36, v193
    v_mul_f32 v37, v37, v193
    v_mul_f32 v38, v38, v193
    v_mul_f32 v39, v39, v193
    s_waitcnt lgkmcnt(4)
    v_mfma_f32_32x32x16_bf16 v[48:63], v[16:19], a[40:43], v[48:63]
    ds_read_b128 v[12:15], v4 offset:36352
    v_mul_f32 v196, v36, v36
    v_mul_f32 v197, v37, v37
    v_mul_f32 v198, v38, v38
    v_mul_f32 v199, v39, v39
    v_fma_f32 v196, v196, s61, v194
    v_fma_f32 v197, v197, s61, v194
    v_fma_f32 v198, v198, s61, v194
    v_fma_f32 v199, v199, s61, v194
    s_waitcnt lgkmcnt(4)
    v_mfma_f32_32x32x16_bf16 v[48:63], v[20:23], a[44:47], v[48:63]
    ds_read_b128 v[16:19], v4 offset:36864
    v_mul_f32 v196, v196, v36
    v_mul_f32 v197, v197, v37
    v_mul_f32 v198, v198, v38
    v_mul_f32 v199, v199, v39
    s_waitcnt lgkmcnt(4)
    v_mfma_f32_32x32x16_bf16 v[48:63], v[24:27], a[48:51], v[48:63]
    ds_read_b128 v[20:23], v4 offset:37376
    v_exp_f32 v196, v196
    v_exp_f32 v197, v197
    v_exp_f32 v198, v198
    v_exp_f32 v199, v199
    s_waitcnt lgkmcnt(4)
    v_mfma_f32_32x32x16_bf16 v[48:63], v[28:31], a[52:55], v[48:63]
    ds_read_b128 v[24:27], v4 offset:37888
    v_add_f32 v196, 1.0, v196
    v_add_f32 v197, 1.0, v197
    v_add_f32 v198, 1.0, v198
    v_add_f32 v199, 1.0, v199
    v_rcp_f32 v196, v196
    v_rcp_f32 v197, v197
    s_waitcnt lgkmcnt(4)
    v_mfma_f32_32x32x16_bf16 v[48:63], v[8:11], a[56:59], v[48:63]
    ds_read_b128 v[28:31], v4 offset:38400
    v_rcp_f32 v198, v198
    v_rcp_f32 v199, v199
    v_mul_f32 v36, v36, v196
    v_mul_f32 v37, v37, v197
    v_mul_f32 v38, v38, v198
    v_mul_f32 v39, v39, v199
    s_waitcnt lgkmcnt(4)
    v_mfma_f32_32x32x16_bf16 v[48:63], v[12:15], a[60:63], v[48:63]
    ds_read_b128 v[8:11], v4 offset:38912
    v_fma_f32 v40, -v192, v152, v40
    v_fma_f32 v41, -v192, v153, v41
    v_fma_f32 v42, -v192, v154, v42
    v_fma_f32 v43, -v192, v155, v43
    s_waitcnt lgkmcnt(4)
    v_mfma_f32_32x32x16_bf16 v[48:63], v[16:19], a[64:67], v[48:63]
    ds_read_b128 v[12:15], v4 offset:39424
    v_mul_f32 v40, v40, v193
    v_mul_f32 v41, v41, v193
    v_mul_f32 v42, v42, v193
    v_mul_f32 v43, v43, v193
    v_mul_f32 v196, v40, v40
    v_mul_f32 v197, v41, v41
    v_mul_f32 v198, v42, v42
    v_mul_f32 v199, v43, v43
    s_waitcnt lgkmcnt(4)
    v_mfma_f32_32x32x16_bf16 v[48:63], v[20:23], a[68:71], v[48:63]
    ds_read_b128 v[16:19], v4 offset:39936
    v_fma_f32 v196, v196, s61, v194
    v_fma_f32 v197, v197, s61, v194
    v_fma_f32 v198, v198, s61, v194
    v_fma_f32 v199, v199, s61, v194
    v_mul_f32 v196, v196, v40
    v_mul_f32 v197, v197, v41
    v_mul_f32 v198, v198, v42
    v_mul_f32 v199, v199, v43
    s_waitcnt lgkmcnt(4)
    v_mfma_f32_32x32x16_bf16 v[48:63], v[24:27], a[72:75], v[48:63]
    ds_read_b128 v[20:23], v4 offset:40448
    v_exp_f32 v196, v196
    v_exp_f32 v197, v197
    v_exp_f32 v198, v198
    v_exp_f32 v199, v199
    s_waitcnt lgkmcnt(4)
    v_mfma_f32_32x32x16_bf16 v[48:63], v[28:31], a[76:79], v[48:63]
    ds_read_b128 v[24:27], v4 offset:40960
    v_add_f32 v196, 1.0, v196
    v_add_f32 v197, 1.0, v197
    v_add_f32 v198, 1.0, v198
    v_add_f32 v199, 1.0, v199
    s_waitcnt lgkmcnt(4)
    v_mfma_f32_32x32x16_bf16 v[48:63], v[8:11], a[80:83], v[48:63]
    ds_read_b128 v[28:31], v4 offset:41472
    v_rcp_f32 v196, v196
    v_rcp_f32 v197, v197
    v_rcp_f32 v198, v198
    v_rcp_f32 v199, v199
    s_waitcnt lgkmcnt(4)
    v_mfma_f32_32x32x16_bf16 v[48:63], v[12:15], a[84:87], v[48:63]
    ds_read_b128 v[8:11], v4 offset:41984
    v_mul_f32 v40, v40, v196
    v_mul_f32 v41, v41, v197
    v_mul_f32 v42, v42, v198
    v_mul_f32 v43, v43, v199
    v_fma_f32 v44, -v192, v156, v44
    v_fma_f32 v45, -v192, v157, v45
    v_fma_f32 v46, -v192, v158, v46
    v_fma_f32 v47, -v192, v159, v47
    s_waitcnt lgkmcnt(4)
    v_mfma_f32_32x32x16_bf16 v[48:63], v[16:19], a[88:91], v[48:63]
    ds_read_b128 v[12:15], v4 offset:42496
    v_mul_f32 v44, v44, v193
    v_mul_f32 v45, v45, v193
    v_mul_f32 v46, v46, v193
    v_mul_f32 v47, v47, v193
    v_mul_f32 v196, v44, v44
    v_mul_f32 v197, v45, v45
    v_mul_f32 v198, v46, v46
    v_mul_f32 v199, v47, v47
    s_waitcnt lgkmcnt(4)
    v_mfma_f32_32x32x16_bf16 v[48:63], v[20:23], a[92:95], v[48:63]
    v_fma_f32 v196, v196, s61, v194
    v_fma_f32 v197, v197, s61, v194
    v_fma_f32 v198, v198, s61, v194
    v_fma_f32 v199, v199, s61, v194
    s_waitcnt lgkmcnt(4)
    v_mfma_f32_32x32x16_bf16 v[48:63], v[24:27], a[96:99], v[48:63]
    v_mul_f32 v196, v196, v44
    v_mul_f32 v197, v197, v45
    v_mul_f32 v198, v198, v46
    v_mul_f32 v199, v199, v47
    v_exp_f32 v196, v196
    v_exp_f32 v197, v197
    s_waitcnt lgkmcnt(4)
    v_mfma_f32_32x32x16_bf16 v[48:63], v[28:31], a[100:103], v[48:63]
    v_exp_f32 v198, v198
    v_exp_f32 v199, v199
    v_add_f32 v196, 1.0, v196
    v_add_f32 v197, 1.0, v197
    v_add_f32 v198, 1.0, v198
    v_add_f32 v199, 1.0, v199
    s_waitcnt lgkmcnt(4)
    v_mfma_f32_32x32x16_bf16 v[48:63], v[8:11], a[104:107], v[48:63]
    v_rcp_f32 v196, v196
    v_rcp_f32 v197, v197
    v_rcp_f32 v198, v198
    v_rcp_f32 v199, v199
    s_waitcnt lgkmcnt(4)
    v_mfma_f32_32x32x16_bf16 v[48:63], v[12:15], a[108:111], v[48:63]
    v_mul_f32 v44, v44, v196
    v_mul_f32 v45, v45, v197
    v_mul_f32 v46, v46, v198
    v_mul_f32 v47, v47, v199
    s_waitcnt vmcnt(0)
    s_nop 6
    v_fma_f32 v48, -v192, v160, v48
    v_fma_f32 v49, -v192, v161, v49
    v_fma_f32 v50, -v192, v162, v50
    v_fma_f32 v51, -v192, v163, v51
    v_mul_f32 v48, v48, v193
    v_mul_f32 v49, v49, v193
    v_mul_f32 v50, v50, v193
    v_mul_f32 v51, v51, v193
    v_mul_f32 v196, v48, v48
    v_mul_f32 v197, v49, v49
    v_mul_f32 v198, v50, v50
    v_mul_f32 v199, v51, v51
    v_fma_f32 v196, v196, s61, v194
    v_fma_f32 v197, v197, s61, v194
    v_fma_f32 v198, v198, s61, v194
    v_fma_f32 v199, v199, s61, v194
    v_mul_f32 v196, v196, v48
    v_mul_f32 v197, v197, v49
    v_mul_f32 v198, v198, v50
    v_mul_f32 v199, v199, v51
    v_exp_f32 v196, v196
    v_exp_f32 v197, v197
    v_exp_f32 v198, v198
    v_exp_f32 v199, v199
    v_add_f32 v196, 1.0, v196
    v_add_f32 v197, 1.0, v197
    v_add_f32 v198, 1.0, v198
    v_add_f32 v199, 1.0, v199
    v_rcp_f32 v196, v196
    v_rcp_f32 v197, v197
    v_rcp_f32 v198, v198
    v_rcp_f32 v199, v199
    v_mul_f32 v48, v48, v196
    v_mul_f32 v49, v49, v197
    v_mul_f32 v50, v50, v198
    v_mul_f32 v51, v51, v199
    v_fma_f32 v52, -v192, v164, v52
    v_fma_f32 v53, -v192, v165, v53
    v_fma_f32 v54, -v192, v166, v54
    v_fma_f32 v55, -v192, v167, v55
    v_mul_f32 v52, v52, v193
    v_mul_f32 v53, v53, v193
    v_mul_f32 v54, v54, v193
    v_mul_f32 v55, v55, v193
    v_mul_f32 v196, v52, v52
    v_mul_f32 v197, v53, v53
    v_mul_f32 v198, v54, v54
    v_mul_f32 v199, v55, v55
    v_fma_f32 v196, v196, s61, v194
    v_fma_f32 v197, v197, s61, v194
    v_fma_f32 v198, v198, s61, v194
    v_fma_f32 v199, v199, s61, v194
    v_mul_f32 v196, v196, v52
    v_mul_f32 v197, v197, v53
    v_mul_f32 v198, v198, v54
    v_mul_f32 v199, v199, v55
    v_exp_f32 v196, v196
    v_exp_f32 v197, v197
    v_exp_f32 v198, v198
    v_exp_f32 v199, v199
    v_add_f32 v196, 1.0, v196
    v_add_f32 v197, 1.0, v197
    v_add_f32 v198, 1.0, v198
    v_add_f32 v199, 1.0, v199
    v_rcp_f32 v196, v196
    v_rcp_f32 v197, v197
    v_rcp_f32 v198, v198
    v_rcp_f32 v199, v199
    v_mul_f32 v52, v52, v196
    v_mul_f32 v53, v53, v197
    v_mul_f32 v54, v54, v198
    v_mul_f32 v55, v55, v199
    v_fma_f32 v56, -v192, v168, v56
    v_fma_f32 v57, -v192, v169, v57
    v_fma_f32 v58, -v192, v170, v58
    v_fma_f32 v59, -v192, v171, v59
    v_mul_f32 v56, v56, v193
    v_mul_f32 v57, v57, v193
    v_mul_f32 v58, v58, v193
    v_mul_f32 v59, v59, v193
    v_mul_f32 v196, v56, v56
    v_mul_f32 v197, v57, v57
    v_mul_f32 v198, v58, v58
    v_mul_f32 v199, v59, v59
    v_fma_f32 v196, v196, s61, v194
    v_fma_f32 v197, v197, s61, v194
    v_fma_f32 v198, v198, s61, v194
    v_fma_f32 v199, v199, s61, v194
    v_mul_f32 v196, v196, v56
    v_mul_f32 v197, v197, v57
    v_mul_f32 v198, v198, v58
    v_mul_f32 v199, v199, v59
    v_exp_f32 v196, v196
    v_exp_f32 v197, v197
    v_exp_f32 v198, v198
    v_exp_f32 v199, v199
    v_add_f32 v196, 1.0, v196
    v_add_f32 v197, 1.0, v197
    v_add_f32 v198, 1.0, v198
    v_add_f32 v199, 1.0, v199
    v_rcp_f32 v196, v196
    v_rcp_f32 v197, v197
    v_rcp_f32 v198, v198
    v_rcp_f32 v199, v199
    v_mul_f32 v56, v56, v196
    v_mul_f32 v57, v57, v197
    v_mul_f32 v58, v58, v198
    v_mul_f32 v59, v59, v199
    v_fma_f32 v60, -v192, v172, v60
    v_fma_f32 v61, -v192, v173, v61
    v_fma_f32 v62, -v192, v174, v62
    v_fma_f32 v63, -v192, v175, v63
    v_mul_f32 v60, v60, v193
    v_mul_f32 v61, v61, v193
    v_mul_f32 v62, v62, v193
    v_mul_f32 v63, v63, v193
    v_mul_f32 v196, v60, v60
    v_mul_f32 v197, v61, v61
    v_mul_f32 v198, v62, v62
    v_mul_f32 v199, v63, v63
    v_fma_f32 v196, v196, s61, v194
    v_fma_f32 v197, v197, s61, v194
    v_fma_f32 v198, v198, s61, v194
    v_fma_f32 v199, v199, s61, v194
    v_mul_f32 v196, v196, v60
    v_mul_f32 v197, v197, v61
    v_mul_f32 v198, v198, v62
    v_mul_f32 v199, v199, v63
    v_exp_f32 v196, v196
    v_exp_f32 v197, v197
    v_exp_f32 v198, v198
    v_exp_f32 v199, v199
    v_add_f32 v196, 1.0, v196
    v_add_f32 v197, 1.0, v197
    v_add_f32 v198, 1.0, v198
    v_add_f32 v199, 1.0, v199
    v_rcp_f32 v196, v196
    v_rcp_f32 v197, v197
    v_rcp_f32 v198, v198
    v_rcp_f32 v199, v199
    v_mul_f32 v60, v60, v196
    v_mul_f32 v61, v61, v197
    v_mul_f32 v62, v62, v198
    v_mul_f32 v63, v63, v199
    v_cvt_pk_bf16_f32 v200, v32, v33
    v_lshlrev_b32 v32, 16, v200
    v_and_b32 v33, 0xffff0000, v200
    v_cvt_pk_bf16_f32 v200, v34, v35
    v_lshlrev_b32 v34, 16, v200
    v_and_b32 v35, 0xffff0000, v200
    v_cvt_pk_bf16_f32 v200, v36, v37
    v_lshlrev_b32 v36, 16, v200
    v_and_b32 v37, 0xffff0000, v200
    v_cvt_pk_bf16_f32 v200, v38, v39
    v_lshlrev_b32 v38, 16, v200
    v_and_b32 v39, 0xffff0000, v200
    v_cvt_pk_bf16_f32 v200, v40, v41
    v_lshlrev_b32 v40, 16, v200
    v_and_b32 v41, 0xffff0000, v200
    v_cvt_pk_bf16_f32 v200, v42, v43
    v_lshlrev_b32 v42, 16, v200
    v_and_b32 v43, 0xffff0000, v200
    v_cvt_pk_bf16_f32 v200, v44, v45
    v_lshlrev_b32 v44, 16, v200
    v_and_b32 v45, 0xffff0000, v200
    v_cvt_pk_bf16_f32 v200, v46, v47
    v_lshlrev_b32 v46, 16, v200
    v_and_b32 v47, 0xffff0000, v200
    v_cvt_pk_bf16_f32 v200, v48, v49
    v_lshlrev_b32 v48, 16, v200
    v_and_b32 v49, 0xffff0000, v200
    v_cvt_pk_bf16_f32 v200, v50, v51
    v_lshlrev_b32 v50, 16, v200
    v_and_b32 v51, 0xffff0000, v200
    v_cvt_pk_bf16_f32 v200, v52, v53
    v_lshlrev_b32 v52, 16, v200
    v_and_b32 v53, 0xffff0000, v200
    v_cvt_pk_bf16_f32 v200, v54, v55
    v_lshlrev_b32 v54, 16, v200
    v_and_b32 v55, 0xffff0000, v200
    v_cvt_pk_bf16_f32 v200, v56, v57
    v_lshlrev_b32 v56, 16, v200
    v_and_b32 v57, 0xffff0000, v200
    v_cvt_pk_bf16_f32 v200, v58, v59
    v_lshlrev_b32 v58, 16, v200
    v_and_b32 v59, 0xffff0000, v200
    v_cvt_pk_bf16_f32 v200, v60, v61
    v_lshlrev_b32 v60, 16, v200
    v_and_b32 v61, 0xffff0000, v200
    v_cvt_pk_bf16_f32 v200, v62, v63
    v_lshlrev_b32 v62, 16, v200
    v_and_b32 v63, 0xffff0000, v200
    v_add_f32 v202, v32, v33
    v_mul_f32 v203, v32, v32
    v_fmac_f32 v203, v33, v33
    v_add_f32 v202, v202, v34
    v_fmac_f32 v203, v34, v34
    v_add_f32 v202, v202, v35
    v_fmac_f32 v203, v35, v35
    v_add_f32 v202, v202, v36
    v_fmac_f32 v203, v36, v36
    v_add_f32 v202, v202, v37
    v_fmac_f32 v203, v37, v37
    v_add_f32 v202, v202, v38
    v_fmac_f32 v203, v38, v38
    v_add_f32 v202, v202, v39
    v_fmac_f32 v203, v39, v39
    v_add_f32 v202, v202, v40
    v_fmac_f32 v203, v40, v40
    v_add_f32 v202, v202, v41
    v_fmac_f32 v203, v41, v41
    v_add_f32 v202, v202, v42
    v_fmac_f32 v203, v42, v42
    v_add_f32 v202, v202, v43
    v_fmac_f32 v203, v43, v43
    v_add_f32 v202, v202, v44
    v_fmac_f32 v203, v44, v44
    v_add_f32 v202, v202, v45
    v_fmac_f32 v203, v45, v45
    v_add_f32 v202, v202, v46
    v_fmac_f32 v203, v46, v46
    v_add_f32 v202, v202, v47
    v_fmac_f32 v203, v47, v47
    v_add_f32 v202, v202, v48
    v_fmac_f32 v203, v48, v48
    v_add_f32 v202, v202, v49
    v_fmac_f32 v203, v49, v49
    v_add_f32 v202, v202, v50
    v_fmac_f32 v203, v50, v50
    v_add_f32 v202, v202, v51
    v_fmac_f32 v203, v51, v51
    v_add_f32 v202, v202, v52
    v_fmac_f32 v203, v52, v52
    v_add_f32 v202, v202, v53
    v_fmac_f32 v203, v53, v53
    v_add_f32 v202, v202, v54
    v_fmac_f32 v203, v54, v54
    v_add_f32 v202, v202, v55
    v_fmac_f32 v203, v55, v55
    v_add_f32 v202, v202, v56
    v_fmac_f32 v203, v56, v56
    v_add_f32 v202, v202, v57
    v_fmac_f32 v203, v57, v57
    v_add_f32 v202, v202, v58
    v_fmac_f32 v203, v58, v58
    v_add_f32 v202, v202, v59
    v_fmac_f32 v203, v59, v59
    v_add_f32 v202, v202, v60
    v_fmac_f32 v203, v60, v60
    v_add_f32 v202, v202, v61
    v_fmac_f32 v203, v61, v61
    v_add_f32 v202, v202, v62
    v_fmac_f32 v203, v62, v62
    v_add_f32 v202, v202, v63
    v_fmac_f32 v203, v63, v63
    v_mov_b32 v201, v202
    s_nop 1
    v_permlane32_swap_b32 v201, v202
    v_add_f32 v202, v202, v201
    v_mov_b32 v201, v203
    s_nop 1
    v_permlane32_swap_b32 v201, v203
    v_add_f32 v203, v203, v201
    s_sub_u32 s49, s41, 14
    s_lshl_b32 s22, s40, 4
    s_add_u32 s22, s22, s49
    s_lshl_b32 s22, s22, 10
    s_lshl_b32 s20, s14, 8
    s_add_u32 s22, s22, s20
    s_add_u32 s22, s22, 127991808
    v_and_b32 v204, 31, v0
    v_lshlrev_b32 v204, 3, v204
    s_mov_b32 exec_hi, 0
    buffer_store_dwordx2 v[202:203], v204, s[8:11], s22 offen sc1
    s_mov_b64 exec, -1
    s_lshl_b32 s22, s40, 14
    s_lshl_b32 s20, s14, 8
    s_add_u32 s22, s22, s20
    s_add_u32 s22, s22, 127991808
tokx_stp:
    s_mov_b32 s23, s22
    buffer_load_dwordx2 v[144:145], v204, s[8:11], s23 offen offset:0 sc1
    buffer_load_dwordx2 v[146:147], v204, s[8:11], s23 offen offset:1024 sc1
    buffer_load_dwordx2 v[148:149], v204, s[8:11], s23 offen offset:2048 sc1
    buffer_load_dwordx2 v[150:151], v204, s[8:11], s23 offen offset:3072 sc1
    s_add_u32 s23, s23, 4096
    buffer_load_dwordx2 v[152:153], v204, s[8:11], s23 offen offset:0 sc1
    buffer_load_dwordx2 v[154:155], v204, s[8:11], s23 offen offset:1024 sc1
    buffer_load_dwordx2 v[156:157], v204, s[8:11], s23 offen offset:2048 sc1
    buffer_load_dwordx2 v[158:159], v204, s[8:11], s23 offen offset:3072 sc1
    s_add_u32 s23, s23, 4096
    buffer_load_dwordx2 v[160:161], v204, s[8:11], s23 offen offset:0 sc1
    buffer_load_dwordx2 v[162:163], v204, s[8:11], s23 offen offset:1024 sc1
    buffer_load_dwordx2 v[164:165], v204, s[8:11], s23 offen offset:2048 sc1
    buffer_load_dwordx2 v[166:167], v204, s[8:11], s23 offen offset:3072 sc1
    s_add_u32 s23, s23, 4096
    buffer_load_dwordx2 v[168:169], v204, s[8:11], s23 offen offset:0 sc1
    buffer_load_dwordx2 v[170:171], v204, s[8:11], s23 offen offset:1024 sc1
    s_waitcnt vmcnt(0)
    v_max3_u32 v180, v145, v147, v149
    v_max3_u32 v180, v180, v151, v153
    v_max3_u32 v180, v180, v155, v157
    v_max3_u32 v180, v180, v159, v161
    v_max3_u32 v180, v180, v163, v165
    v_max3_u32 v180, v180, v167, v169
    v_max_u32 v180, v180, v171
    v_cmp_eq_u32 vcc, -1, v180
    s_cbranch_vccz tokx_stpk
    s_sleep 1
    s_sub_u32 s17, s17, 1
    s_cmp_gt_i32 s17, 0
    s_cbranch_scc1 tokx_stp
tokx_stpk:
    v_pk_add_f32 v[144:145], v[144:145], v[146:147]
    v_pk_add_f32 v[144:145], v[144:145], v[148:149]
    v_pk_add_f32 v[144:145], v[144:145], v[150:151]
    v_pk_add_f32 v[144:145], v[144:145], v[152:153]
    v_pk_add_f32 v[144:145], v[144:145], v[154:155]
    v_pk_add_f32 v[144:145], v[144:145], v[156:157]
    v_pk_add_f32 v[144:145], v[144:145], v[158:159]
    v_pk_add_f32 v[144:145], v[144:145], v[160:161]
    v_pk_add_f32 v[144:145], v[144:145], v[162:163]
    v_pk_add_f32 v[144:145], v[144:145], v[164:165]
    v_pk_add_f32 v[144:145], v[144:145], v[166:167]
    v_pk_add_f32 v[144:145], v[144:145], v[168:169]
    v_pk_add_f32 v[144:145], v[144:145], v[170:171]
    v_mov_b32 v206, v144
    v_mov_b32 v207, v145
    v_mul_f32 v206, 982665509, v206
    v_mul_f32 v207, 982665509, v207
    v_fma_f32 v207, -v206, v206, v207
    v_max_f32 v207, 0, v207
    v_add_f32 v207, 925353388, v207
    v_rsq_f32 v207, v207
    s_nop 0
    v_mul_f32 v206, v206, v207
    v_fma_f32 v32, v32, v207, -v206
    v_fma_f32 v33, v33, v207, -v206
    v_fma_f32 v34, v34, v207, -v206
    v_fma_f32 v35, v35, v207, -v206
    v_fma_f32 v36, v36, v207, -v206
    v_fma_f32 v37, v37, v207, -v206
    v_fma_f32 v38, v38, v207, -v206
    v_fma_f32 v39, v39, v207, -v206
    v_fma_f32 v40, v40, v207, -v206
    v_fma_f32 v41, v41, v207, -v206
    v_fma_f32 v42, v42, v207, -v206
    v_fma_f32 v43, v43, v207, -v206
    v_fma_f32 v44, v44, v207, -v206
    v_fma_f32 v45, v45, v207, -v206
    v_fma_f32 v46, v46, v207, -v206
    v_fma_f32 v47, v47, v207, -v206
    v_fma_f32 v48, v48, v207, -v206
    v_fma_f32 v49, v49, v207, -v206
    v_fma_f32 v50, v50, v207, -v206
    v_fma_f32 v51, v51, v207, -v206
    v_fma_f32 v52, v52, v207, -v206
    v_fma_f32 v53, v53, v207, -v206
    v_fma_f32 v54, v54, v207, -v206
    v_fma_f32 v55, v55, v207, -v206
    v_fma_f32 v56, v56, v207, -v206
    v_fma_f32 v57, v57, v207, -v206
    v_fma_f32 v58, v58, v207, -v206
    v_fma_f32 v59, v59, v207, -v206
    v_fma_f32 v60, v60, v207, -v206
    v_fma_f32 v61, v61, v207, -v206
    v_fma_f32 v62, v62, v207, -v206
    v_fma_f32 v63, v63, v207, -v206
    v_and_b32 v208, 31, v0
    v_mul_u32_u24 v208, 136, v208
    v_lshrrev_b32 v209, 5, v0
    v_lshl_add_u32 v208, v209, 3, v208
    s_mul_i32 s20, s14, 4352
    s_add_u32 s20, s20, 57344
    v_add_u32 v208, s20, v208
    v_cvt_pk_bf16_f32 v216, v32, v33
    v_cvt_pk_bf16_f32 v217, v34, v35
    ds_write_b64 v208, v[216:217] offset:0
    v_cvt_pk_bf16_f32 v218, v36, v37
    v_cvt_pk_bf16_f32 v219, v38, v39
    ds_write_b64 v208, v[218:219] offset:16
    v_cvt_pk_bf16_f32 v220, v40, v41
    v_cvt_pk_bf16_f32 v221, v42, v43
    ds_write_b64 v208, v[220:221] offset:32
    v_cvt_pk_bf16_f32 v222, v44, v45
    v_cvt_pk_bf16_f32 v223, v46, v47
    ds_write_b64 v208, v[222:223] offset:48
    v_cvt_pk_bf16_f32 v224, v48, v49
    v_cvt_pk_bf16_f32 v225, v50, v51
    ds_write_b64 v208, v[224:225] offset:64
    v_cvt_pk_bf16_f32 v226, v52, v53
    v_cvt_pk_bf16_f32 v227, v54, v55
    ds_write_b64 v208, v[226:227] offset:80
    v_cvt_pk_bf16_f32 v228, v56, v57
    v_cvt_pk_bf16_f32 v229, v58, v59
    ds_write_b64 v208, v[228:229] offset:96
    v_cvt_pk_bf16_f32 v230, v60, v61
    v_cvt_pk_bf16_f32 v231, v62, v63
    ds_write_b64 v208, v[230:231] offset:112
    v_bfe_u32 v209, v0, 2, 2
    v_bfe_u32 v210, v0, 4, 1
    v_lshl_add_u32 v209, v210, 3, v209
    v_lshrrev_b32 v210, 5, v0
    v_lshl_add_u32 v209, v210, 4, v209
    v_mul_u32_u24 v209, 136, v209
    v_and_b32 v210, 3, v0
    v_lshl_add_u32 v209, v210, 3, v209
    v_add_u32 v209, s20, v209
    s_waitcnt lgkmcnt(0)
    s_mul_i32 s22, s49, 4
    s_lshl_b32 s22, s22, 7
    s_add_u32 s22, s22, s45
    s_lshl_b32 s22, s22, 9
    s_add_u32 s22, s22, 115343360
    ds_read_b64_tr_b16 v[232:233], v209 offset:0
    ds_read_b64_tr_b16 v[234:235], v209 offset:544
    s_waitcnt lgkmcnt(0)
    buffer_store_dwordx4 v[232:235], v1, s[8:11], s22 offen sc1
    s_add_u32 s22, s22, 65536
    ds_read_b64_tr_b16 v[236:237], v209 offset:32
    ds_read_b64_tr_b16 v[238:239], v209 offset:576
    s_waitcnt lgkmcnt(0)
    buffer_store_dwordx4 v[236:239], v1, s[8:11], s22 offen sc1
    s_add_u32 s22, s22, 65536
    ds_read_b64_tr_b16 v[240:241], v209 offset:64
    ds_read_b64_tr_b16 v[242:243], v209 offset:608
    s_waitcnt lgkmcnt(0)
    buffer_store_dwordx4 v[240:243], v1, s[8:11], s22 offen sc1
    s_add_u32 s22, s22, 65536
    ds_read_b64_tr_b16 v[244:245], v209 offset:96
    ds_read_b64_tr_b16 v[246:247], v209 offset:640
    s_waitcnt lgkmcnt(0)
    buffer_store_dwordx4 v[244:247], v1, s[8:11], s22 offen sc1
    s_add_u32 s22, s22, 65536
    s_waitcnt vmcnt(0)
    s_barrier
    s_cmp_lg_u32 s14, 0
    s_cbranch_scc1 toks2_sg8
    s_lshl_b32 s24, s40, 10
    s_add_u32 s24, s24, 20480000
    v_lshlrev_b32 v250, 7, v0
    v_mov_b32 v251, 1
    s_mov_b64 exec, 0xff
    buffer_atomic_add v251, v250, s[8:11], s24 offen
    s_mov_b64 exec, -1
toks2_sg8:
tok_adv:
    s_barrier
    s_add_u32 s38, s38, 64
    s_branch tok_next
tok_done:
    s_getpc_b64 s[20:21]
ctch3:
    s_sub_u32 s20, s20, ctch3-main_kernel
    s_subb_u32 s21, s21, 0
    v_lshlrev_b32 v248, 7, v0
    s_lshl_b32 s22, s14, 13
    v_add_u32 v248, s22, v248
    v_min_u32 v246, main_code_end-main_kernel-4, v248
    global_load_dword v247, v246, s[20:21]
    v_add_u32 v248, 0x8000, v248
    v_min_u32 v246, main_code_end-main_kernel-4, v248
    global_load_dword v247, v246, s[20:21]
    v_add_u32 v248, 0x8000, v248
    v_min_u32 v246, main_code_end-main_kernel-4, v248
    global_load_dword v247, v246, s[20:21]
    v_add_u32 v248, 0x8000, v248
    s_and_b32 s62, s14, 1
    s_lshr_b32 s63, s14, 1
    s_lshl_b32 s51, s35, 1
    s_add_u32 s51, s51, s63
    s_mul_i32 s52, s51, 57344
    s_add_u32 s52, s52, 109051904
    v_bfe_u32 v249, v0, 4, 1
    v_mul_u32_u24 v249, 28672, v249
    v_lshrrev_b32 v250, 5, v0
    v_lshl_add_u32 v249, v250, 8, v249
    v_and_b32 v250, 15, v0
    v_lshl_add_u32 v249, v250, 4, v249
    s_add_u32 s53, s52, 0
    buffer_load_dwordx4 a[0:3], v249, s[8:11], s53 offen offset:0
    buffer_load_dwordx4 a[4:7], v249, s[8:11], s53 offen offset:512
    buffer_load_dwordx4 a[8:11], v249, s[8:11], s53 offen offset:1024
    buffer_load_dwordx4 a[12:15], v249, s[8:11], s53 offen offset:1536
    buffer_load_dwordx4 a[16:19], v249, s[8:11], s53 offen offset:2048
    buffer_load_dwordx4 a[20:23], v249, s[8:11], s53 offen offset:2560
    buffer_load_dwordx4 a[24:27], v249, s[8:11], s53 offen offset:3072
    buffer_load_dwordx4 a[28:31], v249, s[8:11], s53 offen offset:3584
    s_add_u32 s53, s52, 4096
    buffer_load_dwordx4 a[32:35], v249, s[8:11], s53 offen offset:0
    buffer_load_dwordx4 a[36:39], v249, s[8:11], s53 offen offset:512
    buffer_load_dwordx4 a[40:43], v249, s[8:11], s53 offen offset:1024
    buffer_load_dwordx4 a[44:47], v249, s[8:11], s53 offen offset:1536
    buffer_load_dwordx4 a[48:51], v249, s[8:11], s53 offen offset:2048
    buffer_load_dwordx4 a[52:55], v249, s[8:11], s53 offen offset:2560
    buffer_load_dwordx4 a[56:59], v249, s[8:11], s53 offen offset:3072
    buffer_load_dwordx4 a[60:63], v249, s[8:11], s53 offen offset:3584
    s_add_u32 s53, s52, 8192
    buffer_load_dwordx4 a[64:67], v249, s[8:11], s53 offen offset:0
    buffer_load_dwordx4 a[68:71], v249, s[8:11], s53 offen offset:512
    buffer_load_dwordx4 a[72:75], v249, s[8:11], s53 offen offset:1024
    buffer_load_dwordx4 a[76:79], v249, s[8:11], s53 offen offset:1536
    buffer_load_dwordx4 a[80:83], v249, s[8:11], s53 offen offset:2048
    buffer_load_dwordx4 a[84:87], v249, s[8:11], s53 offen offset:2560
    buffer_load_dwordx4 a[88:91], v249, s[8:11], s53 offen offset:3072
    buffer_load_dwordx4 a[92:95], v249, s[8:11], s53 offen offset:3584
    s_add_u32 s53, s52, 12288
    buffer_load_dwordx4 a[96:99], v249, s[8:11], s53 offen offset:0
    buffer_load_dwordx4 a[100:103], v249, s[8:11], s53 offen offset:512
    buffer_load_dwordx4 a[104:107], v249, s[8:11], s53 offen offset:1024
    buffer_load_dwordx4 a[108:111], v249, s[8:11], s53 offen offset:1536
    buffer_load_dwordx4 a[112:115], v249, s[8:11], s53 offen offset:2048
    buffer_load_dwordx4 a[116:119], v249, s[8:11], s53 offen offset:2560
    buffer_load_dwordx4 a[120:123], v249, s[8:11], s53 offen offset:3072
    buffer_load_dwordx4 a[124:127], v249, s[8:11], s53 offen offset:3584
    s_add_u32 s53, s52, 16384
    buffer_load_dwordx4 a[128:131], v249, s[8:11], s53 offen offset:0
    buffer_load_dwordx4 a[132:135], v249, s[8:11], s53 offen offset:512
    buffer_load_dwordx4 a[136:139], v249, s[8:11], s53 offen offset:1024
    buffer_load_dwordx4 a[140:143], v249, s[8:11], s53 offen offset:1536
    buffer_load_dwordx4 a[144:147], v249, s[8:11], s53 offen offset:2048
    buffer_load_dwordx4 a[148:151], v249, s[8:11], s53 offen offset:2560
    buffer_load_dwordx4 a[152:155], v249, s[8:11], s53 offen offset:3072
    buffer_load_dwordx4 a[156:159], v249, s[8:11], s53 offen offset:3584
    s_add_u32 s53, s52, 20480
    buffer_load_dwordx4 a[160:163], v249, s[8:11], s53 offen offset:0
    buffer_load_dwordx4 a[164:167], v249, s[8:11], s53 offen offset:512
    buffer_load_dwordx4 a[168:171], v249, s[8:11], s53 offen offset:1024
    buffer_load_dwordx4 a[172:175], v249, s[8:11], s53 offen offset:1536
    buffer_load_dwordx4 a[176:179], v249, s[8:11], s53 offen offset:2048
    buffer_load_dwordx4 a[180:183], v249, s[8:11], s53 offen offset:2560
    buffer_load_dwordx4 a[184:187], v249, s[8:11], s53 offen offset:3072
    buffer_load_dwordx4 a[188:191], v249, s[8:11], s53 offen offset:3584
rl_out:
    s_barrier
    s_lshr_b32 s36, s34, 1
    s_load_dwordx2 s[24:25], s[0:1], 96
    s_waitcnt lgkmcnt(0)
    s_mov_b32 s56, s24
    s_and_b32 s57, s25, 0xffff
    s_mov_b32 s58, 1835008
    s_mov_b32 s59, 0x20000
    v_bfe_u32 v2, v0, 4, 1
    v_mul_u32_u24 v2, 28672, v2
    v_lshrrev_b32 v250, 5, v0
    v_lshl_add_u32 v2, v250, 8, v2
    v_and_b32 v250, 15, v0
    v_lshl_add_u32 v2, v250, 4, v2
    v_bfe_u32 v4, v0, 4, 1
    v_mul_u32_u24 v4, 14336, v4
    v_lshrrev_b32 v250, 5, v0
    v_lshl_add_u32 v4, v250, 8, v4
    v_and_b32 v250, 15, v0
    v_lshl_add_u32 v4, v250, 4, v4
    s_and_b32 s62, s14, 1
    s_lshr_b32 s63, s14, 1
    s_lshl_b32 s51, s35, 1
    s_add_u32 s51, s51, s63
    s_mul_i32 s52, s51, 57344
    s_add_u32 s52, s52, 109051904
    s_add_u32 s53, s52, 24576
    buffer_load_dwordx4 a[192:195], v2, s[8:11], s53 offen offset:0
    buffer_load_dwordx4 a[196:199], v2, s[8:11], s53 offen offset:512
    buffer_load_dwordx4 a[200:203], v2, s[8:11], s53 offen offset:1024
    buffer_load_dwordx4 a[204:207], v2, s[8:11], s53 offen offset:1536
    buffer_load_dwordx4 a[208:211], v2, s[8:11], s53 offen offset:2048
    buffer_load_dwordx4 a[212:215], v2, s[8:11], s53 offen offset:2560
    buffer_load_dwordx4 a[216:219], v2, s[8:11], s53 offen offset:3072
    buffer_load_dwordx4 a[220:223], v2, s[8:11], s53 offen offset:3584
    s_lshl_b32 s44, s34, 2
    s_lshl_b32 s20, s62, 1
    s_add_u32 s44, s44, s20
    s_mul_i32 s45, s44, 28672
    s_add_u32 s45, s45, 119537664
    s_mul_i32 s50, s44, 14336
    s_lshl_b32 s20, s51, 10
    s_add_u32 s50, s50, s20
    s_add_u32 s50, s50, 102760448
    s_lshl_b32 s27, s36, 7
    s_add_u32 s27, s27, 20477952
    s_waitcnt vmcnt(0)
    s_cmp_lg_u32 s14, 0
    s_cbranch_scc1 rl_wu_ok
rl_wu:
    buffer_load_dword v251, off, s[8:11], s27 sc1
    s_waitcnt vmcnt(0)
    v_readfirstlane_b32 s26, v251
    s_nop 2
    s_cmp_ge_u32 s26, 7
    s_cbranch_scc1 rl_wu_ok
    s_sleep 2
    s_sub_u32 s17, s17, 1
    s_cmp_gt_i32 s17, 0
    s_cbranch_scc1 rl_wu
rl_wu_ok:
    s_barrier
    buffer_load_dwordx4 v[8:11], v4, s[8:11], s50 offen offset:0 sc1
    buffer_load_dwordx4 v[12:15], v4, s[8:11], s50 offen offset:512 sc1
    s_mul_i32 s20, s63, 14336
    s_add_u32 s45, s45, s20
    s_mul_i32 s20, s62, 57344
    s_mul_i32 s21, s63, 28672
    s_add_u32 s21, s21, s20
    s_add_u32 s48, s45, 0
    s_add_u32 m0, s21, 0
    s_add_u32 s49, s45, 0
    buffer_load_dwordx4 v2, s[8:11], s49 offen lds
    s_add_u32 m0, s21, 1024
    s_add_u32 s49, s45, 512
    buffer_load_dwordx4 v2, s[8:11], s49 offen lds
    s_add_u32 m0, s21, 2048
    s_add_u32 s49, s45, 1024
    buffer_load_dwordx4 v2, s[8:11], s49 offen lds
    s_add_u32 m0, s21, 3072
    s_add_u32 s49, s45, 1536
    buffer_load_dwordx4 v2, s[8:11], s49 offen lds
    s_add_u32 m0, s21, 4096
    s_add_u32 s49, s45, 2048
    buffer_load_dwordx4 v2, s[8:11], s49 offen lds
    s_add_u32 m0, s21, 5120
    s_add_u32 s49, s45, 2560
    buffer_load_dwordx4 v2, s[8:11], s49 offen lds
    s_add_u32 m0, s21, 6144
    s_add_u32 s49, s45, 3072
    buffer_load_dwordx4 v2, s[8:11], s49 offen lds
    s_add_u32 m0, s21, 7168
    s_add_u32 s49, s45, 3584
    buffer_load_dwordx4 v2, s[8:11], s49 offen lds
    s_add_u32 s48, s45, 4096
    s_add_u32 m0, s21, 8192
    s_add_u32 s49, s45, 4096
    buffer_load_dwordx4 v2, s[8:11], s49 offen lds
    s_add_u32 m0, s21, 9216
    s_add_u32 s49, s45, 4608
    buffer_load_dwordx4 v2, s[8:11], s49 offen lds
    s_add_u32 m0, s21, 10240
    s_add_u32 s49, s45, 5120
    buffer_load_dwordx4 v2, s[8:11], s49 offen lds
    s_add_u32 m0, s21, 11264
    s_add_u32 s49, s45, 5632
    buffer_load_dwordx4 v2, s[8:11], s49 offen lds
    s_add_u32 m0, s21, 12288
    s_add_u32 s49, s45, 6144
    buffer_load_dwordx4 v2, s[8:11], s49 offen lds
    s_add_u32 m0, s21, 13312
    s_add_u32 s49, s45, 6656
    buffer_load_dwordx4 v2, s[8:11], s49 offen lds
    s_add_u32 m0, s21, 14336
    s_add_u32 s49, s45, 7168
    buffer_load_dwordx4 v2, s[8:11], s49 offen lds
    s_add_u32 m0, s21, 15360
    s_add_u32 s49, s45, 7680
    buffer_load_dwordx4 v2, s[8:11], s49 offen lds
    s_add_u32 s48, s45, 8192
    s_add_u32 m0, s21, 16384
    s_add_u32 s49, s45, 8192
    buffer_load_dwordx4 v2, s[8:11], s49 offen lds
    s_add_u32 m0, s21, 17408
    s_add_u32 s49, s45, 8704
    buffer_load_dwordx4 v2, s[8:11], s49 offen lds
    s_add_u32 m0, s21, 18432
    s_add_u32 s49, s45, 9216
    buffer_load_dwordx4 v2, s[8:11], s49 offen lds
    s_add_u32 m0, s21, 19456
    s_add_u32 s49, s45, 9728
    buffer_load_dwordx4 v2, s[8:11], s49 offen lds
    s_add_u32 m0, s21, 20480
    s_add_u32 s49, s45, 10240
    buffer_load_dwordx4 v2, s[8:11], s49 offen lds
    s_add_u32 m0, s21, 21504
    s_add_u32 s49, s45, 10752
    buffer_load_dwordx4 v2, s[8:11], s49 offen lds
    s_add_u32 m0, s21, 22528
    s_add_u32 s49, s45, 11264
    buffer_load_dwordx4 v2, s[8:11], s49 offen lds
    s_add_u32 m0, s21, 23552
    s_add_u32 s49, s45, 11776
    buffer_load_dwordx4 v2, s[8:11], s49 offen lds
    s_add_u32 s48, s45, 12288
    s_add_u32 m0, s21, 24576
    s_add_u32 s49, s45, 12288
    buffer_load_dwordx4 v2, s[8:11], s49 offen lds
    s_add_u32 m0, s21, 25600
    s_add_u32 s49, s45, 12800
    buffer_load_dwordx4 v2, s[8:11], s49 offen lds
    s_add_u32 m0, s21, 26624
    s_add_u32 s49, s45, 13312
    buffer_load_dwordx4 v2, s[8:11], s49 offen lds
    s_add_u32 m0, s21, 27648
    s_add_u32 s49, s45, 13824
    buffer_load_dwordx4 v2, s[8:11], s49 offen lds
    v_lshlrev_b32 v5, 4, v0
    v_add_u32 v6, s20, v5
    s_waitcnt vmcnt(0)
    s_barrier
    ds_read_b128 v[16:19], v6 offset:0
    ds_read_b128 v[20:23], v6 offset:1024
    ds_read_b128 v[24:27], v6 offset:2048
    ds_read_b128 v[28:31], v6 offset:3072
    ds_read_b128 v[32:35], v6 offset:4096
    ds_read_b128 v[36:39], v6 offset:5120
    ds_read_b128 v[40:43], v6 offset:6144
    s_waitcnt lgkmcnt(6)
    v_mfma_f32_32x32x16_bf16 v[240:255], a[0:3], v[16:19], 0
    ds_read_b128 v[44:47], v6 offset:7168
    s_waitcnt lgkmcnt(6)
    v_mfma_f32_32x32x16_bf16 v[240:255], a[4:7], v[20:23], v[240:255]
    ds_read_b128 v[16:19], v6 offset:8192
    s_waitcnt lgkmcnt(6)
    v_mfma_f32_32x32x16_bf16 v[240:255], a[8:11], v[24:27], v[240:255]
    ds_read_b128 v[20:23], v6 offset:9216
    s_waitcnt lgkmcnt(6)
    v_mfma_f32_32x32x16_bf16 v[240:255], a[12:15], v[28:31], v[240:255]
    ds_read_b128 v[24:27], v6 offset:10240
    s_waitcnt lgkmcnt(6)
    v_mfma_f32_32x32x16_bf16 v[240:255], a[16:19], v[32:35], v[240:255]
    ds_read_b128 v[28:31], v6 offset:11264
    s_waitcnt lgkmcnt(6)
    v_mfma_f32_32x32x16_bf16 v[240:255], a[20:23], v[36:39], v[240:255]
    ds_read_b128 v[32:35], v6 offset:12288
    s_waitcnt lgkmcnt(6)
    v_mfma_f32_32x32x16_bf16 v[240:255], a[24:27], v[40:43], v[240:255]
    ds_read_b128 v[36:39], v6 offset:13312
    s_waitcnt lgkmcnt(6)
    v_mfma_f32_32x32x16_bf16 v[240:255], a[28:31], v[44:47], v[240:255]
    ds_read_b128 v[40:43], v6 offset:14336
    s_waitcnt lgkmcnt(6)
    v_mfma_f32_32x32x16_bf16 v[240:255], a[32:35], v[16:19], v[240:255]
    ds_read_b128 v[44:47], v6 offset:15360
    s_waitcnt lgkmcnt(6)
    v_mfma_f32_32x32x16_bf16 v[240:255], a[36:39], v[20:23], v[240:255]
    ds_read_b128 v[16:19], v6 offset:16384
    s_waitcnt lgkmcnt(6)
    v_mfma_f32_32x32x16_bf16 v[240:255], a[40:43], v[24:27], v[240:255]
    ds_read_b128 v[20:23], v6 offset:17408
    s_waitcnt lgkmcnt(6)
    v_mfma_f32_32x32x16_bf16 v[240:255], a[44:47], v[28:31], v[240:255]
    ds_read_b128 v[24:27], v6 offset:18432
    s_waitcnt lgkmcnt(6)
    v_mfma_f32_32x32x16_bf16 v[240:255], a[48:51], v[32:35], v[240:255]
    ds_read_b128 v[28:31], v6 offset:19456
    s_waitcnt lgkmcnt(6)
    v_mfma_f32_32x32x16_bf16 v[240:255], a[52:55], v[36:39], v[240:255]
    ds_read_b128 v[32:35], v6 offset:20480
    s_waitcnt lgkmcnt(6)
    v_mfma_f32_32x32x16_bf16 v[240:255], a[56:59], v[40:43], v[240:255]
    ds_read_b128 v[36:39], v6 offset:21504
    s_waitcnt lgkmcnt(6)
    v_mfma_f32_32x32x16_bf16 v[240:255], a[60:63], v[44:47], v[240:255]
    ds_read_b128 v[40:43], v6 offset:22528
    s_waitcnt lgkmcnt(6)
    v_mfma_f32_32x32x16_bf16 v[240:255], a[64:67], v[16:19], v[240:255]
    ds_read_b128 v[44:47], v6 offset:23552
    s_waitcnt lgkmcnt(6)
    v_mfma_f32_32x32x16_bf16 v[240:255], a[68:71], v[20:23], v[240:255]
    ds_read_b128 v[16:19], v6 offset:24576
    s_waitcnt lgkmcnt(6)
    v_mfma_f32_32x32x16_bf16 v[240:255], a[72:75], v[24:27], v[240:255]
    ds_read_b128 v[20:23], v6 offset:25600
    s_waitcnt lgkmcnt(6)
    v_mfma_f32_32x32x16_bf16 v[240:255], a[76:79], v[28:31], v[240:255]
    ds_read_b128 v[24:27], v6 offset:26624
    s_waitcnt lgkmcnt(6)
    v_mfma_f32_32x32x16_bf16 v[240:255], a[80:83], v[32:35], v[240:255]
    ds_read_b128 v[28:31], v6 offset:27648
    s_waitcnt lgkmcnt(6)
    v_mfma_f32_32x32x16_bf16 v[240:255], a[84:87], v[36:39], v[240:255]
    ds_read_b128 v[32:35], v6 offset:28672
    s_waitcnt lgkmcnt(6)
    v_mfma_f32_32x32x16_bf16 v[240:255], a[88:91], v[40:43], v[240:255]
    ds_read_b128 v[36:39], v6 offset:29696
    s_waitcnt lgkmcnt(6)
    v_mfma_f32_32x32x16_bf16 v[240:255], a[92:95], v[44:47], v[240:255]
    ds_read_b128 v[40:43], v6 offset:30720
    s_waitcnt lgkmcnt(6)
    v_mfma_f32_32x32x16_bf16 v[240:255], a[96:99], v[16:19], v[240:255]
    ds_read_b128 v[44:47], v6 offset:31744
    s_waitcnt lgkmcnt(6)
    v_mfma_f32_32x32x16_bf16 v[240:255], a[100:103], v[20:23], v[240:255]
    ds_read_b128 v[16:19], v6 offset:32768
    s_waitcnt lgkmcnt(6)
    v_mfma_f32_32x32x16_bf16 v[240:255], a[104:107], v[24:27], v[240:255]
    ds_read_b128 v[20:23], v6 offset:33792
    s_waitcnt lgkmcnt(6)
    v_mfma_f32_32x32x16_bf16 v[240:255], a[108:111], v[28:31], v[240:255]
    ds_read_b128 v[24:27], v6 offset:34816
    s_waitcnt lgkmcnt(6)
    v_mfma_f32_32x32x16_bf16 v[240:255], a[112:115], v[32:35], v[240:255]
    ds_read_b128 v[28:31], v6 offset:35840
    s_waitcnt lgkmcnt(6)
    v_mfma_f32_32x32x16_bf16 v[240:255], a[116:119], v[36:39], v[240:255]
    ds_read_b128 v[32:35], v6 offset:36864
    s_waitcnt lgkmcnt(6)
    v_mfma_f32_32x32x16_bf16 v[240:255], a[120:123], v[40:43], v[240:255]
    ds_read_b128 v[36:39], v6 offset:37888
    s_waitcnt lgkmcnt(6)
    v_mfma_f32_32x32x16_bf16 v[240:255], a[124:127], v[44:47], v[240:255]
    ds_read_b128 v[40:43], v6 offset:38912
    s_waitcnt lgkmcnt(6)
    v_mfma_f32_32x32x16_bf16 v[240:255], a[128:131], v[16:19], v[240:255]
    ds_read_b128 v[44:47], v6 offset:39936
    s_waitcnt lgkmcnt(6)
    v_mfma_f32_32x32x16_bf16 v[240:255], a[132:135], v[20:23], v[240:255]
    ds_read_b128 v[16:19], v6 offset:40960
    s_waitcnt lgkmcnt(6)
    v_mfma_f32_32x32x16_bf16 v[240:255], a[136:139], v[24:27], v[240:255]
    ds_read_b128 v[20:23], v6 offset:41984
    s_waitcnt lgkmcnt(6)
    v_mfma_f32_32x32x16_bf16 v[240:255], a[140:143], v[28:31], v[240:255]
    ds_read_b128 v[24:27], v6 offset:43008
    s_waitcnt lgkmcnt(6)
    v_mfma_f32_32x32x16_bf16 v[240:255], a[144:147], v[32:35], v[240:255]
    ds_read_b128 v[28:31], v6 offset:44032
    s_waitcnt lgkmcnt(6)
    v_mfma_f32_32x32x16_bf16 v[240:255], a[148:151], v[36:39], v[240:255]
    ds_read_b128 v[32:35], v6 offset:45056
    s_waitcnt lgkmcnt(6)
    v_mfma_f32_32x32x16_bf16 v[240:255], a[152:155], v[40:43], v[240:255]
    ds_read_b128 v[36:39], v6 offset:46080
    s_waitcnt lgkmcnt(6)
    v_mfma_f32_32x32x16_bf16 v[240:255], a[156:159], v[44:47], v[240:255]
    ds_read_b128 v[40:43], v6 offset:47104
    s_waitcnt lgkmcnt(6)
    v_mfma_f32_32x32x16_bf16 v[240:255], a[160:163], v[16:19], v[240:255]
    ds_read_b128 v[44:47], v6 offset:48128
    s_waitcnt lgkmcnt(6)
    v_mfma_f32_32x32x16_bf16 v[240:255], a[164:167], v[20:23], v[240:255]
    ds_read_b128 v[16:19], v6 offset:49152
    s_waitcnt lgkmcnt(6)
    v_mfma_f32_32x32x16_bf16 v[240:255], a[168:171], v[24:27], v[240:255]
    ds_read_b128 v[20:23], v6 offset:50176
    s_waitcnt lgkmcnt(6)
    v_mfma_f32_32x32x16_bf16 v[240:255], a[172:175], v[28:31], v[240:255]
    ds_read_b128 v[24:27], v6 offset:51200
    s_waitcnt lgkmcnt(6)
    v_mfma_f32_32x32x16_bf16 v[240:255], a[176:179], v[32:35], v[240:255]
    ds_read_b128 v[28:31], v6 offset:52224
    s_waitcnt lgkmcnt(6)
    v_mfma_f32_32x32x16_bf16 v[240:255], a[180:183], v[36:39], v[240:255]
    ds_read_b128 v[32:35], v6 offset:53248
    s_waitcnt lgkmcnt(6)
    v_mfma_f32_32x32x16_bf16 v[240:255], a[184:187], v[40:43], v[240:255]
    ds_read_b128 v[36:39], v6 offset:54272
    s_waitcnt lgkmcnt(6)
    v_mfma_f32_32x32x16_bf16 v[240:255], a[188:191], v[44:47], v[240:255]
    ds_read_b128 v[40:43], v6 offset:55296
    s_waitcnt lgkmcnt(6)
    v_mfma_f32_32x32x16_bf16 v[240:255], a[192:195], v[16:19], v[240:255]
    ds_read_b128 v[44:47], v6 offset:56320
    s_waitcnt lgkmcnt(6)
    v_mfma_f32_32x32x16_bf16 v[240:255], a[196:199], v[20:23], v[240:255]
    s_waitcnt lgkmcnt(5)
    v_mfma_f32_32x32x16_bf16 v[240:255], a[200:203], v[24:27], v[240:255]
    s_waitcnt lgkmcnt(4)
    v_mfma_f32_32x32x16_bf16 v[240:255], a[204:207], v[28:31], v[240:255]
    s_waitcnt lgkmcnt(3)
    v_mfma_f32_32x32x16_bf16 v[240:255], a[208:211], v[32:35], v[240:255]
    s_waitcnt lgkmcnt(2)
    v_mfma_f32_32x32x16_bf16 v[240:255], a[212:215], v[36:39], v[240:255]
    s_waitcnt lgkmcnt(1)
    v_mfma_f32_32x32x16_bf16 v[240:255], a[216:219], v[40:43], v[240:255]
    s_waitcnt lgkmcnt(0)
    v_mfma_f32_32x32x16_bf16 v[240:255], a[220:223], v[44:47], v[240:255]
    v_and_b32 v5, 31, v0
    v_mul_u32_u24 v5, 896, v5
    v_lshrrev_b32 v6, 5, v0
    v_lshl_add_u32 v5, v6, 3, v5
    s_mul_i32 s53, s44, 14336
    s_lshl_b32 s20, s51, 6
    s_add_u32 s53, s53, s20
    v_lshlrev_b32 v20, 16, v8
    v_and_b32 v21, 0xffff0000, v8
    v_lshlrev_b32 v22, 16, v10
    v_and_b32 v23, 0xffff0000, v10
    s_nop 0
    v_add_f32 v20, v20, v240
    v_add_f32 v21, v21, v241
    v_add_f32 v22, v22, v242
    v_add_f32 v23, v23, v243
    v_cvt_pk_bf16_f32 v24, v20, v21
    v_cvt_pk_bf16_f32 v25, v22, v23
    buffer_store_dwordx2 v[24:25], v5, s[56:59], s53 offen offset:0
    v_lshlrev_b32 v20, 16, v9
    v_and_b32 v21, 0xffff0000, v9
    v_lshlrev_b32 v22, 16, v11
    v_and_b32 v23, 0xffff0000, v11
    v_add_f32 v20, v20, v244
    v_add_f32 v21, v21, v245
    v_add_f32 v22, v22, v246
    v_add_f32 v23, v23, v247
    v_cvt_pk_bf16_f32 v26, v20, v21
    v_cvt_pk_bf16_f32 v27, v22, v23
    buffer_store_dwordx2 v[26:27], v5, s[56:59], s53 offen offset:16
    v_lshlrev_b32 v20, 16, v12
    v_and_b32 v21, 0xffff0000, v12
    v_lshlrev_b32 v22, 16, v14
    v_and_b32 v23, 0xffff0000, v14
    v_add_f32 v20, v20, v248
    v_add_f32 v21, v21, v249
    v_add_f32 v22, v22, v250
    v_add_f32 v23, v23, v251
    v_cvt_pk_bf16_f32 v28, v20, v21
    v_cvt_pk_bf16_f32 v29, v22, v23
    buffer_store_dwordx2 v[28:29], v5, s[56:59], s53 offen offset:32
    v_lshlrev_b32 v20, 16, v13
    v_and_b32 v21, 0xffff0000, v13
    v_lshlrev_b32 v22, 16, v15
    v_and_b32 v23, 0xffff0000, v15
    v_add_f32 v20, v20, v252
    v_add_f32 v21, v21, v253
    v_add_f32 v22, v22, v254
    v_add_f32 v23, v23, v255
    v_cvt_pk_bf16_f32 v30, v20, v21
    v_cvt_pk_bf16_f32 v31, v22, v23
    buffer_store_dwordx2 v[30:31], v5, s[56:59], s53 offen offset:48
    s_waitcnt vmcnt(0)
ch_exit:
    s_endpgm
main_code_end:
.section .rodata,"a"
.p2align 6
.amdhsa_kernel main_kernel
  .amdhsa_next_free_vgpr 512
  .amdhsa_next_free_sgpr 102
  .amdhsa_accum_offset 256
  .amdhsa_group_segment_fixed_size 0
  .amdhsa_kernarg_size 120
  .amdhsa_user_sgpr_count 2
  .amdhsa_user_sgpr_kernarg_segment_ptr 1
  .amdhsa_system_sgpr_workgroup_id_x 1
  .amdhsa_float_denorm_mode_32 3
.end_amdhsa_kernel
```
